```python
import torch

def _softmax(x, axis=-1):
    return torch.softmax(x, dim=axis)
def _gelu(x):
    return torch.nn.functional.gelu(x, approximate="tanh")
def _silu(x):
    return torch.nn.functional.silu(x)
def _sigmoid(x):
    return torch.sigmoid(x)
def _layernorm(x, axis=-1, eps=1e-5):
    m = x.mean(dim=axis, keepdim=True)
    v = x.var(dim=axis, keepdim=True, unbiased=False)
    return (x - m) / torch.sqrt(v + eps)
def _scatter_add(tgt, idx, src, axis=0):
    return tgt.clone().index_add_(axis, idx, src)
def _segment_sum(src, seg, n):
    out = torch.zeros((n,) + src.shape[1:], dtype=src.dtype)
    return out.index_add_(0, seg, src)
def _pad(x, pw):
    flat = tuple(v for pair in reversed(pw) for v in pair)
    return torch.nn.functional.pad(x, flat)

kernel_name = 'parallel_sum__mha_block__glu_gated_geglu__prompt'

def setup_inputs():

    _w = (lambda a: (lambda t: t.to(torch.bfloat16) if t.is_floating_point() else t)(torch.as_tensor(a)))
    def _A_setup():
        B, S, D, H = 1, 2048, 576, 32
        return {
            "x": _w((lambda *s: torch.randn(*s, dtype=torch.bfloat16) * 0.05)(B, S, D)),
            "wqkv": _w((lambda *s: torch.randn(*s, dtype=torch.bfloat16) * 0.05)(D, 3 * D)),
            "wo": _w((lambda *s: torch.randn(*s, dtype=torch.bfloat16) * 0.05)(D, D)),
        }
    _A_in = _A_setup()

    def _B_setup():
        B, S, Dm, Df = 1, 2048, 576, 4608
        return {
            "x": _w((lambda *s: torch.randn(*s, dtype=torch.bfloat16) * 0.05)(B, S, Dm)),
            "w_gate": _w((lambda *s: torch.randn(*s, dtype=torch.bfloat16) * 0.8)(Dm, Df) * (Dm ** -0.5)),
            "w_up": _w((lambda *s: torch.randn(*s, dtype=torch.bfloat16) * 0.8)(Dm, Df) * (Dm ** -0.5)),
            "w_down": _w((lambda *s: torch.randn(*s, dtype=torch.bfloat16) * 0.8)(Df, Dm) * (Df ** -0.5)),
        }
    _B_in = _B_setup()

    return {
        "A_x": _A_in["x"],
        "A_wqkv": _A_in["wqkv"],
        "A_wo": _A_in["wo"],
        "B_x": _B_in["x"],
        "B_w_gate": _B_in["w_gate"],
        "B_w_up": _B_in["w_up"],
        "B_w_down": _B_in["w_down"],
    }

def reference(A_x, A_wqkv, A_wo, B_x, B_w_gate, B_w_up, B_w_down):
    def _A_ref(x, wqkv, wo):
        B, S, D = x.shape
        H = 32
        Dh = D // H
        qkv = (lambda x, *d: x.permute(*d))((x @ wqkv).reshape(B, S, 3, H, Dh), 2, 0, 3, 1, 4)
        q, k, v = qkv[0], qkv[1], qkv[2]
        scores = torch.einsum("bhqd,bhkd->bhqk", q, k) * (Dh ** -0.5)
        p = _softmax(scores, axis=-1)
        o = torch.einsum("bhqk,bhkd->bhqd", p, v)
        return (lambda x, *d: x.permute(*d))(o, 0, 2, 1, 3).reshape(B, S, D) @ wo

    def _B_ref(x, w_gate, w_up, w_down):
        g = torch.einsum("bsd,df->bsf", x, w_gate)
        u = torch.einsum("bsd,df->bsf", x, w_up)
        h = _gelu(g) * u
        return torch.einsum("bsf,fd->bsd", h, w_down)

    x = A_x
    xn = _layernorm(x, axis=-1)
    return x + _A_ref(xn, A_wqkv, A_wo) + _B_ref(xn, B_w_gate, B_w_up, B_w_down)
```

```asm
; @launch grid=(256,1,1) block=(256,1,1) lds=163840
.amdgcn_target "amdgcn-amd-amdhsa--gfx950"
.text
.p2align 12
.globl parallel_sum__mha_block__glu_gated_geglu__prompt_kernel
.p2align 8
.type parallel_sum__mha_block__glu_gated_geglu__prompt_kernel,@function
parallel_sum__mha_block__glu_gated_geglu__prompt_kernel:
    s_cmp_ge_u32 s2, 256
    s_cbranch_scc1 L_end
    s_load_dwordx2 s[4:5], s[0:1], 0
    s_load_dwordx2 s[12:13], s[0:1], 32
    s_load_dwordx2 s[16:17], s[0:1], 40
    s_load_dwordx2 s[8:9], s[0:1], 8
    s_load_dwordx2 s[24:25], s[0:1], 72
    s_load_dwordx2 s[20:21], s[0:1], 48
    s_lshr_b32 s57, s2, 3
    s_getpc_b64 s[88:89]
L_pc:
    s_lshl_b32 s56, s57, 7
    v_lshl_add_u32 v2, v0, 12, s56
    v_min_u32 v2, L_last-L_pc-4, v2
    v_mov_b32 v3, s89
    v_add_co_u32 v2, vcc, s88, v2
    s_nop 1
    v_addc_co_u32 v3, vcc, 0, v3, vcc
    global_load_dword v254, v[2:3], off
    v_lshrrev_b32 v1, 6, v0
    v_and_b32 v0, 63, v0
    s_and_b32 s56, s2, 7
    v_readfirstlane_b32 s54, v1
    s_and_b32 s53, s56, 1
    s_lshl_b32 s53, s53, 3
    s_and_b32 s58, s57, 7
    s_add_u32 s53, s53, s58
    s_lshr_b32 s52, s56, 1
    s_lshl_b32 s52, s52, 2
    s_lshr_b32 s57, s57, 3
    s_add_u32 s52, s52, s57
    s_lshl_b32 s55, s54, 10
    s_mov_b32 s6, 2359296
    s_mov_b32 s7, 0x20000
    v_lshrrev_b32 v16, 3, v0
    v_and_b32 v17, 7, v0
    v_mul_u32_u24 v18, 1152, v16
    v_lshl_add_u32 v18, v17, 4, v18
    s_lshl_b32 s56, s52, 3
    s_and_b32 s57, s54, 2
    s_add_u32 s56, s56, s57
    s_add_u32 s56, s56, s54
    s_and_b32 s57, s53, 2
    s_add_u32 s56, s56, s57
    s_lshl_b32 s56, s56, 1
    s_and_b32 s57, s53, 1
    s_add_u32 s56, s56, s57
    s_mul_i32 s84, s56, 9216
    s_xor_b32 s57, s56, 1
    s_mul_i32 s85, s57, 9216
    s_xor_b32 s57, s56, 4
    s_mul_i32 s86, s57, 9216
    s_xor_b32 s57, s56, 5
    s_mul_i32 s87, s57, 9216
    s_lshl_b32 s61, s53, 7
    s_and_b32 s80, s53, 7
    s_lshl_b32 s80, s80, 1
    s_lshr_b32 s56, s53, 3
    s_add_u32 s80, s80, s56
    s_cmp_lt_u32 s80, 9
    s_cselect_b32 s56, 18, 7
    s_add_u32 s56, s56, s80
    s_lshl_b32 s62, s56, 7
    s_mov_b32 s30, 5308416
    s_waitcnt lgkmcnt(0)
    buffer_load_dwordx4 v[36:39], v18, s[4:7], s84 offen offset:0
    buffer_load_dwordx4 v[40:43], v18, s[4:7], s84 offen offset:128
    buffer_load_dwordx4 v[44:47], v18, s[4:7], s84 offen offset:256
    s_mov_b32 s31, 0x20000
    s_mul_i32 s56, s53, 288
    s_and_b32 s57, s53, 1
    s_lshl_b32 s59, s57, 5
    s_add_u32 s63, s56, s59
    s_xor_b32 s57, s57, 1
    s_lshl_b32 s57, s57, 8
    s_add_u32 s64, s56, s57
    s_mul_i32 s65, s63, 1152
    s_mul_i32 s66, s64, 1152
    s_lshl_b32 s63, s63, 1
    s_lshl_b32 s64, s64, 1
    s_lshl_b32 s56, s52, 2
    s_add_u32 s56, s56, s54
    s_mul_i32 s56, s56, 9
    v_min_u32 v15, 8, v0
    v_add_u32 v15, s56, v15
    v_mul_u32_u24 v253, 9216, v15
    v_mul_u32_u24 v15, 3456, v15
    s_and_b32 s58, s54, 1
    s_lshl_b32 s58, s58, 2
    v_and_b32 v19, 2, v16
    v_or_b32 v19, s58, v19
    v_xor_b32 v19, v19, v17
    buffer_load_dwordx4 v[48:51], v18, s[4:7], s84 offen offset:384
    buffer_load_dwordx4 v[52:55], v18, s[4:7], s84 offen offset:512
    buffer_load_dwordx4 v[56:59], v18, s[4:7], s84 offen offset:640
    v_lshlrev_b32 v19, 4, v19
    s_lshl_b32 s59, s54, 3
    v_add_u32 v20, s59, v16
    v_mul_u32_u24 v21, 3456, v20
    v_add_u32 v5, v21, v19
    s_mov_b32 s14, 5308416
    s_mov_b32 s15, 0x20000
    s_mov_b32 s10, 1990656
    s_mov_b32 s11, 0x20000
    s_mov_b32 s38, 663552
    s_mov_b32 s39, 0x20000
    s_mov_b32 s18, 5308416
    s_mov_b32 s19, 0x20000
    s_mov_b32 s22, 5308416
    s_mov_b32 s23, 0x20000
    s_mov_b32 s34, 2359296
    s_mov_b32 s35, 0x20000
    s_mov_b32 s42, 256
    s_mov_b32 s43, 0x20000
    s_mov_b32 s26, 268435456
    s_mov_b32 s27, 0x20000
    v_mul_u32_u24 v21, 9216, v20
    v_add_u32 v4, v21, v19
    s_and_b32 s58, s54, 1
    buffer_load_dwordx4 v[60:63], v18, s[4:7], s84 offen offset:768
    buffer_load_dwordx4 v[64:67], v18, s[4:7], s84 offen offset:896
    buffer_load_dwordx4 v[68:71], v18, s[4:7], s84 offen offset:1024
    buffer_load_dword v254, v253, s[12:15], s63 offen offset:0
    s_cmp_lt_u32 s80, 11
    s_cselect_b32 s46, 1990656, 0
    s_mov_b32 s47, 0x20000
    s_cselect_b32 s50, 268435456, 0
    s_mov_b32 s51, 0x20000
    v_lshrrev_b32 v22, 4, v0
    v_bfe_u32 v23, v0, 2, 2
    v_and_b32 v24, 3, v0
    v_lshl_add_u32 v25, v22, 3, v23
    v_lshrrev_b32 v26, 1, v23
    v_and_b32 v27, 1, v22
    v_lshl_or_b32 v26, v27, 1, v26
    s_lshl_b32 s59, s58, 1
    v_xor_b32 v26, s59, v26
    v_lshlrev_b32 v28, 7, v25
    v_lshl_add_u32 v28, v24, 3, v28
    v_lshl_add_u32 v1, v26, 5, v28
    v_xor_b32 v2, 32, v1
    s_lshr_b32 s56, s54, 1
    s_mul_i32 s56, s56, 36864
    s_add_u32 s56, s56, 73728
    v_xor_b32 v26, v0, v22
    v_lshl_add_u32 v10, v26, 4, s56
    v_xor_b32 v11, 64, v10
    s_mul_i32 s56, s54, 18432
    s_add_u32 s56, s56, 73728
    v_xor_b32 v26, v16, v17
    v_lshlrev_b32 v26, 4, v26
    v_lshl_add_u32 v26, v17, 8, v26
    s_and_b32 s57, s53, 1
    s_lshl_b32 s57, s57, 7
    s_add_u32 s56, s56, s57
    v_add_u32 v16, s56, v26
    v_xor_b32 v17, 128, v16
    s_mov_b32 s67, 0x3f803f80
    s_mov_b32 s3, 0xffff0000
    v_cmp_eq_u32 vcc, v22, v23
    v_lshlrev_b32 v26, 4, v24
    v_mov_b32 v12, 0x3f80
    v_mov_b32 v13, 0
    v_cndmask_b32 v12, 0, v12, vcc
    v_lshlrev_b64 v[12:13], v26, v[12:13]
    s_load_dwordx2 s[36:37], s[0:1], 16
    s_load_dwordx2 s[32:33], s[0:1], 56
    s_load_dwordx2 s[40:41], s[0:1], 64
    s_cmp_lt_u32 s54, 2
    s_cselect_b64 s[28:29], s[12:13], s[16:17]
    s_mov_b64 s[44:45], s[8:9]
    s_mov_b64 s[48:49], s[24:25]
    s_cmp_lt_u32 s53, 9
    s_cselect_b32 s0, 0, 9
    s_cselect_b32 s1, 0, 2359296
    s_cselect_b32 s76, 1051597459, 1.0
    s_cmp_lt_u32 s80, 9
    s_cselect_b32 s78, 0, 2
    s_cselect_b32 s71, 5, 18
    s_mov_b32 s79, 3184710632
    s_mul_i32 s56, s54, 589824
    v_add_u32 v26, s56, v4
    v_xor_b32 v35, 64, v26
    s_mul_i32 s56, s54, 9216
    v_add_u32 v27, 72704, v35
    v_add_u32 v28, 145408, v26
    v_add_u32 v29, 221184, v35
    v_add_u32 v30, 293888, v26
    v_add_u32 v31, 366592, v35
    v_add_u32 v32, 442368, v26
    v_add_u32 v33, 515072, v35
    v_add_u32 v34, 587776, v26
    s_waitcnt lgkmcnt(0)
    s_mov_b64 exec, 0
    s_cmp_eq_u32 s54, 0
    s_cbranch_scc1 L_pg1
    s_cmp_eq_u32 s54, 1
    s_cbranch_scc1 L_pg2
    s_cmp_eq_u32 s54, 2
    s_cbranch_scc1 L_pg3
    s_branch L_pg4
L_tour_ret:
    s_mov_b64 exec, -1
    s_waitcnt vmcnt(7)
    v_dot2_f32_bf16 v20, v36, s67, 0
    v_dot2_f32_bf16 v22, v36, v36, 0
    v_mov_b32 v21, 0
    v_mov_b32 v23, 0
    v_dot2c_f32_bf16 v21, s67, v37
    v_dot2c_f32_bf16 v23, v37, v37
    v_dot2c_f32_bf16 v21, s67, v38
    v_dot2c_f32_bf16 v23, v38, v38
    v_dot2c_f32_bf16 v21, s67, v39
    v_dot2c_f32_bf16 v23, v39, v39
    v_dot2c_f32_bf16 v21, s67, v40
    v_dot2c_f32_bf16 v23, v40, v40
    v_dot2c_f32_bf16 v21, s67, v41
    v_dot2c_f32_bf16 v23, v41, v41
    v_dot2c_f32_bf16 v21, s67, v42
    v_dot2c_f32_bf16 v23, v42, v42
    v_dot2c_f32_bf16 v21, s67, v43
    v_dot2c_f32_bf16 v23, v43, v43
    v_dot2c_f32_bf16 v21, s67, v44
    v_dot2c_f32_bf16 v23, v44, v44
    v_dot2c_f32_bf16 v21, s67, v45
    v_dot2c_f32_bf16 v23, v45, v45
    v_dot2c_f32_bf16 v21, s67, v46
    v_dot2c_f32_bf16 v23, v46, v46
    v_dot2c_f32_bf16 v21, s67, v47
    v_dot2c_f32_bf16 v23, v47, v47
    buffer_load_dwordx4 v[72:75], v18, s[4:7], s85 offen offset:0
    buffer_load_dwordx4 v[76:79], v18, s[4:7], s85 offen offset:128
    buffer_load_dwordx4 v[80:83], v18, s[4:7], s85 offen offset:256
    buffer_load_dwordx4 v[84:87], v18, s[4:7], s85 offen offset:384
    buffer_load_dwordx4 v[88:91], v18, s[4:7], s85 offen offset:512
    buffer_load_dwordx4 v[92:95], v18, s[4:7], s85 offen offset:640
    buffer_load_dwordx4 v[96:99], v18, s[4:7], s85 offen offset:768
    buffer_load_dwordx4 v[100:103], v18, s[4:7], s85 offen offset:896
    buffer_load_dwordx4 v[104:107], v18, s[4:7], s85 offen offset:1024
    s_waitcnt vmcnt(13)
    v_dot2c_f32_bf16 v21, s67, v48
    v_dot2c_f32_bf16 v23, v48, v48
    v_dot2c_f32_bf16 v21, s67, v49
    v_dot2c_f32_bf16 v23, v49, v49
    v_dot2c_f32_bf16 v21, s67, v50
    v_dot2c_f32_bf16 v23, v50, v50
    v_dot2c_f32_bf16 v21, s67, v51
    v_dot2c_f32_bf16 v23, v51, v51
    v_dot2c_f32_bf16 v21, s67, v52
    v_dot2c_f32_bf16 v23, v52, v52
    v_dot2c_f32_bf16 v21, s67, v53
    v_dot2c_f32_bf16 v23, v53, v53
    v_dot2c_f32_bf16 v21, s67, v54
    v_dot2c_f32_bf16 v23, v54, v54
    v_dot2c_f32_bf16 v21, s67, v55
    v_dot2c_f32_bf16 v23, v55, v55
    v_dot2c_f32_bf16 v21, s67, v56
    v_dot2c_f32_bf16 v23, v56, v56
    v_dot2c_f32_bf16 v21, s67, v57
    v_dot2c_f32_bf16 v23, v57, v57
    v_dot2c_f32_bf16 v21, s67, v58
    v_dot2c_f32_bf16 v23, v58, v58
    v_dot2c_f32_bf16 v21, s67, v59
    v_dot2c_f32_bf16 v23, v59, v59
    s_waitcnt vmcnt(10)
    v_dot2c_f32_bf16 v21, s67, v60
    v_dot2c_f32_bf16 v23, v60, v60
    v_dot2c_f32_bf16 v21, s67, v61
    v_dot2c_f32_bf16 v23, v61, v61
    v_dot2c_f32_bf16 v21, s67, v62
    v_dot2c_f32_bf16 v23, v62, v62
    v_dot2c_f32_bf16 v21, s67, v63
    v_dot2c_f32_bf16 v23, v63, v63
    v_dot2c_f32_bf16 v21, s67, v64
    v_dot2c_f32_bf16 v23, v64, v64
    v_dot2c_f32_bf16 v21, s67, v65
    v_dot2c_f32_bf16 v23, v65, v65
    v_dot2c_f32_bf16 v21, s67, v66
    v_dot2c_f32_bf16 v23, v66, v66
    v_dot2c_f32_bf16 v21, s67, v67
    v_dot2c_f32_bf16 v23, v67, v67
    v_dot2c_f32_bf16 v21, s67, v68
    v_dot2c_f32_bf16 v23, v68, v68
    v_dot2c_f32_bf16 v21, s67, v69
    v_dot2c_f32_bf16 v23, v69, v69
    v_dot2c_f32_bf16 v21, s67, v70
    v_dot2c_f32_bf16 v23, v70, v70
    v_dot2c_f32_bf16 v21, s67, v71
    v_dot2c_f32_bf16 v23, v71, v71
    v_mfma_f32_16x16x16_bf16 v[180:183], v[12:13], v[36:37], 0
    v_mfma_f32_16x16x16_bf16 v[184:187], v[12:13], v[38:39], 0
    v_mfma_f32_16x16x16_bf16 v[188:191], v[12:13], v[40:41], 0
    v_add_f32 v20, v20, v21
    v_mfma_f32_16x16x16_bf16 v[192:195], v[12:13], v[42:43], 0
    v_add_f32 v22, v22, v23
    v_mfma_f32_16x16x16_bf16 v[196:199], v[12:13], v[44:45], 0
    v_add_f32_dpp v20, v20, v20 quad_perm:[1,0,3,2] row_mask:0xf bank_mask:0xf
    v_mfma_f32_16x16x16_bf16 v[200:203], v[12:13], v[46:47], 0
    v_add_f32_dpp v22, v22, v22 quad_perm:[1,0,3,2] row_mask:0xf bank_mask:0xf
    v_mfma_f32_16x16x16_bf16 v[204:207], v[12:13], v[48:49], 0
    v_add_f32_dpp v20, v20, v20 quad_perm:[2,3,0,1] row_mask:0xf bank_mask:0xf
    v_mfma_f32_16x16x16_bf16 v[208:211], v[12:13], v[50:51], 0
    v_add_f32_dpp v22, v22, v22 quad_perm:[2,3,0,1] row_mask:0xf bank_mask:0xf
    v_mfma_f32_16x16x16_bf16 v[212:215], v[12:13], v[52:53], 0
    v_add_f32_dpp v20, v20, v20 row_half_mirror row_mask:0xf bank_mask:0xf
    v_mfma_f32_16x16x16_bf16 v[216:219], v[12:13], v[54:55], 0
    v_add_f32_dpp v22, v22, v22 row_half_mirror row_mask:0xf bank_mask:0xf
    v_mfma_f32_16x16x16_bf16 v[220:223], v[12:13], v[56:57], 0
    v_mul_f32 v20, 987991609, v20
    v_mfma_f32_16x16x16_bf16 v[224:227], v[12:13], v[58:59], 0
    v_mul_f32 v22, 987991609, v22
    v_mfma_f32_16x16x16_bf16 v[228:231], v[12:13], v[60:61], 0
    v_fma_f32 v22, -v20, v20, v22
    v_mfma_f32_16x16x16_bf16 v[232:235], v[12:13], v[62:63], 0
    v_max_f32 v22, 0, v22
    v_mfma_f32_16x16x16_bf16 v[236:239], v[12:13], v[64:65], 0
    v_cvt_pk_bf16_f32 v22, v22, v22
    v_mfma_f32_16x16x16_bf16 v[240:243], v[12:13], v[66:67], 0
    v_lshlrev_b32 v22, 16, v22
    v_mfma_f32_16x16x16_bf16 v[244:247], v[12:13], v[68:69], 0
    v_add_f32 v22, 925353388, v22
    v_mfma_f32_16x16x16_bf16 v[248:251], v[12:13], v[70:71], 0
    v_cvt_pk_bf16_f32 v22, v22, v22
    v_lshlrev_b32 v22, 16, v22
    v_sqrt_f32 v22, v22
    v_cvt_pk_bf16_f32 v20, v20, v20
    v_lshlrev_b32 v20, 16, v20
    v_cvt_pk_bf16_f32 v22, v22, v22
    v_lshlrev_b32 v22, 16, v22
    v_rcp_f32 v24, v22
    s_nop 0
    v_mul_f32 v25, -v20, v24
    v_pk_fma_f32 v[180:181], v[180:181], v[24:25], v[24:25] op_sel:[0,0,1] op_sel_hi:[1,0,1]
    v_pk_fma_f32 v[182:183], v[182:183], v[24:25], v[24:25] op_sel:[0,0,1] op_sel_hi:[1,0,1]
    v_pk_fma_f32 v[184:185], v[184:185], v[24:25], v[24:25] op_sel:[0,0,1] op_sel_hi:[1,0,1]
    v_pk_fma_f32 v[186:187], v[186:187], v[24:25], v[24:25] op_sel:[0,0,1] op_sel_hi:[1,0,1]
    v_cvt_pk_bf16_f32 v36, v180, v181
    v_cvt_pk_bf16_f32 v37, v182, v183
    v_cvt_pk_bf16_f32 v38, v184, v185
    v_cvt_pk_bf16_f32 v39, v186, v187
    ds_write_b128 v16, v[36:39] offset:0
    buffer_load_dwordx4 v[108:111], v18, s[4:7], s86 offen offset:0
    buffer_load_dwordx4 v[112:115], v18, s[4:7], s86 offen offset:128
    buffer_load_dwordx4 v[116:119], v18, s[4:7], s86 offen offset:256
    buffer_load_dwordx4 v[120:123], v18, s[4:7], s86 offen offset:384
    buffer_load_dwordx4 v[124:127], v18, s[4:7], s86 offen offset:512
    buffer_load_dwordx4 v[128:131], v18, s[4:7], s86 offen offset:640
    buffer_load_dwordx4 v[132:135], v18, s[4:7], s86 offen offset:768
    buffer_load_dwordx4 v[136:139], v18, s[4:7], s86 offen offset:896
    buffer_load_dwordx4 v[140:143], v18, s[4:7], s86 offen offset:1024
    v_pk_fma_f32 v[188:189], v[188:189], v[24:25], v[24:25] op_sel:[0,0,1] op_sel_hi:[1,0,1]
    v_pk_fma_f32 v[190:191], v[190:191], v[24:25], v[24:25] op_sel:[0,0,1] op_sel_hi:[1,0,1]
    v_pk_fma_f32 v[192:193], v[192:193], v[24:25], v[24:25] op_sel:[0,0,1] op_sel_hi:[1,0,1]
    v_pk_fma_f32 v[194:195], v[194:195], v[24:25], v[24:25] op_sel:[0,0,1] op_sel_hi:[1,0,1]
    v_cvt_pk_bf16_f32 v40, v188, v189
    v_cvt_pk_bf16_f32 v41, v190, v191
    v_cvt_pk_bf16_f32 v42, v192, v193
    v_cvt_pk_bf16_f32 v43, v194, v195
    ds_write_b128 v16, v[40:43] offset:2048
    v_pk_fma_f32 v[196:197], v[196:197], v[24:25], v[24:25] op_sel:[0,0,1] op_sel_hi:[1,0,1]
    v_pk_fma_f32 v[198:199], v[198:199], v[24:25], v[24:25] op_sel:[0,0,1] op_sel_hi:[1,0,1]
    v_pk_fma_f32 v[200:201], v[200:201], v[24:25], v[24:25] op_sel:[0,0,1] op_sel_hi:[1,0,1]
    v_pk_fma_f32 v[202:203], v[202:203], v[24:25], v[24:25] op_sel:[0,0,1] op_sel_hi:[1,0,1]
    v_cvt_pk_bf16_f32 v44, v196, v197
    v_cvt_pk_bf16_f32 v45, v198, v199
    v_cvt_pk_bf16_f32 v46, v200, v201
    v_cvt_pk_bf16_f32 v47, v202, v203
    ds_write_b128 v16, v[44:47] offset:4096
    v_pk_fma_f32 v[204:205], v[204:205], v[24:25], v[24:25] op_sel:[0,0,1] op_sel_hi:[1,0,1]
    v_pk_fma_f32 v[206:207], v[206:207], v[24:25], v[24:25] op_sel:[0,0,1] op_sel_hi:[1,0,1]
    v_pk_fma_f32 v[208:209], v[208:209], v[24:25], v[24:25] op_sel:[0,0,1] op_sel_hi:[1,0,1]
    v_pk_fma_f32 v[210:211], v[210:211], v[24:25], v[24:25] op_sel:[0,0,1] op_sel_hi:[1,0,1]
    s_waitcnt vmcnt(17)
    v_mfma_f32_16x16x16_bf16 v[180:183], v[12:13], v[72:73], 0
    v_cvt_pk_bf16_f32 v48, v204, v205
    v_cvt_pk_bf16_f32 v49, v206, v207
    v_cvt_pk_bf16_f32 v50, v208, v209
    v_cvt_pk_bf16_f32 v51, v210, v211
    v_mfma_f32_16x16x16_bf16 v[184:187], v[12:13], v[74:75], 0
    ds_write_b128 v16, v[48:51] offset:6144
    v_pk_fma_f32 v[212:213], v[212:213], v[24:25], v[24:25] op_sel:[0,0,1] op_sel_hi:[1,0,1]
    v_pk_fma_f32 v[214:215], v[214:215], v[24:25], v[24:25] op_sel:[0,0,1] op_sel_hi:[1,0,1]
    v_pk_fma_f32 v[216:217], v[216:217], v[24:25], v[24:25] op_sel:[0,0,1] op_sel_hi:[1,0,1]
    v_pk_fma_f32 v[218:219], v[218:219], v[24:25], v[24:25] op_sel:[0,0,1] op_sel_hi:[1,0,1]
    s_waitcnt vmcnt(16)
    v_mfma_f32_16x16x16_bf16 v[188:191], v[12:13], v[76:77], 0
    v_cvt_pk_bf16_f32 v52, v212, v213
    v_cvt_pk_bf16_f32 v53, v214, v215
    v_cvt_pk_bf16_f32 v54, v216, v217
    v_cvt_pk_bf16_f32 v55, v218, v219
    v_mfma_f32_16x16x16_bf16 v[192:195], v[12:13], v[78:79], 0
    ds_write_b128 v16, v[52:55] offset:8192
    v_pk_fma_f32 v[220:221], v[220:221], v[24:25], v[24:25] op_sel:[0,0,1] op_sel_hi:[1,0,1]
    v_pk_fma_f32 v[222:223], v[222:223], v[24:25], v[24:25] op_sel:[0,0,1] op_sel_hi:[1,0,1]
    v_pk_fma_f32 v[224:225], v[224:225], v[24:25], v[24:25] op_sel:[0,0,1] op_sel_hi:[1,0,1]
    v_pk_fma_f32 v[226:227], v[226:227], v[24:25], v[24:25] op_sel:[0,0,1] op_sel_hi:[1,0,1]
    s_waitcnt vmcnt(15)
    v_mfma_f32_16x16x16_bf16 v[196:199], v[12:13], v[80:81], 0
    v_cvt_pk_bf16_f32 v56, v220, v221
    v_cvt_pk_bf16_f32 v57, v222, v223
    v_cvt_pk_bf16_f32 v58, v224, v225
    v_cvt_pk_bf16_f32 v59, v226, v227
    v_mfma_f32_16x16x16_bf16 v[200:203], v[12:13], v[82:83], 0
    ds_write_b128 v16, v[56:59] offset:10240
    v_pk_fma_f32 v[228:229], v[228:229], v[24:25], v[24:25] op_sel:[0,0,1] op_sel_hi:[1,0,1]
    v_pk_fma_f32 v[230:231], v[230:231], v[24:25], v[24:25] op_sel:[0,0,1] op_sel_hi:[1,0,1]
    v_pk_fma_f32 v[232:233], v[232:233], v[24:25], v[24:25] op_sel:[0,0,1] op_sel_hi:[1,0,1]
    v_pk_fma_f32 v[234:235], v[234:235], v[24:25], v[24:25] op_sel:[0,0,1] op_sel_hi:[1,0,1]
    s_waitcnt vmcnt(14)
    v_mfma_f32_16x16x16_bf16 v[204:207], v[12:13], v[84:85], 0
    v_cvt_pk_bf16_f32 v60, v228, v229
    v_cvt_pk_bf16_f32 v61, v230, v231
    v_cvt_pk_bf16_f32 v62, v232, v233
    v_cvt_pk_bf16_f32 v63, v234, v235
    v_mfma_f32_16x16x16_bf16 v[208:211], v[12:13], v[86:87], 0
    ds_write_b128 v16, v[60:63] offset:12288
    v_pk_fma_f32 v[236:237], v[236:237], v[24:25], v[24:25] op_sel:[0,0,1] op_sel_hi:[1,0,1]
    v_pk_fma_f32 v[238:239], v[238:239], v[24:25], v[24:25] op_sel:[0,0,1] op_sel_hi:[1,0,1]
    v_pk_fma_f32 v[240:241], v[240:241], v[24:25], v[24:25] op_sel:[0,0,1] op_sel_hi:[1,0,1]
    v_pk_fma_f32 v[242:243], v[242:243], v[24:25], v[24:25] op_sel:[0,0,1] op_sel_hi:[1,0,1]
    s_waitcnt vmcnt(13)
    v_mfma_f32_16x16x16_bf16 v[212:215], v[12:13], v[88:89], 0
    v_cvt_pk_bf16_f32 v64, v236, v237
    v_cvt_pk_bf16_f32 v65, v238, v239
    v_cvt_pk_bf16_f32 v66, v240, v241
    v_cvt_pk_bf16_f32 v67, v242, v243
    v_mfma_f32_16x16x16_bf16 v[216:219], v[12:13], v[90:91], 0
    ds_write_b128 v16, v[64:67] offset:14336
    v_pk_fma_f32 v[244:245], v[244:245], v[24:25], v[24:25] op_sel:[0,0,1] op_sel_hi:[1,0,1]
    v_pk_fma_f32 v[246:247], v[246:247], v[24:25], v[24:25] op_sel:[0,0,1] op_sel_hi:[1,0,1]
    v_pk_fma_f32 v[248:249], v[248:249], v[24:25], v[24:25] op_sel:[0,0,1] op_sel_hi:[1,0,1]
    v_pk_fma_f32 v[250:251], v[250:251], v[24:25], v[24:25] op_sel:[0,0,1] op_sel_hi:[1,0,1]
    s_waitcnt vmcnt(12)
    v_mfma_f32_16x16x16_bf16 v[220:223], v[12:13], v[92:93], 0
    v_cvt_pk_bf16_f32 v68, v244, v245
    v_cvt_pk_bf16_f32 v69, v246, v247
    v_cvt_pk_bf16_f32 v70, v248, v249
    v_cvt_pk_bf16_f32 v71, v250, v251
    v_mfma_f32_16x16x16_bf16 v[224:227], v[12:13], v[94:95], 0
    ds_write_b128 v16, v[68:71] offset:16384
    s_waitcnt vmcnt(9)
    buffer_load_dwordx4 v[144:147], v18, s[4:7], s87 offen offset:0
    buffer_load_dwordx4 v[148:151], v18, s[4:7], s87 offen offset:128
    buffer_load_dwordx4 v[152:155], v18, s[4:7], s87 offen offset:256
    buffer_load_dwordx4 v[156:159], v18, s[4:7], s87 offen offset:384
    buffer_load_dwordx4 v[160:163], v18, s[4:7], s87 offen offset:512
    buffer_load_dwordx4 v[164:167], v18, s[4:7], s87 offen offset:640
    buffer_load_dwordx4 v[168:171], v18, s[4:7], s87 offen offset:768
    buffer_load_dwordx4 v[172:175], v18, s[4:7], s87 offen offset:896
    buffer_load_dwordx4 v[176:179], v18, s[4:7], s87 offen offset:1024
    v_dot2_f32_bf16 v20, v72, s67, 0
    v_dot2_f32_bf16 v22, v72, v72, 0
    v_mov_b32 v21, 0
    v_mov_b32 v23, 0
    v_dot2c_f32_bf16 v21, s67, v73
    v_dot2c_f32_bf16 v23, v73, v73
    v_dot2c_f32_bf16 v21, s67, v74
    v_dot2c_f32_bf16 v23, v74, v74
    v_dot2c_f32_bf16 v21, s67, v75
    v_dot2c_f32_bf16 v23, v75, v75
    v_dot2c_f32_bf16 v21, s67, v76
    v_dot2c_f32_bf16 v23, v76, v76
    v_dot2c_f32_bf16 v21, s67, v77
    v_dot2c_f32_bf16 v23, v77, v77
    v_dot2c_f32_bf16 v21, s67, v78
    v_dot2c_f32_bf16 v23, v78, v78
    v_dot2c_f32_bf16 v21, s67, v79
    v_dot2c_f32_bf16 v23, v79, v79
    v_dot2c_f32_bf16 v21, s67, v80
    v_dot2c_f32_bf16 v23, v80, v80
    v_dot2c_f32_bf16 v21, s67, v81
    v_dot2c_f32_bf16 v23, v81, v81
    v_dot2c_f32_bf16 v21, s67, v82
    v_dot2c_f32_bf16 v23, v82, v82
    v_dot2c_f32_bf16 v21, s67, v83
    v_dot2c_f32_bf16 v23, v83, v83
    v_dot2c_f32_bf16 v21, s67, v84
    v_dot2c_f32_bf16 v23, v84, v84
    v_dot2c_f32_bf16 v21, s67, v85
    v_dot2c_f32_bf16 v23, v85, v85
    v_dot2c_f32_bf16 v21, s67, v86
    v_dot2c_f32_bf16 v23, v86, v86
    v_dot2c_f32_bf16 v21, s67, v87
    v_dot2c_f32_bf16 v23, v87, v87
    v_dot2c_f32_bf16 v21, s67, v88
    v_dot2c_f32_bf16 v23, v88, v88
    v_dot2c_f32_bf16 v21, s67, v89
    v_dot2c_f32_bf16 v23, v89, v89
    v_dot2c_f32_bf16 v21, s67, v90
    v_dot2c_f32_bf16 v23, v90, v90
    v_dot2c_f32_bf16 v21, s67, v91
    v_dot2c_f32_bf16 v23, v91, v91
    v_dot2c_f32_bf16 v21, s67, v92
    v_dot2c_f32_bf16 v23, v92, v92
    v_dot2c_f32_bf16 v21, s67, v93
    v_dot2c_f32_bf16 v23, v93, v93
    v_dot2c_f32_bf16 v21, s67, v94
    v_dot2c_f32_bf16 v23, v94, v94
    v_dot2c_f32_bf16 v21, s67, v95
    v_dot2c_f32_bf16 v23, v95, v95
    v_dot2c_f32_bf16 v21, s67, v96
    v_dot2c_f32_bf16 v23, v96, v96
    v_dot2c_f32_bf16 v21, s67, v97
    v_dot2c_f32_bf16 v23, v97, v97
    v_dot2c_f32_bf16 v21, s67, v98
    v_dot2c_f32_bf16 v23, v98, v98
    v_dot2c_f32_bf16 v21, s67, v99
    v_dot2c_f32_bf16 v23, v99, v99
    v_dot2c_f32_bf16 v21, s67, v100
    v_dot2c_f32_bf16 v23, v100, v100
    v_dot2c_f32_bf16 v21, s67, v101
    v_dot2c_f32_bf16 v23, v101, v101
    v_dot2c_f32_bf16 v21, s67, v102
    v_dot2c_f32_bf16 v23, v102, v102
    v_dot2c_f32_bf16 v21, s67, v103
    v_dot2c_f32_bf16 v23, v103, v103
    v_dot2c_f32_bf16 v21, s67, v104
    v_dot2c_f32_bf16 v23, v104, v104
    v_dot2c_f32_bf16 v21, s67, v105
    v_dot2c_f32_bf16 v23, v105, v105
    v_dot2c_f32_bf16 v21, s67, v106
    v_dot2c_f32_bf16 v23, v106, v106
    v_dot2c_f32_bf16 v21, s67, v107
    v_dot2c_f32_bf16 v23, v107, v107
    v_mfma_f32_16x16x16_bf16 v[228:231], v[12:13], v[96:97], 0
    v_mfma_f32_16x16x16_bf16 v[232:235], v[12:13], v[98:99], 0
    v_mfma_f32_16x16x16_bf16 v[236:239], v[12:13], v[100:101], 0
    v_add_f32 v20, v20, v21
    v_mfma_f32_16x16x16_bf16 v[240:243], v[12:13], v[102:103], 0
    v_add_f32 v22, v22, v23
    v_mfma_f32_16x16x16_bf16 v[244:247], v[12:13], v[104:105], 0
    v_add_f32_dpp v20, v20, v20 quad_perm:[1,0,3,2] row_mask:0xf bank_mask:0xf
    v_mfma_f32_16x16x16_bf16 v[248:251], v[12:13], v[106:107], 0
    v_add_f32_dpp v22, v22, v22 quad_perm:[1,0,3,2] row_mask:0xf bank_mask:0xf
    v_add_f32_dpp v20, v20, v20 quad_perm:[2,3,0,1] row_mask:0xf bank_mask:0xf
    s_nop 0
    v_add_f32_dpp v22, v22, v22 quad_perm:[2,3,0,1] row_mask:0xf bank_mask:0xf
    v_add_f32_dpp v20, v20, v20 row_half_mirror row_mask:0xf bank_mask:0xf
    s_nop 0
    v_add_f32_dpp v22, v22, v22 row_half_mirror row_mask:0xf bank_mask:0xf
    v_mul_f32 v20, 987991609, v20
    s_add_u32 m0, s56, 0
    s_add_u32 s60, s63, 0
    buffer_load_dwordx4 v26, s[12:15], s60 offen offset:0  lds
    buffer_load_dwordx4 v27, s[12:15], s60 offen offset:1024  lds
    buffer_load_dwordx4 v28, s[12:15], s60 offen offset:2048  lds
    v_mul_f32 v22, 987991609, v22
    v_fma_f32 v22, -v20, v20, v22
    v_max_f32 v22, 0, v22
    v_cvt_pk_bf16_f32 v22, v22, v22
    v_lshlrev_b32 v22, 16, v22
    v_add_f32 v22, 925353388, v22
    v_cvt_pk_bf16_f32 v22, v22, v22
    v_lshlrev_b32 v22, 16, v22
    v_sqrt_f32 v22, v22
    v_cvt_pk_bf16_f32 v20, v20, v20
    v_lshlrev_b32 v20, 16, v20
    v_cvt_pk_bf16_f32 v22, v22, v22
    v_lshlrev_b32 v22, 16, v22
    v_rcp_f32 v24, v22
    s_nop 0
    v_mul_f32 v25, -v20, v24
    v_pk_fma_f32 v[180:181], v[180:181], v[24:25], v[24:25] op_sel:[0,0,1] op_sel_hi:[1,0,1]
L_pg1:
    s_cbranch_execz L_pg5
    v_pk_fma_f32 v[182:183], v[182:183], v[24:25], v[24:25] op_sel:[0,0,1] op_sel_hi:[1,0,1]
    v_pk_fma_f32 v[184:185], v[184:185], v[24:25], v[24:25] op_sel:[0,0,1] op_sel_hi:[1,0,1]
    v_pk_fma_f32 v[186:187], v[186:187], v[24:25], v[24:25] op_sel:[0,0,1] op_sel_hi:[1,0,1]
    v_cvt_pk_bf16_f32 v72, v180, v181
    v_cvt_pk_bf16_f32 v73, v182, v183
    v_cvt_pk_bf16_f32 v74, v184, v185
    v_cvt_pk_bf16_f32 v75, v186, v187
    ds_write_b128 v17, v[72:75] offset:0
    v_pk_fma_f32 v[188:189], v[188:189], v[24:25], v[24:25] op_sel:[0,0,1] op_sel_hi:[1,0,1]
    v_pk_fma_f32 v[190:191], v[190:191], v[24:25], v[24:25] op_sel:[0,0,1] op_sel_hi:[1,0,1]
    v_pk_fma_f32 v[192:193], v[192:193], v[24:25], v[24:25] op_sel:[0,0,1] op_sel_hi:[1,0,1]
    v_pk_fma_f32 v[194:195], v[194:195], v[24:25], v[24:25] op_sel:[0,0,1] op_sel_hi:[1,0,1]
    v_cvt_pk_bf16_f32 v76, v188, v189
    v_cvt_pk_bf16_f32 v77, v190, v191
    v_cvt_pk_bf16_f32 v78, v192, v193
    v_cvt_pk_bf16_f32 v79, v194, v195
    ds_write_b128 v17, v[76:79] offset:2048
    v_pk_fma_f32 v[196:197], v[196:197], v[24:25], v[24:25] op_sel:[0,0,1] op_sel_hi:[1,0,1]
    v_pk_fma_f32 v[198:199], v[198:199], v[24:25], v[24:25] op_sel:[0,0,1] op_sel_hi:[1,0,1]
    v_pk_fma_f32 v[200:201], v[200:201], v[24:25], v[24:25] op_sel:[0,0,1] op_sel_hi:[1,0,1]
    v_pk_fma_f32 v[202:203], v[202:203], v[24:25], v[24:25] op_sel:[0,0,1] op_sel_hi:[1,0,1]
    v_cvt_pk_bf16_f32 v80, v196, v197
    v_cvt_pk_bf16_f32 v81, v198, v199
    v_cvt_pk_bf16_f32 v82, v200, v201
    v_cvt_pk_bf16_f32 v83, v202, v203
    ds_write_b128 v17, v[80:83] offset:4096
    s_add_u32 m0, s56, 3072
    s_add_u32 s60, s63, 0
    buffer_load_dwordx4 v29, s[12:15], s60 offen offset:0  lds
    buffer_load_dwordx4 v30, s[12:15], s60 offen offset:1024  lds
    buffer_load_dwordx4 v31, s[12:15], s60 offen offset:2048  lds
    v_pk_fma_f32 v[204:205], v[204:205], v[24:25], v[24:25] op_sel:[0,0,1] op_sel_hi:[1,0,1]
    v_pk_fma_f32 v[206:207], v[206:207], v[24:25], v[24:25] op_sel:[0,0,1] op_sel_hi:[1,0,1]
    v_pk_fma_f32 v[208:209], v[208:209], v[24:25], v[24:25] op_sel:[0,0,1] op_sel_hi:[1,0,1]
    v_pk_fma_f32 v[210:211], v[210:211], v[24:25], v[24:25] op_sel:[0,0,1] op_sel_hi:[1,0,1]
    s_waitcnt vmcnt(23)
    v_mfma_f32_16x16x16_bf16 v[180:183], v[12:13], v[108:109], 0
    v_cvt_pk_bf16_f32 v84, v204, v205
    v_cvt_pk_bf16_f32 v85, v206, v207
    v_cvt_pk_bf16_f32 v86, v208, v209
    v_cvt_pk_bf16_f32 v87, v210, v211
    v_mfma_f32_16x16x16_bf16 v[184:187], v[12:13], v[110:111], 0
    ds_write_b128 v17, v[84:87] offset:6144
    v_pk_fma_f32 v[212:213], v[212:213], v[24:25], v[24:25] op_sel:[0,0,1] op_sel_hi:[1,0,1]
    v_pk_fma_f32 v[214:215], v[214:215], v[24:25], v[24:25] op_sel:[0,0,1] op_sel_hi:[1,0,1]
    v_pk_fma_f32 v[216:217], v[216:217], v[24:25], v[24:25] op_sel:[0,0,1] op_sel_hi:[1,0,1]
    v_pk_fma_f32 v[218:219], v[218:219], v[24:25], v[24:25] op_sel:[0,0,1] op_sel_hi:[1,0,1]
    s_waitcnt vmcnt(22)
    v_mfma_f32_16x16x16_bf16 v[188:191], v[12:13], v[112:113], 0
    v_cvt_pk_bf16_f32 v88, v212, v213
    v_cvt_pk_bf16_f32 v89, v214, v215
    v_cvt_pk_bf16_f32 v90, v216, v217
    v_cvt_pk_bf16_f32 v91, v218, v219
    v_mfma_f32_16x16x16_bf16 v[192:195], v[12:13], v[114:115], 0
    ds_write_b128 v17, v[88:91] offset:8192
    v_pk_fma_f32 v[220:221], v[220:221], v[24:25], v[24:25] op_sel:[0,0,1] op_sel_hi:[1,0,1]
    v_pk_fma_f32 v[222:223], v[222:223], v[24:25], v[24:25] op_sel:[0,0,1] op_sel_hi:[1,0,1]
    v_pk_fma_f32 v[224:225], v[224:225], v[24:25], v[24:25] op_sel:[0,0,1] op_sel_hi:[1,0,1]
    v_pk_fma_f32 v[226:227], v[226:227], v[24:25], v[24:25] op_sel:[0,0,1] op_sel_hi:[1,0,1]
    s_waitcnt vmcnt(21)
    v_mfma_f32_16x16x16_bf16 v[196:199], v[12:13], v[116:117], 0
    v_cvt_pk_bf16_f32 v92, v220, v221
    v_cvt_pk_bf16_f32 v93, v222, v223
    v_cvt_pk_bf16_f32 v94, v224, v225
    v_cvt_pk_bf16_f32 v95, v226, v227
    v_mfma_f32_16x16x16_bf16 v[200:203], v[12:13], v[118:119], 0
    ds_write_b128 v17, v[92:95] offset:10240
    v_pk_fma_f32 v[228:229], v[228:229], v[24:25], v[24:25] op_sel:[0,0,1] op_sel_hi:[1,0,1]
    v_pk_fma_f32 v[230:231], v[230:231], v[24:25], v[24:25] op_sel:[0,0,1] op_sel_hi:[1,0,1]
    v_pk_fma_f32 v[232:233], v[232:233], v[24:25], v[24:25] op_sel:[0,0,1] op_sel_hi:[1,0,1]
    v_pk_fma_f32 v[234:235], v[234:235], v[24:25], v[24:25] op_sel:[0,0,1] op_sel_hi:[1,0,1]
    s_waitcnt vmcnt(20)
    v_mfma_f32_16x16x16_bf16 v[204:207], v[12:13], v[120:121], 0
    s_add_u32 m0, s56, 6144
    s_add_u32 s60, s63, 0
    buffer_load_dwordx4 v32, s[12:15], s60 offen offset:0  lds
    buffer_load_dwordx4 v33, s[12:15], s60 offen offset:1024  lds
    buffer_load_dwordx4 v34, s[12:15], s60 offen offset:2048  lds
    v_cvt_pk_bf16_f32 v96, v228, v229
    v_cvt_pk_bf16_f32 v97, v230, v231
    v_cvt_pk_bf16_f32 v98, v232, v233
    v_cvt_pk_bf16_f32 v99, v234, v235
    v_mfma_f32_16x16x16_bf16 v[208:211], v[12:13], v[122:123], 0
    ds_write_b128 v17, v[96:99] offset:12288
    v_pk_fma_f32 v[236:237], v[236:237], v[24:25], v[24:25] op_sel:[0,0,1] op_sel_hi:[1,0,1]
    v_pk_fma_f32 v[238:239], v[238:239], v[24:25], v[24:25] op_sel:[0,0,1] op_sel_hi:[1,0,1]
    v_pk_fma_f32 v[240:241], v[240:241], v[24:25], v[24:25] op_sel:[0,0,1] op_sel_hi:[1,0,1]
    v_pk_fma_f32 v[242:243], v[242:243], v[24:25], v[24:25] op_sel:[0,0,1] op_sel_hi:[1,0,1]
    s_waitcnt vmcnt(22)
    v_mfma_f32_16x16x16_bf16 v[212:215], v[12:13], v[124:125], 0
    v_cvt_pk_bf16_f32 v100, v236, v237
    v_cvt_pk_bf16_f32 v101, v238, v239
    v_cvt_pk_bf16_f32 v102, v240, v241
    v_cvt_pk_bf16_f32 v103, v242, v243
    v_mfma_f32_16x16x16_bf16 v[216:219], v[12:13], v[126:127], 0
    ds_write_b128 v17, v[100:103] offset:14336
    v_pk_fma_f32 v[244:245], v[244:245], v[24:25], v[24:25] op_sel:[0,0,1] op_sel_hi:[1,0,1]
    v_pk_fma_f32 v[246:247], v[246:247], v[24:25], v[24:25] op_sel:[0,0,1] op_sel_hi:[1,0,1]
    v_pk_fma_f32 v[248:249], v[248:249], v[24:25], v[24:25] op_sel:[0,0,1] op_sel_hi:[1,0,1]
    v_pk_fma_f32 v[250:251], v[250:251], v[24:25], v[24:25] op_sel:[0,0,1] op_sel_hi:[1,0,1]
    s_waitcnt vmcnt(21)
    v_mfma_f32_16x16x16_bf16 v[220:223], v[12:13], v[128:129], 0
    v_cvt_pk_bf16_f32 v104, v244, v245
    v_cvt_pk_bf16_f32 v105, v246, v247
    v_cvt_pk_bf16_f32 v106, v248, v249
    v_cvt_pk_bf16_f32 v107, v250, v251
    v_mfma_f32_16x16x16_bf16 v[224:227], v[12:13], v[130:131], 0
    ds_write_b128 v17, v[104:107] offset:16384
    s_waitcnt vmcnt(18)
    v_dot2_f32_bf16 v20, v108, s67, 0
    v_dot2_f32_bf16 v22, v108, v108, 0
    v_mov_b32 v21, 0
    v_mov_b32 v23, 0
    v_dot2c_f32_bf16 v21, s67, v109
    v_dot2c_f32_bf16 v23, v109, v109
    v_dot2c_f32_bf16 v21, s67, v110
    v_dot2c_f32_bf16 v23, v110, v110
    v_dot2c_f32_bf16 v21, s67, v111
    v_dot2c_f32_bf16 v23, v111, v111
    v_dot2c_f32_bf16 v21, s67, v112
    v_dot2c_f32_bf16 v23, v112, v112
    v_dot2c_f32_bf16 v21, s67, v113
    v_dot2c_f32_bf16 v23, v113, v113
    s_add_u32 m0, s56, 36864
    s_add_u32 s60, s63, 2654208
    buffer_load_dwordx4 v26, s[12:15], s60 offen offset:0  lds
    buffer_load_dwordx4 v27, s[12:15], s60 offen offset:1024  lds
    buffer_load_dwordx4 v28, s[12:15], s60 offen offset:2048  lds
    v_dot2c_f32_bf16 v21, s67, v114
    v_dot2c_f32_bf16 v23, v114, v114
    v_dot2c_f32_bf16 v21, s67, v115
    v_dot2c_f32_bf16 v23, v115, v115
    v_dot2c_f32_bf16 v21, s67, v116
    v_dot2c_f32_bf16 v23, v116, v116
    s_waitcnt lgkmcnt(0)
    s_barrier
    ds_read_b128 a[0:3], v10 offset:0
    ds_read_b128 a[4:7], v10 offset:18432
    ds_read_b128 a[16:19], v11 offset:1024
    ds_read_b128 a[20:23], v11 offset:19456
    ds_read_b128 a[32:35], v10 offset:2048
    ds_read_b128 a[36:39], v10 offset:20480
    v_dot2c_f32_bf16 v21, s67, v117
    v_dot2c_f32_bf16 v23, v117, v117
    v_dot2c_f32_bf16 v21, s67, v118
    v_dot2c_f32_bf16 v23, v118, v118
    v_dot2c_f32_bf16 v21, s67, v119
    v_dot2c_f32_bf16 v23, v119, v119
    v_dot2c_f32_bf16 v21, s67, v120
    v_dot2c_f32_bf16 v23, v120, v120
    v_dot2c_f32_bf16 v21, s67, v121
    v_dot2c_f32_bf16 v23, v121, v121
    v_dot2c_f32_bf16 v21, s67, v122
    ds_read_b128 a[48:51], v11 offset:3072
    ds_read_b128 a[52:55], v11 offset:21504
    ds_read_b128 a[64:67], v10 offset:4096
    ds_read_b128 a[68:71], v10 offset:22528
    ds_read_b128 a[80:83], v11 offset:5120
    ds_read_b128 a[84:87], v11 offset:23552
    v_dot2c_f32_bf16 v23, v122, v122
    v_dot2c_f32_bf16 v21, s67, v123
    v_dot2c_f32_bf16 v23, v123, v123
    v_dot2c_f32_bf16 v21, s67, v124
    v_dot2c_f32_bf16 v23, v124, v124
    v_dot2c_f32_bf16 v21, s67, v125
    v_dot2c_f32_bf16 v23, v125, v125
    s_add_u32 m0, s56, 39936
    s_add_u32 s60, s63, 2654208
    buffer_load_dwordx4 v29, s[12:15], s60 offen offset:0  lds
    buffer_load_dwordx4 v30, s[12:15], s60 offen offset:1024  lds
    buffer_load_dwordx4 v31, s[12:15], s60 offen offset:2048  lds
    v_dot2c_f32_bf16 v21, s67, v126
    v_dot2c_f32_bf16 v23, v126, v126
    v_dot2c_f32_bf16 v21, s67, v127
    v_dot2c_f32_bf16 v23, v127, v127
    ds_read_b128 a[96:99], v10 offset:6144
    ds_read_b128 a[100:103], v10 offset:24576
    ds_read_b128 a[112:115], v11 offset:7168
    ds_read_b128 a[116:119], v11 offset:25600
    ds_read_b128 a[128:131], v10 offset:8192
    ds_read_b128 a[132:135], v10 offset:26624
    v_dot2c_f32_bf16 v21, s67, v128
    v_dot2c_f32_bf16 v23, v128, v128
    v_dot2c_f32_bf16 v21, s67, v129
    v_dot2c_f32_bf16 v23, v129, v129
    v_dot2c_f32_bf16 v21, s67, v130
    v_dot2c_f32_bf16 v23, v130, v130
    v_dot2c_f32_bf16 v21, s67, v131
    v_dot2c_f32_bf16 v23, v131, v131
    v_dot2c_f32_bf16 v21, s67, v132
    v_dot2c_f32_bf16 v23, v132, v132
    v_dot2c_f32_bf16 v21, s67, v133
    v_dot2c_f32_bf16 v23, v133, v133
    ds_read_b128 a[144:147], v11 offset:9216
    ds_read_b128 a[148:151], v11 offset:27648
    ds_read_b128 a[160:163], v10 offset:10240
    ds_read_b128 a[164:167], v10 offset:28672
    ds_read_b128 a[176:179], v11 offset:11264
    ds_read_b128 a[180:183], v11 offset:29696
    v_dot2c_f32_bf16 v21, s67, v134
    v_dot2c_f32_bf16 v23, v134, v134
    v_dot2c_f32_bf16 v21, s67, v135
    v_dot2c_f32_bf16 v23, v135, v135
    v_dot2c_f32_bf16 v21, s67, v136
    v_dot2c_f32_bf16 v23, v136, v136
    v_dot2c_f32_bf16 v21, s67, v137
    v_dot2c_f32_bf16 v23, v137, v137
    v_dot2c_f32_bf16 v21, s67, v138
    v_dot2c_f32_bf16 v23, v138, v138
    v_dot2c_f32_bf16 v21, s67, v139
    ds_read_b128 a[192:195], v10 offset:12288
    ds_read_b128 a[196:199], v10 offset:30720
    ds_read_b128 a[208:211], v11 offset:13312
    ds_read_b128 a[212:215], v11 offset:31744
    ds_read_b128 a[224:227], v10 offset:14336
    ds_read_b128 a[228:231], v10 offset:32768
    v_dot2c_f32_bf16 v23, v139, v139
    v_dot2c_f32_bf16 v21, s67, v140
    v_dot2c_f32_bf16 v23, v140, v140
    v_dot2c_f32_bf16 v21, s67, v141
    v_dot2c_f32_bf16 v23, v141, v141
    v_dot2c_f32_bf16 v21, s67, v142
    v_dot2c_f32_bf16 v23, v142, v142
    v_dot2c_f32_bf16 v21, s67, v143
    v_dot2c_f32_bf16 v23, v143, v143
    v_mfma_f32_16x16x16_bf16 v[228:231], v[12:13], v[132:133], 0
    v_mfma_f32_16x16x16_bf16 v[232:235], v[12:13], v[134:135], 0
    ds_read_b128 a[240:243], v11 offset:15360
    ds_read_b128 a[244:247], v11 offset:33792
    ds_read_b128 v[40:43], v10 offset:16384
    ds_read_b128 v[44:47], v10 offset:34816
    ds_read_b128 v[56:59], v11 offset:17408
    s_add_u32 m0, s56, 43008
    s_add_u32 s60, s63, 2654208
    buffer_load_dwordx4 v32, s[12:15], s60 offen offset:0  lds
    buffer_load_dwordx4 v33, s[12:15], s60 offen offset:1024  lds
    buffer_load_dwordx4 v34, s[12:15], s60 offen offset:2048  lds
    ds_read_b128 v[60:63], v11 offset:35840
    v_mfma_f32_16x16x16_bf16 v[236:239], v[12:13], v[136:137], 0
    v_add_f32 v20, v20, v21
    v_mfma_f32_16x16x16_bf16 v[240:243], v[12:13], v[138:139], 0
    v_add_f32 v22, v22, v23
    v_mfma_f32_16x16x16_bf16 v[244:247], v[12:13], v[140:141], 0
    v_add_f32_dpp v20, v20, v20 quad_perm:[1,0,3,2] row_mask:0xf bank_mask:0xf
    v_mfma_f32_16x16x16_bf16 v[248:251], v[12:13], v[142:143], 0
    v_add_f32_dpp v22, v22, v22 quad_perm:[1,0,3,2] row_mask:0xf bank_mask:0xf
    v_add_f32_dpp v20, v20, v20 quad_perm:[2,3,0,1] row_mask:0xf bank_mask:0xf
    s_nop 0
    v_add_f32_dpp v22, v22, v22 quad_perm:[2,3,0,1] row_mask:0xf bank_mask:0xf
    v_add_f32_dpp v20, v20, v20 row_half_mirror row_mask:0xf bank_mask:0xf
    s_nop 0
    v_add_f32_dpp v22, v22, v22 row_half_mirror row_mask:0xf bank_mask:0xf
    v_mul_f32 v20, 987991609, v20
    v_mul_f32 v22, 987991609, v22
    v_fma_f32 v22, -v20, v20, v22
    v_max_f32 v22, 0, v22
    v_cvt_pk_bf16_f32 v22, v22, v22
    v_lshlrev_b32 v22, 16, v22
    v_add_f32 v22, 925353388, v22
    v_cvt_pk_bf16_f32 v22, v22, v22
    v_lshlrev_b32 v22, 16, v22
    v_sqrt_f32 v22, v22
    v_cvt_pk_bf16_f32 v20, v20, v20
    v_lshlrev_b32 v20, 16, v20
    v_cvt_pk_bf16_f32 v22, v22, v22
    v_lshlrev_b32 v22, 16, v22
    v_rcp_f32 v24, v22
    s_nop 0
    v_mul_f32 v25, -v20, v24
    v_pk_fma_f32 v[180:181], v[180:181], v[24:25], v[24:25] op_sel:[0,0,1] op_sel_hi:[1,0,1]
    v_pk_fma_f32 v[182:183], v[182:183], v[24:25], v[24:25] op_sel:[0,0,1] op_sel_hi:[1,0,1]
    v_pk_fma_f32 v[184:185], v[184:185], v[24:25], v[24:25] op_sel:[0,0,1] op_sel_hi:[1,0,1]
    v_pk_fma_f32 v[186:187], v[186:187], v[24:25], v[24:25] op_sel:[0,0,1] op_sel_hi:[1,0,1]
    v_cvt_pk_bf16_f32 v108, v180, v181
    v_cvt_pk_bf16_f32 v109, v182, v183
    v_cvt_pk_bf16_f32 v110, v184, v185
    v_cvt_pk_bf16_f32 v111, v186, v187
    s_waitcnt lgkmcnt(0)
    s_barrier
    ds_write_b128 v16, v[108:111] offset:0
    v_pk_fma_f32 v[188:189], v[188:189], v[24:25], v[24:25] op_sel:[0,0,1] op_sel_hi:[1,0,1]
    v_pk_fma_f32 v[190:191], v[190:191], v[24:25], v[24:25] op_sel:[0,0,1] op_sel_hi:[1,0,1]
    v_pk_fma_f32 v[192:193], v[192:193], v[24:25], v[24:25] op_sel:[0,0,1] op_sel_hi:[1,0,1]
    v_pk_fma_f32 v[194:195], v[194:195], v[24:25], v[24:25] op_sel:[0,0,1] op_sel_hi:[1,0,1]
    v_cvt_pk_bf16_f32 v112, v188, v189
    v_cvt_pk_bf16_f32 v113, v190, v191
    v_cvt_pk_bf16_f32 v114, v192, v193
    v_cvt_pk_bf16_f32 v115, v194, v195
    ds_write_b128 v16, v[112:115] offset:2048
    v_pk_fma_f32 v[196:197], v[196:197], v[24:25], v[24:25] op_sel:[0,0,1] op_sel_hi:[1,0,1]
    v_pk_fma_f32 v[198:199], v[198:199], v[24:25], v[24:25] op_sel:[0,0,1] op_sel_hi:[1,0,1]
    v_pk_fma_f32 v[200:201], v[200:201], v[24:25], v[24:25] op_sel:[0,0,1] op_sel_hi:[1,0,1]
    v_pk_fma_f32 v[202:203], v[202:203], v[24:25], v[24:25] op_sel:[0,0,1] op_sel_hi:[1,0,1]
    v_cvt_pk_bf16_f32 v116, v196, v197
    buffer_load_dword v254, v253, s[16:19], s63 offen offset:0
    buffer_load_dword v254, v253, s[12:15], s63 offen offset:128
    buffer_load_dword v254, v15, s[8:11], s61 offen
    v_cvt_pk_bf16_f32 v117, v198, v199
    v_cvt_pk_bf16_f32 v118, v200, v201
    v_cvt_pk_bf16_f32 v119, v202, v203
    ds_write_b128 v16, v[116:119] offset:4096
    v_pk_fma_f32 v[204:205], v[204:205], v[24:25], v[24:25] op_sel:[0,0,1] op_sel_hi:[1,0,1]
    v_pk_fma_f32 v[206:207], v[206:207], v[24:25], v[24:25] op_sel:[0,0,1] op_sel_hi:[1,0,1]
    v_pk_fma_f32 v[208:209], v[208:209], v[24:25], v[24:25] op_sel:[0,0,1] op_sel_hi:[1,0,1]
    v_pk_fma_f32 v[210:211], v[210:211], v[24:25], v[24:25] op_sel:[0,0,1] op_sel_hi:[1,0,1]
    s_waitcnt vmcnt(29)
    v_mfma_f32_16x16x16_bf16 v[180:183], v[12:13], v[144:145], 0
    v_cvt_pk_bf16_f32 v120, v204, v205
    v_cvt_pk_bf16_f32 v121, v206, v207
    v_cvt_pk_bf16_f32 v122, v208, v209
    v_cvt_pk_bf16_f32 v123, v210, v211
    v_mfma_f32_16x16x16_bf16 v[184:187], v[12:13], v[146:147], 0
    ds_write_b128 v16, v[120:123] offset:6144
    v_pk_fma_f32 v[212:213], v[212:213], v[24:25], v[24:25] op_sel:[0,0,1] op_sel_hi:[1,0,1]
    v_pk_fma_f32 v[214:215], v[214:215], v[24:25], v[24:25] op_sel:[0,0,1] op_sel_hi:[1,0,1]
    v_pk_fma_f32 v[216:217], v[216:217], v[24:25], v[24:25] op_sel:[0,0,1] op_sel_hi:[1,0,1]
    v_pk_fma_f32 v[218:219], v[218:219], v[24:25], v[24:25] op_sel:[0,0,1] op_sel_hi:[1,0,1]
    s_waitcnt vmcnt(28)
    v_mfma_f32_16x16x16_bf16 v[188:191], v[12:13], v[148:149], 0
    v_cvt_pk_bf16_f32 v124, v212, v213
    v_cvt_pk_bf16_f32 v125, v214, v215
    v_cvt_pk_bf16_f32 v126, v216, v217
    v_cvt_pk_bf16_f32 v127, v218, v219
    v_mfma_f32_16x16x16_bf16 v[192:195], v[12:13], v[150:151], 0
    ds_write_b128 v16, v[124:127] offset:8192
    v_pk_fma_f32 v[220:221], v[220:221], v[24:25], v[24:25] op_sel:[0,0,1] op_sel_hi:[1,0,1]
    v_pk_fma_f32 v[222:223], v[222:223], v[24:25], v[24:25] op_sel:[0,0,1] op_sel_hi:[1,0,1]
    v_pk_fma_f32 v[224:225], v[224:225], v[24:25], v[24:25] op_sel:[0,0,1] op_sel_hi:[1,0,1]
    v_pk_fma_f32 v[226:227], v[226:227], v[24:25], v[24:25] op_sel:[0,0,1] op_sel_hi:[1,0,1]
    s_waitcnt vmcnt(27)
    v_mfma_f32_16x16x16_bf16 v[196:199], v[12:13], v[152:153], 0
    v_cvt_pk_bf16_f32 v128, v220, v221
    v_cvt_pk_bf16_f32 v129, v222, v223
    v_cvt_pk_bf16_f32 v130, v224, v225
    v_cvt_pk_bf16_f32 v131, v226, v227
    v_mfma_f32_16x16x16_bf16 v[200:203], v[12:13], v[154:155], 0
    ds_write_b128 v16, v[128:131] offset:10240
    v_pk_fma_f32 v[228:229], v[228:229], v[24:25], v[24:25] op_sel:[0,0,1] op_sel_hi:[1,0,1]
    v_pk_fma_f32 v[230:231], v[230:231], v[24:25], v[24:25] op_sel:[0,0,1] op_sel_hi:[1,0,1]
    v_pk_fma_f32 v[232:233], v[232:233], v[24:25], v[24:25] op_sel:[0,0,1] op_sel_hi:[1,0,1]
    v_pk_fma_f32 v[234:235], v[234:235], v[24:25], v[24:25] op_sel:[0,0,1] op_sel_hi:[1,0,1]
    s_waitcnt vmcnt(26)
    v_mfma_f32_16x16x16_bf16 v[204:207], v[12:13], v[156:157], 0
    v_cvt_pk_bf16_f32 v132, v228, v229
    v_cvt_pk_bf16_f32 v133, v230, v231
    v_cvt_pk_bf16_f32 v134, v232, v233
    v_cvt_pk_bf16_f32 v135, v234, v235
    v_mfma_f32_16x16x16_bf16 v[208:211], v[12:13], v[158:159], 0
    ds_write_b128 v16, v[132:135] offset:12288
    v_pk_fma_f32 v[236:237], v[236:237], v[24:25], v[24:25] op_sel:[0,0,1] op_sel_hi:[1,0,1]
    v_pk_fma_f32 v[238:239], v[238:239], v[24:25], v[24:25] op_sel:[0,0,1] op_sel_hi:[1,0,1]
    v_pk_fma_f32 v[240:241], v[240:241], v[24:25], v[24:25] op_sel:[0,0,1] op_sel_hi:[1,0,1]
    v_pk_fma_f32 v[242:243], v[242:243], v[24:25], v[24:25] op_sel:[0,0,1] op_sel_hi:[1,0,1]
    s_waitcnt vmcnt(25)
    v_mfma_f32_16x16x16_bf16 v[212:215], v[12:13], v[160:161], 0
    v_cvt_pk_bf16_f32 v136, v236, v237
    v_cvt_pk_bf16_f32 v137, v238, v239
    v_cvt_pk_bf16_f32 v138, v240, v241
    v_cvt_pk_bf16_f32 v139, v242, v243
    v_mfma_f32_16x16x16_bf16 v[216:219], v[12:13], v[162:163], 0
    ds_write_b128 v16, v[136:139] offset:14336
    v_pk_fma_f32 v[244:245], v[244:245], v[24:25], v[24:25] op_sel:[0,0,1] op_sel_hi:[1,0,1]
    v_pk_fma_f32 v[246:247], v[246:247], v[24:25], v[24:25] op_sel:[0,0,1] op_sel_hi:[1,0,1]
    v_pk_fma_f32 v[248:249], v[248:249], v[24:25], v[24:25] op_sel:[0,0,1] op_sel_hi:[1,0,1]
    v_pk_fma_f32 v[250:251], v[250:251], v[24:25], v[24:25] op_sel:[0,0,1] op_sel_hi:[1,0,1]
    s_waitcnt vmcnt(24)
    v_mfma_f32_16x16x16_bf16 v[220:223], v[12:13], v[164:165], 0
    v_cvt_pk_bf16_f32 v140, v244, v245
    v_cvt_pk_bf16_f32 v141, v246, v247
    v_cvt_pk_bf16_f32 v142, v248, v249
    v_cvt_pk_bf16_f32 v143, v250, v251
    v_mfma_f32_16x16x16_bf16 v[224:227], v[12:13], v[166:167], 0
    ds_write_b128 v16, v[140:143] offset:16384
    s_waitcnt vmcnt(21)
    v_dot2_f32_bf16 v20, v144, s67, 0
    v_dot2_f32_bf16 v22, v144, v144, 0
    v_mov_b32 v21, 0
    v_mov_b32 v23, 0
    v_dot2c_f32_bf16 v21, s67, v145
    v_dot2c_f32_bf16 v23, v145, v145
    v_dot2c_f32_bf16 v21, s67, v146
    v_dot2c_f32_bf16 v23, v146, v146
    v_dot2c_f32_bf16 v21, s67, v147
    v_dot2c_f32_bf16 v23, v147, v147
    v_dot2c_f32_bf16 v21, s67, v148
    v_dot2c_f32_bf16 v23, v148, v148
    v_dot2c_f32_bf16 v21, s67, v149
    v_dot2c_f32_bf16 v23, v149, v149
    v_dot2c_f32_bf16 v21, s67, v150
    v_dot2c_f32_bf16 v23, v150, v150
    v_dot2c_f32_bf16 v21, s67, v151
    v_dot2c_f32_bf16 v23, v151, v151
    v_dot2c_f32_bf16 v21, s67, v152
    v_dot2c_f32_bf16 v23, v152, v152
    v_dot2c_f32_bf16 v21, s67, v153
    v_dot2c_f32_bf16 v23, v153, v153
    v_dot2c_f32_bf16 v21, s67, v154
    v_dot2c_f32_bf16 v23, v154, v154
    v_dot2c_f32_bf16 v21, s67, v155
    v_dot2c_f32_bf16 v23, v155, v155
    v_dot2c_f32_bf16 v21, s67, v156
    v_dot2c_f32_bf16 v23, v156, v156
    v_dot2c_f32_bf16 v21, s67, v157
    v_dot2c_f32_bf16 v23, v157, v157
    v_dot2c_f32_bf16 v21, s67, v158
    v_dot2c_f32_bf16 v23, v158, v158
    v_dot2c_f32_bf16 v21, s67, v159
    v_dot2c_f32_bf16 v23, v159, v159
    v_dot2c_f32_bf16 v21, s67, v160
    v_dot2c_f32_bf16 v23, v160, v160
    v_dot2c_f32_bf16 v21, s67, v161
    v_dot2c_f32_bf16 v23, v161, v161
    v_dot2c_f32_bf16 v21, s67, v162
    v_dot2c_f32_bf16 v23, v162, v162
    v_dot2c_f32_bf16 v21, s67, v163
    v_dot2c_f32_bf16 v23, v163, v163
    v_dot2c_f32_bf16 v21, s67, v164
    v_dot2c_f32_bf16 v23, v164, v164
    v_dot2c_f32_bf16 v21, s67, v165
    v_dot2c_f32_bf16 v23, v165, v165
    v_dot2c_f32_bf16 v21, s67, v166
    v_dot2c_f32_bf16 v23, v166, v166
    v_dot2c_f32_bf16 v21, s67, v167
    v_dot2c_f32_bf16 v23, v167, v167
    v_dot2c_f32_bf16 v21, s67, v168
    v_dot2c_f32_bf16 v23, v168, v168
    v_dot2c_f32_bf16 v21, s67, v169
    v_dot2c_f32_bf16 v23, v169, v169
    v_dot2c_f32_bf16 v21, s67, v170
    v_dot2c_f32_bf16 v23, v170, v170
    v_dot2c_f32_bf16 v21, s67, v171
    v_dot2c_f32_bf16 v23, v171, v171
    v_dot2c_f32_bf16 v21, s67, v172
    v_dot2c_f32_bf16 v23, v172, v172
    v_dot2c_f32_bf16 v21, s67, v173
    v_dot2c_f32_bf16 v23, v173, v173
    v_dot2c_f32_bf16 v21, s67, v174
    v_dot2c_f32_bf16 v23, v174, v174
    v_dot2c_f32_bf16 v21, s67, v175
    v_dot2c_f32_bf16 v23, v175, v175
    v_dot2c_f32_bf16 v21, s67, v176
    v_dot2c_f32_bf16 v23, v176, v176
    v_dot2c_f32_bf16 v21, s67, v177
    v_dot2c_f32_bf16 v23, v177, v177
    v_dot2c_f32_bf16 v21, s67, v178
    v_dot2c_f32_bf16 v23, v178, v178
    v_dot2c_f32_bf16 v21, s67, v179
    v_dot2c_f32_bf16 v23, v179, v179
    v_mfma_f32_16x16x16_bf16 v[228:231], v[12:13], v[168:169], 0
    v_mfma_f32_16x16x16_bf16 v[232:235], v[12:13], v[170:171], 0
    v_mfma_f32_16x16x16_bf16 v[236:239], v[12:13], v[172:173], 0
    v_add_f32 v20, v20, v21
    v_mfma_f32_16x16x16_bf16 v[240:243], v[12:13], v[174:175], 0
    v_add_f32 v22, v22, v23
    v_mfma_f32_16x16x16_bf16 v[244:247], v[12:13], v[176:177], 0
    v_add_f32_dpp v20, v20, v20 quad_perm:[1,0,3,2] row_mask:0xf bank_mask:0xf
    v_mfma_f32_16x16x16_bf16 v[248:251], v[12:13], v[178:179], 0
    v_add_f32_dpp v22, v22, v22 quad_perm:[1,0,3,2] row_mask:0xf bank_mask:0xf
    v_add_f32_dpp v20, v20, v20 quad_perm:[2,3,0,1] row_mask:0xf bank_mask:0xf
    s_nop 0
    v_add_f32_dpp v22, v22, v22 quad_perm:[2,3,0,1] row_mask:0xf bank_mask:0xf
    v_add_f32_dpp v20, v20, v20 row_half_mirror row_mask:0xf bank_mask:0xf
    s_nop 0
    v_add_f32_dpp v22, v22, v22 row_half_mirror row_mask:0xf bank_mask:0xf
    v_mul_f32 v20, 987991609, v20
    v_mul_f32 v22, 987991609, v22
    v_fma_f32 v22, -v20, v20, v22
    v_max_f32 v22, 0, v22
    v_cvt_pk_bf16_f32 v22, v22, v22
    v_lshlrev_b32 v22, 16, v22
    v_add_f32 v22, 925353388, v22
    v_cvt_pk_bf16_f32 v22, v22, v22
    v_lshlrev_b32 v22, 16, v22
    v_sqrt_f32 v22, v22
    v_cvt_pk_bf16_f32 v20, v20, v20
    v_lshlrev_b32 v20, 16, v20
    v_cvt_pk_bf16_f32 v22, v22, v22
    v_lshlrev_b32 v22, 16, v22
    v_rcp_f32 v24, v22
    s_nop 0
    v_mul_f32 v25, -v20, v24
    v_pk_fma_f32 v[180:181], v[180:181], v[24:25], v[24:25] op_sel:[0,0,1] op_sel_hi:[1,0,1]
    v_pk_fma_f32 v[182:183], v[182:183], v[24:25], v[24:25] op_sel:[0,0,1] op_sel_hi:[1,0,1]
    v_pk_fma_f32 v[184:185], v[184:185], v[24:25], v[24:25] op_sel:[0,0,1] op_sel_hi:[1,0,1]
    v_pk_fma_f32 v[186:187], v[186:187], v[24:25], v[24:25] op_sel:[0,0,1] op_sel_hi:[1,0,1]
    v_cvt_pk_bf16_f32 v144, v180, v181
    v_cvt_pk_bf16_f32 v145, v182, v183
    v_cvt_pk_bf16_f32 v146, v184, v185
    v_cvt_pk_bf16_f32 v147, v186, v187
    ds_write_b128 v17, v[144:147] offset:0
    v_pk_fma_f32 v[188:189], v[188:189], v[24:25], v[24:25] op_sel:[0,0,1] op_sel_hi:[1,0,1]
    v_pk_fma_f32 v[190:191], v[190:191], v[24:25], v[24:25] op_sel:[0,0,1] op_sel_hi:[1,0,1]
    v_pk_fma_f32 v[192:193], v[192:193], v[24:25], v[24:25] op_sel:[0,0,1] op_sel_hi:[1,0,1]
    v_pk_fma_f32 v[194:195], v[194:195], v[24:25], v[24:25] op_sel:[0,0,1] op_sel_hi:[1,0,1]
    v_cvt_pk_bf16_f32 v148, v188, v189
    v_cvt_pk_bf16_f32 v149, v190, v191
    v_cvt_pk_bf16_f32 v150, v192, v193
    v_cvt_pk_bf16_f32 v151, v194, v195
    ds_write_b128 v17, v[148:151] offset:2048
    v_pk_fma_f32 v[196:197], v[196:197], v[24:25], v[24:25] op_sel:[0,0,1] op_sel_hi:[1,0,1]
    v_pk_fma_f32 v[198:199], v[198:199], v[24:25], v[24:25] op_sel:[0,0,1] op_sel_hi:[1,0,1]
    v_pk_fma_f32 v[200:201], v[200:201], v[24:25], v[24:25] op_sel:[0,0,1] op_sel_hi:[1,0,1]
    v_pk_fma_f32 v[202:203], v[202:203], v[24:25], v[24:25] op_sel:[0,0,1] op_sel_hi:[1,0,1]
    v_cvt_pk_bf16_f32 v152, v196, v197
    v_cvt_pk_bf16_f32 v153, v198, v199
    v_cvt_pk_bf16_f32 v154, v200, v201
    v_cvt_pk_bf16_f32 v155, v202, v203
    ds_write_b128 v17, v[152:155] offset:4096
    v_pk_fma_f32 v[204:205], v[204:205], v[24:25], v[24:25] op_sel:[0,0,1] op_sel_hi:[1,0,1]
    v_pk_fma_f32 v[206:207], v[206:207], v[24:25], v[24:25] op_sel:[0,0,1] op_sel_hi:[1,0,1]
    v_pk_fma_f32 v[208:209], v[208:209], v[24:25], v[24:25] op_sel:[0,0,1] op_sel_hi:[1,0,1]
    v_pk_fma_f32 v[210:211], v[210:211], v[24:25], v[24:25] op_sel:[0,0,1] op_sel_hi:[1,0,1]
    v_cvt_pk_bf16_f32 v156, v204, v205
    v_cvt_pk_bf16_f32 v157, v206, v207
    v_cvt_pk_bf16_f32 v158, v208, v209
    v_cvt_pk_bf16_f32 v159, v210, v211
    ds_write_b128 v17, v[156:159] offset:6144
    v_pk_fma_f32 v[212:213], v[212:213], v[24:25], v[24:25] op_sel:[0,0,1] op_sel_hi:[1,0,1]
    v_pk_fma_f32 v[214:215], v[214:215], v[24:25], v[24:25] op_sel:[0,0,1] op_sel_hi:[1,0,1]
    v_pk_fma_f32 v[216:217], v[216:217], v[24:25], v[24:25] op_sel:[0,0,1] op_sel_hi:[1,0,1]
    v_pk_fma_f32 v[218:219], v[218:219], v[24:25], v[24:25] op_sel:[0,0,1] op_sel_hi:[1,0,1]
    v_cvt_pk_bf16_f32 v160, v212, v213
    v_cvt_pk_bf16_f32 v161, v214, v215
    v_cvt_pk_bf16_f32 v162, v216, v217
    v_cvt_pk_bf16_f32 v163, v218, v219
    ds_write_b128 v17, v[160:163] offset:8192
    v_pk_fma_f32 v[220:221], v[220:221], v[24:25], v[24:25] op_sel:[0,0,1] op_sel_hi:[1,0,1]
    v_pk_fma_f32 v[222:223], v[222:223], v[24:25], v[24:25] op_sel:[0,0,1] op_sel_hi:[1,0,1]
    v_pk_fma_f32 v[224:225], v[224:225], v[24:25], v[24:25] op_sel:[0,0,1] op_sel_hi:[1,0,1]
    v_pk_fma_f32 v[226:227], v[226:227], v[24:25], v[24:25] op_sel:[0,0,1] op_sel_hi:[1,0,1]
    v_cvt_pk_bf16_f32 v164, v220, v221
    v_cvt_pk_bf16_f32 v165, v222, v223
    v_cvt_pk_bf16_f32 v166, v224, v225
    v_cvt_pk_bf16_f32 v167, v226, v227
    ds_write_b128 v17, v[164:167] offset:10240
    v_pk_fma_f32 v[228:229], v[228:229], v[24:25], v[24:25] op_sel:[0,0,1] op_sel_hi:[1,0,1]
    v_pk_fma_f32 v[230:231], v[230:231], v[24:25], v[24:25] op_sel:[0,0,1] op_sel_hi:[1,0,1]
    v_pk_fma_f32 v[232:233], v[232:233], v[24:25], v[24:25] op_sel:[0,0,1] op_sel_hi:[1,0,1]
    v_pk_fma_f32 v[234:235], v[234:235], v[24:25], v[24:25] op_sel:[0,0,1] op_sel_hi:[1,0,1]
    v_cvt_pk_bf16_f32 v168, v228, v229
    v_cvt_pk_bf16_f32 v169, v230, v231
    v_cvt_pk_bf16_f32 v170, v232, v233
    v_cvt_pk_bf16_f32 v171, v234, v235
    ds_write_b128 v17, v[168:171] offset:12288
    v_pk_fma_f32 v[236:237], v[236:237], v[24:25], v[24:25] op_sel:[0,0,1] op_sel_hi:[1,0,1]
    v_pk_fma_f32 v[238:239], v[238:239], v[24:25], v[24:25] op_sel:[0,0,1] op_sel_hi:[1,0,1]
    v_pk_fma_f32 v[240:241], v[240:241], v[24:25], v[24:25] op_sel:[0,0,1] op_sel_hi:[1,0,1]
    v_pk_fma_f32 v[242:243], v[242:243], v[24:25], v[24:25] op_sel:[0,0,1] op_sel_hi:[1,0,1]
    v_cvt_pk_bf16_f32 v172, v236, v237
    v_cvt_pk_bf16_f32 v173, v238, v239
    v_cvt_pk_bf16_f32 v174, v240, v241
    v_cvt_pk_bf16_f32 v175, v242, v243
    ds_write_b128 v17, v[172:175] offset:14336
    v_pk_fma_f32 v[244:245], v[244:245], v[24:25], v[24:25] op_sel:[0,0,1] op_sel_hi:[1,0,1]
    v_pk_fma_f32 v[246:247], v[246:247], v[24:25], v[24:25] op_sel:[0,0,1] op_sel_hi:[1,0,1]
    v_pk_fma_f32 v[248:249], v[248:249], v[24:25], v[24:25] op_sel:[0,0,1] op_sel_hi:[1,0,1]
    v_pk_fma_f32 v[250:251], v[250:251], v[24:25], v[24:25] op_sel:[0,0,1] op_sel_hi:[1,0,1]
    v_cvt_pk_bf16_f32 v176, v244, v245
    v_cvt_pk_bf16_f32 v177, v246, v247
    v_cvt_pk_bf16_f32 v178, v248, v249
    v_cvt_pk_bf16_f32 v179, v250, v251
    ds_write_b128 v17, v[176:179] offset:16384
    s_lshr_b32 s56, s54, 1
    s_mul_i32 s56, s56, 18432
    s_and_b32 s58, s54, 1
    s_lshl_b32 s59, s58, 10
    s_add_u32 s59, s59, s56
    s_lshl_b32 s84, s58, 12
    s_xor_b32 s85, s84, 4096
    s_lshl_b32 s58, s58, 6
    v_mov_b32 v252, 3222493025
    s_waitcnt vmcnt(12) lgkmcnt(0)
    s_barrier
    ds_read_b64_tr_b16 v[16:17], v1 offset:0
    ds_read_b64_tr_b16 v[18:19], v1 offset:512
    ds_read_b64_tr_b16 v[20:21], v1 offset:4096
    ds_read_b64_tr_b16 v[22:23], v1 offset:4608
    ds_read_b64_tr_b16 v[24:25], v1 offset:8192
    ds_read_b64_tr_b16 v[26:27], v1 offset:8704
    ds_read_b128 a[8:11], v10 offset:0
    ds_read_b128 a[24:27], v11 offset:1024
    ds_read_b128 a[40:43], v10 offset:2048
    s_waitcnt lgkmcnt(7)
    v_mfma_f32_16x16x32_bf16 v[72:75], v[16:19], a[0:3], 0
    s_waitcnt lgkmcnt(3)
    ds_read_b128 a[44:47], v10 offset:20480
    v_mfma_f32_16x16x32_bf16 v[72:75], v[20:23], a[16:19], v[72:75]
    s_lshl_b32 s81, s53, 4
    s_add_u32 s81, s81, s52
    ds_read_b128 a[28:31], v11 offset:19456
    v_mfma_f32_16x16x32_bf16 v[72:75], v[24:27], a[32:35], v[72:75]
    s_lshl_b32 s81, s81, 2
    s_add_u32 s81, s81, s54
    ds_read_b128 a[12:15], v10 offset:18432
    v_mfma_f32_16x16x32_bf16 v[76:79], v[24:27], a[36:39], 0
    buffer_load_dword v254, v253, s[16:19], s63 offen offset:128
    v_mfma_f32_16x16x32_bf16 v[76:79], v[20:23], a[20:23], v[76:79]
    s_mul_i32 s77, s81, 648
    ds_read_b64_tr_b16 v[28:29], v1 offset:12288
    ds_read_b64_tr_b16 v[30:31], v1 offset:12800
    v_mfma_f32_16x16x32_bf16 v[76:79], v[16:19], a[4:7], v[76:79]
    s_waitcnt lgkmcnt(5)
    s_mul_i32 s81, s81, 9
    ds_read_b64_tr_b16 v[32:33], v1 offset:16384
    v_mfma_f32_16x16x32_bf16 v[80:83], v[16:19], a[8:11], 0
    buffer_load_dword v254, v253, s[12:15], s64 offen
    v_mfma_f32_16x16x32_bf16 v[80:83], v[20:23], a[24:27], v[80:83]
    s_and_b32 s86, s54, 1
    ds_read_b64_tr_b16 v[34:35], v1 offset:16896
    ds_read_b64_tr_b16 v[36:37], v1 offset:20480
    v_mfma_f32_16x16x32_bf16 v[80:83], v[24:27], a[40:43], v[80:83]
    s_waitcnt lgkmcnt(5)
    ds_read_b64_tr_b16 v[38:39], v1 offset:20992
    v_min_u32 v190, 8, v0
    v_mfma_f32_16x16x32_bf16 v[84:87], v[24:27], a[44:47], 0
L_pg2:
    s_cbranch_execz L_pg6
    buffer_load_dword v254, v253, s[16:19], s64 offen
    v_mfma_f32_16x16x32_bf16 v[84:87], v[20:23], a[28:31], v[84:87]
    s_sub_u32 s0, s53, s0
    ds_read_b128 a[56:59], v11 offset:3072
    ds_read_b128 a[60:63], v11 offset:21504
    v_mfma_f32_16x16x32_bf16 v[84:87], v[16:19], a[12:15], v[84:87]
    s_waitcnt lgkmcnt(6)
    ds_read_b128 a[72:75], v10 offset:4096
    v_add_u32 v190, s81, v190
    v_mfma_f32_16x16x32_bf16 v[72:75], v[28:31], a[48:51], v[72:75]
    s_waitcnt lgkmcnt(5)
    ds_read_b64_tr_b16 v[16:17], v1 offset:24576
    v_lshrrev_b32 v191, 1, v190
    v_mfma_f32_16x16x32_bf16 v[72:75], v[32:35], a[64:67], v[72:75]
    s_waitcnt lgkmcnt(4)
    ds_read_b64_tr_b16 v[18:19], v1 offset:25088
    ds_read_b128 a[76:79], v10 offset:22528
    v_mfma_f32_16x16x32_bf16 v[72:75], v[36:39], a[80:83], v[72:75]
    buffer_load_dword v254, v253, s[12:15], s63 offen offset:256
    v_mfma_f32_16x16x32_bf16 v[76:79], v[36:39], a[84:87], v[76:79]
    s_lshr_b32 s81, s54, 1
    ds_read_b128 a[88:91], v11 offset:5120
    ds_read_b128 a[92:95], v11 offset:23552
    v_mfma_f32_16x16x32_bf16 v[76:79], v[32:35], a[68:71], v[76:79]
    s_lshl_b32 s81, s81, 12
    ds_read_b64_tr_b16 v[20:21], v1 offset:28672
    v_mul_u32_u24 v191, 896, v191
    v_mfma_f32_16x16x32_bf16 v[76:79], v[28:31], a[52:55], v[76:79]
    s_waitcnt lgkmcnt(7)
    ds_read_b64_tr_b16 v[22:23], v1 offset:29184
    v_lshl_add_u32 v14, v190, 7, v191
    v_mfma_f32_16x16x32_bf16 v[80:83], v[28:31], a[56:59], v[80:83]
    s_waitcnt lgkmcnt(4)
    ds_read_b64_tr_b16 v[24:25], v1 offset:32768
    ds_read_b128 a[104:107], v10 offset:6144
    v_mfma_f32_16x16x32_bf16 v[80:83], v[32:35], a[72:75], v[80:83]
    s_waitcnt lgkmcnt(4)
    ds_read_b64_tr_b16 v[26:27], v1 offset:33280
    ds_read_b128 a[108:111], v10 offset:24576
    v_mfma_f32_16x16x32_bf16 v[80:83], v[36:39], a[88:91], v[80:83]
    s_lshl_b32 s0, s0, 1
    ds_read_b128 a[120:123], v11 offset:7168
    v_min_u32 v190, 5, v0
    v_mfma_f32_16x16x32_bf16 v[84:87], v[36:39], a[92:95], v[84:87]
    s_add_u32 s0, s0, s86
    ds_read_b128 a[124:127], v11 offset:25600
    v_lshl_add_u32 v15, v190, 7, s77
    v_mfma_f32_16x16x32_bf16 v[84:87], v[32:35], a[76:79], v[84:87]
    s_and_b32 s77, s54, 1
    ds_read_b128 a[136:139], v10 offset:8192
    v_lshrrev_b32 v184, 3, v0
    v_mfma_f32_16x16x32_bf16 v[84:87], v[28:31], a[60:63], v[84:87]
    ds_read_b128 a[140:143], v10 offset:26624
    v_xor_b32 v185, v0, v184
    v_mfma_f32_16x16x32_bf16 v[72:75], v[16:19], a[96:99], v[72:75]
    s_waitcnt lgkmcnt(8)
    ds_read_b64_tr_b16 v[28:29], v2 offset:0
    v_and_b32 v185, 6, v185
    v_mfma_f32_16x16x32_bf16 v[72:75], v[20:23], a[112:115], v[72:75]
    s_waitcnt lgkmcnt(6)
    ds_read_b64_tr_b16 v[30:31], v2 offset:512
    v_and_or_b32 v185, v0, 1, v185
    v_mfma_f32_16x16x32_bf16 v[72:75], v[24:27], a[128:131], v[72:75]
    s_mul_i32 s3, s77, 4088
    ds_read_b64_tr_b16 v[32:33], v2 offset:4096
    v_lshl_add_u32 v184, s54, 3, v184
    v_mfma_f32_16x16x32_bf16 v[76:79], v[24:27], a[132:135], v[76:79]
    s_lshl_b32 s0, s0, 2
    ds_read_b64_tr_b16 v[34:35], v2 offset:4608
    ds_read_b128 a[152:155], v11 offset:9216
    v_mfma_f32_16x16x32_bf16 v[76:79], v[20:23], a[116:119], v[76:79]
    s_sub_u32 s78, s80, s78
    ds_read_b64_tr_b16 v[36:37], v2 offset:8192
    v_mul_u32_u24 v184, 1152, v184
    v_mfma_f32_16x16x32_bf16 v[76:79], v[16:19], a[100:103], v[76:79]
    s_waitcnt lgkmcnt(10)
    ds_read_b64_tr_b16 v[38:39], v2 offset:8704
    ds_read_b128 a[156:159], v11 offset:27648
    v_mfma_f32_16x16x32_bf16 v[80:83], v[16:19], a[104:107], v[80:83]
    s_waitcnt lgkmcnt(10)
    ds_read_b128 a[168:171], v10 offset:10240
    v_lshl_add_u32 v7, v185, 4, v184
    v_mfma_f32_16x16x32_bf16 v[80:83], v[20:23], a[120:123], v[80:83]
    s_waitcnt lgkmcnt(9)
    ds_read_b128 a[172:175], v10 offset:28672
    v_lshrrev_b32 v186, 2, v0
    v_mfma_f32_16x16x32_bf16 v[80:83], v[24:27], a[136:139], v[80:83]
    s_min_u32 s78, s78, 8
    ds_read_b128 a[184:187], v11 offset:11264
    v_lshrrev_b32 v187, 5, v0
    v_mfma_f32_16x16x32_bf16 v[84:87], v[24:27], a[140:143], v[84:87]
    s_lshl_b32 s78, s78, 1
    ds_read_b128 a[188:191], v11 offset:29696
    v_and_b32 v188, 3, v0
    v_mfma_f32_16x16x32_bf16 v[84:87], v[20:23], a[124:127], v[84:87]
    s_add_u32 s78, s78, s86
    ds_read_b128 a[200:203], v10 offset:12288
    v_lshlrev_b32 v187, 1, v187
    v_mfma_f32_16x16x32_bf16 v[84:87], v[16:19], a[108:111], v[84:87]
    s_waitcnt lgkmcnt(11)
    ds_read_b128 a[204:207], v10 offset:30720
    v_xor_b32 v187, v187, v188
    v_mfma_f32_16x16x32_bf16 v[88:91], v[28:31], a[0:3], 0
    s_waitcnt lgkmcnt(10)
    ds_read_b64_tr_b16 v[16:17], v2 offset:12288
    v_lshl_add_u32 v189, s77, 4, v186
    v_mfma_f32_16x16x32_bf16 v[88:91], v[32:35], a[16:19], v[88:91]
    s_waitcnt lgkmcnt(8)
    ds_read_b64_tr_b16 v[18:19], v2 offset:12800
    v_mul_u32_u24 v189, 9216, v189
    v_mfma_f32_16x16x32_bf16 v[88:91], v[36:39], a[32:35], v[88:91]
    s_lshl_b32 s71, s71, 8
    ds_read_b64_tr_b16 v[20:21], v2 offset:16384
    v_lshl_add_u32 v6, v187, 4, v189
    v_mfma_f32_16x16x32_bf16 v[92:95], v[36:39], a[36:39], 0
    s_lshl_b32 s86, s86, 15
    ds_read_b64_tr_b16 v[22:23], v2 offset:16896
    v_and_b32 v187, 12, v186
    v_mfma_f32_16x16x32_bf16 v[92:95], v[32:35], a[20:23], v[92:95]
    ds_read_b64_tr_b16 v[24:25], v2 offset:20480
    ds_read_b128 a[216:219], v11 offset:13312
    v_mfma_f32_16x16x32_bf16 v[92:95], v[28:31], a[4:7], v[92:95]
    ds_read_b64_tr_b16 v[26:27], v2 offset:20992
    ds_read_b128 a[220:223], v11 offset:31744
    v_mfma_f32_16x16x32_bf16 v[96:99], v[28:31], a[8:11], 0
    ds_read_b128 a[232:235], v10 offset:14336
    v_add_u32 v186, v186, v187
    v_mfma_f32_16x16x32_bf16 v[96:99], v[32:35], a[24:27], v[96:99]
    ds_read_b128 a[236:239], v10 offset:32768
    v_bfe_u32 v187, v0, 4, 1
    v_mfma_f32_16x16x32_bf16 v[96:99], v[36:39], a[40:43], v[96:99]
    ds_read_b128 a[248:251], v11 offset:15360
    v_xor_b32 v187, s77, v187
    v_mfma_f32_16x16x32_bf16 v[100:103], v[36:39], a[44:47], 0
    ds_read_b128 a[252:255], v11 offset:33792
    v_lshlrev_b32 v186, 6, v186
    v_mfma_f32_16x16x32_bf16 v[100:103], v[32:35], a[28:31], v[100:103]
    ds_read_b128 v[48:51], v10 offset:16384
    v_lshl_add_u32 v186, v188, 3, v186
    v_mfma_f32_16x16x32_bf16 v[100:103], v[28:31], a[12:15], v[100:103]
    s_waitcnt lgkmcnt(11)
    ds_read_b128 v[52:55], v10 offset:34816
    v_lshl_add_u32 v186, v187, 5, v186
    v_mfma_f32_16x16x32_bf16 v[88:91], v[16:19], a[48:51], v[88:91]
    s_waitcnt lgkmcnt(10)
    ds_read_b64_tr_b16 v[28:29], v2 offset:24576
    v_add_u32 v3, 0, v186
    v_mfma_f32_16x16x32_bf16 v[88:91], v[20:23], a[64:67], v[88:91]
    s_waitcnt lgkmcnt(8)
    ds_read_b64_tr_b16 v[30:31], v2 offset:25088
    v_lshl_add_u32 v9, v0, 4, s81
    v_mfma_f32_16x16x32_bf16 v[88:91], v[24:27], a[80:83], v[88:91]
    ds_read_b64_tr_b16 v[32:33], v2 offset:28672
    v_add_u32 v9, 110592, v9
    v_mfma_f32_16x16x32_bf16 v[92:95], v[24:27], a[84:87], v[92:95]
    ds_read_b64_tr_b16 v[34:35], v2 offset:29184
    v_lshl_add_u32 v8, s77, 3, v9
    v_mfma_f32_16x16x32_bf16 v[92:95], v[20:23], a[68:71], v[92:95]
    s_xor_b32 s77, s77, 1
    ds_read_b64_tr_b16 v[36:37], v2 offset:32768
    ds_read_b128 v[64:67], v11 offset:17408
    v_mfma_f32_16x16x32_bf16 v[92:95], v[16:19], a[52:55], v[92:95]
    s_lshl_b32 s77, s77, 12
    s_add_u32 s77, s77, s81
    ds_read_b64_tr_b16 v[38:39], v2 offset:33280
    v_mfma_f32_16x16x32_bf16 v[96:99], v[16:19], a[56:59], v[96:99]
    s_add_u32 s81, s81, s3
    v_add_u32 v1, 36864, v1
    v_add_u32 v2, 36864, v2
    v_mfma_f32_16x16x32_bf16 v[96:99], v[20:23], a[72:75], v[96:99]
    ds_read_b128 v[68:71], v11 offset:35840
    v_lshrrev_b32 v200, 5, v0
    v_mfma_f32_16x16x32_bf16 v[96:99], v[24:27], a[88:91], v[96:99]
    s_add_u32 s60, s63, 0
    v_and_b32 v201, 31, v0
    v_add_u32 v200, s0, v200
    v_mfma_f32_16x16x32_bf16 v[100:103], v[24:27], a[92:95], v[100:103]
    s_add_u32 m0, s55, 73728
    v_lshl_add_u32 v201, v201, 4, s1
    v_mul_u32_u24 v202, 57, v200
    v_mfma_f32_16x16x32_bf16 v[100:103], v[20:23], a[76:79], v[100:103]
    s_lshl_b32 s0, s52, 2
    v_lshrrev_b32 v202, 9, v202
    v_mul_u32_u24 v202, 290304, v202
    v_mfma_f32_16x16x32_bf16 v[100:103], v[16:19], a[60:63], v[100:103]
    s_waitcnt lgkmcnt(6)
    v_lshl_add_u32 v202, v200, 9, v202
    v_add_u32 v12, v201, v202
    v_mfma_f32_16x16x32_bf16 v[88:91], v[28:31], a[96:99], v[88:91]
    s_waitcnt lgkmcnt(4)
    v_add_u32 v200, 2, v200
    v_mul_u32_u24 v202, 57, v200
    v_mfma_f32_16x16x32_bf16 v[88:91], v[32:35], a[112:115], v[88:91]
    s_waitcnt vmcnt(7) lgkmcnt(0)
    s_barrier
    v_mfma_f32_16x16x32_bf16 v[88:91], v[36:39], a[128:131], v[88:91]
    buffer_load_dwordx4 v4, s[16:19], s60 offen  lds
    v_mfma_f32_16x16x32_bf16 v[92:95], v[36:39], a[132:135], v[92:95]
    s_add_u32 s60, s63, 294912
    ds_read_b64_tr_b16 v[16:17], v1 offset:0
    v_lshrrev_b32 v202, 9, v202
    v_mfma_f32_16x16x32_bf16 v[92:95], v[32:35], a[116:119], v[92:95]
    s_add_u32 m0, s55, 77824
    ds_read_b64_tr_b16 v[18:19], v1 offset:512
    v_mul_u32_u24 v202, 290304, v202
    v_mfma_f32_16x16x32_bf16 v[92:95], v[28:31], a[100:103], v[92:95]
    s_and_b32 s1, s54, 2
    ds_read_b64_tr_b16 v[20:21], v1 offset:4096
    v_lshl_add_u32 v202, v200, 9, v202
    v_mfma_f32_16x16x32_bf16 v[96:99], v[28:31], a[104:107], v[96:99]
    s_add_u32 s82, s0, s1
    ds_read_b64_tr_b16 v[22:23], v1 offset:4608
    v_add_u32 v13, v201, v202
    v_mfma_f32_16x16x32_bf16 v[96:99], v[32:35], a[120:123], v[96:99]
    buffer_load_dwordx4 v4, s[16:19], s60 offen  lds
    v_mfma_f32_16x16x32_bf16 v[96:99], v[36:39], a[136:139], v[96:99]
    s_add_u32 s60, s63, 589824
    ds_read_b64_tr_b16 v[24:25], v1 offset:8192
    ds_read_b64_tr_b16 v[26:27], v1 offset:8704
    v_mfma_f32_16x16x32_bf16 v[100:103], v[36:39], a[140:143], v[100:103]
    s_add_u32 m0, s55, 81920
    s_bfe_u32 s1, s53, 65537
    s_add_u32 s82, s82, s1
    v_mfma_f32_16x16x32_bf16 v[100:103], v[32:35], a[124:127], v[100:103]
    s_xor_b32 s72, s82, 1
    s_mul_i32 s68, s82, 4608
    s_mul_i32 s69, s72, 4608
    v_mfma_f32_16x16x32_bf16 v[100:103], v[28:31], a[108:111], v[100:103]
    s_waitcnt lgkmcnt(4)
    s_mul_i32 s70, s82, s71
    s_mul_i32 s71, s72, s71
    v_mfma_f32_16x16x32_bf16 v[72:75], v[16:19], a[144:147], v[72:75]
    s_waitcnt lgkmcnt(2)
    s_mul_i32 s82, s82, 589824
    ds_read_b64_tr_b16 v[28:29], v1 offset:12288
    v_mfma_f32_16x16x32_bf16 v[72:75], v[20:23], a[160:163], v[72:75]
    s_waitcnt lgkmcnt(1)
    s_mul_i32 s72, s72, 589824
    ds_read_b64_tr_b16 v[30:31], v1 offset:12800
    v_mfma_f32_16x16x32_bf16 v[72:75], v[24:27], a[176:179], v[72:75]
    buffer_load_dwordx4 v4, s[16:19], s60 offen  lds
    v_mfma_f32_16x16x32_bf16 v[76:79], v[24:27], a[180:183], v[76:79]
    s_add_u32 s60, s63, 884736
    s_lshl_b32 s1, s53, 10
    ds_read_b64_tr_b16 v[32:33], v1 offset:16384
    v_mfma_f32_16x16x32_bf16 v[76:79], v[20:23], a[164:167], v[76:79]
    s_add_u32 m0, s55, 86016
    s_add_u32 s1, s1, s86
    ds_read_b64_tr_b16 v[34:35], v1 offset:16896
    v_mfma_f32_16x16x32_bf16 v[76:79], v[16:19], a[148:151], v[76:79]
    buffer_load_dwordx4 v4, s[16:19], s60 offen  lds
    v_mfma_f32_16x16x32_bf16 v[80:83], v[16:19], a[152:155], v[80:83]
    s_add_u32 s60, s63, 1179648
    s_add_u32 s1, s1, 9961472
    ds_read_b64_tr_b16 v[36:37], v1 offset:20480
    v_mfma_f32_16x16x32_bf16 v[80:83], v[20:23], a[168:171], v[80:83]
    s_add_u32 m0, s55, 90112
    s_add_u32 s82, s82, s1
    ds_read_b64_tr_b16 v[38:39], v1 offset:20992
    v_mfma_f32_16x16x32_bf16 v[80:83], v[24:27], a[184:187], v[80:83]
    s_add_u32 s72, s72, s1
    s_add_u32 s0, s0, s54
    s_mul_i32 s0, s0, 1280
    v_mfma_f32_16x16x32_bf16 v[84:87], v[24:27], a[188:191], v[84:87]
    s_mul_i32 s1, s53, 163840
    s_add_u32 s0, s0, s1
    s_add_u32 s0, s0, 4718880
    v_mfma_f32_16x16x32_bf16 v[84:87], v[20:23], a[172:175], v[84:87]
    buffer_load_dwordx4 v4, s[16:19], s60 offen  lds
    v_mfma_f32_16x16x32_bf16 v[84:87], v[16:19], a[156:159], v[84:87]
    s_waitcnt lgkmcnt(4)
    v_bfe_u32 v203, v0, 2, 1
    v_and_b32 v204, 3, v0
    v_mfma_f32_16x16x32_bf16 v[84:87], v[28:31], a[204:207], v[84:87]
    s_waitcnt lgkmcnt(2)
    ds_read_b64_tr_b16 v[16:17], v1 offset:24576
    v_mul_u32_u24 v203, 81920, v203
    v_mfma_f32_16x16x32_bf16 v[84:87], v[32:35], a[220:223], v[84:87]
    s_waitcnt lgkmcnt(1)
    ds_read_b64_tr_b16 v[18:19], v1 offset:25088
    v_mul_u32_u24 v204, 320, v204
    v_mfma_f32_16x16x32_bf16 v[84:87], v[36:39], a[236:239], v[84:87]
    s_add_u32 s60, s63, 1474560
    ds_read_b64_tr_b16 v[20:21], v1 offset:28672
    v_lshrrev_b32 v205, 3, v0
    v_mfma_f32_16x16x32_bf16 v[80:83], v[36:39], a[232:235], v[80:83]
    s_add_u32 m0, s55, 94208
    ds_read_b64_tr_b16 v[22:23], v1 offset:29184
    v_add_u32 v203, v203, v204
    v_mfma_f32_16x16x32_bf16 v[80:83], v[32:35], a[216:219], v[80:83]
    buffer_load_dwordx4 v4, s[16:19], s60 offen  lds
    v_mfma_f32_16x16x32_bf16 v[80:83], v[28:31], a[200:203], v[80:83]
    s_add_u32 s60, s63, 1769472
    ds_read_b64_tr_b16 v[24:25], v1 offset:32768
    v_lshl_add_u32 v203, v205, 28, v203
    v_mfma_f32_16x16x32_bf16 v[76:79], v[28:31], a[196:199], v[76:79]
    s_add_u32 m0, s55, 98304
    ds_read_b64_tr_b16 v[26:27], v1 offset:33280
    v_mov_b32 v208, 0x3f803f80
    v_mfma_f32_16x16x32_bf16 v[76:79], v[32:35], a[212:215], v[76:79]
    s_lshl_b32 s1, s53, 3
    v_mov_b32 v209, 0x3f803f80
    v_mov_b32 v210, 0x3f803f80
    v_mfma_f32_16x16x32_bf16 v[76:79], v[36:39], a[228:231], v[76:79]
    buffer_load_dwordx4 v4, s[16:19], s60 offen  lds
    v_mfma_f32_16x16x32_bf16 v[72:75], v[36:39], a[224:227], v[72:75]
    s_add_u32 s60, s63, 2064384
    v_mov_b32 v211, 0x3f803f80
    v_mov_b32 v213, 0
    v_mfma_f32_16x16x32_bf16 v[72:75], v[32:35], a[208:211], v[72:75]
    s_add_u32 m0, s55, 102400
    v_mov_b32 v212, 0x7fff0000
    v_lshrrev_b32 v10, 3, v253
    v_mfma_f32_16x16x32_bf16 v[72:75], v[28:31], a[192:195], v[72:75]
    s_waitcnt lgkmcnt(4)
    v_lshl_add_u32 v10, v10, 1, v10
    v_mfma_f32_16x16x32_bf16 v[72:75], v[16:19], a[240:243], v[72:75]
    s_waitcnt lgkmcnt(2)
    ds_read_b64_tr_b16 v[28:29], v2 offset:24576
    v_mfma_f32_16x16x32_bf16 v[72:75], v[20:23], v[40:43], v[72:75]
    s_waitcnt lgkmcnt(1)
    ds_read_b64_tr_b16 v[30:31], v2 offset:25088
    v_mfma_f32_16x16x32_bf16 v[72:75], v[24:27], v[56:59], v[72:75]
    buffer_load_dwordx4 v4, s[16:19], s60 offen  lds
    v_mfma_f32_16x16x32_bf16 v[76:79], v[24:27], v[60:63], v[76:79]
    s_add_u32 s60, s63, 2359296
    ds_read_b64_tr_b16 v[32:33], v2 offset:28672
    v_mfma_f32_16x16x32_bf16 v[76:79], v[20:23], v[44:47], v[76:79]
    s_add_u32 m0, s55, 106496
    ds_read_b64_tr_b16 v[34:35], v2 offset:29184
    v_mfma_f32_16x16x32_bf16 v[76:79], v[16:19], a[244:247], v[76:79]
    ds_read_b64_tr_b16 v[36:37], v2 offset:32768
    v_mfma_f32_16x16x32_bf16 v[80:83], v[16:19], a[248:251], v[80:83]
    buffer_load_dwordx4 v4, s[16:19], s60 offen  lds
    v_mfma_f32_16x16x32_bf16 v[80:83], v[20:23], v[48:51], v[80:83]
    s_add_u32 s60, s63, 2654208
    ds_read_b64_tr_b16 v[38:39], v2 offset:33280
    v_mul_f32 v248, v72, v72
    v_mfma_f32_16x16x32_bf16 v[80:83], v[24:27], v[64:67], v[80:83]
    s_add_u32 m0, s55, 110592
    v_fma_f32 v248, v248, s79, v252
    v_mul_f32 v248, v248, v72
    v_mfma_f32_16x16x32_bf16 v[84:87], v[24:27], v[68:71], v[84:87]
    v_exp_f32 v248, v248
    v_mfma_f32_16x16x32_bf16 v[84:87], v[20:23], v[52:55], v[84:87]
    v_add_f32 v248, 1.0, v248
    v_mul_f32 v249, v73, v73
    v_mfma_f32_16x16x32_bf16 v[84:87], v[16:19], a[252:255], v[84:87]
    s_waitcnt lgkmcnt(4)
    v_rcp_f32 v248, v248
    v_mfma_f32_16x16x32_bf16 v[100:103], v[28:31], a[252:255], v[100:103]
    s_waitcnt lgkmcnt(2)
    ds_read_b64_tr_b16 v[16:17], v2 offset:12288
    v_mul_f32 v72, v72, v248
    v_mfma_f32_16x16x32_bf16 v[100:103], v[32:35], v[52:55], v[100:103]
    s_waitcnt lgkmcnt(1)
    ds_read_b64_tr_b16 v[18:19], v2 offset:12800
    v_fma_f32 v249, v249, s79, v252
    v_mfma_f32_16x16x32_bf16 v[100:103], v[36:39], v[68:71], v[100:103]
    buffer_load_dwordx4 v4, s[16:19], s60 offen  lds
    v_mfma_f32_16x16x32_bf16 v[96:99], v[36:39], v[64:67], v[96:99]
    s_add_u32 s60, s63, 2949120
    ds_read_b64_tr_b16 v[20:21], v2 offset:16384
    v_mul_f32 v249, v249, v73
    v_mfma_f32_16x16x32_bf16 v[96:99], v[32:35], v[48:51], v[96:99]
    s_add_u32 m0, s55, 114688
    ds_read_b64_tr_b16 v[22:23], v2 offset:16896
    v_mul_f32 v250, v74, v74
    v_mfma_f32_16x16x32_bf16 v[96:99], v[28:31], a[248:251], v[96:99]
    buffer_load_dwordx4 v4, s[16:19], s60 offen  lds
    v_mfma_f32_16x16x32_bf16 v[92:95], v[28:31], a[244:247], v[92:95]
    s_add_u32 s60, s63, 3244032
    ds_read_b64_tr_b16 v[24:25], v2 offset:20480
    v_fma_f32 v250, v250, s79, v252
    v_mfma_f32_16x16x32_bf16 v[92:95], v[32:35], v[44:47], v[92:95]
    s_add_u32 m0, s55, 118784
    ds_read_b64_tr_b16 v[26:27], v2 offset:20992
    v_mul_f32 v250, v250, v74
    v_mfma_f32_16x16x32_bf16 v[92:95], v[36:39], v[60:63], v[92:95]
    v_exp_f32 v249, v249
    v_mfma_f32_16x16x32_bf16 v[88:91], v[36:39], v[56:59], v[88:91]
    v_exp_f32 v250, v250
    v_mfma_f32_16x16x32_bf16 v[88:91], v[32:35], v[40:43], v[88:91]
    buffer_load_dwordx4 v4, s[16:19], s60 offen  lds
    v_mfma_f32_16x16x32_bf16 v[88:91], v[28:31], a[240:243], v[88:91]
    s_waitcnt lgkmcnt(4)
    v_add_f32 v249, 1.0, v249
    v_add_f32 v250, 1.0, v250
    v_mfma_f32_16x16x32_bf16 v[88:91], v[16:19], a[192:195], v[88:91]
    s_waitcnt lgkmcnt(2)
    ds_read_b64_tr_b16 v[28:29], v2 offset:0
    v_mul_f32 v251, v75, v75
    v_mfma_f32_16x16x32_bf16 v[88:91], v[20:23], a[208:211], v[88:91]
    s_waitcnt lgkmcnt(1)
    ds_read_b64_tr_b16 v[30:31], v2 offset:512
    v_fma_f32 v251, v251, s79, v252
    v_mfma_f32_16x16x32_bf16 v[88:91], v[24:27], a[224:227], v[88:91]
    s_add_u32 s60, s63, 3538944
    ds_read_b64_tr_b16 v[32:33], v2 offset:4096
    v_mul_f32 v251, v251, v75
    v_mfma_f32_16x16x32_bf16 v[92:95], v[24:27], a[228:231], v[92:95]
    s_add_u32 m0, s55, 122880
    ds_read_b64_tr_b16 v[34:35], v2 offset:4608
    v_mul_f32 v248, v76, v76
    v_mfma_f32_16x16x32_bf16 v[92:95], v[20:23], a[212:215], v[92:95]
    buffer_load_dwordx4 v4, s[16:19], s60 offen  lds
    v_mfma_f32_16x16x32_bf16 v[92:95], v[16:19], a[196:199], v[92:95]
    s_add_u32 s60, s63, 3833856
    ds_read_b64_tr_b16 v[36:37], v2 offset:8192
    v_fma_f32 v248, v248, s79, v252
    v_mfma_f32_16x16x32_bf16 v[96:99], v[16:19], a[200:203], v[96:99]
    s_add_u32 m0, s55, 126976
    ds_read_b64_tr_b16 v[38:39], v2 offset:8704
    v_mul_f32 v248, v248, v76
    v_mfma_f32_16x16x32_bf16 v[96:99], v[20:23], a[216:219], v[96:99]
    v_add_u32 v1, 36864, v1
    v_add_u32 v2, 36864, v2
    v_mfma_f32_16x16x32_bf16 v[96:99], v[24:27], a[232:235], v[96:99]
    v_rcp_f32 v249, v249
    v_mfma_f32_16x16x32_bf16 v[100:103], v[24:27], a[236:239], v[100:103]
    buffer_load_dwordx4 v4, s[16:19], s60 offen  lds
    v_mfma_f32_16x16x32_bf16 v[100:103], v[20:23], a[220:223], v[100:103]
    s_add_u32 s60, s63, 4128768
    v_rcp_f32 v250, v250
    v_mfma_f32_16x16x32_bf16 v[100:103], v[16:19], a[204:207], v[100:103]
    s_waitcnt lgkmcnt(4)
    v_exp_f32 v251, v251
    v_mfma_f32_16x16x32_bf16 v[100:103], v[28:31], a[156:159], v[100:103]
    s_waitcnt lgkmcnt(2)
    v_exp_f32 v248, v248
    v_mfma_f32_16x16x32_bf16 v[100:103], v[32:35], a[172:175], v[100:103]
    s_waitcnt vmcnt(5) lgkmcnt(0)
    s_barrier
    v_mfma_f32_16x16x32_bf16 v[100:103], v[36:39], a[188:191], v[100:103]
    s_add_u32 m0, s55, 131072
    ds_read_b64_tr_b16 v[16:17], v1 offset:0
    v_mul_f32 v73, v73, v249
    v_mfma_f32_16x16x32_bf16 v[96:99], v[36:39], a[184:187], v[96:99]
    buffer_load_dwordx4 v4, s[16:19], s60 offen  lds
    v_mfma_f32_16x16x32_bf16 v[96:99], v[32:35], a[168:171], v[96:99]
    s_add_u32 s60, s63, 4423680
    ds_read_b64_tr_b16 v[18:19], v1 offset:512
    v_mul_f32 v74, v74, v250
    v_mfma_f32_16x16x32_bf16 v[96:99], v[28:31], a[152:155], v[96:99]
    s_add_u32 m0, s55, 135168
    ds_read_b64_tr_b16 v[20:21], v1 offset:4096
    v_add_f32 v251, 1.0, v251
    v_mfma_f32_16x16x32_bf16 v[92:95], v[28:31], a[148:151], v[92:95]
    ds_read_b64_tr_b16 v[22:23], v1 offset:4608
    v_add_f32 v248, 1.0, v248
    v_mfma_f32_16x16x32_bf16 v[92:95], v[32:35], a[164:167], v[92:95]
    ds_read_b64_tr_b16 v[24:25], v1 offset:8192
    v_mul_f32 v249, v77, v77
    v_mfma_f32_16x16x32_bf16 v[92:95], v[36:39], a[180:183], v[92:95]
    buffer_load_dwordx4 v4, s[16:19], s60 offen  lds
    v_mfma_f32_16x16x32_bf16 v[88:91], v[36:39], a[176:179], v[88:91]
    s_add_u32 s60, s63, 4718592
    ds_read_b64_tr_b16 v[26:27], v1 offset:8704
    v_fma_f32 v249, v249, s79, v252
    v_mfma_f32_16x16x32_bf16 v[88:91], v[32:35], a[160:163], v[88:91]
    s_add_u32 m0, s55, 139264
    v_rcp_f32 v251, v251
    v_mfma_f32_16x16x32_bf16 v[88:91], v[28:31], a[144:147], v[88:91]
    s_waitcnt lgkmcnt(4)
    v_rcp_f32 v248, v248
    v_mfma_f32_16x16x32_bf16 v[104:107], v[16:19], a[0:3], 0
    s_waitcnt lgkmcnt(2)
    ds_read_b64_tr_b16 v[28:29], v1 offset:12288
    v_mul_f32 v75, v75, v251
    v_mfma_f32_16x16x32_bf16 v[104:107], v[20:23], a[16:19], v[104:107]
    s_waitcnt lgkmcnt(1)
    ds_read_b64_tr_b16 v[30:31], v1 offset:12800
    v_mul_f32 v76, v76, v248
    v_mfma_f32_16x16x32_bf16 v[104:107], v[24:27], a[32:35], v[104:107]
    buffer_load_dwordx4 v4, s[16:19], s60 offen  lds
    v_mfma_f32_16x16x32_bf16 v[108:111], v[24:27], a[36:39], 0
    s_add_u32 s60, s63, 5013504
    ds_read_b64_tr_b16 v[32:33], v1 offset:16384
    v_mul_f32 v249, v249, v77
    v_mfma_f32_16x16x32_bf16 v[108:111], v[20:23], a[20:23], v[108:111]
    s_add_u32 m0, s55, 143360
    ds_read_b64_tr_b16 v[34:35], v1 offset:16896
    v_mul_f32 v250, v78, v78
    v_mfma_f32_16x16x32_bf16 v[108:111], v[16:19], a[4:7], v[108:111]
    ds_read_b64_tr_b16 v[36:37], v1 offset:20480
    v_fma_f32 v250, v250, s79, v252
    v_mfma_f32_16x16x32_bf16 v[112:115], v[16:19], a[8:11], 0
    ds_read_b64_tr_b16 v[38:39], v1 offset:20992
    v_mul_f32 v250, v250, v78
    v_mfma_f32_16x16x32_bf16 v[112:115], v[20:23], a[24:27], v[112:115]
    buffer_load_dwordx4 v4, s[16:19], s60 offen  lds
    v_mfma_f32_16x16x32_bf16 v[112:115], v[24:27], a[40:43], v[112:115]
    s_add_u32 s60, s63, 128
    v_exp_f32 v249, v249
    v_mfma_f32_16x16x32_bf16 v[116:119], v[24:27], a[44:47], 0
    s_add_u32 m0, s55, 0
    v_exp_f32 v250, v250
    v_mfma_f32_16x16x32_bf16 v[116:119], v[20:23], a[28:31], v[116:119]
    v_add_f32 v249, 1.0, v249
    v_add_f32 v250, 1.0, v250
    v_mfma_f32_16x16x32_bf16 v[116:119], v[16:19], a[12:15], v[116:119]
    s_waitcnt lgkmcnt(4)
    v_rcp_f32 v249, v249
    v_mfma_f32_16x16x32_bf16 v[116:119], v[28:31], a[60:63], v[116:119]
    s_waitcnt lgkmcnt(2)
    ds_read_b64_tr_b16 v[16:17], v1 offset:24576
    v_mul_f32 v77, v77, v249
    v_mfma_f32_16x16x32_bf16 v[116:119], v[32:35], a[76:79], v[116:119]
    s_waitcnt lgkmcnt(1)
    ds_read_b64_tr_b16 v[18:19], v1 offset:25088
    v_mul_f32 v251, v79, v79
    v_mfma_f32_16x16x32_bf16 v[116:119], v[36:39], a[92:95], v[116:119]
    buffer_load_dwordx4 v4, s[12:15], s60 offen  lds
    v_mfma_f32_16x16x32_bf16 v[112:115], v[36:39], a[88:91], v[112:115]
    s_add_u32 s60, s63, 295040
    ds_read_b64_tr_b16 v[20:21], v1 offset:28672
    v_fma_f32 v251, v251, s79, v252
    v_mfma_f32_16x16x32_bf16 v[112:115], v[32:35], a[72:75], v[112:115]
    s_add_u32 m0, s55, 4096
    ds_read_b64_tr_b16 v[22:23], v1 offset:29184
    v_mul_f32 v251, v251, v79
    v_mfma_f32_16x16x32_bf16 v[112:115], v[28:31], a[56:59], v[112:115]
    ds_read_b64_tr_b16 v[24:25], v1 offset:32768
    v_mul_f32 v248, v80, v80
    v_mfma_f32_16x16x32_bf16 v[108:111], v[28:31], a[52:55], v[108:111]
    buffer_load_dwordx4 v4, s[12:15], s60 offen  lds
    v_mfma_f32_16x16x32_bf16 v[108:111], v[32:35], a[68:71], v[108:111]
    s_add_u32 s60, s63, 589952
    ds_read_b64_tr_b16 v[26:27], v1 offset:33280
    v_fma_f32 v248, v248, s79, v252
    v_mfma_f32_16x16x32_bf16 v[108:111], v[36:39], a[84:87], v[108:111]
    s_add_u32 m0, s55, 8192
    v_rcp_f32 v250, v250
    v_mfma_f32_16x16x32_bf16 v[104:107], v[36:39], a[80:83], v[104:107]
    v_exp_f32 v251, v251
    v_mfma_f32_16x16x32_bf16 v[104:107], v[32:35], a[64:67], v[104:107]
    v_mul_f32 v78, v78, v250
    v_add_f32 v251, 1.0, v251
    v_mfma_f32_16x16x32_bf16 v[104:107], v[28:31], a[48:51], v[104:107]
    s_waitcnt lgkmcnt(4)
    v_rcp_f32 v251, v251
    v_mfma_f32_16x16x32_bf16 v[104:107], v[16:19], a[96:99], v[104:107]
    s_waitcnt lgkmcnt(2)
    ds_read_b64_tr_b16 v[28:29], v2 offset:24576
    v_mul_f32 v79, v79, v251
    v_mfma_f32_16x16x32_bf16 v[104:107], v[20:23], a[112:115], v[104:107]
    s_waitcnt lgkmcnt(1)
    ds_read_b64_tr_b16 v[30:31], v2 offset:25088
    v_mul_f32 v248, v248, v80
    v_mfma_f32_16x16x32_bf16 v[104:107], v[24:27], a[128:131], v[104:107]
    buffer_load_dwordx4 v4, s[12:15], s60 offen  lds
    v_mfma_f32_16x16x32_bf16 v[108:111], v[24:27], a[132:135], v[108:111]
    s_add_u32 s60, s63, 884864
    ds_read_b64_tr_b16 v[32:33], v2 offset:28672
    v_mul_f32 v249, v81, v81
    v_mfma_f32_16x16x32_bf16 v[108:111], v[20:23], a[116:119], v[108:111]
    s_add_u32 m0, s55, 12288
    ds_read_b64_tr_b16 v[34:35], v2 offset:29184
    v_fma_f32 v249, v249, s79, v252
    v_mfma_f32_16x16x32_bf16 v[108:111], v[16:19], a[100:103], v[108:111]
    buffer_load_dwordx4 v4, s[12:15], s60 offen  lds
    v_mfma_f32_16x16x32_bf16 v[112:115], v[16:19], a[104:107], v[112:115]
    s_add_u32 s60, s63, 1179776
    ds_read_b64_tr_b16 v[36:37], v2 offset:32768
    v_mul_f32 v249, v249, v81
    v_mfma_f32_16x16x32_bf16 v[112:115], v[20:23], a[120:123], v[112:115]
    s_add_u32 m0, s55, 16384
    ds_read_b64_tr_b16 v[38:39], v2 offset:33280
    v_mul_f32 v250, v82, v82
    v_mfma_f32_16x16x32_bf16 v[112:115], v[24:27], a[136:139], v[112:115]
    v_exp_f32 v248, v248
    v_mfma_f32_16x16x32_bf16 v[116:119], v[24:27], a[140:143], v[116:119]
    v_exp_f32 v249, v249
    v_mfma_f32_16x16x32_bf16 v[116:119], v[20:23], a[124:127], v[116:119]
    buffer_load_dwordx4 v4, s[12:15], s60 offen  lds
    v_mfma_f32_16x16x32_bf16 v[116:119], v[16:19], a[108:111], v[116:119]
    s_waitcnt lgkmcnt(4)
    v_add_f32 v248, 1.0, v248
    v_add_f32 v249, 1.0, v249
    v_mfma_f32_16x16x32_bf16 v[132:135], v[28:31], a[108:111], 0
    s_waitcnt lgkmcnt(2)
    ds_read_b64_tr_b16 v[16:17], v2 offset:12288
    v_fma_f32 v250, v250, s79, v252
    v_mfma_f32_16x16x32_bf16 v[132:135], v[32:35], a[124:127], v[132:135]
    s_waitcnt lgkmcnt(1)
    ds_read_b64_tr_b16 v[18:19], v2 offset:12800
    v_mul_f32 v250, v250, v82
    v_mfma_f32_16x16x32_bf16 v[132:135], v[36:39], a[140:143], v[132:135]
    s_add_u32 s60, s63, 1474688
    ds_read_b64_tr_b16 v[20:21], v2 offset:16384
    v_mul_f32 v251, v83, v83
    v_mfma_f32_16x16x32_bf16 v[128:131], v[36:39], a[136:139], 0
    s_add_u32 m0, s55, 20480
    ds_read_b64_tr_b16 v[22:23], v2 offset:16896
    v_fma_f32 v251, v251, s79, v252
    v_mfma_f32_16x16x32_bf16 v[128:131], v[32:35], a[120:123], v[128:131]
    buffer_load_dwordx4 v4, s[12:15], s60 offen  lds
    v_mfma_f32_16x16x32_bf16 v[128:131], v[28:31], a[104:107], v[128:131]
    s_add_u32 s60, s63, 1769600
L_pg3:
    s_cbranch_execz L_pg7
    ds_read_b64_tr_b16 v[24:25], v2 offset:20480
    v_mul_f32 v251, v251, v83
    v_mfma_f32_16x16x32_bf16 v[124:127], v[28:31], a[100:103], 0
    s_add_u32 m0, s55, 24576
    ds_read_b64_tr_b16 v[26:27], v2 offset:20992
    v_mfma_f32_16x16x32_bf16 v[124:127], v[32:35], a[116:119], v[124:127]
    v_rcp_f32 v248, v248
    v_mfma_f32_16x16x32_bf16 v[124:127], v[36:39], a[132:135], v[124:127]
    v_rcp_f32 v249, v249
    v_mfma_f32_16x16x32_bf16 v[120:123], v[36:39], a[128:131], 0
    buffer_load_dwordx4 v4, s[12:15], s60 offen  lds
    v_mfma_f32_16x16x32_bf16 v[120:123], v[32:35], a[112:115], v[120:123]
    s_add_u32 s60, s63, 2064512
    v_exp_f32 v250, v250
    v_mfma_f32_16x16x32_bf16 v[120:123], v[28:31], a[96:99], v[120:123]
    s_waitcnt lgkmcnt(4)
    v_exp_f32 v251, v251
    v_mfma_f32_16x16x32_bf16 v[120:123], v[16:19], a[48:51], v[120:123]
    s_waitcnt lgkmcnt(2)
    ds_read_b64_tr_b16 v[28:29], v2 offset:0
    v_mul_f32 v80, v80, v248
    v_mfma_f32_16x16x32_bf16 v[120:123], v[20:23], a[64:67], v[120:123]
    s_waitcnt lgkmcnt(1)
    ds_read_b64_tr_b16 v[30:31], v2 offset:512
    v_mul_f32 v81, v81, v249
    v_mfma_f32_16x16x32_bf16 v[120:123], v[24:27], a[80:83], v[120:123]
    s_add_u32 m0, s55, 28672
    ds_read_b64_tr_b16 v[32:33], v2 offset:4096
    v_add_f32 v250, 1.0, v250
    v_mfma_f32_16x16x32_bf16 v[124:127], v[24:27], a[84:87], v[124:127]
    buffer_load_dwordx4 v4, s[12:15], s60 offen  lds
    v_mfma_f32_16x16x32_bf16 v[124:127], v[20:23], a[68:71], v[124:127]
    s_add_u32 s60, s63, 2359424
    ds_read_b64_tr_b16 v[34:35], v2 offset:4608
    v_add_f32 v251, 1.0, v251
    v_mfma_f32_16x16x32_bf16 v[124:127], v[16:19], a[52:55], v[124:127]
    s_add_u32 m0, s55, 32768
    ds_read_b64_tr_b16 v[36:37], v2 offset:8192
    v_mul_f32 v248, v84, v84
    v_mfma_f32_16x16x32_bf16 v[128:131], v[16:19], a[56:59], v[128:131]
    ds_read_b64_tr_b16 v[38:39], v2 offset:8704
    v_fma_f32 v248, v248, s79, v252
    v_mfma_f32_16x16x32_bf16 v[128:131], v[20:23], a[72:75], v[128:131]
    v_add_u32 v1, 36864, v1
    v_add_u32 v2, 36864, v2
    v_mfma_f32_16x16x32_bf16 v[128:131], v[24:27], a[88:91], v[128:131]
    buffer_load_dwordx4 v4, s[12:15], s60 offen  lds
    v_mfma_f32_16x16x32_bf16 v[132:135], v[24:27], a[92:95], v[132:135]
    s_add_u32 s60, s63, 2654336
    v_rcp_f32 v250, v250
    v_mfma_f32_16x16x32_bf16 v[132:135], v[20:23], a[76:79], v[132:135]
    s_add_u32 m0, s55, 36864
    v_rcp_f32 v251, v251
    v_mfma_f32_16x16x32_bf16 v[132:135], v[16:19], a[60:63], v[132:135]
    s_waitcnt lgkmcnt(4)
    v_mul_f32 v82, v82, v250
    v_mul_f32 v83, v83, v251
    v_mfma_f32_16x16x32_bf16 v[132:135], v[28:31], a[12:15], v[132:135]
    s_waitcnt lgkmcnt(2)
    v_mul_f32 v248, v248, v84
    v_mul_f32 v249, v85, v85
    v_mfma_f32_16x16x32_bf16 v[132:135], v[32:35], a[28:31], v[132:135]
    s_waitcnt vmcnt(9) lgkmcnt(0)
    s_barrier
    v_mfma_f32_16x16x32_bf16 v[132:135], v[36:39], a[44:47], v[132:135]
    buffer_load_dwordx4 v4, s[12:15], s60 offen  lds
    v_mfma_f32_16x16x32_bf16 v[128:131], v[36:39], a[40:43], v[128:131]
    s_add_u32 s60, s63, 2949248
    ds_read_b64_tr_b16 v[16:17], v1 offset:0
    v_fma_f32 v249, v249, s79, v252
    v_mfma_f32_16x16x32_bf16 v[128:131], v[32:35], a[24:27], v[128:131]
    s_add_u32 m0, s55, 40960
    ds_read_b64_tr_b16 v[18:19], v1 offset:512
    v_mul_f32 v249, v249, v85
    v_mfma_f32_16x16x32_bf16 v[128:131], v[28:31], a[8:11], v[128:131]
    ds_read_b64_tr_b16 v[20:21], v1 offset:4096
    v_mul_f32 v250, v86, v86
    v_mfma_f32_16x16x32_bf16 v[124:127], v[28:31], a[4:7], v[124:127]
    ds_read_b64_tr_b16 v[22:23], v1 offset:4608
    v_fma_f32 v250, v250, s79, v252
    v_mfma_f32_16x16x32_bf16 v[124:127], v[32:35], a[20:23], v[124:127]
    buffer_load_dwordx4 v4, s[12:15], s60 offen  lds
    v_mfma_f32_16x16x32_bf16 v[124:127], v[36:39], a[36:39], v[124:127]
    s_add_u32 s60, s63, 3244160
    ds_read_b64_tr_b16 v[24:25], v1 offset:8192
    ds_read_b64_tr_b16 v[26:27], v1 offset:8704
    v_mfma_f32_16x16x32_bf16 v[120:123], v[36:39], a[32:35], v[120:123]
    s_add_u32 m0, s55, 45056
    v_exp_f32 v248, v248
    v_mfma_f32_16x16x32_bf16 v[120:123], v[32:35], a[16:19], v[120:123]
    v_exp_f32 v249, v249
    v_mfma_f32_16x16x32_bf16 v[120:123], v[28:31], a[0:3], v[120:123]
    s_waitcnt lgkmcnt(4)
    v_add_f32 v248, 1.0, v248
    v_add_f32 v249, 1.0, v249
    v_mfma_f32_16x16x32_bf16 v[104:107], v[16:19], a[144:147], v[104:107]
    s_waitcnt lgkmcnt(2)
    ds_read_b64_tr_b16 v[28:29], v1 offset:12288
    v_mul_f32 v250, v250, v86
    v_mfma_f32_16x16x32_bf16 v[104:107], v[20:23], a[160:163], v[104:107]
    s_waitcnt lgkmcnt(1)
    ds_read_b64_tr_b16 v[30:31], v1 offset:12800
    v_mul_f32 v251, v87, v87
    v_mfma_f32_16x16x32_bf16 v[104:107], v[24:27], a[176:179], v[104:107]
    buffer_load_dwordx4 v4, s[12:15], s60 offen  lds
    v_mfma_f32_16x16x32_bf16 v[108:111], v[24:27], a[180:183], v[108:111]
    s_add_u32 s60, s63, 3539072
    ds_read_b64_tr_b16 v[32:33], v1 offset:16384
    v_fma_f32 v251, v251, s79, v252
    v_mfma_f32_16x16x32_bf16 v[108:111], v[20:23], a[164:167], v[108:111]
    s_add_u32 m0, s55, 49152
    ds_read_b64_tr_b16 v[34:35], v1 offset:16896
    v_mul_f32 v251, v251, v87
    v_mfma_f32_16x16x32_bf16 v[108:111], v[16:19], a[148:151], v[108:111]
    ds_read_b64_tr_b16 v[36:37], v1 offset:20480
    v_mfma_f32_16x16x32_bf16 v[112:115], v[16:19], a[152:155], v[112:115]
    buffer_load_dwordx4 v4, s[12:15], s60 offen  lds
    v_mfma_f32_16x16x32_bf16 v[112:115], v[20:23], a[168:171], v[112:115]
    s_add_u32 s60, s63, 3833984
    ds_read_b64_tr_b16 v[38:39], v1 offset:20992
    v_mfma_f32_16x16x32_bf16 v[112:115], v[24:27], a[184:187], v[112:115]
    s_add_u32 m0, s55, 53248
    v_rcp_f32 v248, v248
    v_mfma_f32_16x16x32_bf16 v[116:119], v[24:27], a[188:191], v[116:119]
    v_rcp_f32 v249, v249
    v_mfma_f32_16x16x32_bf16 v[116:119], v[20:23], a[172:175], v[116:119]
    v_exp_f32 v250, v250
    v_mfma_f32_16x16x32_bf16 v[116:119], v[16:19], a[156:159], v[116:119]
    s_waitcnt lgkmcnt(4)
    v_exp_f32 v251, v251
    v_mfma_f32_16x16x32_bf16 v[116:119], v[28:31], a[204:207], v[116:119]
    s_waitcnt lgkmcnt(2)
    ds_read_b64_tr_b16 v[16:17], v1 offset:24576
    v_mul_f32 v84, v84, v248
    v_mfma_f32_16x16x32_bf16 v[116:119], v[32:35], a[220:223], v[116:119]
    s_waitcnt lgkmcnt(1)
    ds_read_b64_tr_b16 v[18:19], v1 offset:25088
    v_mul_f32 v85, v85, v249
    v_mfma_f32_16x16x32_bf16 v[116:119], v[36:39], a[236:239], v[116:119]
    buffer_load_dwordx4 v4, s[12:15], s60 offen  lds
    v_mfma_f32_16x16x32_bf16 v[112:115], v[36:39], a[232:235], v[112:115]
    s_add_u32 s60, s63, 4128896
    ds_read_b64_tr_b16 v[20:21], v1 offset:28672
    v_add_f32 v250, 1.0, v250
    v_mfma_f32_16x16x32_bf16 v[112:115], v[32:35], a[216:219], v[112:115]
    s_add_u32 m0, s55, 57344
    ds_read_b64_tr_b16 v[22:23], v1 offset:29184
    v_add_f32 v251, 1.0, v251
    v_mfma_f32_16x16x32_bf16 v[112:115], v[28:31], a[200:203], v[112:115]
    buffer_load_dwordx4 v4, s[12:15], s60 offen  lds
    v_mfma_f32_16x16x32_bf16 v[108:111], v[28:31], a[196:199], v[108:111]
    s_add_u32 s60, s63, 4423808
    ds_read_b64_tr_b16 v[24:25], v1 offset:32768
    v_mul_f32 v248, v100, v100
    v_mfma_f32_16x16x32_bf16 v[108:111], v[32:35], a[212:215], v[108:111]
    s_add_u32 m0, s55, 61440
    ds_read_b64_tr_b16 v[26:27], v1 offset:33280
    v_fma_f32 v248, v248, s79, v252
    v_mfma_f32_16x16x32_bf16 v[108:111], v[36:39], a[228:231], v[108:111]
    v_rcp_f32 v250, v250
    v_mfma_f32_16x16x32_bf16 v[104:107], v[36:39], a[224:227], v[104:107]
    v_rcp_f32 v251, v251
    v_mfma_f32_16x16x32_bf16 v[104:107], v[32:35], a[208:211], v[104:107]
    v_mul_f32 v86, v86, v250
    v_mul_f32 v87, v87, v251
    v_mfma_f32_16x16x32_bf16 v[104:107], v[28:31], a[192:195], v[104:107]
    s_waitcnt lgkmcnt(4)
    v_mul_f32 v248, v248, v100
    v_mul_f32 v249, v101, v101
    v_mfma_f32_16x16x32_bf16 v[104:107], v[16:19], a[240:243], v[104:107]
    s_waitcnt lgkmcnt(2)
    ds_read_b64_tr_b16 v[28:29], v2 offset:24576
    v_fma_f32 v249, v249, s79, v252
    v_mfma_f32_16x16x32_bf16 v[104:107], v[20:23], v[40:43], v[104:107]
    s_waitcnt lgkmcnt(1)
    ds_read_b64_tr_b16 v[30:31], v2 offset:25088
    v_mul_f32 v249, v249, v101
    v_mfma_f32_16x16x32_bf16 v[104:107], v[24:27], v[56:59], v[104:107]
    buffer_load_dwordx4 v4, s[12:15], s60 offen  lds
    v_mfma_f32_16x16x32_bf16 v[108:111], v[24:27], v[60:63], v[108:111]
    s_add_u32 s60, s63, 4718720
    ds_read_b64_tr_b16 v[32:33], v2 offset:28672
    v_mul_f32 v250, v102, v102
    v_mfma_f32_16x16x32_bf16 v[108:111], v[20:23], v[44:47], v[108:111]
    s_add_u32 m0, s55, 65536
    ds_read_b64_tr_b16 v[34:35], v2 offset:29184
    v_fma_f32 v250, v250, s79, v252
    v_mfma_f32_16x16x32_bf16 v[108:111], v[16:19], a[244:247], v[108:111]
    buffer_load_dwordx4 v4, s[12:15], s60 offen  lds
    v_mfma_f32_16x16x32_bf16 v[112:115], v[16:19], a[248:251], v[112:115]
    s_add_u32 s60, s63, 5013632
    ds_read_b64_tr_b16 v[36:37], v2 offset:32768
    v_mul_f32 v104, v104, v72
    v_mfma_f32_16x16x32_bf16 v[112:115], v[20:23], v[48:51], v[112:115]
    s_add_u32 m0, s55, 69632
    ds_read_b64_tr_b16 v[38:39], v2 offset:33280
    v_mul_f32 v105, v105, v73
    v_mfma_f32_16x16x32_bf16 v[112:115], v[24:27], v[64:67], v[112:115]
    v_exp_f32 v248, v248
    v_mfma_f32_16x16x32_bf16 v[116:119], v[24:27], v[68:71], v[116:119]
    v_exp_f32 v249, v249
    v_mfma_f32_16x16x32_bf16 v[116:119], v[20:23], v[52:55], v[116:119]
    buffer_load_dwordx4 v4, s[12:15], s60 offen  lds
    v_mfma_f32_16x16x32_bf16 v[116:119], v[16:19], a[252:255], v[116:119]
    s_waitcnt lgkmcnt(4)
    v_mul_f32 v106, v106, v74
    v_mul_f32 v107, v107, v75
    v_mfma_f32_16x16x32_bf16 v[132:135], v[28:31], a[252:255], v[132:135]
    s_waitcnt lgkmcnt(2)
    ds_read_b64_tr_b16 v[16:17], v2 offset:12288
    v_mul_f32 v108, v108, v76
    v_mfma_f32_16x16x32_bf16 v[132:135], v[32:35], v[52:55], v[132:135]
    s_waitcnt lgkmcnt(1)
    ds_read_b64_tr_b16 v[18:19], v2 offset:12800
    v_mul_f32 v109, v109, v77
    v_mfma_f32_16x16x32_bf16 v[132:135], v[36:39], v[68:71], v[132:135]
    s_add_u32 s60, s63, 128
    ds_read_b64_tr_b16 v[20:21], v2 offset:16384
    v_mul_f32 v110, v110, v78
    v_mfma_f32_16x16x32_bf16 v[128:131], v[36:39], v[64:67], v[128:131]
    s_add_u32 m0, s55, 73728
    ds_read_b64_tr_b16 v[22:23], v2 offset:16896
    v_mul_f32 v111, v111, v79
    v_mfma_f32_16x16x32_bf16 v[128:131], v[32:35], v[48:51], v[128:131]
    buffer_load_dwordx4 v4, s[16:19], s60 offen  lds
    v_mfma_f32_16x16x32_bf16 v[128:131], v[28:31], a[248:251], v[128:131]
    s_add_u32 s60, s63, 295040
    ds_read_b64_tr_b16 v[24:25], v2 offset:20480
    v_mul_f32 v112, v112, v80
    v_mfma_f32_16x16x32_bf16 v[124:127], v[28:31], a[244:247], v[124:127]
    s_add_u32 m0, s55, 77824
    ds_read_b64_tr_b16 v[26:27], v2 offset:20992
    v_mul_f32 v113, v113, v81
    v_mfma_f32_16x16x32_bf16 v[124:127], v[32:35], v[44:47], v[124:127]
    v_mul_f32 v114, v114, v82
    v_mul_f32 v115, v115, v83
    v_mfma_f32_16x16x32_bf16 v[124:127], v[36:39], v[60:63], v[124:127]
    v_mul_f32 v116, v116, v84
    v_mul_f32 v117, v117, v85
    v_mfma_f32_16x16x32_bf16 v[120:123], v[36:39], v[56:59], v[120:123]
    buffer_load_dwordx4 v4, s[16:19], s60 offen  lds
    v_mfma_f32_16x16x32_bf16 v[120:123], v[32:35], v[40:43], v[120:123]
    s_add_u32 s60, s63, 589952
    v_mul_f32 v118, v118, v86
    v_mul_f32 v119, v119, v87
    v_mfma_f32_16x16x32_bf16 v[120:123], v[28:31], a[240:243], v[120:123]
    s_waitcnt lgkmcnt(4)
    v_cvt_pk_bf16_f32 v168, v104, v105
    v_cvt_pk_bf16_f32 v169, v106, v107
    v_mfma_f32_16x16x32_bf16 v[120:123], v[16:19], a[192:195], v[120:123]
    s_waitcnt lgkmcnt(2)
    ds_read_b64_tr_b16 v[28:29], v2 offset:0
    v_cvt_pk_bf16_f32 v172, v108, v109
    v_mfma_f32_16x16x32_bf16 v[120:123], v[20:23], a[208:211], v[120:123]
    s_waitcnt lgkmcnt(1)
    ds_read_b64_tr_b16 v[30:31], v2 offset:512
    v_cvt_pk_bf16_f32 v173, v110, v111
    v_mfma_f32_16x16x32_bf16 v[120:123], v[24:27], a[224:227], v[120:123]
    s_add_u32 m0, s55, 81920
    ds_read_b64_tr_b16 v[32:33], v2 offset:4096
    v_cvt_pk_bf16_f32 v176, v112, v113
    v_mfma_f32_16x16x32_bf16 v[124:127], v[24:27], a[228:231], v[124:127]
    buffer_load_dwordx4 v4, s[16:19], s60 offen  lds
    v_mfma_f32_16x16x32_bf16 v[124:127], v[20:23], a[212:215], v[124:127]
    s_add_u32 s60, s63, 884864
    ds_read_b64_tr_b16 v[34:35], v2 offset:4608
    v_cvt_pk_bf16_f32 v177, v114, v115
    v_mfma_f32_16x16x32_bf16 v[124:127], v[16:19], a[196:199], v[124:127]
    s_add_u32 m0, s55, 86016
    ds_read_b64_tr_b16 v[36:37], v2 offset:8192
    v_cvt_pk_bf16_f32 v180, v116, v117
    v_mfma_f32_16x16x32_bf16 v[128:131], v[16:19], a[200:203], v[128:131]
    ds_read_b64_tr_b16 v[38:39], v2 offset:8704
    v_cvt_pk_bf16_f32 v181, v118, v119
    v_mfma_f32_16x16x32_bf16 v[128:131], v[20:23], a[216:219], v[128:131]
    v_add_u32 v1, 4294856704, v1
    v_add_u32 v2, 4294856704, v2
    v_mfma_f32_16x16x32_bf16 v[128:131], v[24:27], a[232:235], v[128:131]
    buffer_load_dwordx4 v4, s[16:19], s60 offen  lds
    v_mfma_f32_16x16x32_bf16 v[132:135], v[24:27], a[236:239], v[132:135]
    s_add_u32 s60, s63, 1179776
    v_add_f32 v248, 1.0, v248
    v_add_f32 v249, 1.0, v249
    v_mfma_f32_16x16x32_bf16 v[132:135], v[20:23], a[220:223], v[132:135]
    s_add_u32 m0, s55, 90112
    v_rcp_f32 v248, v248
    v_mfma_f32_16x16x32_bf16 v[132:135], v[16:19], a[204:207], v[132:135]
    s_waitcnt lgkmcnt(4)
    v_rcp_f32 v249, v249
    v_mfma_f32_16x16x32_bf16 v[132:135], v[28:31], a[156:159], v[132:135]
    s_waitcnt lgkmcnt(2)
    v_mul_f32 v100, v100, v248
    v_mul_f32 v101, v101, v249
    v_mfma_f32_16x16x32_bf16 v[132:135], v[32:35], a[172:175], v[132:135]
    s_waitcnt vmcnt(13) lgkmcnt(0)
    s_barrier
    v_mfma_f32_16x16x32_bf16 v[132:135], v[36:39], a[188:191], v[132:135]
    buffer_load_dwordx4 v4, s[16:19], s60 offen  lds
    v_mfma_f32_16x16x32_bf16 v[128:131], v[36:39], a[184:187], v[128:131]
    s_add_u32 s60, s63, 1474688
    ds_read_b64_tr_b16 v[16:17], v1 offset:0
    v_mul_f32 v250, v250, v102
    v_mfma_f32_16x16x32_bf16 v[128:131], v[32:35], a[168:171], v[128:131]
    s_add_u32 m0, s55, 94208
    ds_read_b64_tr_b16 v[18:19], v1 offset:512
    v_mul_f32 v251, v103, v103
    v_mfma_f32_16x16x32_bf16 v[128:131], v[28:31], a[152:155], v[128:131]
    ds_read_b64_tr_b16 v[20:21], v1 offset:4096
    v_fma_f32 v251, v251, s79, v252
    v_mfma_f32_16x16x32_bf16 v[124:127], v[28:31], a[148:151], v[124:127]
    ds_read_b64_tr_b16 v[22:23], v1 offset:4608
    v_mul_f32 v132, v132, v100
    v_mfma_f32_16x16x32_bf16 v[124:127], v[32:35], a[164:167], v[124:127]
    buffer_load_dwordx4 v4, s[16:19], s60 offen  lds
    v_mfma_f32_16x16x32_bf16 v[124:127], v[36:39], a[180:183], v[124:127]
    s_add_u32 s60, s63, 1769600
    ds_read_b64_tr_b16 v[24:25], v1 offset:8192
    ds_read_b64_tr_b16 v[26:27], v1 offset:8704
    v_mfma_f32_16x16x32_bf16 v[120:123], v[36:39], a[176:179], v[120:123]
    s_add_u32 m0, s55, 98304
    v_exp_f32 v250, v250
    v_mfma_f32_16x16x32_bf16 v[120:123], v[32:35], a[160:163], v[120:123]
    v_mul_f32 v133, v133, v101
    v_cvt_pk_bf16_f32 v182, v132, v133
    v_mfma_f32_16x16x32_bf16 v[120:123], v[28:31], a[144:147], v[120:123]
    s_waitcnt lgkmcnt(4)
    v_add_f32 v250, 1.0, v250
    v_mul_f32 v251, v251, v103
    v_mfma_f32_16x16x32_bf16 v[136:139], v[16:19], a[0:3], 0
    s_waitcnt lgkmcnt(2)
    ds_read_b64_tr_b16 v[28:29], v1 offset:12288
    v_mul_f32 v248, v96, v96
    v_mfma_f32_16x16x32_bf16 v[136:139], v[20:23], a[16:19], v[136:139]
    s_waitcnt lgkmcnt(1)
    ds_read_b64_tr_b16 v[30:31], v1 offset:12800
    v_fma_f32 v248, v248, s79, v252
    v_mfma_f32_16x16x32_bf16 v[136:139], v[24:27], a[32:35], v[136:139]
    buffer_load_dwordx4 v4, s[16:19], s60 offen  lds
    v_mfma_f32_16x16x32_bf16 v[140:143], v[24:27], a[36:39], 0
    s_add_u32 s60, s63, 2064512
    ds_read_b64_tr_b16 v[32:33], v1 offset:16384
    v_mul_f32 v248, v248, v96
    v_mfma_f32_16x16x32_bf16 v[140:143], v[20:23], a[20:23], v[140:143]
    s_add_u32 m0, s55, 102400
    ds_read_b64_tr_b16 v[34:35], v1 offset:16896
    v_mul_f32 v249, v97, v97
    v_mfma_f32_16x16x32_bf16 v[140:143], v[16:19], a[4:7], v[140:143]
    ds_read_b64_tr_b16 v[36:37], v1 offset:20480
    v_fma_f32 v249, v249, s79, v252
    v_mfma_f32_16x16x32_bf16 v[144:147], v[16:19], a[8:11], 0
    buffer_load_dwordx4 v4, s[16:19], s60 offen  lds
    v_mfma_f32_16x16x32_bf16 v[144:147], v[20:23], a[24:27], v[144:147]
    s_add_u32 s60, s63, 2359424
    ds_read_b64_tr_b16 v[38:39], v1 offset:20992
    v_mul_f32 v249, v249, v97
    v_mfma_f32_16x16x32_bf16 v[144:147], v[24:27], a[40:43], v[144:147]
    s_add_u32 m0, s55, 106496
    v_rcp_f32 v250, v250
    v_mfma_f32_16x16x32_bf16 v[148:151], v[24:27], a[44:47], 0
    v_exp_f32 v251, v251
    v_mfma_f32_16x16x32_bf16 v[148:151], v[20:23], a[28:31], v[148:151]
    v_exp_f32 v248, v248
    v_mfma_f32_16x16x32_bf16 v[148:151], v[16:19], a[12:15], v[148:151]
    s_waitcnt lgkmcnt(4)
    v_exp_f32 v249, v249
    v_mfma_f32_16x16x32_bf16 v[148:151], v[28:31], a[60:63], v[148:151]
    s_waitcnt lgkmcnt(2)
    ds_read_b64_tr_b16 v[16:17], v1 offset:24576
    v_mul_f32 v102, v102, v250
    v_mfma_f32_16x16x32_bf16 v[148:151], v[32:35], a[76:79], v[148:151]
    s_waitcnt lgkmcnt(1)
    ds_read_b64_tr_b16 v[18:19], v1 offset:25088
    v_mul_f32 v134, v134, v102
    v_mfma_f32_16x16x32_bf16 v[148:151], v[36:39], a[92:95], v[148:151]
    buffer_load_dwordx4 v4, s[16:19], s60 offen  lds
    v_mfma_f32_16x16x32_bf16 v[144:147], v[36:39], a[88:91], v[144:147]
    s_add_u32 s60, s63, 2654336
    ds_read_b64_tr_b16 v[20:21], v1 offset:28672
    v_add_f32 v251, 1.0, v251
    v_mfma_f32_16x16x32_bf16 v[144:147], v[32:35], a[72:75], v[144:147]
    s_add_u32 m0, s55, 110592
    ds_read_b64_tr_b16 v[22:23], v1 offset:29184
    v_add_f32 v248, 1.0, v248
    v_mfma_f32_16x16x32_bf16 v[144:147], v[28:31], a[56:59], v[144:147]
    buffer_load_dwordx4 v4, s[16:19], s60 offen  lds
    v_mfma_f32_16x16x32_bf16 v[140:143], v[28:31], a[52:55], v[140:143]
    s_add_u32 s60, s63, 2949248
    ds_read_b64_tr_b16 v[24:25], v1 offset:32768
    v_add_f32 v249, 1.0, v249
    v_mfma_f32_16x16x32_bf16 v[140:143], v[32:35], a[68:71], v[140:143]
    s_add_u32 m0, s55, 114688
    ds_read_b64_tr_b16 v[26:27], v1 offset:33280
    v_mul_f32 v250, v98, v98
    v_mfma_f32_16x16x32_bf16 v[140:143], v[36:39], a[84:87], v[140:143]
    v_rcp_f32 v251, v251
    v_mfma_f32_16x16x32_bf16 v[136:139], v[36:39], a[80:83], v[136:139]
    v_rcp_f32 v248, v248
    v_mfma_f32_16x16x32_bf16 v[136:139], v[32:35], a[64:67], v[136:139]
    buffer_load_dwordx4 v4, s[16:19], s60 offen  lds
    v_mfma_f32_16x16x32_bf16 v[136:139], v[28:31], a[48:51], v[136:139]
    s_waitcnt lgkmcnt(4)
    v_rcp_f32 v249, v249
    v_mfma_f32_16x16x32_bf16 v[136:139], v[16:19], a[96:99], v[136:139]
    s_waitcnt lgkmcnt(2)
    ds_read_b64_tr_b16 v[28:29], v2 offset:24576
    v_mul_f32 v103, v103, v251
    v_mfma_f32_16x16x32_bf16 v[136:139], v[20:23], a[112:115], v[136:139]
    s_waitcnt lgkmcnt(1)
    ds_read_b64_tr_b16 v[30:31], v2 offset:25088
    v_mul_f32 v135, v135, v103
    v_mfma_f32_16x16x32_bf16 v[136:139], v[24:27], a[128:131], v[136:139]
    s_add_u32 s60, s63, 3244160
    ds_read_b64_tr_b16 v[32:33], v2 offset:28672
    v_cvt_pk_bf16_f32 v183, v134, v135
    v_mfma_f32_16x16x32_bf16 v[140:143], v[24:27], a[132:135], v[140:143]
    s_add_u32 m0, s55, 118784
    ds_read_b64_tr_b16 v[34:35], v2 offset:29184
    v_mul_f32 v96, v96, v248
    v_mfma_f32_16x16x32_bf16 v[140:143], v[20:23], a[116:119], v[140:143]
    buffer_load_dwordx4 v4, s[16:19], s60 offen  lds
    v_mfma_f32_16x16x32_bf16 v[140:143], v[16:19], a[100:103], v[140:143]
    s_add_u32 s60, s63, 3539072
    ds_read_b64_tr_b16 v[36:37], v2 offset:32768
    v_mul_f32 v128, v128, v96
    v_mfma_f32_16x16x32_bf16 v[144:147], v[16:19], a[104:107], v[144:147]
    s_add_u32 m0, s55, 122880
    ds_read_b64_tr_b16 v[38:39], v2 offset:33280
    v_mul_f32 v97, v97, v249
    v_mfma_f32_16x16x32_bf16 v[144:147], v[20:23], a[120:123], v[144:147]
    v_mul_f32 v129, v129, v97
    v_cvt_pk_bf16_f32 v178, v128, v129
    v_mfma_f32_16x16x32_bf16 v[144:147], v[24:27], a[136:139], v[144:147]
    v_fma_f32 v250, v250, s79, v252
    v_mul_f32 v250, v250, v98
    v_mfma_f32_16x16x32_bf16 v[148:151], v[24:27], a[140:143], v[148:151]
    buffer_load_dwordx4 v4, s[16:19], s60 offen  lds
    v_mfma_f32_16x16x32_bf16 v[148:151], v[20:23], a[124:127], v[148:151]
    s_add_u32 s60, s63, 3833984
    v_exp_f32 v250, v250
    v_mfma_f32_16x16x32_bf16 v[148:151], v[16:19], a[108:111], v[148:151]
    s_waitcnt lgkmcnt(4)
    v_add_f32 v250, 1.0, v250
    v_mul_f32 v251, v99, v99
    v_mfma_f32_16x16x32_bf16 v[164:167], v[28:31], a[108:111], 0
    s_waitcnt lgkmcnt(2)
    ds_read_b64_tr_b16 v[16:17], v2 offset:12288
    v_fma_f32 v251, v251, s79, v252
    v_mfma_f32_16x16x32_bf16 v[164:167], v[32:35], a[124:127], v[164:167]
    s_waitcnt lgkmcnt(1)
    ds_read_b64_tr_b16 v[18:19], v2 offset:12800
    v_mul_f32 v251, v251, v99
    v_mfma_f32_16x16x32_bf16 v[164:167], v[36:39], a[140:143], v[164:167]
    s_add_u32 m0, s55, 126976
    ds_read_b64_tr_b16 v[20:21], v2 offset:16384
    v_mul_f32 v248, v92, v92
    v_mfma_f32_16x16x32_bf16 v[160:163], v[36:39], a[136:139], 0
    buffer_load_dwordx4 v4, s[16:19], s60 offen  lds
    v_mfma_f32_16x16x32_bf16 v[160:163], v[32:35], a[120:123], v[160:163]
    s_add_u32 s60, s63, 4128896
    ds_read_b64_tr_b16 v[22:23], v2 offset:16896
    v_fma_f32 v248, v248, s79, v252
    v_mfma_f32_16x16x32_bf16 v[160:163], v[28:31], a[104:107], v[160:163]
    s_add_u32 m0, s55, 131072
    ds_read_b64_tr_b16 v[24:25], v2 offset:20480
    v_mul_f32 v248, v248, v92
    v_mfma_f32_16x16x32_bf16 v[156:159], v[28:31], a[100:103], 0
    ds_read_b64_tr_b16 v[26:27], v2 offset:20992
    v_mul_f32 v249, v93, v93
    v_mfma_f32_16x16x32_bf16 v[156:159], v[32:35], a[116:119], v[156:159]
    v_rcp_f32 v250, v250
    v_mfma_f32_16x16x32_bf16 v[156:159], v[36:39], a[132:135], v[156:159]
    buffer_load_dwordx4 v4, s[16:19], s60 offen  lds
    v_mfma_f32_16x16x32_bf16 v[152:155], v[36:39], a[128:131], 0
    s_add_u32 s60, s63, 4423808
    v_exp_f32 v251, v251
    v_mfma_f32_16x16x32_bf16 v[152:155], v[32:35], a[112:115], v[152:155]
    s_add_u32 m0, s55, 135168
    v_exp_f32 v248, v248
    v_mfma_f32_16x16x32_bf16 v[152:155], v[28:31], a[96:99], v[152:155]
    s_waitcnt lgkmcnt(4)
    v_mul_f32 v98, v98, v250
    v_mul_f32 v130, v130, v98
    v_mfma_f32_16x16x32_bf16 v[152:155], v[16:19], a[48:51], v[152:155]
    s_waitcnt lgkmcnt(2)
    ds_read_b64_tr_b16 v[28:29], v2 offset:0
    v_add_f32 v251, 1.0, v251
    v_mfma_f32_16x16x32_bf16 v[152:155], v[20:23], a[64:67], v[152:155]
    s_waitcnt lgkmcnt(1)
    ds_read_b64_tr_b16 v[30:31], v2 offset:512
    v_add_f32 v248, 1.0, v248
    v_mfma_f32_16x16x32_bf16 v[152:155], v[24:27], a[80:83], v[152:155]
    buffer_load_dwordx4 v4, s[16:19], s60 offen  lds
    v_mfma_f32_16x16x32_bf16 v[156:159], v[24:27], a[84:87], v[156:159]
    s_add_u32 s60, s63, 4718720
    ds_read_b64_tr_b16 v[32:33], v2 offset:4096
    v_fma_f32 v249, v249, s79, v252
    v_mfma_f32_16x16x32_bf16 v[156:159], v[20:23], a[68:71], v[156:159]
    s_add_u32 m0, s55, 139264
    ds_read_b64_tr_b16 v[34:35], v2 offset:4608
    v_mul_f32 v249, v249, v93
    v_mfma_f32_16x16x32_bf16 v[156:159], v[16:19], a[52:55], v[156:159]
    ds_read_b64_tr_b16 v[36:37], v2 offset:8192
    v_mul_f32 v250, v94, v94
    v_mfma_f32_16x16x32_bf16 v[160:163], v[16:19], a[56:59], v[160:163]
    ds_read_b64_tr_b16 v[38:39], v2 offset:8704
    v_fma_f32 v250, v250, s79, v252
    v_mfma_f32_16x16x32_bf16 v[160:163], v[20:23], a[72:75], v[160:163]
    v_add_u32 v1, 36864, v1
    v_add_u32 v2, 36864, v2
    v_mfma_f32_16x16x32_bf16 v[160:163], v[24:27], a[88:91], v[160:163]
    buffer_load_dwordx4 v4, s[16:19], s60 offen  lds
    v_mfma_f32_16x16x32_bf16 v[164:167], v[24:27], a[92:95], v[164:167]
    s_add_u32 s60, s63, 5013632
    v_rcp_f32 v251, v251
    v_mfma_f32_16x16x32_bf16 v[164:167], v[20:23], a[76:79], v[164:167]
    s_add_u32 m0, s55, 143360
    v_rcp_f32 v248, v248
    v_mfma_f32_16x16x32_bf16 v[164:167], v[16:19], a[60:63], v[164:167]
    s_waitcnt lgkmcnt(4)
    v_exp_f32 v249, v249
    v_mfma_f32_16x16x32_bf16 v[164:167], v[28:31], a[12:15], v[164:167]
    s_waitcnt lgkmcnt(2)
    v_mul_f32 v99, v99, v251
    v_mul_f32 v131, v131, v99
    v_mfma_f32_16x16x32_bf16 v[164:167], v[32:35], a[28:31], v[164:167]
    s_waitcnt vmcnt(17) lgkmcnt(0)
    s_barrier
    v_mfma_f32_16x16x32_bf16 v[164:167], v[36:39], a[44:47], v[164:167]
    buffer_load_dwordx4 v4, s[16:19], s60 offen  lds
    v_mfma_f32_16x16x32_bf16 v[160:163], v[36:39], a[40:43], v[160:163]
    s_add_u32 s60, s64, 0
    ds_read_b64_tr_b16 v[16:17], v1 offset:0
    v_cvt_pk_bf16_f32 v179, v130, v131
    v_mfma_f32_16x16x32_bf16 v[160:163], v[32:35], a[24:27], v[160:163]
    s_add_u32 m0, s59, 0
    ds_read_b64_tr_b16 v[18:19], v1 offset:512
    v_mul_f32 v92, v92, v248
    v_mfma_f32_16x16x32_bf16 v[160:163], v[28:31], a[8:11], v[160:163]
    ds_read_b64_tr_b16 v[20:21], v1 offset:4096
    v_mul_f32 v124, v124, v92
    v_mfma_f32_16x16x32_bf16 v[156:159], v[28:31], a[4:7], v[156:159]
    buffer_load_dwordx4 v6, s[28:31], s60 offen  lds
    v_mfma_f32_16x16x32_bf16 v[156:159], v[32:35], a[20:23], v[156:159]
    ds_read_b64_tr_b16 v[22:23], v1 offset:4608
    ds_read_b64_tr_b16 v[24:25], v1 offset:8192
    v_mfma_f32_16x16x32_bf16 v[156:159], v[36:39], a[36:39], v[156:159]
    ds_read_b64_tr_b16 v[26:27], v1 offset:8704
    v_add_f32 v249, 1.0, v249
    v_mfma_f32_16x16x32_bf16 v[152:155], v[36:39], a[32:35], v[152:155]
    v_rcp_f32 v249, v249
    v_mfma_f32_16x16x32_bf16 v[152:155], v[32:35], a[16:19], v[152:155]
    v_mul_f32 v93, v93, v249
    v_mul_f32 v125, v125, v93
    v_mfma_f32_16x16x32_bf16 v[152:155], v[28:31], a[0:3], v[152:155]
    s_waitcnt lgkmcnt(4)
    v_cvt_pk_bf16_f32 v174, v124, v125
    v_mul_f32 v250, v250, v94
    v_mfma_f32_16x16x32_bf16 v[136:139], v[16:19], a[144:147], v[136:139]
    s_waitcnt lgkmcnt(2)
    ds_read_b64_tr_b16 v[28:29], v1 offset:12288
    v_mul_f32 v251, v95, v95
    v_mfma_f32_16x16x32_bf16 v[136:139], v[20:23], a[160:163], v[136:139]
    s_waitcnt lgkmcnt(1)
    ds_read_b64_tr_b16 v[30:31], v1 offset:12800
    v_fma_f32 v251, v251, s79, v252
    v_mfma_f32_16x16x32_bf16 v[136:139], v[24:27], a[176:179], v[136:139]
    s_add_u32 s60, s64, 294912
    ds_read_b64_tr_b16 v[32:33], v1 offset:16384
    v_mul_f32 v251, v251, v95
    v_mfma_f32_16x16x32_bf16 v[140:143], v[24:27], a[180:183], v[140:143]
    s_add_u32 m0, s59, 2048
    ds_read_b64_tr_b16 v[34:35], v1 offset:16896
    v_mul_f32 v248, v88, v88
    v_mfma_f32_16x16x32_bf16 v[140:143], v[20:23], a[164:167], v[140:143]
    ds_read_b64_tr_b16 v[36:37], v1 offset:20480
    v_fma_f32 v248, v248, s79, v252
    v_mfma_f32_16x16x32_bf16 v[140:143], v[16:19], a[148:151], v[140:143]
    buffer_load_dwordx4 v6, s[28:31], s60 offen  lds
    v_mfma_f32_16x16x32_bf16 v[144:147], v[16:19], a[152:155], v[144:147]
    ds_read_b64_tr_b16 v[38:39], v1 offset:20992
    v_mul_f32 v248, v248, v88
    v_mfma_f32_16x16x32_bf16 v[144:147], v[20:23], a[168:171], v[144:147]
    buffer_store_dwordx4 v[208:211], v203, s[24:27], s0 offen sc1
    v_mfma_f32_16x16x32_bf16 v[144:147], v[24:27], a[184:187], v[144:147]
    s_lshl_b32 s0, s52, 10
    v_exp_f32 v250, v250
    v_mfma_f32_16x16x32_bf16 v[148:151], v[24:27], a[188:191], v[148:151]
    s_add_u32 s60, s64, 589824
    v_exp_f32 v251, v251
    v_mfma_f32_16x16x32_bf16 v[148:151], v[20:23], a[172:175], v[148:151]
    s_add_u32 m0, s59, 4096
    v_exp_f32 v248, v248
    v_mfma_f32_16x16x32_bf16 v[148:151], v[16:19], a[156:159], v[148:151]
    s_waitcnt lgkmcnt(4)
    v_add_f32 v250, 1.0, v250
    v_add_f32 v251, 1.0, v251
    v_mfma_f32_16x16x32_bf16 v[148:151], v[28:31], a[204:207], v[148:151]
    s_waitcnt lgkmcnt(2)
    ds_read_b64_tr_b16 v[16:17], v1 offset:24576
    v_add_f32 v248, 1.0, v248
    v_mfma_f32_16x16x32_bf16 v[148:151], v[32:35], a[220:223], v[148:151]
    s_waitcnt lgkmcnt(1)
    ds_read_b64_tr_b16 v[18:19], v1 offset:25088
    v_mul_f32 v249, v89, v89
    v_mfma_f32_16x16x32_bf16 v[148:151], v[36:39], a[236:239], v[148:151]
    s_add_u32 s0, s0, s1
    ds_read_b64_tr_b16 v[20:21], v1 offset:28672
L_pg4:
    s_cbranch_execz L_pg8
    v_fma_f32 v249, v249, s79, v252
    v_mfma_f32_16x16x32_bf16 v[144:147], v[36:39], a[232:235], v[144:147]
    buffer_load_dwordx4 v6, s[28:31], s60 offen  lds
    v_mfma_f32_16x16x32_bf16 v[144:147], v[32:35], a[216:219], v[144:147]
    s_lshr_b32 s1, s53, 2
    ds_read_b64_tr_b16 v[22:23], v1 offset:29184
    v_mul_f32 v249, v249, v89
    v_mfma_f32_16x16x32_bf16 v[144:147], v[28:31], a[200:203], v[144:147]
    s_mul_i32 s1, s1, 96
    s_add_u32 s0, s0, s1
    ds_read_b64_tr_b16 v[24:25], v1 offset:32768
    v_mfma_f32_16x16x32_bf16 v[140:143], v[28:31], a[196:199], v[140:143]
    s_lshr_b32 s1, s54, 1
    s_lshl_b32 s86, s1, 9
    ds_read_b64_tr_b16 v[26:27], v1 offset:33280
    v_mfma_f32_16x16x32_bf16 v[140:143], v[32:35], a[212:215], v[140:143]
    s_lshl_b32 s87, s1, 2
    v_rcp_f32 v250, v250
    v_mfma_f32_16x16x32_bf16 v[140:143], v[36:39], a[228:231], v[140:143]
    s_add_u32 s60, s64, 884736
    v_rcp_f32 v251, v251
    v_mfma_f32_16x16x32_bf16 v[136:139], v[36:39], a[224:227], v[136:139]
    s_add_u32 m0, s59, 6144
    v_rcp_f32 v248, v248
    v_mfma_f32_16x16x32_bf16 v[136:139], v[32:35], a[208:211], v[136:139]
    s_add_u32 s86, s86, s0
    v_exp_f32 v249, v249
    v_mfma_f32_16x16x32_bf16 v[136:139], v[28:31], a[192:195], v[136:139]
    s_waitcnt lgkmcnt(4)
    v_mul_f32 v94, v94, v250
    v_mul_f32 v126, v126, v94
    v_mfma_f32_16x16x32_bf16 v[136:139], v[16:19], a[240:243], v[136:139]
    s_waitcnt lgkmcnt(2)
    ds_read_b64_tr_b16 v[28:29], v2 offset:24576
    v_mul_f32 v95, v95, v251
    v_mfma_f32_16x16x32_bf16 v[136:139], v[20:23], v[40:43], v[136:139]
    s_waitcnt lgkmcnt(1)
    ds_read_b64_tr_b16 v[30:31], v2 offset:25088
    v_mul_f32 v127, v127, v95
    v_mfma_f32_16x16x32_bf16 v[136:139], v[24:27], v[56:59], v[136:139]
    buffer_load_dwordx4 v6, s[28:31], s60 offen  lds
    v_mfma_f32_16x16x32_bf16 v[140:143], v[24:27], v[60:63], v[140:143]
    s_add_u32 s87, s87, s0
    ds_read_b64_tr_b16 v[32:33], v2 offset:28672
    v_cvt_pk_bf16_f32 v175, v126, v127
    v_mfma_f32_16x16x32_bf16 v[140:143], v[20:23], v[44:47], v[140:143]
    s_and_b32 s1, s54, 1
    ds_read_b64_tr_b16 v[34:35], v2 offset:29184
    v_mul_f32 v88, v88, v248
    v_mfma_f32_16x16x32_bf16 v[140:143], v[16:19], a[244:247], v[140:143]
    s_lshl_b32 s0, s1, 2
    ds_read_b64_tr_b16 v[36:37], v2 offset:32768
    v_mul_f32 v120, v120, v88
    v_mfma_f32_16x16x32_bf16 v[144:147], v[16:19], a[248:251], v[144:147]
    s_add_u32 s60, s64, 1179648
    ds_read_b64_tr_b16 v[38:39], v2 offset:33280
    v_add_f32 v249, 1.0, v249
    v_mfma_f32_16x16x32_bf16 v[144:147], v[20:23], v[48:51], v[144:147]
    s_add_u32 m0, s59, 8192
    v_rcp_f32 v249, v249
    v_mfma_f32_16x16x32_bf16 v[144:147], v[24:27], v[64:67], v[144:147]
    s_add_u32 s86, s86, s0
    v_mul_f32 v89, v89, v249
    v_mul_f32 v121, v121, v89
    v_mfma_f32_16x16x32_bf16 v[148:151], v[24:27], v[68:71], v[148:151]
    s_lshl_b32 s0, s1, 9
    v_cvt_pk_bf16_f32 v170, v120, v121
    v_mul_f32 v250, v90, v90
    v_mfma_f32_16x16x32_bf16 v[148:151], v[20:23], v[52:55], v[148:151]
    s_add_u32 s87, s87, s0
    v_fma_f32 v250, v250, s79, v252
    v_mul_f32 v250, v250, v90
    v_mfma_f32_16x16x32_bf16 v[148:151], v[16:19], a[252:255], v[148:151]
    s_waitcnt lgkmcnt(4)
    v_exp_f32 v250, v250
    v_mfma_f32_16x16x32_bf16 v[164:167], v[28:31], a[252:255], v[164:167]
    s_waitcnt lgkmcnt(2)
    ds_read_b64_tr_b16 v[16:17], v2 offset:12288
    v_add_f32 v250, 1.0, v250
    v_mfma_f32_16x16x32_bf16 v[164:167], v[32:35], v[52:55], v[164:167]
    s_waitcnt lgkmcnt(1)
    ds_read_b64_tr_b16 v[18:19], v2 offset:12800
    v_mul_f32 v251, v91, v91
    v_mfma_f32_16x16x32_bf16 v[164:167], v[36:39], v[68:71], v[164:167]
    buffer_load_dwordx4 v6, s[28:31], s60 offen  lds
    v_mfma_f32_16x16x32_bf16 v[160:163], v[36:39], v[64:67], v[160:163]
    s_add_u32 s86, s86, 9699328
    ds_read_b64_tr_b16 v[20:21], v2 offset:16384
    v_fma_f32 v251, v251, s79, v252
    v_mfma_f32_16x16x32_bf16 v[160:163], v[32:35], v[48:51], v[160:163]
    s_add_u32 s87, s87, 9715712
    ds_read_b64_tr_b16 v[22:23], v2 offset:16896
    v_mul_f32 v251, v251, v91
    v_mfma_f32_16x16x32_bf16 v[160:163], v[28:31], a[248:251], v[160:163]
    s_add_u32 s60, s64, 1474560
    ds_read_b64_tr_b16 v[24:25], v2 offset:20480
    v_mul_f32 v248, v136, v136
    v_mfma_f32_16x16x32_bf16 v[156:159], v[28:31], a[244:247], v[156:159]
    s_add_u32 m0, s59, 10240
    ds_read_b64_tr_b16 v[26:27], v2 offset:20992
    v_fma_f32 v248, v248, s79, v252
    v_mfma_f32_16x16x32_bf16 v[156:159], v[32:35], v[44:47], v[156:159]
    v_rcp_f32 v250, v250
    v_mfma_f32_16x16x32_bf16 v[156:159], v[36:39], v[60:63], v[156:159]
    v_exp_f32 v251, v251
    v_mfma_f32_16x16x32_bf16 v[152:155], v[36:39], v[56:59], v[152:155]
    v_mul_f32 v90, v90, v250
    v_mul_f32 v122, v122, v90
    v_mfma_f32_16x16x32_bf16 v[152:155], v[32:35], v[40:43], v[152:155]
    v_add_f32 v251, 1.0, v251
    v_mul_f32 v248, v248, v136
    v_mfma_f32_16x16x32_bf16 v[152:155], v[28:31], a[240:243], v[152:155]
    s_waitcnt lgkmcnt(4)
    v_rcp_f32 v251, v251
    v_mfma_f32_16x16x32_bf16 v[152:155], v[16:19], a[192:195], v[152:155]
    s_waitcnt lgkmcnt(2)
    ds_read_b64_tr_b16 v[28:29], v2 offset:0
    v_mul_f32 v91, v91, v251
    v_mfma_f32_16x16x32_bf16 v[152:155], v[20:23], a[208:211], v[152:155]
    s_waitcnt lgkmcnt(1)
    ds_read_b64_tr_b16 v[30:31], v2 offset:512
    v_mul_f32 v123, v123, v91
    v_mfma_f32_16x16x32_bf16 v[152:155], v[24:27], a[224:227], v[152:155]
    buffer_load_dwordx4 v6, s[28:31], s60 offen  lds
    v_mfma_f32_16x16x32_bf16 v[156:159], v[24:27], a[228:231], v[156:159]
    s_add_u32 s60, s64, 1769472
    ds_read_b64_tr_b16 v[32:33], v2 offset:4096
    v_cvt_pk_bf16_f32 v171, v122, v123
    v_mfma_f32_16x16x32_bf16 v[156:159], v[20:23], a[212:215], v[156:159]
    s_add_u32 m0, s59, 12288
    ds_read_b64_tr_b16 v[34:35], v2 offset:4608
    v_mul_f32 v249, v137, v137
    v_mfma_f32_16x16x32_bf16 v[156:159], v[16:19], a[196:199], v[156:159]
    ds_read_b64_tr_b16 v[36:37], v2 offset:8192
    v_fma_f32 v249, v249, s79, v252
    v_mfma_f32_16x16x32_bf16 v[160:163], v[16:19], a[200:203], v[160:163]
    ds_read_b64_tr_b16 v[38:39], v2 offset:8704
    v_mul_f32 v249, v249, v137
    v_mfma_f32_16x16x32_bf16 v[160:163], v[20:23], a[216:219], v[160:163]
    v_add_u32 v1, 36864, v1
    v_add_u32 v2, 36864, v2
    v_mfma_f32_16x16x32_bf16 v[160:163], v[24:27], a[232:235], v[160:163]
    v_exp_f32 v248, v248
    v_mfma_f32_16x16x32_bf16 v[164:167], v[24:27], a[236:239], v[164:167]
    buffer_load_dwordx4 v6, s[28:31], s60 offen  lds
    v_mfma_f32_16x16x32_bf16 v[164:167], v[20:23], a[220:223], v[164:167]
    v_exp_f32 v249, v249
    v_mfma_f32_16x16x32_bf16 v[164:167], v[16:19], a[204:207], v[164:167]
    s_waitcnt lgkmcnt(4)
    v_add_f32 v248, 1.0, v248
    v_add_f32 v249, 1.0, v249
    v_mfma_f32_16x16x32_bf16 v[164:167], v[28:31], a[156:159], v[164:167]
    s_waitcnt lgkmcnt(2)
    v_rcp_f32 v248, v248
    v_mfma_f32_16x16x32_bf16 v[164:167], v[32:35], a[172:175], v[164:167]
    s_waitcnt vmcnt(17) lgkmcnt(0)
    s_barrier
    v_mfma_f32_16x16x32_bf16 v[164:167], v[36:39], a[188:191], v[164:167]
    s_add_u32 s60, s64, 2064384
    ds_read_b64_tr_b16 v[16:17], v1 offset:0
    v_mul_f32 v136, v136, v248
    v_mfma_f32_16x16x32_bf16 v[160:163], v[36:39], a[184:187], v[160:163]
    s_add_u32 m0, s59, 14336
    ds_read_b64_tr_b16 v[18:19], v1 offset:512
    v_mul_f32 v250, v138, v138
    v_mfma_f32_16x16x32_bf16 v[160:163], v[32:35], a[168:171], v[160:163]
    ds_read_b64_tr_b16 v[20:21], v1 offset:4096
    v_fma_f32 v250, v250, s79, v252
    v_mfma_f32_16x16x32_bf16 v[160:163], v[28:31], a[152:155], v[160:163]
    ds_read_b64_tr_b16 v[22:23], v1 offset:4608
    v_mul_f32 v250, v250, v138
    v_mfma_f32_16x16x32_bf16 v[156:159], v[28:31], a[148:151], v[156:159]
    ds_read_b64_tr_b16 v[24:25], v1 offset:8192
    v_mul_f32 v251, v139, v139
    v_mfma_f32_16x16x32_bf16 v[156:159], v[32:35], a[164:167], v[156:159]
    ds_read_b64_tr_b16 v[26:27], v1 offset:8704
    v_fma_f32 v251, v251, s79, v252
    v_mfma_f32_16x16x32_bf16 v[156:159], v[36:39], a[180:183], v[156:159]
    buffer_load_dwordx4 v6, s[28:31], s60 offen  lds
    v_mfma_f32_16x16x32_bf16 v[152:155], v[36:39], a[176:179], v[152:155]
    v_rcp_f32 v249, v249
    v_mfma_f32_16x16x32_bf16 v[152:155], v[32:35], a[160:163], v[152:155]
    v_exp_f32 v250, v250
    v_mfma_f32_16x16x32_bf16 v[152:155], v[28:31], a[144:147], v[152:155]
    s_waitcnt lgkmcnt(4)
    v_mul_f32 v137, v137, v249
    v_add_f32 v250, 1.0, v250
    v_mfma_f32_16x16x32_bf16 v[72:75], v[16:19], a[0:3], 0
    s_waitcnt lgkmcnt(2)
    ds_read_b64_tr_b16 v[28:29], v1 offset:12288
    v_mul_f32 v251, v251, v139
    v_mfma_f32_16x16x32_bf16 v[72:75], v[20:23], a[16:19], v[72:75]
    s_waitcnt lgkmcnt(1)
    ds_read_b64_tr_b16 v[30:31], v1 offset:12800
    v_mul_f32 v248, v140, v140
    v_mfma_f32_16x16x32_bf16 v[72:75], v[24:27], a[32:35], v[72:75]
    s_add_u32 s60, s64, 2359296
    ds_read_b64_tr_b16 v[32:33], v1 offset:16384
    v_fma_f32 v248, v248, s79, v252
    v_mfma_f32_16x16x32_bf16 v[76:79], v[24:27], a[36:39], 0
    s_add_u32 m0, s59, 16384
    ds_read_b64_tr_b16 v[34:35], v1 offset:16896
    v_mul_f32 v248, v248, v140
    v_mfma_f32_16x16x32_bf16 v[76:79], v[20:23], a[20:23], v[76:79]
    ds_read_b64_tr_b16 v[36:37], v1 offset:20480
    v_mul_f32 v249, v141, v141
    v_mfma_f32_16x16x32_bf16 v[76:79], v[16:19], a[4:7], v[76:79]
    ds_read_b64_tr_b16 v[38:39], v1 offset:20992
    v_fma_f32 v249, v249, s79, v252
    v_mfma_f32_16x16x32_bf16 v[80:83], v[16:19], a[8:11], 0
    buffer_load_dwordx4 v6, s[28:31], s60 offen  lds
    v_mfma_f32_16x16x32_bf16 v[80:83], v[20:23], a[24:27], v[80:83]
    v_rcp_f32 v250, v250
    v_mfma_f32_16x16x32_bf16 v[80:83], v[24:27], a[40:43], v[80:83]
    v_exp_f32 v251, v251
    v_mfma_f32_16x16x32_bf16 v[84:87], v[24:27], a[44:47], 0
    v_exp_f32 v248, v248
    v_mfma_f32_16x16x32_bf16 v[84:87], v[20:23], a[28:31], v[84:87]
    v_mul_f32 v138, v138, v250
    v_add_f32 v251, 1.0, v251
    v_mfma_f32_16x16x32_bf16 v[84:87], v[16:19], a[12:15], v[84:87]
    s_waitcnt lgkmcnt(4)
    v_rcp_f32 v251, v251
    v_mfma_f32_16x16x32_bf16 v[84:87], v[28:31], a[60:63], v[84:87]
    s_waitcnt lgkmcnt(2)
    ds_read_b64_tr_b16 v[16:17], v1 offset:24576
    v_mul_f32 v139, v139, v251
    v_mfma_f32_16x16x32_bf16 v[84:87], v[32:35], a[76:79], v[84:87]
    s_waitcnt lgkmcnt(1)
    ds_read_b64_tr_b16 v[18:19], v1 offset:25088
    v_add_f32 v248, 1.0, v248
    v_mfma_f32_16x16x32_bf16 v[84:87], v[36:39], a[92:95], v[84:87]
    s_add_u32 s60, s64, 2654208
    ds_read_b64_tr_b16 v[20:21], v1 offset:28672
    v_mul_f32 v249, v249, v141
    v_mfma_f32_16x16x32_bf16 v[80:83], v[36:39], a[88:91], v[80:83]
    s_add_u32 m0, s59, 36864
    ds_read_b64_tr_b16 v[22:23], v1 offset:29184
    v_mul_f32 v250, v142, v142
    v_mfma_f32_16x16x32_bf16 v[80:83], v[32:35], a[72:75], v[80:83]
    ds_read_b64_tr_b16 v[24:25], v1 offset:32768
    v_fma_f32 v250, v250, s79, v252
    v_mfma_f32_16x16x32_bf16 v[80:83], v[28:31], a[56:59], v[80:83]
    buffer_load_dwordx4 v6, s[28:31], s60 offen  lds
    v_mfma_f32_16x16x32_bf16 v[76:79], v[28:31], a[52:55], v[76:79]
    ds_read_b64_tr_b16 v[26:27], v1 offset:33280
    v_mul_f32 v250, v250, v142
    v_mfma_f32_16x16x32_bf16 v[76:79], v[32:35], a[68:71], v[76:79]
    v_rcp_f32 v248, v248
    v_mfma_f32_16x16x32_bf16 v[76:79], v[36:39], a[84:87], v[76:79]
    v_exp_f32 v249, v249
    v_mfma_f32_16x16x32_bf16 v[72:75], v[36:39], a[80:83], v[72:75]
    s_add_u32 s60, s64, 2949120
    v_exp_f32 v250, v250
    v_mfma_f32_16x16x32_bf16 v[72:75], v[32:35], a[64:67], v[72:75]
    s_add_u32 m0, s59, 38912
    v_mul_f32 v140, v140, v248
    v_add_f32 v249, 1.0, v249
    v_mfma_f32_16x16x32_bf16 v[72:75], v[28:31], a[48:51], v[72:75]
    s_waitcnt lgkmcnt(4)
    v_rcp_f32 v249, v249
    v_mfma_f32_16x16x32_bf16 v[72:75], v[16:19], a[96:99], v[72:75]
    s_waitcnt lgkmcnt(2)
    ds_read_b64_tr_b16 v[28:29], v2 offset:24576
    v_mul_f32 v141, v141, v249
    v_mfma_f32_16x16x32_bf16 v[72:75], v[20:23], a[112:115], v[72:75]
    s_waitcnt lgkmcnt(1)
    ds_read_b64_tr_b16 v[30:31], v2 offset:25088
    v_add_f32 v250, 1.0, v250
    v_mfma_f32_16x16x32_bf16 v[72:75], v[24:27], a[128:131], v[72:75]
    ds_read_b64_tr_b16 v[32:33], v2 offset:28672
    v_mul_f32 v251, v143, v143
    v_mfma_f32_16x16x32_bf16 v[76:79], v[24:27], a[132:135], v[76:79]
    buffer_load_dwordx4 v6, s[28:31], s60 offen  lds
    v_mfma_f32_16x16x32_bf16 v[76:79], v[20:23], a[116:119], v[76:79]
    ds_read_b64_tr_b16 v[34:35], v2 offset:29184
    v_fma_f32 v251, v251, s79, v252
    v_mfma_f32_16x16x32_bf16 v[76:79], v[16:19], a[100:103], v[76:79]
    ds_read_b64_tr_b16 v[36:37], v2 offset:32768
    v_mul_f32 v251, v251, v143
    v_mfma_f32_16x16x32_bf16 v[80:83], v[16:19], a[104:107], v[80:83]
    buffer_load_dword v254, v253, s[16:19], s63 offen offset:256
    v_mfma_f32_16x16x32_bf16 v[80:83], v[20:23], a[120:123], v[80:83]
    ds_read_b64_tr_b16 v[38:39], v2 offset:33280
    v_mul_f32 v248, v144, v144
    v_mfma_f32_16x16x32_bf16 v[80:83], v[24:27], a[136:139], v[80:83]
    s_add_u32 s60, s64, 3244032
    v_rcp_f32 v250, v250
    v_mfma_f32_16x16x32_bf16 v[84:87], v[24:27], a[140:143], v[84:87]
    s_add_u32 m0, s59, 40960
    v_exp_f32 v251, v251
    v_mfma_f32_16x16x32_bf16 v[84:87], v[20:23], a[124:127], v[84:87]
    v_mul_f32 v142, v142, v250
    v_add_f32 v251, 1.0, v251
    v_mfma_f32_16x16x32_bf16 v[84:87], v[16:19], a[108:111], v[84:87]
    s_waitcnt lgkmcnt(4)
    v_rcp_f32 v251, v251
    v_mfma_f32_16x16x32_bf16 v[100:103], v[28:31], a[108:111], 0
    s_waitcnt lgkmcnt(2)
    ds_read_b64_tr_b16 v[16:17], v2 offset:12288
    v_mul_f32 v143, v143, v251
    v_mfma_f32_16x16x32_bf16 v[100:103], v[32:35], a[124:127], v[100:103]
    s_waitcnt lgkmcnt(1)
    ds_read_b64_tr_b16 v[18:19], v2 offset:12800
    v_fma_f32 v248, v248, s79, v252
    v_mfma_f32_16x16x32_bf16 v[100:103], v[36:39], a[140:143], v[100:103]
    buffer_load_dwordx4 v6, s[28:31], s60 offen  lds
    v_mfma_f32_16x16x32_bf16 v[96:99], v[36:39], a[136:139], 0
    ds_read_b64_tr_b16 v[20:21], v2 offset:16384
    v_mul_f32 v248, v248, v144
    v_mfma_f32_16x16x32_bf16 v[96:99], v[32:35], a[120:123], v[96:99]
    ds_read_b64_tr_b16 v[22:23], v2 offset:16896
    v_mul_f32 v249, v145, v145
    v_mfma_f32_16x16x32_bf16 v[96:99], v[28:31], a[104:107], v[96:99]
    ds_read_b64_tr_b16 v[24:25], v2 offset:20480
    v_fma_f32 v249, v249, s79, v252
    v_mfma_f32_16x16x32_bf16 v[92:95], v[28:31], a[100:103], 0
    s_add_u32 s60, s64, 3538944
    ds_read_b64_tr_b16 v[26:27], v2 offset:20992
    v_mul_f32 v249, v249, v145
    v_mfma_f32_16x16x32_bf16 v[92:95], v[32:35], a[116:119], v[92:95]
    s_add_u32 m0, s59, 43008
    v_exp_f32 v248, v248
    v_mfma_f32_16x16x32_bf16 v[92:95], v[36:39], a[132:135], v[92:95]
    v_exp_f32 v249, v249
    v_mfma_f32_16x16x32_bf16 v[88:91], v[36:39], a[128:131], 0
    v_add_f32 v248, 1.0, v248
    v_add_f32 v249, 1.0, v249
    v_mfma_f32_16x16x32_bf16 v[88:91], v[32:35], a[112:115], v[88:91]
    v_rcp_f32 v248, v248
    v_mfma_f32_16x16x32_bf16 v[88:91], v[28:31], a[96:99], v[88:91]
    s_waitcnt lgkmcnt(4)
    v_rcp_f32 v249, v249
    v_mfma_f32_16x16x32_bf16 v[88:91], v[16:19], a[48:51], v[88:91]
    s_waitcnt lgkmcnt(2)
    ds_read_b64_tr_b16 v[28:29], v2 offset:0
    v_mul_f32 v144, v144, v248
    v_mfma_f32_16x16x32_bf16 v[88:91], v[20:23], a[64:67], v[88:91]
    s_waitcnt lgkmcnt(1)
    ds_read_b64_tr_b16 v[30:31], v2 offset:512
    v_mul_f32 v145, v145, v249
    v_mfma_f32_16x16x32_bf16 v[88:91], v[24:27], a[80:83], v[88:91]
    buffer_load_dwordx4 v6, s[28:31], s60 offen  lds
    v_mfma_f32_16x16x32_bf16 v[92:95], v[24:27], a[84:87], v[92:95]
    ds_read_b64_tr_b16 v[32:33], v2 offset:4096
    v_mul_f32 v250, v146, v146
    v_mfma_f32_16x16x32_bf16 v[92:95], v[20:23], a[68:71], v[92:95]
    ds_read_b64_tr_b16 v[34:35], v2 offset:4608
    v_fma_f32 v250, v250, s79, v252
    v_mfma_f32_16x16x32_bf16 v[92:95], v[16:19], a[52:55], v[92:95]
    s_add_u32 s60, s64, 3833856
    ds_read_b64_tr_b16 v[36:37], v2 offset:8192
    v_mul_f32 v250, v250, v146
    v_mfma_f32_16x16x32_bf16 v[96:99], v[16:19], a[56:59], v[96:99]
    s_add_u32 m0, s59, 45056
    ds_read_b64_tr_b16 v[38:39], v2 offset:8704
    v_mul_f32 v251, v147, v147
    v_mfma_f32_16x16x32_bf16 v[96:99], v[20:23], a[72:75], v[96:99]
    v_add_u32 v1, 36864, v1
    v_add_u32 v2, 36864, v2
    v_mfma_f32_16x16x32_bf16 v[96:99], v[24:27], a[88:91], v[96:99]
    v_exp_f32 v250, v250
    v_mfma_f32_16x16x32_bf16 v[100:103], v[24:27], a[92:95], v[100:103]
    v_add_f32 v250, 1.0, v250
    v_fma_f32 v251, v251, s79, v252
    v_mfma_f32_16x16x32_bf16 v[100:103], v[20:23], a[76:79], v[100:103]
    v_rcp_f32 v250, v250
    v_mfma_f32_16x16x32_bf16 v[100:103], v[16:19], a[60:63], v[100:103]
    s_waitcnt lgkmcnt(4)
    v_mul_f32 v146, v146, v250
    v_mul_f32 v251, v251, v147
    v_mfma_f32_16x16x32_bf16 v[100:103], v[28:31], a[12:15], v[100:103]
    s_waitcnt lgkmcnt(2)
    v_exp_f32 v251, v251
    v_mfma_f32_16x16x32_bf16 v[100:103], v[32:35], a[28:31], v[100:103]
    s_waitcnt vmcnt(15) lgkmcnt(0)
    s_barrier
    v_mfma_f32_16x16x32_bf16 v[100:103], v[36:39], a[44:47], v[100:103]
    buffer_load_dwordx4 v6, s[28:31], s60 offen  lds
    v_mfma_f32_16x16x32_bf16 v[96:99], v[36:39], a[40:43], v[96:99]
    s_add_u32 s60, s64, 4128768
    ds_read_b64_tr_b16 v[16:17], v1 offset:0
    v_add_f32 v251, 1.0, v251
    v_mfma_f32_16x16x32_bf16 v[96:99], v[32:35], a[24:27], v[96:99]
    s_add_u32 m0, s59, 47104
    ds_read_b64_tr_b16 v[18:19], v1 offset:512
    v_mul_f32 v248, v148, v148
    v_mfma_f32_16x16x32_bf16 v[96:99], v[28:31], a[8:11], v[96:99]
    ds_read_b64_tr_b16 v[20:21], v1 offset:4096
    v_fma_f32 v248, v248, s79, v252
    v_mfma_f32_16x16x32_bf16 v[92:95], v[28:31], a[4:7], v[92:95]
    ds_read_b64_tr_b16 v[22:23], v1 offset:4608
    v_mul_f32 v248, v248, v148
    v_mfma_f32_16x16x32_bf16 v[92:95], v[32:35], a[20:23], v[92:95]
    ds_read_b64_tr_b16 v[24:25], v1 offset:8192
    v_mul_f32 v249, v149, v149
    v_mfma_f32_16x16x32_bf16 v[92:95], v[36:39], a[36:39], v[92:95]
    ds_read_b64_tr_b16 v[26:27], v1 offset:8704
    v_fma_f32 v249, v249, s79, v252
    v_mfma_f32_16x16x32_bf16 v[88:91], v[36:39], a[32:35], v[88:91]
    buffer_load_dwordx4 v6, s[28:31], s60 offen  lds
    v_mfma_f32_16x16x32_bf16 v[88:91], v[32:35], a[16:19], v[88:91]
    v_rcp_f32 v251, v251
    v_mfma_f32_16x16x32_bf16 v[88:91], v[28:31], a[0:3], v[88:91]
    s_waitcnt lgkmcnt(4)
    v_exp_f32 v248, v248
    v_mfma_f32_16x16x32_bf16 v[72:75], v[16:19], a[144:147], v[72:75]
    s_waitcnt lgkmcnt(2)
    v_writelane_b32 v212, s86, 0
    v_writelane_b32 v212, s87, 1
    buffer_store_dword v213, v212, s[24:27], 0 offen sc1
    v_mfma_f32_16x16x32_bf16 v[72:75], v[20:23], a[160:163], v[72:75]
    s_waitcnt lgkmcnt(0)
    ds_read_b64_tr_b16 v[28:29], v1 offset:12288
    v_mul_f32 v147, v147, v251
    v_mfma_f32_16x16x32_bf16 v[72:75], v[24:27], a[176:179], v[72:75]
    s_add_u32 s60, s64, 4423680
    ds_read_b64_tr_b16 v[30:31], v1 offset:12800
    v_add_f32 v248, 1.0, v248
    v_mfma_f32_16x16x32_bf16 v[76:79], v[24:27], a[180:183], v[76:79]
    s_add_u32 m0, s59, 49152
    ds_read_b64_tr_b16 v[32:33], v1 offset:16384
    v_mul_f32 v249, v249, v149
    v_mfma_f32_16x16x32_bf16 v[76:79], v[20:23], a[164:167], v[76:79]
    s_lshl_b32 s86, s2, 2
    ds_read_b64_tr_b16 v[34:35], v1 offset:16896
    v_mul_f32 v250, v150, v150
    v_mfma_f32_16x16x32_bf16 v[76:79], v[16:19], a[148:151], v[76:79]
    s_add_u32 s86, s86, s54
    ds_read_b64_tr_b16 v[36:37], v1 offset:20480
    v_fma_f32 v250, v250, s79, v252
    v_mfma_f32_16x16x32_bf16 v[80:83], v[16:19], a[152:155], v[80:83]
    s_mul_i32 s86, s86, 2304
    ds_read_b64_tr_b16 v[38:39], v1 offset:20992
    v_mul_f32 v250, v250, v150
    v_mfma_f32_16x16x32_bf16 v[80:83], v[20:23], a[168:171], v[80:83]
    s_add_u32 s86, s86, 7340032
    v_rcp_f32 v248, v248
    v_mfma_f32_16x16x32_bf16 v[80:83], v[24:27], a[184:187], v[80:83]
    buffer_load_dwordx4 v6, s[28:31], s60 offen  lds
    v_mfma_f32_16x16x32_bf16 v[84:87], v[24:27], a[188:191], v[84:87]
    v_exp_f32 v249, v249
    v_mfma_f32_16x16x32_bf16 v[84:87], v[20:23], a[172:175], v[84:87]
    v_exp_f32 v250, v250
    v_mfma_f32_16x16x32_bf16 v[84:87], v[16:19], a[156:159], v[84:87]
    s_waitcnt lgkmcnt(4)
    v_mul_f32 v148, v148, v248
    v_add_f32 v249, 1.0, v249
    v_mfma_f32_16x16x32_bf16 v[84:87], v[28:31], a[204:207], v[84:87]
    s_waitcnt lgkmcnt(2)
    ds_read_b64_tr_b16 v[16:17], v1 offset:24576
    v_add_f32 v250, 1.0, v250
    v_mfma_f32_16x16x32_bf16 v[84:87], v[32:35], a[220:223], v[84:87]
    s_waitcnt lgkmcnt(1)
    ds_read_b64_tr_b16 v[18:19], v1 offset:25088
    v_mul_f32 v251, v151, v151
    v_mfma_f32_16x16x32_bf16 v[84:87], v[36:39], a[236:239], v[84:87]
    s_add_u32 s60, s64, 4718592
    ds_read_b64_tr_b16 v[20:21], v1 offset:28672
    v_fma_f32 v251, v251, s79, v252
    v_mfma_f32_16x16x32_bf16 v[80:83], v[36:39], a[232:235], v[80:83]
    s_add_u32 m0, s59, 51200
    ds_read_b64_tr_b16 v[22:23], v1 offset:29184
    v_mul_f32 v251, v251, v151
    v_mfma_f32_16x16x32_bf16 v[80:83], v[32:35], a[216:219], v[80:83]
    ds_read_b64_tr_b16 v[24:25], v1 offset:32768
    v_mul_f32 v248, v164, v164
    v_mfma_f32_16x16x32_bf16 v[80:83], v[28:31], a[200:203], v[80:83]
    ds_read_b64_tr_b16 v[26:27], v1 offset:33280
    v_fma_f32 v248, v248, s79, v252
    v_mfma_f32_16x16x32_bf16 v[76:79], v[28:31], a[196:199], v[76:79]
    buffer_load_dwordx4 v6, s[28:31], s60 offen  lds
    v_mfma_f32_16x16x32_bf16 v[76:79], v[32:35], a[212:215], v[76:79]
    v_rcp_f32 v249, v249
    v_mfma_f32_16x16x32_bf16 v[76:79], v[36:39], a[228:231], v[76:79]
    v_rcp_f32 v250, v250
    v_mfma_f32_16x16x32_bf16 v[72:75], v[36:39], a[224:227], v[72:75]
    v_exp_f32 v251, v251
    v_mfma_f32_16x16x32_bf16 v[72:75], v[32:35], a[208:211], v[72:75]
    v_mul_f32 v149, v149, v249
    v_mul_f32 v150, v150, v250
    v_mfma_f32_16x16x32_bf16 v[72:75], v[28:31], a[192:195], v[72:75]
    s_waitcnt lgkmcnt(4)
    v_add_f32 v251, 1.0, v251
    v_mul_f32 v248, v248, v164
    v_mfma_f32_16x16x32_bf16 v[72:75], v[16:19], a[240:243], v[72:75]
    s_waitcnt lgkmcnt(2)
    ds_read_b64_tr_b16 v[28:29], v2 offset:24576
    v_mul_f32 v249, v165, v165
    v_mfma_f32_16x16x32_bf16 v[72:75], v[20:23], v[40:43], v[72:75]
    s_waitcnt lgkmcnt(1)
    ds_read_b64_tr_b16 v[30:31], v2 offset:25088
    v_fma_f32 v249, v249, s79, v252
    v_mfma_f32_16x16x32_bf16 v[72:75], v[24:27], v[56:59], v[72:75]
    s_add_u32 s60, s64, 5013504
    ds_read_b64_tr_b16 v[32:33], v2 offset:28672
    v_mul_f32 v249, v249, v165
    v_mfma_f32_16x16x32_bf16 v[76:79], v[24:27], v[60:63], v[76:79]
    s_add_u32 m0, s59, 53248
    ds_read_b64_tr_b16 v[34:35], v2 offset:29184
    v_mul_f32 v250, v166, v166
    v_mfma_f32_16x16x32_bf16 v[76:79], v[20:23], v[44:47], v[76:79]
    ds_read_b64_tr_b16 v[36:37], v2 offset:32768
    v_fma_f32 v250, v250, s79, v252
    v_mfma_f32_16x16x32_bf16 v[76:79], v[16:19], a[244:247], v[76:79]
    buffer_load_dwordx4 v6, s[28:31], s60 offen  lds
    v_mfma_f32_16x16x32_bf16 v[80:83], v[16:19], a[248:251], v[80:83]
    ds_read_b64_tr_b16 v[38:39], v2 offset:33280
    v_mul_f32 v72, v72, v136
    v_mfma_f32_16x16x32_bf16 v[80:83], v[20:23], v[48:51], v[80:83]
    v_rcp_f32 v251, v251
    v_mfma_f32_16x16x32_bf16 v[80:83], v[24:27], v[64:67], v[80:83]
    v_exp_f32 v248, v248
    v_mfma_f32_16x16x32_bf16 v[84:87], v[24:27], v[68:71], v[84:87]
    s_add_u32 s60, s63, 256
    v_exp_f32 v249, v249
    v_mfma_f32_16x16x32_bf16 v[84:87], v[20:23], v[52:55], v[84:87]
    s_add_u32 m0, s55, 73728
    v_mul_f32 v73, v73, v137
    v_mul_f32 v74, v74, v138
    v_mfma_f32_16x16x32_bf16 v[84:87], v[16:19], a[252:255], v[84:87]
    s_waitcnt lgkmcnt(4)
    v_mul_f32 v75, v75, v139
    v_mul_f32 v76, v76, v140
    v_mfma_f32_16x16x32_bf16 v[100:103], v[28:31], a[252:255], v[100:103]
    s_waitcnt lgkmcnt(2)
    ds_read_b64_tr_b16 v[16:17], v2 offset:12288
    v_mul_f32 v77, v77, v141
    v_mfma_f32_16x16x32_bf16 v[100:103], v[32:35], v[52:55], v[100:103]
    s_waitcnt lgkmcnt(1)
    ds_read_b64_tr_b16 v[18:19], v2 offset:12800
    v_mul_f32 v78, v78, v142
    v_mfma_f32_16x16x32_bf16 v[100:103], v[36:39], v[68:71], v[100:103]
    ds_read_b64_tr_b16 v[20:21], v2 offset:16384
    v_mul_f32 v79, v79, v143
    v_mfma_f32_16x16x32_bf16 v[96:99], v[36:39], v[64:67], v[96:99]
    buffer_load_dwordx4 v4, s[12:15], s60 offen  lds
    v_mfma_f32_16x16x32_bf16 v[96:99], v[32:35], v[48:51], v[96:99]
    s_add_u32 s60, s63, 295168
    ds_read_b64_tr_b16 v[22:23], v2 offset:16896
    v_mul_f32 v80, v80, v144
    v_mfma_f32_16x16x32_bf16 v[96:99], v[28:31], a[248:251], v[96:99]
    s_add_u32 m0, s55, 77824
    ds_read_b64_tr_b16 v[24:25], v2 offset:20480
    v_mul_f32 v81, v81, v145
    v_mfma_f32_16x16x32_bf16 v[92:95], v[28:31], a[244:247], v[92:95]
    ds_read_b64_tr_b16 v[26:27], v2 offset:20992
    v_mul_f32 v82, v82, v146
    v_mfma_f32_16x16x32_bf16 v[92:95], v[32:35], v[44:47], v[92:95]
    v_mul_f32 v83, v83, v147
    v_mul_f32 v84, v84, v148
    v_mfma_f32_16x16x32_bf16 v[92:95], v[36:39], v[60:63], v[92:95]
    v_mul_f32 v85, v85, v149
    v_mul_f32 v86, v86, v150
    v_mfma_f32_16x16x32_bf16 v[88:91], v[36:39], v[56:59], v[88:91]
    buffer_load_dwordx4 v4, s[12:15], s60 offen  lds
    v_mfma_f32_16x16x32_bf16 v[88:91], v[32:35], v[40:43], v[88:91]
    s_add_u32 s60, s63, 590080
    v_cvt_pk_bf16_f32 v184, v72, v73
    v_cvt_pk_bf16_f32 v185, v74, v75
    v_mfma_f32_16x16x32_bf16 v[88:91], v[28:31], a[240:243], v[88:91]
    s_waitcnt lgkmcnt(4)
    v_cvt_pk_bf16_f32 v188, v76, v77
    v_cvt_pk_bf16_f32 v189, v78, v79
    v_mfma_f32_16x16x32_bf16 v[88:91], v[16:19], a[192:195], v[88:91]
    s_waitcnt lgkmcnt(2)
    ds_read_b64_tr_b16 v[28:29], v2 offset:0
    v_cvt_pk_bf16_f32 v192, v80, v81
    v_mfma_f32_16x16x32_bf16 v[88:91], v[20:23], a[208:211], v[88:91]
    s_waitcnt lgkmcnt(1)
    ds_read_b64_tr_b16 v[30:31], v2 offset:512
    v_cvt_pk_bf16_f32 v193, v82, v83
    v_mfma_f32_16x16x32_bf16 v[88:91], v[24:27], a[224:227], v[88:91]
    s_add_u32 m0, s55, 81920
    ds_read_b64_tr_b16 v[32:33], v2 offset:4096
    v_cvt_pk_bf16_f32 v196, v84, v85
    v_mfma_f32_16x16x32_bf16 v[92:95], v[24:27], a[228:231], v[92:95]
    buffer_load_dwordx4 v4, s[12:15], s60 offen  lds
    v_mfma_f32_16x16x32_bf16 v[92:95], v[20:23], a[212:215], v[92:95]
    s_add_u32 s60, s63, 884992
    ds_read_b64_tr_b16 v[34:35], v2 offset:4608
    v_mul_f32 v151, v151, v251
    v_mfma_f32_16x16x32_bf16 v[92:95], v[16:19], a[196:199], v[92:95]
    s_add_u32 m0, s55, 86016
    ds_read_b64_tr_b16 v[36:37], v2 offset:8192
    v_mul_f32 v87, v87, v151
    v_mfma_f32_16x16x32_bf16 v[96:99], v[16:19], a[200:203], v[96:99]
    ds_read_b64_tr_b16 v[38:39], v2 offset:8704
    v_cvt_pk_bf16_f32 v197, v86, v87
    v_mfma_f32_16x16x32_bf16 v[96:99], v[20:23], a[216:219], v[96:99]
    v_add_f32 v248, 1.0, v248
    v_add_f32 v249, 1.0, v249
    v_mfma_f32_16x16x32_bf16 v[96:99], v[24:27], a[232:235], v[96:99]
    buffer_load_dwordx4 v4, s[12:15], s60 offen  lds
    v_mfma_f32_16x16x32_bf16 v[100:103], v[24:27], a[236:239], v[100:103]
    s_add_u32 s60, s63, 1179904
    v_rcp_f32 v248, v248
    v_mfma_f32_16x16x32_bf16 v[100:103], v[20:23], a[220:223], v[100:103]
    s_add_u32 m0, s55, 90112
    v_rcp_f32 v249, v249
    v_mfma_f32_16x16x32_bf16 v[100:103], v[16:19], a[204:207], v[100:103]
    s_waitcnt lgkmcnt(4)
    v_mul_f32 v164, v164, v248
    v_mul_f32 v165, v165, v249
    v_mfma_f32_16x16x32_bf16 v[100:103], v[28:31], a[156:159], v[100:103]
    s_waitcnt lgkmcnt(2)
    v_mul_f32 v250, v250, v166
    v_mul_f32 v251, v167, v167
    v_mfma_f32_16x16x32_bf16 v[100:103], v[32:35], a[172:175], v[100:103]
    s_waitcnt vmcnt(15) lgkmcnt(0)
    s_barrier
    v_mfma_f32_16x16x32_bf16 v[100:103], v[36:39], a[188:191], v[100:103]
    buffer_load_dwordx4 v4, s[12:15], s60 offen  lds
    v_mfma_f32_16x16x32_bf16 v[96:99], v[36:39], a[184:187], v[96:99]
    s_add_u32 s60, s63, 1474816
    ds_read_b64_tr_b16 v[16:17], v3 offset:0
    v_fma_f32 v251, v251, s79, v252
    v_mfma_f32_16x16x32_bf16 v[96:99], v[32:35], a[168:171], v[96:99]
    s_add_u32 m0, s55, 94208
    ds_read_b64_tr_b16 v[18:19], v3 offset:256
    v_mul_f32 v251, v251, v167
    v_mfma_f32_16x16x32_bf16 v[96:99], v[28:31], a[152:155], v[96:99]
    ds_read_b64_tr_b16 v[20:21], v3 offset:2048
L_pg5:
    s_cbranch_execz L_pg9
    v_mul_f32 v248, v160, v160
    v_mfma_f32_16x16x32_bf16 v[92:95], v[28:31], a[148:151], v[92:95]
    ds_read_b64_tr_b16 v[22:23], v3 offset:2304
    v_mul_f32 v100, v100, v164
    v_mfma_f32_16x16x32_bf16 v[92:95], v[32:35], a[164:167], v[92:95]
    buffer_load_dwordx4 v4, s[12:15], s60 offen  lds
    v_mfma_f32_16x16x32_bf16 v[92:95], v[36:39], a[180:183], v[92:95]
    s_add_u32 s60, s63, 1769728
    ds_read_b64_tr_b16 v[24:25], v3 offset:4096
    ds_read_b64_tr_b16 v[26:27], v3 offset:4352
    v_mfma_f32_16x16x32_bf16 v[88:91], v[36:39], a[176:179], v[88:91]
    s_add_u32 m0, s55, 98304
    v_exp_f32 v250, v250
    v_mfma_f32_16x16x32_bf16 v[88:91], v[32:35], a[160:163], v[88:91]
    v_exp_f32 v251, v251
    v_mfma_f32_16x16x32_bf16 v[88:91], v[28:31], a[144:147], v[88:91]
    s_waitcnt lgkmcnt(4)
    v_mul_f32 v101, v101, v165
    v_cvt_pk_bf16_f32 v198, v100, v101
    v_mfma_f32_16x16x32_bf16 v[104:107], v[16:19], a[0:3], 0
    s_waitcnt lgkmcnt(2)
    ds_read_b64_tr_b16 v[28:29], v3 offset:6144
    v_add_f32 v250, 1.0, v250
    v_mfma_f32_16x16x32_bf16 v[104:107], v[20:23], a[16:19], v[104:107]
    s_waitcnt lgkmcnt(1)
    ds_read_b64_tr_b16 v[30:31], v3 offset:6400
    v_add_f32 v251, 1.0, v251
    v_mfma_f32_16x16x32_bf16 v[104:107], v[24:27], a[32:35], v[104:107]
    buffer_load_dwordx4 v4, s[12:15], s60 offen  lds
    v_mfma_f32_16x16x32_bf16 v[108:111], v[24:27], a[36:39], 0
    s_add_u32 s60, s63, 2064640
    ds_read_b64_tr_b16 v[32:33], v3 offset:8192
    v_fma_f32 v248, v248, s79, v252
    v_mfma_f32_16x16x32_bf16 v[108:111], v[20:23], a[20:23], v[108:111]
    s_add_u32 m0, s55, 102400
    ds_read_b64_tr_b16 v[34:35], v3 offset:8448
    v_mul_f32 v248, v248, v160
    v_mfma_f32_16x16x32_bf16 v[108:111], v[16:19], a[4:7], v[108:111]
    ds_read_b64_tr_b16 v[36:37], v3 offset:10240
    v_mul_f32 v249, v161, v161
    v_mfma_f32_16x16x32_bf16 v[112:115], v[16:19], a[8:11], 0
    buffer_load_dwordx4 v4, s[12:15], s60 offen  lds
    v_mfma_f32_16x16x32_bf16 v[112:115], v[20:23], a[24:27], v[112:115]
    s_add_u32 s60, s63, 2359552
    ds_read_b64_tr_b16 v[38:39], v3 offset:10496
    v_fma_f32 v249, v249, s79, v252
    v_mfma_f32_16x16x32_bf16 v[112:115], v[24:27], a[40:43], v[112:115]
    s_add_u32 m0, s55, 106496
    v_rcp_f32 v250, v250
    v_mfma_f32_16x16x32_bf16 v[116:119], v[24:27], a[44:47], 0
    v_rcp_f32 v251, v251
    v_mfma_f32_16x16x32_bf16 v[116:119], v[20:23], a[28:31], v[116:119]
    v_exp_f32 v248, v248
    v_mfma_f32_16x16x32_bf16 v[116:119], v[16:19], a[12:15], v[116:119]
    s_waitcnt lgkmcnt(4)
    v_mul_f32 v166, v166, v250
    v_mul_f32 v102, v102, v166
    v_mfma_f32_16x16x32_bf16 v[116:119], v[28:31], a[60:63], v[116:119]
    s_waitcnt lgkmcnt(2)
    ds_read_b64_tr_b16 v[16:17], v3 offset:12288
    v_mul_f32 v167, v167, v251
    v_mfma_f32_16x16x32_bf16 v[116:119], v[32:35], a[76:79], v[116:119]
    s_waitcnt lgkmcnt(1)
    ds_read_b64_tr_b16 v[18:19], v3 offset:12544
    v_mul_f32 v103, v103, v167
    v_mfma_f32_16x16x32_bf16 v[116:119], v[36:39], a[92:95], v[116:119]
    buffer_load_dwordx4 v4, s[12:15], s60 offen  lds
    v_mfma_f32_16x16x32_bf16 v[112:115], v[36:39], a[88:91], v[112:115]
    s_add_u32 s60, s63, 2654464
    ds_read_b64_tr_b16 v[20:21], v3 offset:14336
    v_cvt_pk_bf16_f32 v199, v102, v103
    v_mfma_f32_16x16x32_bf16 v[112:115], v[32:35], a[72:75], v[112:115]
    s_add_u32 m0, s55, 110592
    ds_read_b64_tr_b16 v[22:23], v3 offset:14592
    v_add_f32 v248, 1.0, v248
    v_mfma_f32_16x16x32_bf16 v[112:115], v[28:31], a[56:59], v[112:115]
    buffer_load_dwordx4 v4, s[12:15], s60 offen  lds
    v_mfma_f32_16x16x32_bf16 v[108:111], v[28:31], a[52:55], v[108:111]
    s_add_u32 s60, s63, 2949376
    ds_read_b64_tr_b16 v[24:25], v3 offset:16384
    v_mul_f32 v249, v249, v161
    v_mfma_f32_16x16x32_bf16 v[108:111], v[32:35], a[68:71], v[108:111]
    s_add_u32 m0, s55, 114688
    ds_read_b64_tr_b16 v[26:27], v3 offset:16640
    v_mul_f32 v250, v162, v162
    v_mfma_f32_16x16x32_bf16 v[108:111], v[36:39], a[84:87], v[108:111]
    v_rcp_f32 v248, v248
    v_mfma_f32_16x16x32_bf16 v[104:107], v[36:39], a[80:83], v[104:107]
    v_exp_f32 v249, v249
    v_mfma_f32_16x16x32_bf16 v[104:107], v[32:35], a[64:67], v[104:107]
    buffer_load_dwordx4 v4, s[12:15], s60 offen  lds
    v_mfma_f32_16x16x32_bf16 v[104:107], v[28:31], a[48:51], v[104:107]
    s_waitcnt lgkmcnt(4)
    v_mul_f32 v160, v160, v248
    v_mul_f32 v96, v96, v160
    v_mfma_f32_16x16x32_bf16 v[104:107], v[16:19], a[96:99], v[104:107]
    s_waitcnt lgkmcnt(2)
    ds_read_b64_tr_b16 v[28:29], v3 offset:30720
    v_add_f32 v249, 1.0, v249
    v_mfma_f32_16x16x32_bf16 v[104:107], v[20:23], a[112:115], v[104:107]
    s_waitcnt lgkmcnt(1)
    ds_read_b64_tr_b16 v[30:31], v3 offset:30976
    v_fma_f32 v250, v250, s79, v252
    v_mfma_f32_16x16x32_bf16 v[104:107], v[24:27], a[128:131], v[104:107]
    s_add_u32 s60, s63, 3244288
    ds_read_b64_tr_b16 v[32:33], v3 offset:32768
    v_mul_f32 v250, v250, v162
    v_mfma_f32_16x16x32_bf16 v[108:111], v[24:27], a[132:135], v[108:111]
    s_add_u32 m0, s55, 118784
    ds_read_b64_tr_b16 v[34:35], v3 offset:33024
    v_mul_f32 v251, v163, v163
    v_mfma_f32_16x16x32_bf16 v[108:111], v[20:23], a[116:119], v[108:111]
    buffer_load_dwordx4 v4, s[12:15], s60 offen  lds
    v_mfma_f32_16x16x32_bf16 v[108:111], v[16:19], a[100:103], v[108:111]
    s_add_u32 s60, s63, 3539200
    ds_read_b64_tr_b16 v[36:37], v3 offset:34816
    v_fma_f32 v251, v251, s79, v252
    v_mfma_f32_16x16x32_bf16 v[112:115], v[16:19], a[104:107], v[112:115]
    s_add_u32 m0, s55, 122880
    ds_read_b64_tr_b16 v[38:39], v3 offset:35072
    v_mul_f32 v251, v251, v163
    v_mfma_f32_16x16x32_bf16 v[112:115], v[20:23], a[120:123], v[112:115]
    v_rcp_f32 v249, v249
    v_mfma_f32_16x16x32_bf16 v[112:115], v[24:27], a[136:139], v[112:115]
    v_exp_f32 v250, v250
    v_mfma_f32_16x16x32_bf16 v[116:119], v[24:27], a[140:143], v[116:119]
    buffer_load_dwordx4 v4, s[12:15], s60 offen  lds
    v_mfma_f32_16x16x32_bf16 v[116:119], v[20:23], a[124:127], v[116:119]
    s_add_u32 s60, s63, 3834112
    v_exp_f32 v251, v251
    v_mfma_f32_16x16x32_bf16 v[116:119], v[16:19], a[108:111], v[116:119]
    s_waitcnt lgkmcnt(4)
    v_mul_f32 v161, v161, v249
    v_mul_f32 v97, v97, v161
    v_mfma_f32_16x16x32_bf16 v[132:135], v[28:31], a[108:111], 0
    s_waitcnt lgkmcnt(2)
    ds_read_b64_tr_b16 v[16:17], v3 offset:24576
    v_cvt_pk_bf16_f32 v194, v96, v97
    v_mfma_f32_16x16x32_bf16 v[132:135], v[32:35], a[124:127], v[132:135]
    s_waitcnt lgkmcnt(1)
    ds_read_b64_tr_b16 v[18:19], v3 offset:24832
    v_add_f32 v250, 1.0, v250
    v_mfma_f32_16x16x32_bf16 v[132:135], v[36:39], a[140:143], v[132:135]
    s_add_u32 m0, s55, 126976
    ds_read_b64_tr_b16 v[20:21], v3 offset:26624
    v_add_f32 v251, 1.0, v251
    v_mfma_f32_16x16x32_bf16 v[128:131], v[36:39], a[136:139], 0
    buffer_load_dwordx4 v4, s[12:15], s60 offen  lds
    v_mfma_f32_16x16x32_bf16 v[128:131], v[32:35], a[120:123], v[128:131]
    s_add_u32 s60, s63, 4129024
    ds_read_b64_tr_b16 v[22:23], v3 offset:26880
    v_mul_f32 v248, v156, v156
    v_mfma_f32_16x16x32_bf16 v[128:131], v[28:31], a[104:107], v[128:131]
    s_add_u32 m0, s55, 131072
    ds_read_b64_tr_b16 v[24:25], v3 offset:28672
    v_fma_f32 v248, v248, s79, v252
    v_mfma_f32_16x16x32_bf16 v[124:127], v[28:31], a[100:103], 0
    ds_read_b64_tr_b16 v[26:27], v3 offset:28928
    v_mul_f32 v248, v248, v156
    v_mfma_f32_16x16x32_bf16 v[124:127], v[32:35], a[116:119], v[124:127]
    v_rcp_f32 v250, v250
    v_mfma_f32_16x16x32_bf16 v[124:127], v[36:39], a[132:135], v[124:127]
    buffer_load_dwordx4 v4, s[12:15], s60 offen  lds
    v_mfma_f32_16x16x32_bf16 v[120:123], v[36:39], a[128:131], 0
    s_add_u32 s60, s63, 4423936
    v_rcp_f32 v251, v251
    v_mfma_f32_16x16x32_bf16 v[120:123], v[32:35], a[112:115], v[120:123]
    s_add_u32 m0, s55, 135168
    v_exp_f32 v248, v248
    v_mfma_f32_16x16x32_bf16 v[120:123], v[28:31], a[96:99], v[120:123]
    s_waitcnt lgkmcnt(4)
    v_mul_f32 v162, v162, v250
    v_mul_f32 v98, v98, v162
    v_mfma_f32_16x16x32_bf16 v[120:123], v[16:19], a[48:51], v[120:123]
    s_waitcnt lgkmcnt(2)
    ds_read_b64_tr_b16 v[28:29], v3 offset:18432
    v_mul_f32 v163, v163, v251
    v_mfma_f32_16x16x32_bf16 v[120:123], v[20:23], a[64:67], v[120:123]
    s_waitcnt lgkmcnt(1)
    ds_read_b64_tr_b16 v[30:31], v3 offset:18688
    v_mul_f32 v99, v99, v163
    v_mfma_f32_16x16x32_bf16 v[120:123], v[24:27], a[80:83], v[120:123]
    buffer_load_dwordx4 v4, s[12:15], s60 offen  lds
    v_mfma_f32_16x16x32_bf16 v[124:127], v[24:27], a[84:87], v[124:127]
    s_add_u32 s60, s63, 4718848
    ds_read_b64_tr_b16 v[32:33], v3 offset:20480
    v_cvt_pk_bf16_f32 v195, v98, v99
    v_mfma_f32_16x16x32_bf16 v[124:127], v[20:23], a[68:71], v[124:127]
    s_add_u32 m0, s55, 139264
    ds_read_b64_tr_b16 v[34:35], v3 offset:20736
    v_add_f32 v248, 1.0, v248
    v_mfma_f32_16x16x32_bf16 v[124:127], v[16:19], a[52:55], v[124:127]
    ds_read_b64_tr_b16 v[36:37], v3 offset:22528
    v_mul_f32 v249, v157, v157
    v_mfma_f32_16x16x32_bf16 v[128:131], v[16:19], a[56:59], v[128:131]
    ds_read_b64_tr_b16 v[38:39], v3 offset:22784
    v_fma_f32 v249, v249, s79, v252
    v_mfma_f32_16x16x32_bf16 v[128:131], v[20:23], a[72:75], v[128:131]
    v_add_u32 v3, 36864, v3
    v_mul_f32 v249, v249, v157
    v_mfma_f32_16x16x32_bf16 v[128:131], v[24:27], a[88:91], v[128:131]
    buffer_load_dwordx4 v4, s[12:15], s60 offen  lds
    v_mfma_f32_16x16x32_bf16 v[132:135], v[24:27], a[92:95], v[132:135]
    s_add_u32 s60, s63, 5013760
    v_rcp_f32 v248, v248
    v_mfma_f32_16x16x32_bf16 v[132:135], v[20:23], a[76:79], v[132:135]
    s_add_u32 m0, s55, 143360
    v_exp_f32 v249, v249
    v_mfma_f32_16x16x32_bf16 v[132:135], v[16:19], a[60:63], v[132:135]
    s_waitcnt lgkmcnt(4)
    v_mul_f32 v156, v156, v248
    v_mul_f32 v92, v92, v156
    v_mfma_f32_16x16x32_bf16 v[132:135], v[28:31], a[12:15], v[132:135]
    s_waitcnt lgkmcnt(2)
    v_add_f32 v249, 1.0, v249
    v_mul_f32 v250, v158, v158
    v_mfma_f32_16x16x32_bf16 v[132:135], v[32:35], a[28:31], v[132:135]
    s_waitcnt vmcnt(17) lgkmcnt(0)
    s_barrier
    v_mfma_f32_16x16x32_bf16 v[132:135], v[36:39], a[44:47], v[132:135]
    buffer_load_dwordx4 v4, s[12:15], s60 offen  lds
    v_mfma_f32_16x16x32_bf16 v[128:131], v[36:39], a[40:43], v[128:131]
    s_add_u32 s60, s63, 256
    ds_read_b64_tr_b16 v[16:17], v3 offset:0
    v_fma_f32 v250, v250, s79, v252
    v_mfma_f32_16x16x32_bf16 v[128:131], v[32:35], a[24:27], v[128:131]
    s_add_u32 m0, s55, 0
    ds_read_b64_tr_b16 v[18:19], v3 offset:256
    v_mul_f32 v250, v250, v158
    v_mfma_f32_16x16x32_bf16 v[128:131], v[28:31], a[8:11], v[128:131]
    ds_read_b64_tr_b16 v[20:21], v3 offset:2048
    v_mul_f32 v251, v159, v159
    v_mfma_f32_16x16x32_bf16 v[124:127], v[28:31], a[4:7], v[124:127]
    buffer_load_dwordx4 v4, s[16:19], s60 offen  lds
    v_mfma_f32_16x16x32_bf16 v[124:127], v[32:35], a[20:23], v[124:127]
    s_add_u32 s60, s63, 295168
    ds_read_b64_tr_b16 v[22:23], v3 offset:2304
    ds_read_b64_tr_b16 v[24:25], v3 offset:4096
    v_mfma_f32_16x16x32_bf16 v[124:127], v[36:39], a[36:39], v[124:127]
    s_add_u32 m0, s55, 4096
    ds_read_b64_tr_b16 v[26:27], v3 offset:4352
    v_fma_f32 v251, v251, s79, v252
    v_mfma_f32_16x16x32_bf16 v[120:123], v[36:39], a[32:35], v[120:123]
    v_rcp_f32 v249, v249
    v_mfma_f32_16x16x32_bf16 v[120:123], v[32:35], a[16:19], v[120:123]
    v_exp_f32 v250, v250
    v_mfma_f32_16x16x32_bf16 v[120:123], v[28:31], a[0:3], v[120:123]
    s_waitcnt lgkmcnt(4)
    v_mul_f32 v157, v157, v249
    v_mul_f32 v93, v93, v157
    v_mfma_f32_16x16x32_bf16 v[104:107], v[16:19], a[144:147], v[104:107]
    s_waitcnt lgkmcnt(2)
    ds_read_b64_tr_b16 v[28:29], v3 offset:6144
    v_cvt_pk_bf16_f32 v190, v92, v93
    v_mfma_f32_16x16x32_bf16 v[104:107], v[20:23], a[160:163], v[104:107]
    s_waitcnt lgkmcnt(1)
    ds_read_b64_tr_b16 v[30:31], v3 offset:6400
    v_add_f32 v250, 1.0, v250
    v_mfma_f32_16x16x32_bf16 v[104:107], v[24:27], a[176:179], v[104:107]
    buffer_load_dwordx4 v4, s[16:19], s60 offen  lds
    v_mfma_f32_16x16x32_bf16 v[108:111], v[24:27], a[180:183], v[108:111]
    s_add_u32 s60, s63, 590080
    ds_read_b64_tr_b16 v[32:33], v3 offset:8192
    v_mul_f32 v251, v251, v159
    v_mfma_f32_16x16x32_bf16 v[108:111], v[20:23], a[164:167], v[108:111]
    s_add_u32 m0, s55, 8192
    ds_read_b64_tr_b16 v[34:35], v3 offset:8448
    v_mul_f32 v248, v152, v152
    v_mfma_f32_16x16x32_bf16 v[108:111], v[16:19], a[148:151], v[108:111]
    buffer_load_dwordx4 v4, s[16:19], s60 offen  lds
    v_mfma_f32_16x16x32_bf16 v[112:115], v[16:19], a[152:155], v[112:115]
    s_add_u32 s60, s63, 884992
    ds_read_b64_tr_b16 v[36:37], v3 offset:10240
    v_fma_f32 v248, v248, s79, v252
    v_mfma_f32_16x16x32_bf16 v[112:115], v[20:23], a[168:171], v[112:115]
    s_add_u32 m0, s55, 12288
    ds_read_b64_tr_b16 v[38:39], v3 offset:10496
    v_mul_f32 v248, v248, v152
    v_mfma_f32_16x16x32_bf16 v[112:115], v[24:27], a[184:187], v[112:115]
    v_rcp_f32 v250, v250
    v_mfma_f32_16x16x32_bf16 v[116:119], v[24:27], a[188:191], v[116:119]
    v_exp_f32 v251, v251
    v_mfma_f32_16x16x32_bf16 v[116:119], v[20:23], a[172:175], v[116:119]
    v_exp_f32 v248, v248
    v_mfma_f32_16x16x32_bf16 v[116:119], v[16:19], a[156:159], v[116:119]
    s_waitcnt lgkmcnt(4)
    v_mul_f32 v158, v158, v250
    v_mul_f32 v94, v94, v158
    v_mfma_f32_16x16x32_bf16 v[116:119], v[28:31], a[204:207], v[116:119]
    s_waitcnt lgkmcnt(2)
    ds_read_b64_tr_b16 v[16:17], v3 offset:12288
    v_add_f32 v251, 1.0, v251
    v_mfma_f32_16x16x32_bf16 v[116:119], v[32:35], a[220:223], v[116:119]
    s_waitcnt lgkmcnt(1)
    ds_read_b64_tr_b16 v[18:19], v3 offset:12544
    v_add_f32 v248, 1.0, v248
    v_mfma_f32_16x16x32_bf16 v[116:119], v[36:39], a[236:239], v[116:119]
    buffer_load_dwordx4 v4, s[16:19], s60 offen  lds
    v_mfma_f32_16x16x32_bf16 v[112:115], v[36:39], a[232:235], v[112:115]
    s_add_u32 s60, s63, 1179904
    ds_read_b64_tr_b16 v[20:21], v3 offset:14336
    v_mul_f32 v249, v153, v153
    v_mfma_f32_16x16x32_bf16 v[112:115], v[32:35], a[216:219], v[112:115]
    s_add_u32 m0, s55, 16384
    ds_read_b64_tr_b16 v[22:23], v3 offset:14592
    v_fma_f32 v249, v249, s79, v252
    v_mfma_f32_16x16x32_bf16 v[112:115], v[28:31], a[200:203], v[112:115]
    ds_read_b64_tr_b16 v[24:25], v3 offset:16384
    v_mul_f32 v249, v249, v153
    v_mfma_f32_16x16x32_bf16 v[108:111], v[28:31], a[196:199], v[108:111]
    ds_read_b64_tr_b16 v[26:27], v3 offset:16640
    v_mul_f32 v250, v154, v154
    v_mfma_f32_16x16x32_bf16 v[108:111], v[32:35], a[212:215], v[108:111]
    buffer_load_dwordx4 v4, s[16:19], s60 offen  lds
    v_mfma_f32_16x16x32_bf16 v[108:111], v[36:39], a[228:231], v[108:111]
    s_add_u32 s60, s63, 1474816
    v_rcp_f32 v251, v251
    v_mfma_f32_16x16x32_bf16 v[104:107], v[36:39], a[224:227], v[104:107]
    s_add_u32 m0, s55, 20480
    v_rcp_f32 v248, v248
    v_mfma_f32_16x16x32_bf16 v[104:107], v[32:35], a[208:211], v[104:107]
    v_exp_f32 v249, v249
    v_mfma_f32_16x16x32_bf16 v[104:107], v[28:31], a[192:195], v[104:107]
    s_waitcnt lgkmcnt(4)
    v_mul_f32 v159, v159, v251
    v_mul_f32 v95, v95, v159
    v_mfma_f32_16x16x32_bf16 v[104:107], v[16:19], a[240:243], v[104:107]
    s_waitcnt lgkmcnt(2)
    ds_read_b64_tr_b16 v[28:29], v3 offset:30720
    v_cvt_pk_bf16_f32 v191, v94, v95
    v_mfma_f32_16x16x32_bf16 v[104:107], v[20:23], v[40:43], v[104:107]
    s_waitcnt lgkmcnt(1)
    ds_read_b64_tr_b16 v[30:31], v3 offset:30976
    v_mul_f32 v152, v152, v248
    v_mfma_f32_16x16x32_bf16 v[104:107], v[24:27], v[56:59], v[104:107]
    buffer_load_dwordx4 v4, s[16:19], s60 offen  lds
    v_mfma_f32_16x16x32_bf16 v[108:111], v[24:27], v[60:63], v[108:111]
    s_add_u32 s60, s63, 1769728
    ds_read_b64_tr_b16 v[32:33], v3 offset:32768
    v_mul_f32 v88, v88, v152
    v_mfma_f32_16x16x32_bf16 v[108:111], v[20:23], v[44:47], v[108:111]
    s_add_u32 m0, s55, 24576
    ds_read_b64_tr_b16 v[34:35], v3 offset:33024
    v_add_f32 v249, 1.0, v249
    v_mfma_f32_16x16x32_bf16 v[108:111], v[16:19], a[244:247], v[108:111]
    ds_read_b64_tr_b16 v[36:37], v3 offset:34816
    v_fma_f32 v250, v250, s79, v252
    v_mfma_f32_16x16x32_bf16 v[112:115], v[16:19], a[248:251], v[112:115]
    ds_read_b64_tr_b16 v[38:39], v3 offset:35072
    v_mul_f32 v250, v250, v154
    v_mfma_f32_16x16x32_bf16 v[112:115], v[20:23], v[48:51], v[112:115]
    v_rcp_f32 v249, v249
    v_mfma_f32_16x16x32_bf16 v[112:115], v[24:27], v[64:67], v[112:115]
    v_exp_f32 v250, v250
    v_mfma_f32_16x16x32_bf16 v[116:119], v[24:27], v[68:71], v[116:119]
    buffer_load_dwordx4 v4, s[16:19], s60 offen  lds
    v_mfma_f32_16x16x32_bf16 v[116:119], v[20:23], v[52:55], v[116:119]
    v_mul_f32 v153, v153, v249
    v_mul_f32 v89, v89, v153
    v_mfma_f32_16x16x32_bf16 v[116:119], v[16:19], a[252:255], v[116:119]
    s_waitcnt lgkmcnt(4)
    v_cvt_pk_bf16_f32 v186, v88, v89
    v_add_f32 v250, 1.0, v250
    v_mfma_f32_16x16x32_bf16 v[132:135], v[28:31], a[252:255], v[132:135]
    s_waitcnt lgkmcnt(2)
    ds_read_b64_tr_b16 v[16:17], v3 offset:24576
    v_mul_f32 v251, v155, v155
    v_mfma_f32_16x16x32_bf16 v[132:135], v[32:35], v[52:55], v[132:135]
    s_waitcnt lgkmcnt(1)
    ds_read_b64_tr_b16 v[18:19], v3 offset:24832
    v_fma_f32 v251, v251, s79, v252
    v_mfma_f32_16x16x32_bf16 v[132:135], v[36:39], v[68:71], v[132:135]
    s_add_u32 s60, s63, 2064640
    ds_read_b64_tr_b16 v[20:21], v3 offset:26624
    v_mul_f32 v251, v251, v155
    v_mfma_f32_16x16x32_bf16 v[128:131], v[36:39], v[64:67], v[128:131]
    s_add_u32 m0, s55, 28672
    ds_read_b64_tr_b16 v[22:23], v3 offset:26880
    v_mul_f32 v248, v104, v104
    v_mfma_f32_16x16x32_bf16 v[128:131], v[32:35], v[48:51], v[128:131]
    ds_read_b64_tr_b16 v[24:25], v3 offset:28672
    v_fma_f32 v248, v248, s79, v252
    v_mfma_f32_16x16x32_bf16 v[128:131], v[28:31], a[248:251], v[128:131]
    buffer_load_dwordx4 v4, s[16:19], s60 offen  lds
    v_mfma_f32_16x16x32_bf16 v[124:127], v[28:31], a[244:247], v[124:127]
    s_add_u32 s60, s63, 2359552
    ds_read_b64_tr_b16 v[26:27], v3 offset:28928
    v_mul_f32 v248, v248, v104
    v_mfma_f32_16x16x32_bf16 v[124:127], v[32:35], v[44:47], v[124:127]
    s_add_u32 m0, s55, 32768
    v_rcp_f32 v250, v250
    v_mfma_f32_16x16x32_bf16 v[124:127], v[36:39], v[60:63], v[124:127]
    v_exp_f32 v251, v251
    v_mfma_f32_16x16x32_bf16 v[120:123], v[36:39], v[56:59], v[120:123]
    v_exp_f32 v248, v248
    v_mfma_f32_16x16x32_bf16 v[120:123], v[32:35], v[40:43], v[120:123]
    v_mul_f32 v154, v154, v250
    v_mul_f32 v90, v90, v154
    v_mfma_f32_16x16x32_bf16 v[120:123], v[28:31], a[240:243], v[120:123]
    s_waitcnt lgkmcnt(4)
    v_add_f32 v251, 1.0, v251
    v_add_f32 v248, 1.0, v248
    v_mfma_f32_16x16x32_bf16 v[120:123], v[16:19], a[192:195], v[120:123]
    s_waitcnt lgkmcnt(2)
    ds_read_b64_tr_b16 v[28:29], v3 offset:18432
    v_mul_f32 v249, v105, v105
    v_mfma_f32_16x16x32_bf16 v[120:123], v[20:23], a[208:211], v[120:123]
    s_waitcnt lgkmcnt(1)
    ds_read_b64_tr_b16 v[30:31], v3 offset:18688
    v_fma_f32 v249, v249, s79, v252
    v_mfma_f32_16x16x32_bf16 v[120:123], v[24:27], a[224:227], v[120:123]
    v_add_u32 v1, 4294930432, v1
    v_add_u32 v2, 4294930432, v2
    v_mfma_f32_16x16x32_bf16 v[124:127], v[24:27], a[228:231], v[124:127]
    buffer_load_dwordx4 v4, s[16:19], s60 offen  lds
    v_mfma_f32_16x16x32_bf16 v[124:127], v[20:23], a[212:215], v[124:127]
    ds_read_b64_tr_b16 v[32:33], v3 offset:20480
    v_mul_f32 v249, v249, v105
    v_mfma_f32_16x16x32_bf16 v[124:127], v[16:19], a[196:199], v[124:127]
    ds_read_b64_tr_b16 v[34:35], v3 offset:20736
    v_mul_f32 v250, v106, v106
    v_mfma_f32_16x16x32_bf16 v[128:131], v[16:19], a[200:203], v[128:131]
    ds_read_b64_tr_b16 v[36:37], v3 offset:22528
    v_fma_f32 v250, v250, s79, v252
    v_mfma_f32_16x16x32_bf16 v[128:131], v[20:23], a[216:219], v[128:131]
    ds_read_b64_tr_b16 v[38:39], v3 offset:22784
    v_mul_f32 v250, v250, v106
    v_mfma_f32_16x16x32_bf16 v[128:131], v[24:27], a[232:235], v[128:131]
    s_add_u32 s60, s63, 2654464
    v_rcp_f32 v251, v251
    v_mfma_f32_16x16x32_bf16 v[132:135], v[24:27], a[236:239], v[132:135]
    s_add_u32 m0, s55, 36864
    v_rcp_f32 v248, v248
    v_mfma_f32_16x16x32_bf16 v[132:135], v[20:23], a[220:223], v[132:135]
    v_exp_f32 v249, v249
    v_mfma_f32_16x16x32_bf16 v[132:135], v[16:19], a[204:207], v[132:135]
    s_waitcnt lgkmcnt(4)
    v_exp_f32 v250, v250
    v_mfma_f32_16x16x32_bf16 v[132:135], v[28:31], a[156:159], v[132:135]
    s_waitcnt lgkmcnt(2)
    v_mul_f32 v155, v155, v251
    v_mul_f32 v91, v91, v155
    v_mfma_f32_16x16x32_bf16 v[132:135], v[32:35], a[172:175], v[132:135]
    s_waitcnt vmcnt(18) lgkmcnt(0)
    s_barrier
    v_mfma_f32_16x16x32_bf16 v[132:135], v[36:39], a[188:191], v[132:135]
    buffer_load_dwordx4 v4, s[16:19], s60 offen  lds
    v_mfma_f32_16x16x32_bf16 v[128:131], v[36:39], a[184:187], v[128:131]
    s_add_u32 s60, s63, 2949376
    ds_read_b64_tr_b16 v[16:17], v1 offset:0
    v_cvt_pk_bf16_f32 v187, v90, v91
    v_mfma_f32_16x16x32_bf16 v[128:131], v[32:35], a[168:171], v[128:131]
    s_add_u32 m0, s55, 40960
    ds_read_b64_tr_b16 v[18:19], v1 offset:512
    v_mul_f32 v104, v104, v248
    v_mfma_f32_16x16x32_bf16 v[128:131], v[28:31], a[152:155], v[128:131]
    ds_read_b64_tr_b16 v[20:21], v1 offset:4096
    v_add_f32 v249, 1.0, v249
    v_mfma_f32_16x16x32_bf16 v[124:127], v[28:31], a[148:151], v[124:127]
    ds_read_b64_tr_b16 v[22:23], v1 offset:4608
    v_add_f32 v250, 1.0, v250
    v_mfma_f32_16x16x32_bf16 v[124:127], v[32:35], a[164:167], v[124:127]
    ds_read_b64_tr_b16 v[24:25], v1 offset:8192
    v_mul_f32 v251, v107, v107
    v_mfma_f32_16x16x32_bf16 v[124:127], v[36:39], a[180:183], v[124:127]
    ds_read_b64_tr_b16 v[26:27], v1 offset:8704
    v_fma_f32 v251, v251, s79, v252
    v_mfma_f32_16x16x32_bf16 v[120:123], v[36:39], a[176:179], v[120:123]
    buffer_load_dwordx4 v4, s[16:19], s60 offen  lds
    v_mfma_f32_16x16x32_bf16 v[120:123], v[32:35], a[160:163], v[120:123]
    s_add_u32 s60, s63, 3244288
    v_rcp_f32 v249, v249
    v_mfma_f32_16x16x32_bf16 v[120:123], v[28:31], a[144:147], v[120:123]
    s_waitcnt lgkmcnt(4)
    v_rcp_f32 v250, v250
    v_mfma_f32_16x16x32_bf16 v[136:139], v[16:19], a[0:3], 0
    s_waitcnt lgkmcnt(2)
    ds_read_b64_tr_b16 v[28:29], v1 offset:12288
    v_mul_f32 v105, v105, v249
    v_mfma_f32_16x16x32_bf16 v[136:139], v[20:23], a[16:19], v[136:139]
    s_waitcnt lgkmcnt(1)
    ds_read_b64_tr_b16 v[30:31], v1 offset:12800
    v_mul_f32 v106, v106, v250
    v_mfma_f32_16x16x32_bf16 v[136:139], v[24:27], a[32:35], v[136:139]
    s_add_u32 m0, s55, 45056
    ds_read_b64_tr_b16 v[32:33], v1 offset:16384
    v_mul_f32 v251, v251, v107
    v_mfma_f32_16x16x32_bf16 v[140:143], v[24:27], a[36:39], 0
    ds_read_b64_tr_b16 v[34:35], v1 offset:16896
    v_mul_f32 v120, v120, v104
    v_mfma_f32_16x16x32_bf16 v[140:143], v[20:23], a[20:23], v[140:143]
    buffer_load_dwordx4 v4, s[16:19], s60 offen  lds
    v_mfma_f32_16x16x32_bf16 v[140:143], v[16:19], a[4:7], v[140:143]
    s_add_u32 s60, s63, 3539200
    ds_read_b64_tr_b16 v[36:37], v1 offset:20480
    v_mul_f32 v121, v121, v105
    v_mfma_f32_16x16x32_bf16 v[144:147], v[16:19], a[8:11], 0
    s_add_u32 m0, s55, 49152
    ds_read_b64_tr_b16 v[38:39], v1 offset:20992
    v_mul_f32 v122, v122, v106
    v_mfma_f32_16x16x32_bf16 v[144:147], v[20:23], a[24:27], v[144:147]
    v_exp_f32 v251, v251
    v_mfma_f32_16x16x32_bf16 v[144:147], v[24:27], a[40:43], v[144:147]
    v_add_f32 v251, 1.0, v251
    v_mul_f32 v248, v108, v108
    v_mfma_f32_16x16x32_bf16 v[148:151], v[24:27], a[44:47], 0
    v_rcp_f32 v251, v251
    v_mfma_f32_16x16x32_bf16 v[148:151], v[20:23], a[28:31], v[148:151]
    v_mul_f32 v107, v107, v251
    v_mul_f32 v123, v123, v107
    v_mfma_f32_16x16x32_bf16 v[148:151], v[16:19], a[12:15], v[148:151]
    s_waitcnt lgkmcnt(4)
    v_cvt_pk_bf16_f32 v104, v120, v121
    v_cvt_pk_bf16_f32 v105, v122, v123
    v_mfma_f32_16x16x32_bf16 v[148:151], v[28:31], a[60:63], v[148:151]
    s_waitcnt lgkmcnt(2)
    ds_read_b64_tr_b16 v[16:17], v1 offset:24576
    v_fma_f32 v248, v248, s79, v252
    v_mfma_f32_16x16x32_bf16 v[148:151], v[32:35], a[76:79], v[148:151]
    s_waitcnt lgkmcnt(1)
    ds_read_b64_tr_b16 v[18:19], v1 offset:25088
    v_mul_f32 v248, v248, v108
    v_mfma_f32_16x16x32_bf16 v[148:151], v[36:39], a[92:95], v[148:151]
    buffer_load_dwordx4 v4, s[16:19], s60 offen  lds
    v_mfma_f32_16x16x32_bf16 v[144:147], v[36:39], a[88:91], v[144:147]
    s_add_u32 s60, s63, 3834112
    ds_read_b64_tr_b16 v[20:21], v1 offset:28672
    v_mul_f32 v249, v109, v109
    v_mfma_f32_16x16x32_bf16 v[144:147], v[32:35], a[72:75], v[144:147]
    s_add_u32 m0, s55, 53248
    ds_read_b64_tr_b16 v[22:23], v1 offset:29184
    v_fma_f32 v249, v249, s79, v252
    v_mfma_f32_16x16x32_bf16 v[144:147], v[28:31], a[56:59], v[144:147]
    ds_read_b64_tr_b16 v[24:25], v1 offset:32768
    v_mul_f32 v249, v249, v109
    v_mfma_f32_16x16x32_bf16 v[140:143], v[28:31], a[52:55], v[140:143]
    ds_read_b64_tr_b16 v[26:27], v1 offset:33280
    v_mul_f32 v250, v110, v110
    v_mfma_f32_16x16x32_bf16 v[140:143], v[32:35], a[68:71], v[140:143]
    buffer_load_dwordx4 v4, s[16:19], s60 offen  lds
    v_mfma_f32_16x16x32_bf16 v[140:143], v[36:39], a[84:87], v[140:143]
    s_add_u32 s60, s63, 4129024
    ds_write_b64 v8, v[104:105] offset:36864
    v_mfma_f32_16x16x32_bf16 v[136:139], v[36:39], a[80:83], v[136:139]
    s_add_u32 m0, s55, 57344
    v_exp_f32 v248, v248
    v_mfma_f32_16x16x32_bf16 v[136:139], v[32:35], a[64:67], v[136:139]
    v_exp_f32 v249, v249
    v_mfma_f32_16x16x32_bf16 v[136:139], v[28:31], a[48:51], v[136:139]
    s_waitcnt lgkmcnt(5)
    v_add_f32 v248, 1.0, v248
    v_add_f32 v249, 1.0, v249
    v_mfma_f32_16x16x32_bf16 v[136:139], v[16:19], a[96:99], v[136:139]
    s_waitcnt lgkmcnt(3)
    ds_read_b64_tr_b16 v[28:29], v2 offset:24576
    v_fma_f32 v250, v250, s79, v252
    v_mfma_f32_16x16x32_bf16 v[136:139], v[20:23], a[112:115], v[136:139]
    s_waitcnt lgkmcnt(2)
    ds_read_b64_tr_b16 v[30:31], v2 offset:25088
    v_mul_f32 v250, v250, v110
    v_mfma_f32_16x16x32_bf16 v[136:139], v[24:27], a[128:131], v[136:139]
    buffer_load_dwordx4 v4, s[16:19], s60 offen  lds
    v_mfma_f32_16x16x32_bf16 v[140:143], v[24:27], a[132:135], v[140:143]
    s_add_u32 s60, s63, 4423936
    ds_read_b64_tr_b16 v[32:33], v2 offset:28672
    v_mul_f32 v251, v111, v111
    v_mfma_f32_16x16x32_bf16 v[140:143], v[20:23], a[116:119], v[140:143]
    s_add_u32 m0, s55, 61440
    ds_read_b64_tr_b16 v[34:35], v2 offset:29184
    v_fma_f32 v251, v251, s79, v252
    v_mfma_f32_16x16x32_bf16 v[140:143], v[16:19], a[100:103], v[140:143]
    ds_read_b64_tr_b16 v[36:37], v2 offset:32768
    v_mul_f32 v251, v251, v111
    v_mfma_f32_16x16x32_bf16 v[144:147], v[16:19], a[104:107], v[144:147]
    ds_read_b64_tr_b16 v[38:39], v2 offset:33280
    v_lshlrev_b32 v220, 4, v0
    v_mfma_f32_16x16x32_bf16 v[144:147], v[20:23], a[120:123], v[144:147]
    v_rcp_f32 v248, v248
    v_mfma_f32_16x16x32_bf16 v[144:147], v[24:27], a[136:139], v[144:147]
    v_rcp_f32 v249, v249
    v_mfma_f32_16x16x32_bf16 v[148:151], v[24:27], a[140:143], v[148:151]
    buffer_load_dwordx4 v4, s[16:19], s60 offen  lds
    v_mfma_f32_16x16x32_bf16 v[148:151], v[20:23], a[124:127], v[148:151]
    v_exp_f32 v250, v250
    v_mfma_f32_16x16x32_bf16 v[148:151], v[16:19], a[108:111], v[148:151]
    s_waitcnt lgkmcnt(4)
    v_exp_f32 v251, v251
    v_mfma_f32_16x16x32_bf16 v[164:167], v[28:31], a[108:111], 0
    s_waitcnt lgkmcnt(2)
    ds_read_b64_tr_b16 v[16:17], v2 offset:12288
    v_mul_f32 v108, v108, v248
    v_mfma_f32_16x16x32_bf16 v[164:167], v[32:35], a[124:127], v[164:167]
    s_waitcnt lgkmcnt(1)
    ds_read_b64_tr_b16 v[18:19], v2 offset:12800
    v_mul_f32 v109, v109, v249
    v_mfma_f32_16x16x32_bf16 v[164:167], v[36:39], a[140:143], v[164:167]
    s_add_u32 s60, s63, 4718848
    ds_read_b64_tr_b16 v[20:21], v2 offset:16384
    v_add_f32 v250, 1.0, v250
    v_mfma_f32_16x16x32_bf16 v[160:163], v[36:39], a[136:139], 0
    s_add_u32 m0, s55, 65536
    ds_read_b64_tr_b16 v[22:23], v2 offset:16896
    v_add_f32 v251, 1.0, v251
    v_mfma_f32_16x16x32_bf16 v[160:163], v[32:35], a[120:123], v[160:163]
    ds_read_b64_tr_b16 v[24:25], v2 offset:20480
    v_mul_f32 v124, v124, v108
    v_mfma_f32_16x16x32_bf16 v[160:163], v[28:31], a[104:107], v[160:163]
    buffer_load_dwordx4 v4, s[16:19], s60 offen  lds
    v_mfma_f32_16x16x32_bf16 v[156:159], v[28:31], a[100:103], 0
    s_add_u32 s60, s63, 5013760
L_pg6:
    s_cbranch_execz L_pg10
    ds_read_b64_tr_b16 v[26:27], v2 offset:20992
    v_mul_f32 v125, v125, v109
    v_mfma_f32_16x16x32_bf16 v[156:159], v[32:35], a[116:119], v[156:159]
    s_add_u32 m0, s55, 69632
    v_rcp_f32 v250, v250
    v_mfma_f32_16x16x32_bf16 v[156:159], v[36:39], a[132:135], v[156:159]
    v_rcp_f32 v251, v251
    v_mfma_f32_16x16x32_bf16 v[152:155], v[36:39], a[128:131], 0
    v_mul_f32 v110, v110, v250
    v_mul_f32 v111, v111, v251
    v_mfma_f32_16x16x32_bf16 v[152:155], v[32:35], a[112:115], v[152:155]
    v_mul_f32 v126, v126, v110
    v_mul_f32 v127, v127, v111
    v_mfma_f32_16x16x32_bf16 v[152:155], v[28:31], a[96:99], v[152:155]
    s_waitcnt lgkmcnt(4)
    v_cvt_pk_bf16_f32 v108, v124, v125
    v_cvt_pk_bf16_f32 v109, v126, v127
    v_mfma_f32_16x16x32_bf16 v[152:155], v[16:19], a[48:51], v[152:155]
    s_waitcnt lgkmcnt(2)
    ds_read_b64_tr_b16 v[28:29], v2 offset:0
    v_mul_f32 v248, v112, v112
    v_mfma_f32_16x16x32_bf16 v[152:155], v[20:23], a[64:67], v[152:155]
    s_waitcnt lgkmcnt(1)
    ds_read_b64_tr_b16 v[30:31], v2 offset:512
    v_fma_f32 v248, v248, s79, v252
    v_mfma_f32_16x16x32_bf16 v[152:155], v[24:27], a[80:83], v[152:155]
    buffer_load_dwordx4 v4, s[16:19], s60 offen  lds
    v_mfma_f32_16x16x32_bf16 v[156:159], v[24:27], a[84:87], v[156:159]
    ds_read_b64_tr_b16 v[32:33], v2 offset:4096
    v_mul_f32 v248, v248, v112
    v_mfma_f32_16x16x32_bf16 v[156:159], v[20:23], a[68:71], v[156:159]
    ds_read_b64_tr_b16 v[34:35], v2 offset:4608
    v_mul_f32 v249, v113, v113
    v_mfma_f32_16x16x32_bf16 v[156:159], v[16:19], a[52:55], v[156:159]
    ds_read_b64_tr_b16 v[36:37], v2 offset:8192
    v_fma_f32 v249, v249, s79, v252
    v_mfma_f32_16x16x32_bf16 v[160:163], v[16:19], a[56:59], v[160:163]
    ds_read_b64_tr_b16 v[38:39], v2 offset:8704
    v_mul_f32 v249, v249, v113
    v_mfma_f32_16x16x32_bf16 v[160:163], v[20:23], a[72:75], v[160:163]
    v_add_u32 v1, 36864, v1
    v_add_u32 v2, 36864, v2
    v_mfma_f32_16x16x32_bf16 v[160:163], v[24:27], a[88:91], v[160:163]
    s_add_u32 s60, s61, 0
    ds_write_b64 v8, v[108:109] offset:37888
    v_mfma_f32_16x16x32_bf16 v[164:167], v[24:27], a[92:95], v[164:167]
    s_add_u32 m0, s55, 73728
    v_exp_f32 v248, v248
    v_mfma_f32_16x16x32_bf16 v[164:167], v[20:23], a[76:79], v[164:167]
    v_exp_f32 v249, v249
    v_mfma_f32_16x16x32_bf16 v[164:167], v[16:19], a[60:63], v[164:167]
    s_waitcnt lgkmcnt(5)
    v_add_f32 v248, 1.0, v248
    v_add_f32 v249, 1.0, v249
    v_mfma_f32_16x16x32_bf16 v[164:167], v[28:31], a[12:15], v[164:167]
    s_waitcnt lgkmcnt(3)
    v_rcp_f32 v248, v248
    v_mfma_f32_16x16x32_bf16 v[164:167], v[32:35], a[28:31], v[164:167]
    s_waitcnt vmcnt(18) lgkmcnt(0)
    s_barrier
    v_mfma_f32_16x16x32_bf16 v[164:167], v[36:39], a[44:47], v[164:167]
    buffer_load_dwordx4 v5, s[8:11], s60 offen  lds
    v_mfma_f32_16x16x32_bf16 v[160:163], v[36:39], a[40:43], v[160:163]
    s_add_u32 s60, s61, 110592
    ds_read_b64_tr_b16 v[16:17], v1 offset:0
    v_mul_f32 v112, v112, v248
    v_mfma_f32_16x16x32_bf16 v[160:163], v[32:35], a[24:27], v[160:163]
    s_add_u32 m0, s55, 77824
    ds_read_b64_tr_b16 v[18:19], v1 offset:512
    v_mul_f32 v250, v114, v114
    v_mfma_f32_16x16x32_bf16 v[160:163], v[28:31], a[8:11], v[160:163]
    ds_read_b64_tr_b16 v[20:21], v1 offset:4096
    v_fma_f32 v250, v250, s79, v252
    v_mfma_f32_16x16x32_bf16 v[156:159], v[28:31], a[4:7], v[156:159]
    ds_read_b64_tr_b16 v[22:23], v1 offset:4608
    v_mul_f32 v250, v250, v114
    v_mfma_f32_16x16x32_bf16 v[156:159], v[32:35], a[20:23], v[156:159]
    ds_read_b64_tr_b16 v[24:25], v1 offset:8192
    v_mul_f32 v251, v115, v115
    v_mfma_f32_16x16x32_bf16 v[156:159], v[36:39], a[36:39], v[156:159]
    ds_read_b64_tr_b16 v[26:27], v1 offset:8704
    v_fma_f32 v251, v251, s79, v252
    v_mfma_f32_16x16x32_bf16 v[152:155], v[36:39], a[32:35], v[152:155]
    buffer_load_dwordx4 v5, s[8:11], s60 offen  lds
    v_mfma_f32_16x16x32_bf16 v[152:155], v[32:35], a[16:19], v[152:155]
    s_add_u32 s60, s61, 221184
    v_rcp_f32 v249, v249
    v_mfma_f32_16x16x32_bf16 v[152:155], v[28:31], a[0:3], v[152:155]
    s_waitcnt lgkmcnt(4)
    v_exp_f32 v250, v250
    v_mfma_f32_16x16x32_bf16 v[136:139], v[16:19], a[144:147], v[136:139]
    s_waitcnt lgkmcnt(2)
    ds_read_b64_tr_b16 v[28:29], v1 offset:12288
    v_mul_f32 v113, v113, v249
    v_mfma_f32_16x16x32_bf16 v[136:139], v[20:23], a[160:163], v[136:139]
    s_waitcnt lgkmcnt(1)
    ds_read_b64_tr_b16 v[30:31], v1 offset:12800
    v_add_f32 v250, 1.0, v250
    v_mfma_f32_16x16x32_bf16 v[136:139], v[24:27], a[176:179], v[136:139]
    s_add_u32 m0, s55, 81920
    ds_read_b64_tr_b16 v[32:33], v1 offset:16384
    v_mul_f32 v251, v251, v115
    v_mfma_f32_16x16x32_bf16 v[140:143], v[24:27], a[180:183], v[140:143]
    ds_read_b64_tr_b16 v[34:35], v1 offset:16896
    v_mul_f32 v128, v128, v112
    v_mfma_f32_16x16x32_bf16 v[140:143], v[20:23], a[164:167], v[140:143]
    buffer_load_dwordx4 v5, s[8:11], s60 offen  lds
    v_mfma_f32_16x16x32_bf16 v[140:143], v[16:19], a[148:151], v[140:143]
    s_add_u32 s60, s61, 331776
    ds_read_b64_tr_b16 v[36:37], v1 offset:20480
    v_mul_f32 v129, v129, v113
    v_mfma_f32_16x16x32_bf16 v[144:147], v[16:19], a[152:155], v[144:147]
    s_add_u32 m0, s55, 86016
    ds_read_b64_tr_b16 v[38:39], v1 offset:20992
    v_mul_f32 v248, v116, v116
    v_mfma_f32_16x16x32_bf16 v[144:147], v[20:23], a[168:171], v[144:147]
    v_rcp_f32 v250, v250
    v_mfma_f32_16x16x32_bf16 v[144:147], v[24:27], a[184:187], v[144:147]
    v_exp_f32 v251, v251
    v_mfma_f32_16x16x32_bf16 v[148:151], v[24:27], a[188:191], v[148:151]
    v_mul_f32 v114, v114, v250
    v_add_f32 v251, 1.0, v251
    v_mfma_f32_16x16x32_bf16 v[148:151], v[20:23], a[172:175], v[148:151]
    v_rcp_f32 v251, v251
    v_mfma_f32_16x16x32_bf16 v[148:151], v[16:19], a[156:159], v[148:151]
    s_waitcnt lgkmcnt(4)
    v_mul_f32 v115, v115, v251
    v_mul_f32 v130, v130, v114
    v_mfma_f32_16x16x32_bf16 v[148:151], v[28:31], a[204:207], v[148:151]
    s_waitcnt lgkmcnt(2)
    ds_read_b64_tr_b16 v[16:17], v1 offset:24576
    v_mul_f32 v131, v131, v115
    v_mfma_f32_16x16x32_bf16 v[148:151], v[32:35], a[220:223], v[148:151]
    s_waitcnt lgkmcnt(1)
    ds_read_b64_tr_b16 v[18:19], v1 offset:25088
    v_cvt_pk_bf16_f32 v112, v128, v129
    v_mfma_f32_16x16x32_bf16 v[148:151], v[36:39], a[236:239], v[148:151]
    buffer_load_dwordx4 v5, s[8:11], s60 offen  lds
    v_mfma_f32_16x16x32_bf16 v[144:147], v[36:39], a[232:235], v[144:147]
    s_add_u32 s60, s61, 442368
    ds_read_b64_tr_b16 v[20:21], v1 offset:28672
    v_cvt_pk_bf16_f32 v113, v130, v131
    v_mfma_f32_16x16x32_bf16 v[144:147], v[32:35], a[216:219], v[144:147]
    s_add_u32 m0, s55, 90112
    ds_read_b64_tr_b16 v[22:23], v1 offset:29184
    v_fma_f32 v248, v248, s79, v252
    v_mfma_f32_16x16x32_bf16 v[144:147], v[28:31], a[200:203], v[144:147]
    ds_read_b64_tr_b16 v[24:25], v1 offset:32768
    v_mul_f32 v248, v248, v116
    v_mfma_f32_16x16x32_bf16 v[140:143], v[28:31], a[196:199], v[140:143]
    ds_read_b64_tr_b16 v[26:27], v1 offset:33280
    v_mul_f32 v249, v117, v117
    v_mfma_f32_16x16x32_bf16 v[140:143], v[32:35], a[212:215], v[140:143]
    buffer_load_dwordx4 v5, s[8:11], s60 offen  lds
    v_mfma_f32_16x16x32_bf16 v[140:143], v[36:39], a[228:231], v[140:143]
    s_add_u32 s60, s61, 552960
    ds_write_b64 v8, v[112:113] offset:38912
    v_mfma_f32_16x16x32_bf16 v[136:139], v[36:39], a[224:227], v[136:139]
    s_add_u32 m0, s55, 94208
    v_exp_f32 v248, v248
    v_mfma_f32_16x16x32_bf16 v[136:139], v[32:35], a[208:211], v[136:139]
    v_add_f32 v248, 1.0, v248
    v_fma_f32 v249, v249, s79, v252
    v_mfma_f32_16x16x32_bf16 v[136:139], v[28:31], a[192:195], v[136:139]
    s_waitcnt lgkmcnt(5)
    v_rcp_f32 v248, v248
    v_mfma_f32_16x16x32_bf16 v[136:139], v[16:19], a[240:243], v[136:139]
    s_waitcnt lgkmcnt(3)
    ds_read_b64_tr_b16 v[28:29], v2 offset:24576
    v_mul_f32 v116, v116, v248
    v_mfma_f32_16x16x32_bf16 v[136:139], v[20:23], v[40:43], v[136:139]
    s_waitcnt lgkmcnt(2)
    ds_read_b64_tr_b16 v[30:31], v2 offset:25088
    v_mul_f32 v249, v249, v117
    v_mfma_f32_16x16x32_bf16 v[136:139], v[24:27], v[56:59], v[136:139]
    buffer_load_dwordx4 v5, s[8:11], s60 offen  lds
    v_mfma_f32_16x16x32_bf16 v[140:143], v[24:27], v[60:63], v[140:143]
    s_add_u32 s60, s61, 663552
    ds_read_b64_tr_b16 v[32:33], v2 offset:28672
    v_mul_f32 v250, v118, v118
    v_mfma_f32_16x16x32_bf16 v[140:143], v[20:23], v[44:47], v[140:143]
    s_add_u32 m0, s55, 98304
    ds_read_b64_tr_b16 v[34:35], v2 offset:29184
    v_fma_f32 v250, v250, s79, v252
    v_mfma_f32_16x16x32_bf16 v[140:143], v[16:19], a[244:247], v[140:143]
    ds_read_b64_tr_b16 v[36:37], v2 offset:32768
    v_mul_f32 v250, v250, v118
    v_mfma_f32_16x16x32_bf16 v[144:147], v[16:19], a[248:251], v[144:147]
    ds_read_b64_tr_b16 v[38:39], v2 offset:33280
    v_mul_f32 v251, v119, v119
    v_mfma_f32_16x16x32_bf16 v[144:147], v[20:23], v[48:51], v[144:147]
    v_exp_f32 v249, v249
    v_mfma_f32_16x16x32_bf16 v[144:147], v[24:27], v[64:67], v[144:147]
    v_exp_f32 v250, v250
    v_mfma_f32_16x16x32_bf16 v[148:151], v[24:27], v[68:71], v[148:151]
    buffer_load_dwordx4 v5, s[8:11], s60 offen  lds
    v_mfma_f32_16x16x32_bf16 v[148:151], v[20:23], v[52:55], v[148:151]
    v_add_f32 v249, 1.0, v249
    v_add_f32 v250, 1.0, v250
    v_mfma_f32_16x16x32_bf16 v[148:151], v[16:19], a[252:255], v[148:151]
    s_waitcnt lgkmcnt(4)
    v_rcp_f32 v249, v249
    v_mfma_f32_16x16x32_bf16 v[164:167], v[28:31], a[252:255], v[164:167]
    s_waitcnt lgkmcnt(2)
    ds_read_b64_tr_b16 v[16:17], v2 offset:12288
    v_mul_f32 v117, v117, v249
    v_mfma_f32_16x16x32_bf16 v[164:167], v[32:35], v[52:55], v[164:167]
    s_waitcnt lgkmcnt(1)
    ds_read_b64_tr_b16 v[18:19], v2 offset:12800
    v_fma_f32 v251, v251, s79, v252
    v_mfma_f32_16x16x32_bf16 v[164:167], v[36:39], v[68:71], v[164:167]
    s_add_u32 s60, s61, 774144
    ds_read_b64_tr_b16 v[20:21], v2 offset:16384
    v_mul_f32 v251, v251, v119
    v_mfma_f32_16x16x32_bf16 v[160:163], v[36:39], v[64:67], v[160:163]
    s_add_u32 m0, s55, 102400
    ds_read_b64_tr_b16 v[22:23], v2 offset:16896
    v_mul_f32 v132, v132, v116
    v_mfma_f32_16x16x32_bf16 v[160:163], v[32:35], v[48:51], v[160:163]
    ds_read_b64_tr_b16 v[24:25], v2 offset:20480
    v_mul_f32 v133, v133, v117
    v_mfma_f32_16x16x32_bf16 v[160:163], v[28:31], a[248:251], v[160:163]
    buffer_load_dwordx4 v5, s[8:11], s60 offen  lds
    v_mfma_f32_16x16x32_bf16 v[156:159], v[28:31], a[244:247], v[156:159]
    s_add_u32 s60, s61, 884736
    ds_read_b64_tr_b16 v[26:27], v2 offset:20992
    v_mul_f32 v248, v136, v136
    v_mfma_f32_16x16x32_bf16 v[156:159], v[32:35], v[44:47], v[156:159]
    s_add_u32 m0, s55, 106496
    v_rcp_f32 v250, v250
    v_mfma_f32_16x16x32_bf16 v[156:159], v[36:39], v[60:63], v[156:159]
    v_exp_f32 v251, v251
    v_mfma_f32_16x16x32_bf16 v[152:155], v[36:39], v[56:59], v[152:155]
    v_mul_f32 v118, v118, v250
    v_add_f32 v251, 1.0, v251
    v_mfma_f32_16x16x32_bf16 v[152:155], v[32:35], v[40:43], v[152:155]
    v_rcp_f32 v251, v251
    v_mfma_f32_16x16x32_bf16 v[152:155], v[28:31], a[240:243], v[152:155]
    s_waitcnt lgkmcnt(4)
    v_mul_f32 v119, v119, v251
    v_mul_f32 v134, v134, v118
    v_mfma_f32_16x16x32_bf16 v[152:155], v[16:19], a[192:195], v[152:155]
    s_waitcnt lgkmcnt(2)
    ds_read_b64_tr_b16 v[28:29], v2 offset:0
    v_mul_f32 v135, v135, v119
    v_mfma_f32_16x16x32_bf16 v[152:155], v[20:23], a[208:211], v[152:155]
    s_waitcnt lgkmcnt(1)
    ds_read_b64_tr_b16 v[30:31], v2 offset:512
    v_cvt_pk_bf16_f32 v116, v132, v133
    v_mfma_f32_16x16x32_bf16 v[152:155], v[24:27], a[224:227], v[152:155]
    buffer_load_dwordx4 v5, s[8:11], s60 offen  lds
    v_mfma_f32_16x16x32_bf16 v[156:159], v[24:27], a[228:231], v[156:159]
    ds_read_b64_tr_b16 v[32:33], v2 offset:4096
    v_cvt_pk_bf16_f32 v117, v134, v135
    v_mfma_f32_16x16x32_bf16 v[156:159], v[20:23], a[212:215], v[156:159]
    ds_read_b64_tr_b16 v[34:35], v2 offset:4608
    v_fma_f32 v248, v248, s79, v252
    v_mfma_f32_16x16x32_bf16 v[156:159], v[16:19], a[196:199], v[156:159]
    ds_read_b64_tr_b16 v[36:37], v2 offset:8192
    v_mul_f32 v248, v248, v136
    v_mfma_f32_16x16x32_bf16 v[160:163], v[16:19], a[200:203], v[160:163]
    ds_read_b64_tr_b16 v[38:39], v2 offset:8704
    v_mul_f32 v249, v137, v137
    v_mfma_f32_16x16x32_bf16 v[160:163], v[20:23], a[216:219], v[160:163]
    v_add_u32 v1, 4294856704, v1
    v_add_u32 v2, 4294856704, v2
    v_mfma_f32_16x16x32_bf16 v[160:163], v[24:27], a[232:235], v[160:163]
    s_add_u32 s60, s61, 995328
    ds_write_b64 v8, v[116:117] offset:39936
    v_mfma_f32_16x16x32_bf16 v[164:167], v[24:27], a[236:239], v[164:167]
    s_add_u32 m0, s55, 110592
    v_exp_f32 v248, v248
    v_mfma_f32_16x16x32_bf16 v[164:167], v[20:23], a[220:223], v[164:167]
    v_add_u32 v8, s81, v8
    v_add_f32 v248, 1.0, v248
    v_mfma_f32_16x16x32_bf16 v[164:167], v[16:19], a[204:207], v[164:167]
    s_waitcnt lgkmcnt(5)
    v_rcp_f32 v248, v248
    v_mfma_f32_16x16x32_bf16 v[164:167], v[28:31], a[156:159], v[164:167]
    s_waitcnt lgkmcnt(3)
    v_mul_f32 v136, v136, v248
    v_fma_f32 v249, v249, s79, v252
    v_mfma_f32_16x16x32_bf16 v[164:167], v[32:35], a[172:175], v[164:167]
    s_waitcnt vmcnt(18) lgkmcnt(0)
    s_barrier
    v_mfma_f32_16x16x32_bf16 v[164:167], v[36:39], a[188:191], v[164:167]
    buffer_load_dwordx4 v5, s[8:11], s60 offen  lds
    v_mfma_f32_16x16x32_bf16 v[160:163], v[36:39], a[184:187], v[160:163]
    buffer_load_dword v254, v253, s[12:15], s63 offen offset:384
    v_mfma_f32_16x16x32_bf16 v[160:163], v[32:35], a[168:171], v[160:163]
    s_add_u32 s60, s61, 1105920
    ds_read_b64_tr_b16 v[16:17], v1 offset:0
    ds_read_b64_tr_b16 v[18:19], v1 offset:512
    v_mfma_f32_16x16x32_bf16 v[160:163], v[28:31], a[152:155], v[160:163]
    s_add_u32 m0, s55, 114688
    ds_read_b64_tr_b16 v[20:21], v1 offset:4096
    v_mul_f32 v249, v249, v137
    v_mfma_f32_16x16x32_bf16 v[156:159], v[28:31], a[148:151], v[156:159]
    ds_read_b64_tr_b16 v[22:23], v1 offset:4608
    v_mul_f32 v250, v138, v138
    v_mfma_f32_16x16x32_bf16 v[156:159], v[32:35], a[164:167], v[156:159]
    ds_read_b64_tr_b16 v[24:25], v1 offset:8192
    v_fma_f32 v250, v250, s79, v252
    v_mfma_f32_16x16x32_bf16 v[156:159], v[36:39], a[180:183], v[156:159]
    ds_read_b64_tr_b16 v[26:27], v1 offset:8704
    v_mul_f32 v250, v250, v138
    v_mfma_f32_16x16x32_bf16 v[152:155], v[36:39], a[176:179], v[152:155]
    buffer_load_dwordx4 v5, s[8:11], s60 offen  lds
    v_mfma_f32_16x16x32_bf16 v[152:155], v[32:35], a[160:163], v[152:155]
    s_add_u32 s60, s61, 1216512
    v_exp_f32 v249, v249
    v_mfma_f32_16x16x32_bf16 v[152:155], v[28:31], a[144:147], v[152:155]
    s_waitcnt lgkmcnt(4)
    v_exp_f32 v250, v250
    v_mfma_f32_16x16x32_bf16 v[72:75], v[16:19], a[0:3], 0
    s_waitcnt lgkmcnt(2)
    ds_read_b64_tr_b16 v[28:29], v1 offset:12288
    v_add_f32 v249, 1.0, v249
    v_mfma_f32_16x16x32_bf16 v[72:75], v[20:23], a[16:19], v[72:75]
    s_waitcnt lgkmcnt(1)
    ds_read_b64_tr_b16 v[30:31], v1 offset:12800
    v_add_f32 v250, 1.0, v250
    v_mfma_f32_16x16x32_bf16 v[72:75], v[24:27], a[32:35], v[72:75]
    s_add_u32 m0, s55, 118784
    ds_read_b64_tr_b16 v[32:33], v1 offset:16384
    v_mul_f32 v251, v139, v139
    v_mfma_f32_16x16x32_bf16 v[76:79], v[24:27], a[36:39], 0
    ds_read_b64_tr_b16 v[34:35], v1 offset:16896
    v_fma_f32 v251, v251, s79, v252
    v_mfma_f32_16x16x32_bf16 v[76:79], v[20:23], a[20:23], v[76:79]
    buffer_load_dwordx4 v5, s[8:11], s60 offen  lds
    v_mfma_f32_16x16x32_bf16 v[76:79], v[16:19], a[4:7], v[76:79]
    s_add_u32 s60, s61, 1327104
    ds_read_b64_tr_b16 v[36:37], v1 offset:20480
    v_mul_f32 v251, v251, v139
    v_mfma_f32_16x16x32_bf16 v[80:83], v[16:19], a[8:11], 0
    s_add_u32 m0, s55, 122880
    ds_read_b64_tr_b16 v[38:39], v1 offset:20992
    v_mul_f32 v248, v140, v140
    v_mfma_f32_16x16x32_bf16 v[80:83], v[20:23], a[24:27], v[80:83]
    v_rcp_f32 v249, v249
    v_mfma_f32_16x16x32_bf16 v[80:83], v[24:27], a[40:43], v[80:83]
    ds_read_b128 v[232:235], v9 offset:36864
    v_mul_f32 v137, v137, v249
    v_mfma_f32_16x16x32_bf16 v[84:87], v[24:27], a[44:47], 0
    v_rcp_f32 v250, v250
    v_mfma_f32_16x16x32_bf16 v[84:87], v[20:23], a[28:31], v[84:87]
    v_exp_f32 v251, v251
    v_mfma_f32_16x16x32_bf16 v[84:87], v[16:19], a[12:15], v[84:87]
    s_waitcnt lgkmcnt(5)
    v_mul_f32 v138, v138, v250
    v_add_f32 v251, 1.0, v251
    v_mfma_f32_16x16x32_bf16 v[84:87], v[28:31], a[60:63], v[84:87]
    s_waitcnt lgkmcnt(3)
    ds_read_b64_tr_b16 v[16:17], v1 offset:24576
    v_fma_f32 v248, v248, s79, v252
    v_mfma_f32_16x16x32_bf16 v[84:87], v[32:35], a[76:79], v[84:87]
    s_waitcnt lgkmcnt(2)
    ds_read_b64_tr_b16 v[18:19], v1 offset:25088
    v_mul_f32 v248, v248, v140
    v_mfma_f32_16x16x32_bf16 v[84:87], v[36:39], a[92:95], v[84:87]
    buffer_load_dwordx4 v5, s[8:11], s60 offen  lds
    v_mfma_f32_16x16x32_bf16 v[80:83], v[36:39], a[88:91], v[80:83]
    s_add_u32 s60, s61, 1437696
    ds_read_b64_tr_b16 v[20:21], v1 offset:28672
    v_mul_f32 v249, v141, v141
    v_mfma_f32_16x16x32_bf16 v[80:83], v[32:35], a[72:75], v[80:83]
    s_add_u32 m0, s55, 126976
    ds_read_b64_tr_b16 v[22:23], v1 offset:29184
    v_fma_f32 v249, v249, s79, v252
    v_mfma_f32_16x16x32_bf16 v[80:83], v[28:31], a[56:59], v[80:83]
    ds_read_b64_tr_b16 v[24:25], v1 offset:32768
    v_mul_f32 v249, v249, v141
    v_mfma_f32_16x16x32_bf16 v[76:79], v[28:31], a[52:55], v[76:79]
    ds_read_b64_tr_b16 v[26:27], v1 offset:33280
    v_mul_f32 v250, v142, v142
    v_mfma_f32_16x16x32_bf16 v[76:79], v[32:35], a[68:71], v[76:79]
    buffer_load_dwordx4 v5, s[8:11], s60 offen  lds
    v_mfma_f32_16x16x32_bf16 v[76:79], v[36:39], a[84:87], v[76:79]
    s_add_u32 s60, s61, 1548288
    ds_read_b128 v[236:239], v9 offset:37888
    v_fma_f32 v250, v250, s79, v252
    v_mfma_f32_16x16x32_bf16 v[72:75], v[36:39], a[80:83], v[72:75]
    s_add_u32 m0, s55, 131072
    v_rcp_f32 v251, v251
    v_mfma_f32_16x16x32_bf16 v[72:75], v[32:35], a[64:67], v[72:75]
    v_exp_f32 v248, v248
    v_mfma_f32_16x16x32_bf16 v[72:75], v[28:31], a[48:51], v[72:75]
    s_waitcnt lgkmcnt(5)
    v_exp_f32 v249, v249
    v_mfma_f32_16x16x32_bf16 v[72:75], v[16:19], a[96:99], v[72:75]
    s_waitcnt lgkmcnt(3)
    ds_read_b64_tr_b16 v[28:29], v2 offset:24576
    v_mul_f32 v139, v139, v251
    v_mfma_f32_16x16x32_bf16 v[72:75], v[20:23], a[112:115], v[72:75]
    s_waitcnt lgkmcnt(2)
    ds_read_b64_tr_b16 v[30:31], v2 offset:25088
    v_add_f32 v248, 1.0, v248
    v_mfma_f32_16x16x32_bf16 v[72:75], v[24:27], a[128:131], v[72:75]
    buffer_load_dwordx4 v5, s[8:11], s60 offen  lds
    v_mfma_f32_16x16x32_bf16 v[76:79], v[24:27], a[132:135], v[76:79]
    s_add_u32 s60, s61, 1658880
    ds_read_b64_tr_b16 v[32:33], v2 offset:28672
    v_add_f32 v249, 1.0, v249
    v_mfma_f32_16x16x32_bf16 v[76:79], v[20:23], a[116:119], v[76:79]
    s_add_u32 m0, s55, 135168
    ds_read_b64_tr_b16 v[34:35], v2 offset:29184
    v_mul_f32 v250, v250, v142
    v_mfma_f32_16x16x32_bf16 v[76:79], v[16:19], a[100:103], v[76:79]
    ds_read_b64_tr_b16 v[36:37], v2 offset:32768
    v_mul_f32 v251, v143, v143
    v_mfma_f32_16x16x32_bf16 v[80:83], v[16:19], a[104:107], v[80:83]
    ds_read_b64_tr_b16 v[38:39], v2 offset:33280
    v_fma_f32 v251, v251, s79, v252
    v_mfma_f32_16x16x32_bf16 v[80:83], v[20:23], a[120:123], v[80:83]
    v_rcp_f32 v248, v248
    v_mfma_f32_16x16x32_bf16 v[80:83], v[24:27], a[136:139], v[80:83]
    ds_read_b128 v[240:243], v9 offset:38912
    v_mul_f32 v140, v140, v248
    v_mfma_f32_16x16x32_bf16 v[84:87], v[24:27], a[140:143], v[84:87]
    buffer_load_dwordx4 v5, s[8:11], s60 offen  lds
    v_mfma_f32_16x16x32_bf16 v[84:87], v[20:23], a[124:127], v[84:87]
    v_rcp_f32 v249, v249
    v_mfma_f32_16x16x32_bf16 v[84:87], v[16:19], a[108:111], v[84:87]
    s_waitcnt lgkmcnt(5)
    v_exp_f32 v250, v250
    v_mfma_f32_16x16x32_bf16 v[100:103], v[28:31], a[108:111], 0
    s_waitcnt lgkmcnt(3)
    ds_read_b64_tr_b16 v[16:17], v2 offset:12288
    v_mul_f32 v141, v141, v249
    v_mfma_f32_16x16x32_bf16 v[100:103], v[32:35], a[124:127], v[100:103]
    s_waitcnt lgkmcnt(2)
    ds_read_b64_tr_b16 v[18:19], v2 offset:12800
    v_add_f32 v250, 1.0, v250
    v_mfma_f32_16x16x32_bf16 v[100:103], v[36:39], a[140:143], v[100:103]
    s_add_u32 s60, s61, 1769472
    ds_read_b64_tr_b16 v[20:21], v2 offset:16384
    v_mul_f32 v251, v251, v143
    v_mfma_f32_16x16x32_bf16 v[96:99], v[36:39], a[136:139], 0
    s_add_u32 m0, s55, 139264
    ds_read_b64_tr_b16 v[22:23], v2 offset:16896
    v_mul_f32 v248, v144, v144
    v_mfma_f32_16x16x32_bf16 v[96:99], v[32:35], a[120:123], v[96:99]
    ds_read_b64_tr_b16 v[24:25], v2 offset:20480
    v_fma_f32 v248, v248, s79, v252
    v_mfma_f32_16x16x32_bf16 v[96:99], v[28:31], a[104:107], v[96:99]
    buffer_load_dwordx4 v5, s[8:11], s60 offen  lds
    v_mfma_f32_16x16x32_bf16 v[92:95], v[28:31], a[100:103], 0
    s_add_u32 s60, s61, 1880064
    ds_read_b64_tr_b16 v[26:27], v2 offset:20992
    v_mul_f32 v248, v248, v144
    v_mfma_f32_16x16x32_bf16 v[92:95], v[32:35], a[116:119], v[92:95]
    s_add_u32 m0, s55, 143360
    v_rcp_f32 v250, v250
    v_mfma_f32_16x16x32_bf16 v[92:95], v[36:39], a[132:135], v[92:95]
    ds_read_b128 v[244:247], v9 offset:39936
    v_mul_f32 v142, v142, v250
    v_mfma_f32_16x16x32_bf16 v[88:91], v[36:39], a[128:131], 0
    v_exp_f32 v251, v251
    v_mfma_f32_16x16x32_bf16 v[88:91], v[32:35], a[112:115], v[88:91]
    v_exp_f32 v248, v248
    v_mfma_f32_16x16x32_bf16 v[88:91], v[28:31], a[96:99], v[88:91]
    s_waitcnt lgkmcnt(5)
    v_add_u32 v9, s77, v9
    v_add_f32 v251, 1.0, v251
    v_mfma_f32_16x16x32_bf16 v[88:91], v[16:19], a[48:51], v[88:91]
    s_waitcnt lgkmcnt(3)
    ds_read_b64_tr_b16 v[28:29], v2 offset:0
    v_add_f32 v248, 1.0, v248
    v_mfma_f32_16x16x32_bf16 v[88:91], v[20:23], a[64:67], v[88:91]
    s_waitcnt lgkmcnt(2)
    ds_read_b64_tr_b16 v[30:31], v2 offset:512
    v_mul_f32 v249, v145, v145
    v_mfma_f32_16x16x32_bf16 v[88:91], v[24:27], a[80:83], v[88:91]
    buffer_load_dwordx4 v5, s[8:11], s60 offen  lds
    v_mfma_f32_16x16x32_bf16 v[92:95], v[24:27], a[84:87], v[92:95]
    ds_read_b64_tr_b16 v[32:33], v2 offset:4096
    v_fma_f32 v249, v249, s79, v252
    v_mfma_f32_16x16x32_bf16 v[92:95], v[20:23], a[68:71], v[92:95]
    ds_read_b64_tr_b16 v[34:35], v2 offset:4608
    v_mul_f32 v249, v249, v145
    v_mfma_f32_16x16x32_bf16 v[92:95], v[16:19], a[52:55], v[92:95]
    ds_read_b64_tr_b16 v[36:37], v2 offset:8192
    v_mul_f32 v250, v146, v146
    v_mfma_f32_16x16x32_bf16 v[96:99], v[16:19], a[56:59], v[96:99]
    ds_read_b64_tr_b16 v[38:39], v2 offset:8704
    v_fma_f32 v250, v250, s79, v252
    v_mfma_f32_16x16x32_bf16 v[96:99], v[20:23], a[72:75], v[96:99]
    v_add_u32 v1, 36864, v1
    v_add_u32 v2, 36864, v2
    v_mfma_f32_16x16x32_bf16 v[96:99], v[24:27], a[88:91], v[96:99]
    s_add_u32 s60, s63, 384
    v_rcp_f32 v251, v251
    v_mfma_f32_16x16x32_bf16 v[100:103], v[24:27], a[92:95], v[100:103]
    s_add_u32 m0, s55, 0
    v_rcp_f32 v248, v248
    v_mfma_f32_16x16x32_bf16 v[100:103], v[20:23], a[76:79], v[100:103]
    v_exp_f32 v249, v249
    v_mfma_f32_16x16x32_bf16 v[100:103], v[16:19], a[60:63], v[100:103]
    s_waitcnt lgkmcnt(4)
    v_mul_f32 v143, v143, v251
    v_mul_f32 v144, v144, v248
    v_mfma_f32_16x16x32_bf16 v[100:103], v[28:31], a[12:15], v[100:103]
    s_waitcnt lgkmcnt(2)
    v_add_f32 v249, 1.0, v249
    v_mul_f32 v250, v250, v146
    v_mfma_f32_16x16x32_bf16 v[100:103], v[32:35], a[28:31], v[100:103]
    s_waitcnt vmcnt(19) lgkmcnt(0)
    s_barrier
    v_mfma_f32_16x16x32_bf16 v[100:103], v[36:39], a[44:47], v[100:103]
    buffer_load_dwordx4 v4, s[12:15], s60 offen  lds
    v_mfma_f32_16x16x32_bf16 v[96:99], v[36:39], a[40:43], v[96:99]
    s_add_u32 s60, s63, 295296
    ds_read_b64_tr_b16 v[16:17], v1 offset:0
    v_mul_f32 v251, v147, v147
    v_mfma_f32_16x16x32_bf16 v[96:99], v[32:35], a[24:27], v[96:99]
    s_add_u32 m0, s55, 4096
    ds_read_b64_tr_b16 v[18:19], v1 offset:512
    v_fma_f32 v251, v251, s79, v252
    v_mfma_f32_16x16x32_bf16 v[96:99], v[28:31], a[8:11], v[96:99]
    ds_read_b64_tr_b16 v[20:21], v1 offset:4096
    v_mul_f32 v251, v251, v147
    v_mfma_f32_16x16x32_bf16 v[92:95], v[28:31], a[4:7], v[92:95]
    ds_read_b64_tr_b16 v[22:23], v1 offset:4608
    v_mul_f32 v248, v148, v148
    v_mfma_f32_16x16x32_bf16 v[92:95], v[32:35], a[20:23], v[92:95]
    ds_read_b64_tr_b16 v[24:25], v1 offset:8192
    v_fma_f32 v248, v248, s79, v252
    v_mfma_f32_16x16x32_bf16 v[92:95], v[36:39], a[36:39], v[92:95]
    ds_read_b64_tr_b16 v[26:27], v1 offset:8704
    v_mul_f32 v248, v248, v148
    v_mfma_f32_16x16x32_bf16 v[88:91], v[36:39], a[32:35], v[88:91]
    buffer_load_dwordx4 v4, s[12:15], s60 offen  lds
    v_mfma_f32_16x16x32_bf16 v[88:91], v[32:35], a[16:19], v[88:91]
    s_add_u32 s60, s63, 590208
    v_rcp_f32 v249, v249
    v_mfma_f32_16x16x32_bf16 v[88:91], v[28:31], a[0:3], v[88:91]
    s_waitcnt lgkmcnt(4)
    v_exp_f32 v250, v250
    v_mfma_f32_16x16x32_bf16 v[72:75], v[16:19], a[144:147], v[72:75]
    s_waitcnt lgkmcnt(2)
    ds_read_b64_tr_b16 v[28:29], v1 offset:12288
    v_mul_f32 v145, v145, v249
    v_mfma_f32_16x16x32_bf16 v[72:75], v[20:23], a[160:163], v[72:75]
    s_waitcnt lgkmcnt(1)
    ds_read_b64_tr_b16 v[30:31], v1 offset:12800
    v_add_f32 v250, 1.0, v250
    v_mfma_f32_16x16x32_bf16 v[72:75], v[24:27], a[176:179], v[72:75]
    s_add_u32 m0, s55, 8192
    ds_read_b64_tr_b16 v[32:33], v1 offset:16384
    v_mul_f32 v249, v149, v149
    v_mfma_f32_16x16x32_bf16 v[76:79], v[24:27], a[180:183], v[76:79]
    ds_read_b64_tr_b16 v[34:35], v1 offset:16896
    v_fma_f32 v249, v249, s79, v252
    v_mfma_f32_16x16x32_bf16 v[76:79], v[20:23], a[164:167], v[76:79]
    buffer_load_dwordx4 v4, s[12:15], s60 offen  lds
    v_mfma_f32_16x16x32_bf16 v[76:79], v[16:19], a[148:151], v[76:79]
    s_add_u32 s60, s63, 885120
    ds_read_b64_tr_b16 v[36:37], v1 offset:20480
    v_mul_f32 v249, v249, v149
    v_mfma_f32_16x16x32_bf16 v[80:83], v[16:19], a[152:155], v[80:83]
    s_add_u32 m0, s55, 12288
    ds_read_b64_tr_b16 v[38:39], v1 offset:20992
    v_mov_b32 v216, -1
    v_mfma_f32_16x16x32_bf16 v[80:83], v[20:23], a[168:171], v[80:83]
    v_rcp_f32 v250, v250
    v_mfma_f32_16x16x32_bf16 v[80:83], v[24:27], a[184:187], v[80:83]
    v_exp_f32 v251, v251
    v_mfma_f32_16x16x32_bf16 v[84:87], v[24:27], a[188:191], v[84:87]
    v_exp_f32 v248, v248
    v_mfma_f32_16x16x32_bf16 v[84:87], v[20:23], a[172:175], v[84:87]
    buffer_load_dword v254, v253, s[16:19], s63 offen offset:384
    v_mfma_f32_16x16x32_bf16 v[84:87], v[16:19], a[156:159], v[84:87]
    s_waitcnt lgkmcnt(4)
    v_exp_f32 v249, v249
    v_mfma_f32_16x16x32_bf16 v[84:87], v[28:31], a[204:207], v[84:87]
    s_waitcnt lgkmcnt(2)
    ds_read_b64_tr_b16 v[16:17], v1 offset:24576
    v_mul_f32 v146, v146, v250
    v_mfma_f32_16x16x32_bf16 v[84:87], v[32:35], a[220:223], v[84:87]
    s_waitcnt lgkmcnt(1)
    ds_read_b64_tr_b16 v[18:19], v1 offset:25088
    v_add_f32 v251, 1.0, v251
    v_mfma_f32_16x16x32_bf16 v[84:87], v[36:39], a[236:239], v[84:87]
    buffer_load_dwordx4 v4, s[12:15], s60 offen  lds
    v_mfma_f32_16x16x32_bf16 v[80:83], v[36:39], a[232:235], v[80:83]
    s_add_u32 s60, s63, 1180032
    ds_read_b64_tr_b16 v[20:21], v1 offset:28672
    v_add_f32 v248, 1.0, v248
    v_mfma_f32_16x16x32_bf16 v[80:83], v[32:35], a[216:219], v[80:83]
    s_add_u32 m0, s55, 16384
    ds_read_b64_tr_b16 v[22:23], v1 offset:29184
    v_add_f32 v249, 1.0, v249
    v_mfma_f32_16x16x32_bf16 v[80:83], v[28:31], a[200:203], v[80:83]
    ds_read_b64_tr_b16 v[24:25], v1 offset:32768
    v_mul_f32 v250, v150, v150
    v_mfma_f32_16x16x32_bf16 v[76:79], v[28:31], a[196:199], v[76:79]
    ds_read_b64_tr_b16 v[26:27], v1 offset:33280
    v_fma_f32 v250, v250, s79, v252
    v_mfma_f32_16x16x32_bf16 v[76:79], v[32:35], a[212:215], v[76:79]
    buffer_load_dwordx4 v4, s[12:15], s60 offen  lds
    v_mfma_f32_16x16x32_bf16 v[76:79], v[36:39], a[228:231], v[76:79]
    s_add_u32 s60, s63, 1474944
    v_rcp_f32 v251, v251
    v_mfma_f32_16x16x32_bf16 v[72:75], v[36:39], a[224:227], v[72:75]
    s_add_u32 m0, s55, 20480
    v_rcp_f32 v248, v248
    v_mfma_f32_16x16x32_bf16 v[72:75], v[32:35], a[208:211], v[72:75]
    v_rcp_f32 v249, v249
    v_mfma_f32_16x16x32_bf16 v[72:75], v[28:31], a[192:195], v[72:75]
    s_waitcnt lgkmcnt(4)
    v_mul_f32 v147, v147, v251
    v_mul_f32 v148, v148, v248
L_pg7:
    s_cbranch_execz L_pg11
    v_mfma_f32_16x16x32_bf16 v[72:75], v[16:19], a[240:243], v[72:75]
    s_waitcnt lgkmcnt(2)
    ds_read_b64_tr_b16 v[28:29], v2 offset:24576
    v_mul_f32 v149, v149, v249
    v_mfma_f32_16x16x32_bf16 v[72:75], v[20:23], v[40:43], v[72:75]
    s_waitcnt lgkmcnt(1)
    ds_read_b64_tr_b16 v[30:31], v2 offset:25088
    v_mul_f32 v250, v250, v150
    v_mfma_f32_16x16x32_bf16 v[72:75], v[24:27], v[56:59], v[72:75]
    buffer_load_dwordx4 v4, s[12:15], s60 offen  lds
    v_mfma_f32_16x16x32_bf16 v[76:79], v[24:27], v[60:63], v[76:79]
    s_add_u32 s60, s63, 1769856
    ds_read_b64_tr_b16 v[32:33], v2 offset:28672
    v_mul_f32 v251, v151, v151
    v_mfma_f32_16x16x32_bf16 v[76:79], v[20:23], v[44:47], v[76:79]
    s_add_u32 m0, s55, 24576
    ds_read_b64_tr_b16 v[34:35], v2 offset:29184
    v_fma_f32 v251, v251, s79, v252
    v_mfma_f32_16x16x32_bf16 v[76:79], v[16:19], a[244:247], v[76:79]
    ds_read_b64_tr_b16 v[36:37], v2 offset:32768
    v_mul_f32 v251, v251, v151
    v_mfma_f32_16x16x32_bf16 v[80:83], v[16:19], a[248:251], v[80:83]
    ds_read_b64_tr_b16 v[38:39], v2 offset:33280
    v_mul_f32 v72, v72, v136
    v_mfma_f32_16x16x32_bf16 v[80:83], v[20:23], v[48:51], v[80:83]
    v_exp_f32 v250, v250
    v_mfma_f32_16x16x32_bf16 v[80:83], v[24:27], v[64:67], v[80:83]
    v_exp_f32 v251, v251
    v_mfma_f32_16x16x32_bf16 v[84:87], v[24:27], v[68:71], v[84:87]
    buffer_load_dwordx4 v4, s[12:15], s60 offen  lds
    v_mfma_f32_16x16x32_bf16 v[84:87], v[20:23], v[52:55], v[84:87]
    v_mul_f32 v73, v73, v137
    v_mul_f32 v74, v74, v138
    v_mfma_f32_16x16x32_bf16 v[84:87], v[16:19], a[252:255], v[84:87]
    s_waitcnt lgkmcnt(4)
    v_mul_f32 v75, v75, v139
    v_mul_f32 v76, v76, v140
    v_mfma_f32_16x16x32_bf16 v[100:103], v[28:31], a[252:255], v[100:103]
    s_waitcnt lgkmcnt(2)
    ds_read_b64_tr_b16 v[16:17], v2 offset:12288
    v_mul_f32 v77, v77, v141
    v_mfma_f32_16x16x32_bf16 v[100:103], v[32:35], v[52:55], v[100:103]
    s_waitcnt lgkmcnt(1)
    ds_read_b64_tr_b16 v[18:19], v2 offset:12800
    v_mul_f32 v78, v78, v142
    v_mfma_f32_16x16x32_bf16 v[100:103], v[36:39], v[68:71], v[100:103]
    s_add_u32 s60, s63, 2064768
    ds_read_b64_tr_b16 v[20:21], v2 offset:16384
    v_mul_f32 v79, v79, v143
    v_mfma_f32_16x16x32_bf16 v[96:99], v[36:39], v[64:67], v[96:99]
    s_add_u32 m0, s55, 28672
    ds_read_b64_tr_b16 v[22:23], v2 offset:16896
    v_mul_f32 v80, v80, v144
    v_mfma_f32_16x16x32_bf16 v[96:99], v[32:35], v[48:51], v[96:99]
    ds_read_b64_tr_b16 v[24:25], v2 offset:20480
    v_mul_f32 v81, v81, v145
    v_mfma_f32_16x16x32_bf16 v[96:99], v[28:31], a[248:251], v[96:99]
    buffer_load_dwordx4 v4, s[12:15], s60 offen  lds
    v_mfma_f32_16x16x32_bf16 v[92:95], v[28:31], a[244:247], v[92:95]
    s_add_u32 s60, s63, 2359680
    ds_read_b64_tr_b16 v[26:27], v2 offset:20992
    v_mul_f32 v82, v82, v146
    v_mfma_f32_16x16x32_bf16 v[92:95], v[32:35], v[44:47], v[92:95]
    s_add_u32 m0, s55, 32768
    v_mul_f32 v83, v83, v147
    v_mul_f32 v84, v84, v148
    v_mfma_f32_16x16x32_bf16 v[92:95], v[36:39], v[60:63], v[92:95]
    v_mul_f32 v85, v85, v149
    v_cvt_pk_bf16_f32 v200, v72, v73
    v_mfma_f32_16x16x32_bf16 v[88:91], v[36:39], v[56:59], v[88:91]
    v_cvt_pk_bf16_f32 v201, v74, v75
    v_cvt_pk_bf16_f32 v204, v76, v77
    v_mfma_f32_16x16x32_bf16 v[88:91], v[32:35], v[40:43], v[88:91]
    v_cvt_pk_bf16_f32 v205, v78, v79
    v_cvt_pk_bf16_f32 v208, v80, v81
    v_mfma_f32_16x16x32_bf16 v[88:91], v[28:31], a[240:243], v[88:91]
    s_waitcnt lgkmcnt(4)
    v_cvt_pk_bf16_f32 v209, v82, v83
    v_cvt_pk_bf16_f32 v212, v84, v85
    v_mfma_f32_16x16x32_bf16 v[88:91], v[16:19], a[192:195], v[88:91]
    s_waitcnt lgkmcnt(2)
    ds_read_b64_tr_b16 v[28:29], v2 offset:0
    v_add_f32 v250, 1.0, v250
    v_mfma_f32_16x16x32_bf16 v[88:91], v[20:23], a[208:211], v[88:91]
    s_waitcnt lgkmcnt(1)
    ds_read_b64_tr_b16 v[30:31], v2 offset:512
    v_add_f32 v251, 1.0, v251
    v_mfma_f32_16x16x32_bf16 v[88:91], v[24:27], a[224:227], v[88:91]
    buffer_load_dwordx4 v4, s[12:15], s60 offen  lds
    v_mfma_f32_16x16x32_bf16 v[92:95], v[24:27], a[228:231], v[92:95]
    ds_read_b64_tr_b16 v[32:33], v2 offset:4096
    v_mul_f32 v248, v164, v164
    v_mfma_f32_16x16x32_bf16 v[92:95], v[20:23], a[212:215], v[92:95]
    ds_read_b64_tr_b16 v[34:35], v2 offset:4608
    v_fma_f32 v248, v248, s79, v252
    v_mfma_f32_16x16x32_bf16 v[92:95], v[16:19], a[196:199], v[92:95]
    ds_read_b64_tr_b16 v[36:37], v2 offset:8192
    v_mul_f32 v248, v248, v164
    v_mfma_f32_16x16x32_bf16 v[96:99], v[16:19], a[200:203], v[96:99]
    ds_read_b64_tr_b16 v[38:39], v2 offset:8704
    v_mul_f32 v249, v165, v165
    v_mfma_f32_16x16x32_bf16 v[96:99], v[20:23], a[216:219], v[96:99]
    v_add_u32 v1, 36864, v1
    v_add_u32 v2, 36864, v2
    v_mfma_f32_16x16x32_bf16 v[96:99], v[24:27], a[232:235], v[96:99]
    s_add_u32 s60, s63, 2654592
    v_rcp_f32 v250, v250
    v_mfma_f32_16x16x32_bf16 v[100:103], v[24:27], a[236:239], v[100:103]
    s_add_u32 m0, s55, 36864
    v_rcp_f32 v251, v251
    v_mfma_f32_16x16x32_bf16 v[100:103], v[20:23], a[220:223], v[100:103]
    v_exp_f32 v248, v248
    v_mfma_f32_16x16x32_bf16 v[100:103], v[16:19], a[204:207], v[100:103]
    s_waitcnt lgkmcnt(4)
    v_mul_f32 v150, v150, v250
    v_mul_f32 v86, v86, v150
    v_mfma_f32_16x16x32_bf16 v[100:103], v[28:31], a[156:159], v[100:103]
    s_waitcnt lgkmcnt(2)
    v_mul_f32 v151, v151, v251
    v_mul_f32 v87, v87, v151
    v_mfma_f32_16x16x32_bf16 v[100:103], v[32:35], a[172:175], v[100:103]
    s_waitcnt vmcnt(20) lgkmcnt(0)
    s_barrier
    v_mfma_f32_16x16x32_bf16 v[100:103], v[36:39], a[188:191], v[100:103]
    buffer_load_dwordx4 v4, s[12:15], s60 offen  lds
    v_mfma_f32_16x16x32_bf16 v[96:99], v[36:39], a[184:187], v[96:99]
    s_add_u32 s60, s63, 2949504
    ds_read_b64_tr_b16 v[16:17], v1 offset:0
    v_cvt_pk_bf16_f32 v213, v86, v87
    v_mfma_f32_16x16x32_bf16 v[96:99], v[32:35], a[168:171], v[96:99]
    s_add_u32 m0, s55, 40960
    ds_read_b64_tr_b16 v[18:19], v1 offset:512
    v_add_f32 v248, 1.0, v248
    v_mfma_f32_16x16x32_bf16 v[96:99], v[28:31], a[152:155], v[96:99]
    ds_read_b64_tr_b16 v[20:21], v1 offset:4096
    v_fma_f32 v249, v249, s79, v252
    v_mfma_f32_16x16x32_bf16 v[92:95], v[28:31], a[148:151], v[92:95]
    ds_read_b64_tr_b16 v[22:23], v1 offset:4608
    v_mul_f32 v249, v249, v165
    v_mfma_f32_16x16x32_bf16 v[92:95], v[32:35], a[164:167], v[92:95]
    ds_read_b64_tr_b16 v[24:25], v1 offset:8192
    v_mul_f32 v250, v166, v166
    v_mfma_f32_16x16x32_bf16 v[92:95], v[36:39], a[180:183], v[92:95]
    ds_read_b64_tr_b16 v[26:27], v1 offset:8704
    v_fma_f32 v250, v250, s79, v252
    v_mfma_f32_16x16x32_bf16 v[88:91], v[36:39], a[176:179], v[88:91]
    buffer_load_dwordx4 v4, s[12:15], s60 offen  lds
    v_mfma_f32_16x16x32_bf16 v[88:91], v[32:35], a[160:163], v[88:91]
    s_add_u32 s60, s63, 3244416
    v_rcp_f32 v248, v248
    v_mfma_f32_16x16x32_bf16 v[88:91], v[28:31], a[144:147], v[88:91]
    s_waitcnt lgkmcnt(4)
    v_exp_f32 v249, v249
    v_mfma_f32_16x16x32_bf16 v[104:107], v[16:19], a[0:3], 0
    s_waitcnt lgkmcnt(2)
    ds_read_b64_tr_b16 v[28:29], v1 offset:12288
    v_mul_f32 v164, v164, v248
    v_mfma_f32_16x16x32_bf16 v[104:107], v[20:23], a[16:19], v[104:107]
    s_waitcnt lgkmcnt(1)
    ds_read_b64_tr_b16 v[30:31], v1 offset:12800
    v_mul_f32 v100, v100, v164
    v_mfma_f32_16x16x32_bf16 v[104:107], v[24:27], a[32:35], v[104:107]
    s_add_u32 m0, s55, 45056
    ds_read_b64_tr_b16 v[32:33], v1 offset:16384
    v_add_f32 v249, 1.0, v249
    v_mfma_f32_16x16x32_bf16 v[108:111], v[24:27], a[36:39], 0
    ds_read_b64_tr_b16 v[34:35], v1 offset:16896
    v_mul_f32 v250, v250, v166
    v_mfma_f32_16x16x32_bf16 v[108:111], v[20:23], a[20:23], v[108:111]
    buffer_load_dwordx4 v4, s[12:15], s60 offen  lds
    v_mfma_f32_16x16x32_bf16 v[108:111], v[16:19], a[4:7], v[108:111]
    s_add_u32 s60, s63, 3539328
    ds_read_b64_tr_b16 v[36:37], v1 offset:20480
    v_mul_f32 v251, v167, v167
    v_mfma_f32_16x16x32_bf16 v[112:115], v[16:19], a[8:11], 0
    s_add_u32 m0, s55, 49152
    ds_read_b64_tr_b16 v[38:39], v1 offset:20992
    v_fma_f32 v251, v251, s79, v252
    v_mfma_f32_16x16x32_bf16 v[112:115], v[20:23], a[24:27], v[112:115]
    v_rcp_f32 v249, v249
    v_mfma_f32_16x16x32_bf16 v[112:115], v[24:27], a[40:43], v[112:115]
    v_exp_f32 v250, v250
    v_mfma_f32_16x16x32_bf16 v[116:119], v[24:27], a[44:47], 0
    v_mul_f32 v165, v165, v249
    v_mul_f32 v101, v101, v165
    v_mfma_f32_16x16x32_bf16 v[116:119], v[20:23], a[28:31], v[116:119]
    v_cvt_pk_bf16_f32 v214, v100, v101
    v_add_f32 v250, 1.0, v250
    v_mfma_f32_16x16x32_bf16 v[116:119], v[16:19], a[12:15], v[116:119]
    s_waitcnt lgkmcnt(4)
    v_rcp_f32 v250, v250
    v_mfma_f32_16x16x32_bf16 v[116:119], v[28:31], a[60:63], v[116:119]
    s_waitcnt lgkmcnt(2)
    ds_read_b64_tr_b16 v[16:17], v1 offset:24576
    v_mul_f32 v166, v166, v250
    v_mfma_f32_16x16x32_bf16 v[116:119], v[32:35], a[76:79], v[116:119]
    s_waitcnt lgkmcnt(1)
    ds_read_b64_tr_b16 v[18:19], v1 offset:25088
    v_mul_f32 v102, v102, v166
    v_mfma_f32_16x16x32_bf16 v[116:119], v[36:39], a[92:95], v[116:119]
    buffer_load_dwordx4 v4, s[12:15], s60 offen  lds
    v_mfma_f32_16x16x32_bf16 v[112:115], v[36:39], a[88:91], v[112:115]
    s_add_u32 s60, s63, 3834240
    ds_read_b64_tr_b16 v[20:21], v1 offset:28672
    v_mul_f32 v251, v251, v167
    v_mfma_f32_16x16x32_bf16 v[112:115], v[32:35], a[72:75], v[112:115]
    s_add_u32 m0, s55, 53248
    ds_read_b64_tr_b16 v[22:23], v1 offset:29184
    v_mul_f32 v248, v160, v160
    v_mfma_f32_16x16x32_bf16 v[112:115], v[28:31], a[56:59], v[112:115]
    ds_read_b64_tr_b16 v[24:25], v1 offset:32768
    v_fma_f32 v248, v248, s79, v252
    v_mfma_f32_16x16x32_bf16 v[108:111], v[28:31], a[52:55], v[108:111]
    ds_read_b64_tr_b16 v[26:27], v1 offset:33280
    v_mul_f32 v248, v248, v160
    v_mfma_f32_16x16x32_bf16 v[108:111], v[32:35], a[68:71], v[108:111]
    buffer_load_dwordx4 v4, s[12:15], s60 offen  lds
    v_mfma_f32_16x16x32_bf16 v[108:111], v[36:39], a[84:87], v[108:111]
    s_add_u32 s60, s63, 4129152
    v_exp_f32 v251, v251
    v_mfma_f32_16x16x32_bf16 v[104:107], v[36:39], a[80:83], v[104:107]
    s_add_u32 m0, s55, 57344
    v_exp_f32 v248, v248
    v_mfma_f32_16x16x32_bf16 v[104:107], v[32:35], a[64:67], v[104:107]
    v_add_f32 v251, 1.0, v251
    v_add_f32 v248, 1.0, v248
    v_mfma_f32_16x16x32_bf16 v[104:107], v[28:31], a[48:51], v[104:107]
    s_waitcnt lgkmcnt(4)
    v_rcp_f32 v251, v251
    v_mfma_f32_16x16x32_bf16 v[104:107], v[16:19], a[96:99], v[104:107]
    s_waitcnt lgkmcnt(2)
    ds_read_b64_tr_b16 v[28:29], v2 offset:24576
    v_mul_f32 v167, v167, v251
    v_mfma_f32_16x16x32_bf16 v[104:107], v[20:23], a[112:115], v[104:107]
    s_waitcnt lgkmcnt(1)
    ds_read_b64_tr_b16 v[30:31], v2 offset:25088
    v_mul_f32 v103, v103, v167
    v_mfma_f32_16x16x32_bf16 v[104:107], v[24:27], a[128:131], v[104:107]
    buffer_load_dwordx4 v4, s[12:15], s60 offen  lds
    v_mfma_f32_16x16x32_bf16 v[108:111], v[24:27], a[132:135], v[108:111]
    s_add_u32 s60, s63, 4424064
    ds_read_b64_tr_b16 v[32:33], v2 offset:28672
    v_cvt_pk_bf16_f32 v215, v102, v103
    v_mfma_f32_16x16x32_bf16 v[108:111], v[20:23], a[116:119], v[108:111]
    s_add_u32 m0, s55, 61440
    ds_read_b64_tr_b16 v[34:35], v2 offset:29184
    v_mul_f32 v249, v161, v161
    v_mfma_f32_16x16x32_bf16 v[108:111], v[16:19], a[100:103], v[108:111]
    ds_read_b64_tr_b16 v[36:37], v2 offset:32768
    v_fma_f32 v249, v249, s79, v252
    v_mfma_f32_16x16x32_bf16 v[112:115], v[16:19], a[104:107], v[112:115]
    buffer_load_dword v254, v10, s[44:47], s62 offen
    v_mfma_f32_16x16x32_bf16 v[112:115], v[20:23], a[120:123], v[112:115]
    ds_read_b64_tr_b16 v[38:39], v2 offset:33280
    v_mul_f32 v249, v249, v161
    v_mfma_f32_16x16x32_bf16 v[112:115], v[24:27], a[136:139], v[112:115]
    buffer_load_dword v254, v14, s[20:23], 0 offen offset:0
    v_mfma_f32_16x16x32_bf16 v[116:119], v[24:27], a[140:143], v[116:119]
    buffer_load_dwordx4 v4, s[12:15], s60 offen  lds
    v_mfma_f32_16x16x32_bf16 v[116:119], v[20:23], a[124:127], v[116:119]
    v_rcp_f32 v248, v248
    v_mfma_f32_16x16x32_bf16 v[116:119], v[16:19], a[108:111], v[116:119]
    s_waitcnt lgkmcnt(4)
    v_exp_f32 v249, v249
    v_mfma_f32_16x16x32_bf16 v[132:135], v[28:31], a[108:111], 0
    s_waitcnt lgkmcnt(2)
    ds_read_b64_tr_b16 v[16:17], v2 offset:12288
    v_mul_f32 v160, v160, v248
    v_mfma_f32_16x16x32_bf16 v[132:135], v[32:35], a[124:127], v[132:135]
    s_waitcnt lgkmcnt(1)
    ds_read_b64_tr_b16 v[18:19], v2 offset:12800
    v_mul_f32 v96, v96, v160
    v_mfma_f32_16x16x32_bf16 v[132:135], v[36:39], a[140:143], v[132:135]
    s_add_u32 s60, s63, 4718976
    ds_read_b64_tr_b16 v[20:21], v2 offset:16384
    v_add_f32 v249, 1.0, v249
    v_mfma_f32_16x16x32_bf16 v[128:131], v[36:39], a[136:139], 0
    s_add_u32 m0, s55, 65536
    ds_read_b64_tr_b16 v[22:23], v2 offset:16896
    v_mul_f32 v250, v162, v162
    v_mfma_f32_16x16x32_bf16 v[128:131], v[32:35], a[120:123], v[128:131]
    ds_read_b64_tr_b16 v[24:25], v2 offset:20480
    v_fma_f32 v250, v250, s79, v252
    v_mfma_f32_16x16x32_bf16 v[128:131], v[28:31], a[104:107], v[128:131]
    buffer_load_dwordx4 v4, s[12:15], s60 offen  lds
    v_mfma_f32_16x16x32_bf16 v[124:127], v[28:31], a[100:103], 0
    s_add_u32 s60, s63, 5013888
    ds_read_b64_tr_b16 v[26:27], v2 offset:20992
    v_mul_f32 v250, v250, v162
    v_mfma_f32_16x16x32_bf16 v[124:127], v[32:35], a[116:119], v[124:127]
    s_add_u32 m0, s55, 69632
    v_rcp_f32 v249, v249
    v_mfma_f32_16x16x32_bf16 v[124:127], v[36:39], a[132:135], v[124:127]
    v_exp_f32 v250, v250
    v_mfma_f32_16x16x32_bf16 v[120:123], v[36:39], a[128:131], 0
    v_mul_f32 v161, v161, v249
    v_mul_f32 v97, v97, v161
    v_mfma_f32_16x16x32_bf16 v[120:123], v[32:35], a[112:115], v[120:123]
    v_cvt_pk_bf16_f32 v210, v96, v97
    v_add_f32 v250, 1.0, v250
    v_mfma_f32_16x16x32_bf16 v[120:123], v[28:31], a[96:99], v[120:123]
    s_waitcnt lgkmcnt(4)
    v_rcp_f32 v250, v250
    v_mfma_f32_16x16x32_bf16 v[120:123], v[16:19], a[48:51], v[120:123]
    s_waitcnt lgkmcnt(2)
    ds_read_b64_tr_b16 v[28:29], v2 offset:0
    v_mul_f32 v162, v162, v250
    v_mfma_f32_16x16x32_bf16 v[120:123], v[20:23], a[64:67], v[120:123]
    s_waitcnt lgkmcnt(1)
    ds_read_b64_tr_b16 v[30:31], v2 offset:512
    v_mul_f32 v98, v98, v162
    v_mfma_f32_16x16x32_bf16 v[120:123], v[24:27], a[80:83], v[120:123]
    buffer_load_dwordx4 v4, s[12:15], s60 offen  lds
    v_mfma_f32_16x16x32_bf16 v[124:127], v[24:27], a[84:87], v[124:127]
    ds_read_b64_tr_b16 v[32:33], v2 offset:4096
    v_mul_f32 v251, v163, v163
    v_mfma_f32_16x16x32_bf16 v[124:127], v[20:23], a[68:71], v[124:127]
    ds_read_b64_tr_b16 v[34:35], v2 offset:4608
    v_fma_f32 v251, v251, s79, v252
    v_mfma_f32_16x16x32_bf16 v[124:127], v[16:19], a[52:55], v[124:127]
    ds_read_b64_tr_b16 v[36:37], v2 offset:8192
    v_mul_f32 v251, v251, v163
    v_mfma_f32_16x16x32_bf16 v[128:131], v[16:19], a[56:59], v[128:131]
    ds_read_b64_tr_b16 v[38:39], v2 offset:8704
    v_mul_f32 v248, v156, v156
    v_mfma_f32_16x16x32_bf16 v[128:131], v[20:23], a[72:75], v[128:131]
    v_add_u32 v1, 36864, v1
    v_add_u32 v2, 36864, v2
    v_mfma_f32_16x16x32_bf16 v[128:131], v[24:27], a[88:91], v[128:131]
    s_add_u32 s60, s63, 384
    v_exp_f32 v251, v251
    v_mfma_f32_16x16x32_bf16 v[132:135], v[24:27], a[92:95], v[132:135]
    s_add_u32 m0, s55, 73728
    v_add_f32 v251, 1.0, v251
    v_fma_f32 v248, v248, s79, v252
    v_mfma_f32_16x16x32_bf16 v[132:135], v[20:23], a[76:79], v[132:135]
    v_rcp_f32 v251, v251
    v_mfma_f32_16x16x32_bf16 v[132:135], v[16:19], a[60:63], v[132:135]
    s_waitcnt lgkmcnt(4)
    v_mul_f32 v163, v163, v251
    v_mul_f32 v99, v99, v163
    v_mfma_f32_16x16x32_bf16 v[132:135], v[28:31], a[12:15], v[132:135]
    s_waitcnt lgkmcnt(2)
    v_cvt_pk_bf16_f32 v211, v98, v99
    v_mul_f32 v248, v248, v156
    v_mfma_f32_16x16x32_bf16 v[132:135], v[32:35], a[28:31], v[132:135]
    s_waitcnt vmcnt(21) lgkmcnt(0)
    s_barrier
    v_mfma_f32_16x16x32_bf16 v[132:135], v[36:39], a[44:47], v[132:135]
    buffer_load_dwordx4 v4, s[16:19], s60 offen  lds
    v_mfma_f32_16x16x32_bf16 v[128:131], v[36:39], a[40:43], v[128:131]
    s_add_u32 s60, s63, 295296
    ds_read_b64_tr_b16 v[16:17], v1 offset:0
    v_mul_f32 v249, v157, v157
    v_mfma_f32_16x16x32_bf16 v[128:131], v[32:35], a[24:27], v[128:131]
    s_add_u32 m0, s55, 77824
    ds_read_b64_tr_b16 v[18:19], v1 offset:512
    v_fma_f32 v249, v249, s79, v252
    v_mfma_f32_16x16x32_bf16 v[128:131], v[28:31], a[8:11], v[128:131]
    ds_read_b64_tr_b16 v[20:21], v1 offset:4096
    v_mul_f32 v249, v249, v157
    v_mfma_f32_16x16x32_bf16 v[124:127], v[28:31], a[4:7], v[124:127]
    ds_read_b64_tr_b16 v[22:23], v1 offset:4608
    v_mul_f32 v250, v158, v158
    v_mfma_f32_16x16x32_bf16 v[124:127], v[32:35], a[20:23], v[124:127]
    ds_read_b64_tr_b16 v[24:25], v1 offset:8192
    v_fma_f32 v250, v250, s79, v252
    v_mfma_f32_16x16x32_bf16 v[124:127], v[36:39], a[36:39], v[124:127]
    ds_read_b64_tr_b16 v[26:27], v1 offset:8704
    v_mul_f32 v250, v250, v158
    v_mfma_f32_16x16x32_bf16 v[120:123], v[36:39], a[32:35], v[120:123]
    buffer_load_dwordx4 v4, s[16:19], s60 offen  lds
    v_mfma_f32_16x16x32_bf16 v[120:123], v[32:35], a[16:19], v[120:123]
    s_add_u32 s60, s63, 590208
    v_exp_f32 v248, v248
    v_mfma_f32_16x16x32_bf16 v[120:123], v[28:31], a[0:3], v[120:123]
    s_waitcnt lgkmcnt(4)
    v_exp_f32 v249, v249
    v_mfma_f32_16x16x32_bf16 v[104:107], v[16:19], a[144:147], v[104:107]
    s_waitcnt lgkmcnt(2)
    ds_read_b64_tr_b16 v[28:29], v1 offset:12288
    v_add_f32 v248, 1.0, v248
    v_mfma_f32_16x16x32_bf16 v[104:107], v[20:23], a[160:163], v[104:107]
    s_waitcnt lgkmcnt(1)
    ds_read_b64_tr_b16 v[30:31], v1 offset:12800
    v_add_f32 v249, 1.0, v249
    v_mfma_f32_16x16x32_bf16 v[104:107], v[24:27], a[176:179], v[104:107]
    s_add_u32 m0, s55, 81920
    ds_read_b64_tr_b16 v[32:33], v1 offset:16384
    v_mul_f32 v251, v159, v159
    v_mfma_f32_16x16x32_bf16 v[108:111], v[24:27], a[180:183], v[108:111]
    ds_read_b64_tr_b16 v[34:35], v1 offset:16896
    v_fma_f32 v251, v251, s79, v252
    v_mfma_f32_16x16x32_bf16 v[108:111], v[20:23], a[164:167], v[108:111]
    buffer_load_dwordx4 v4, s[16:19], s60 offen  lds
    v_mfma_f32_16x16x32_bf16 v[108:111], v[16:19], a[148:151], v[108:111]
    s_add_u32 s60, s63, 885120
    ds_read_b64_tr_b16 v[36:37], v1 offset:20480
    v_mul_f32 v251, v251, v159
    v_mfma_f32_16x16x32_bf16 v[112:115], v[16:19], a[152:155], v[112:115]
    s_add_u32 m0, s55, 86016
    ds_read_b64_tr_b16 v[38:39], v1 offset:20992
    v_mov_b32 v217, -1
    v_mfma_f32_16x16x32_bf16 v[112:115], v[20:23], a[168:171], v[112:115]
    v_rcp_f32 v248, v248
    v_mfma_f32_16x16x32_bf16 v[112:115], v[24:27], a[184:187], v[112:115]
    v_rcp_f32 v249, v249
    v_mfma_f32_16x16x32_bf16 v[116:119], v[24:27], a[188:191], v[116:119]
    v_exp_f32 v250, v250
    v_mfma_f32_16x16x32_bf16 v[116:119], v[20:23], a[172:175], v[116:119]
    v_exp_f32 v251, v251
    v_mfma_f32_16x16x32_bf16 v[116:119], v[16:19], a[156:159], v[116:119]
    s_waitcnt lgkmcnt(4)
    v_mul_f32 v156, v156, v248
    v_mul_f32 v92, v92, v156
    v_mfma_f32_16x16x32_bf16 v[116:119], v[28:31], a[204:207], v[116:119]
    s_waitcnt lgkmcnt(2)
    ds_read_b64_tr_b16 v[16:17], v1 offset:24576
    v_mul_f32 v157, v157, v249
    v_mfma_f32_16x16x32_bf16 v[116:119], v[32:35], a[220:223], v[116:119]
    s_waitcnt lgkmcnt(1)
    ds_read_b64_tr_b16 v[18:19], v1 offset:25088
    v_mul_f32 v93, v93, v157
    v_mfma_f32_16x16x32_bf16 v[116:119], v[36:39], a[236:239], v[116:119]
    buffer_load_dwordx4 v4, s[16:19], s60 offen  lds
    v_mfma_f32_16x16x32_bf16 v[112:115], v[36:39], a[232:235], v[112:115]
    s_add_u32 s60, s63, 1180032
    ds_read_b64_tr_b16 v[20:21], v1 offset:28672
    v_cvt_pk_bf16_f32 v206, v92, v93
    v_mfma_f32_16x16x32_bf16 v[112:115], v[32:35], a[216:219], v[112:115]
    s_add_u32 m0, s55, 90112
    ds_read_b64_tr_b16 v[22:23], v1 offset:29184
    v_add_f32 v250, 1.0, v250
    v_mfma_f32_16x16x32_bf16 v[112:115], v[28:31], a[200:203], v[112:115]
    ds_read_b64_tr_b16 v[24:25], v1 offset:32768
    v_add_f32 v251, 1.0, v251
    v_mfma_f32_16x16x32_bf16 v[108:111], v[28:31], a[196:199], v[108:111]
    ds_read_b64_tr_b16 v[26:27], v1 offset:33280
    v_mul_f32 v248, v152, v152
    v_mfma_f32_16x16x32_bf16 v[108:111], v[32:35], a[212:215], v[108:111]
    buffer_load_dwordx4 v4, s[16:19], s60 offen  lds
    v_mfma_f32_16x16x32_bf16 v[108:111], v[36:39], a[228:231], v[108:111]
    s_add_u32 s60, s63, 1474944
    v_rcp_f32 v250, v250
    v_mfma_f32_16x16x32_bf16 v[104:107], v[36:39], a[224:227], v[104:107]
    s_add_u32 m0, s55, 94208
    v_rcp_f32 v251, v251
    v_mfma_f32_16x16x32_bf16 v[104:107], v[32:35], a[208:211], v[104:107]
    v_mul_f32 v158, v158, v250
    v_mul_f32 v94, v94, v158
    v_mfma_f32_16x16x32_bf16 v[104:107], v[28:31], a[192:195], v[104:107]
    s_waitcnt lgkmcnt(4)
    v_mul_f32 v159, v159, v251
    v_mul_f32 v95, v95, v159
    v_mfma_f32_16x16x32_bf16 v[104:107], v[16:19], a[240:243], v[104:107]
    s_waitcnt lgkmcnt(2)
    ds_read_b64_tr_b16 v[28:29], v2 offset:24576
    v_cvt_pk_bf16_f32 v207, v94, v95
    v_mfma_f32_16x16x32_bf16 v[104:107], v[20:23], v[40:43], v[104:107]
    s_waitcnt lgkmcnt(1)
    ds_read_b64_tr_b16 v[30:31], v2 offset:25088
    v_fma_f32 v248, v248, s79, v252
    v_mfma_f32_16x16x32_bf16 v[104:107], v[24:27], v[56:59], v[104:107]
    buffer_load_dwordx4 v4, s[16:19], s60 offen  lds
    v_mfma_f32_16x16x32_bf16 v[108:111], v[24:27], v[60:63], v[108:111]
    s_add_u32 s60, s63, 1769856
    ds_read_b64_tr_b16 v[32:33], v2 offset:28672
    v_mul_f32 v248, v248, v152
    v_mfma_f32_16x16x32_bf16 v[108:111], v[20:23], v[44:47], v[108:111]
    s_add_u32 m0, s55, 98304
    ds_read_b64_tr_b16 v[34:35], v2 offset:29184
    v_mul_f32 v249, v153, v153
    v_mfma_f32_16x16x32_bf16 v[108:111], v[16:19], a[244:247], v[108:111]
    ds_read_b64_tr_b16 v[36:37], v2 offset:32768
    v_fma_f32 v249, v249, s79, v252
    v_mfma_f32_16x16x32_bf16 v[112:115], v[16:19], a[248:251], v[112:115]
    ds_read_b64_tr_b16 v[38:39], v2 offset:33280
    v_mul_f32 v249, v249, v153
    v_mfma_f32_16x16x32_bf16 v[112:115], v[20:23], v[48:51], v[112:115]
    v_exp_f32 v248, v248
    v_mfma_f32_16x16x32_bf16 v[112:115], v[24:27], v[64:67], v[112:115]
    v_exp_f32 v249, v249
    v_mfma_f32_16x16x32_bf16 v[116:119], v[24:27], v[68:71], v[116:119]
    buffer_load_dwordx4 v4, s[16:19], s60 offen  lds
    v_mfma_f32_16x16x32_bf16 v[116:119], v[20:23], v[52:55], v[116:119]
    v_add_f32 v248, 1.0, v248
    v_add_f32 v249, 1.0, v249
    v_mfma_f32_16x16x32_bf16 v[116:119], v[16:19], a[252:255], v[116:119]
    s_waitcnt lgkmcnt(4)
    v_rcp_f32 v248, v248
    v_mfma_f32_16x16x32_bf16 v[132:135], v[28:31], a[252:255], v[132:135]
    s_waitcnt lgkmcnt(2)
    ds_read_b64_tr_b16 v[16:17], v2 offset:12288
    v_mul_f32 v152, v152, v248
    v_mfma_f32_16x16x32_bf16 v[132:135], v[32:35], v[52:55], v[132:135]
    s_waitcnt lgkmcnt(1)
    ds_read_b64_tr_b16 v[18:19], v2 offset:12800
    v_mul_f32 v88, v88, v152
    v_mfma_f32_16x16x32_bf16 v[132:135], v[36:39], v[68:71], v[132:135]
    s_add_u32 s60, s63, 2064768
    ds_read_b64_tr_b16 v[20:21], v2 offset:16384
    v_mul_f32 v250, v154, v154
    v_mfma_f32_16x16x32_bf16 v[128:131], v[36:39], v[64:67], v[128:131]
    s_add_u32 m0, s55, 102400
    ds_read_b64_tr_b16 v[22:23], v2 offset:16896
    v_fma_f32 v250, v250, s79, v252
    v_mfma_f32_16x16x32_bf16 v[128:131], v[32:35], v[48:51], v[128:131]
    ds_read_b64_tr_b16 v[24:25], v2 offset:20480
    v_mul_f32 v250, v250, v154
    v_mfma_f32_16x16x32_bf16 v[128:131], v[28:31], a[248:251], v[128:131]
    buffer_load_dwordx4 v4, s[16:19], s60 offen  lds
    v_mfma_f32_16x16x32_bf16 v[124:127], v[28:31], a[244:247], v[124:127]
    s_add_u32 s60, s63, 2359680
    ds_read_b64_tr_b16 v[26:27], v2 offset:20992
    v_mul_f32 v251, v155, v155
    v_mfma_f32_16x16x32_bf16 v[124:127], v[32:35], v[44:47], v[124:127]
    s_add_u32 m0, s55, 106496
    v_rcp_f32 v249, v249
    v_mfma_f32_16x16x32_bf16 v[124:127], v[36:39], v[60:63], v[124:127]
    v_exp_f32 v250, v250
    v_mfma_f32_16x16x32_bf16 v[120:123], v[36:39], v[56:59], v[120:123]
    v_mul_f32 v153, v153, v249
    v_mul_f32 v89, v89, v153
    v_mfma_f32_16x16x32_bf16 v[120:123], v[32:35], v[40:43], v[120:123]
    v_cvt_pk_bf16_f32 v202, v88, v89
    v_add_f32 v250, 1.0, v250
    v_mfma_f32_16x16x32_bf16 v[120:123], v[28:31], a[240:243], v[120:123]
    s_waitcnt lgkmcnt(4)
    v_rcp_f32 v250, v250
    v_mfma_f32_16x16x32_bf16 v[120:123], v[16:19], a[192:195], v[120:123]
    s_waitcnt lgkmcnt(2)
    ds_read_b64_tr_b16 v[28:29], v2 offset:0
    v_mul_f32 v154, v154, v250
    v_mfma_f32_16x16x32_bf16 v[120:123], v[20:23], a[208:211], v[120:123]
    s_waitcnt lgkmcnt(1)
    ds_read_b64_tr_b16 v[30:31], v2 offset:512
    v_mul_f32 v90, v90, v154
    v_mfma_f32_16x16x32_bf16 v[120:123], v[24:27], a[224:227], v[120:123]
    buffer_load_dwordx4 v4, s[16:19], s60 offen  lds
    v_mfma_f32_16x16x32_bf16 v[124:127], v[24:27], a[228:231], v[124:127]
    ds_read_b64_tr_b16 v[32:33], v2 offset:4096
    v_fma_f32 v251, v251, s79, v252
    v_mfma_f32_16x16x32_bf16 v[124:127], v[20:23], a[212:215], v[124:127]
    ds_read_b64_tr_b16 v[34:35], v2 offset:4608
    v_mul_f32 v251, v251, v155
    v_mfma_f32_16x16x32_bf16 v[124:127], v[16:19], a[196:199], v[124:127]
    ds_read_b64_tr_b16 v[36:37], v2 offset:8192
    v_mul_f32 v104, s76, v104
    v_mfma_f32_16x16x32_bf16 v[128:131], v[16:19], a[200:203], v[128:131]
    ds_read_b64_tr_b16 v[38:39], v2 offset:8704
    v_mul_f32 v105, s76, v105
    v_mfma_f32_16x16x32_bf16 v[128:131], v[20:23], a[216:219], v[128:131]
    v_add_u32 v1, 4294856704, v1
    v_add_u32 v2, 4294856704, v2
    v_mfma_f32_16x16x32_bf16 v[128:131], v[24:27], a[232:235], v[128:131]
    s_add_u32 s60, s63, 2654592
    v_exp_f32 v251, v251
    v_mfma_f32_16x16x32_bf16 v[132:135], v[24:27], a[236:239], v[132:135]
    s_add_u32 m0, s55, 110592
    v_add_f32 v251, 1.0, v251
    v_cvt_pk_bf16_f32 v104, v104, v105
    v_mfma_f32_16x16x32_bf16 v[132:135], v[20:23], a[220:223], v[132:135]
    v_rcp_f32 v251, v251
    v_mfma_f32_16x16x32_bf16 v[132:135], v[16:19], a[204:207], v[132:135]
    s_waitcnt lgkmcnt(4)
    v_mul_f32 v155, v155, v251
    v_mul_f32 v91, v91, v155
    v_mfma_f32_16x16x32_bf16 v[132:135], v[28:31], a[156:159], v[132:135]
    s_waitcnt lgkmcnt(2)
    v_cvt_pk_bf16_f32 v203, v90, v91
    v_mul_f32 v106, s76, v106
    v_mfma_f32_16x16x32_bf16 v[132:135], v[32:35], a[172:175], v[132:135]
    s_waitcnt vmcnt(20) lgkmcnt(0)
    s_barrier
    v_mfma_f32_16x16x32_bf16 v[132:135], v[36:39], a[188:191], v[132:135]
    buffer_load_dwordx4 v4, s[16:19], s60 offen  lds
    v_mfma_f32_16x16x32_bf16 v[128:131], v[36:39], a[184:187], v[128:131]
    s_add_u32 s60, s63, 2949504
    ds_read_b64_tr_b16 v[16:17], v1 offset:0
    v_mul_f32 v107, s76, v107
    v_mfma_f32_16x16x32_bf16 v[128:131], v[32:35], a[168:171], v[128:131]
    s_add_u32 m0, s55, 114688
    ds_read_b64_tr_b16 v[18:19], v1 offset:512
    v_cvt_pk_bf16_f32 v105, v106, v107
    v_mfma_f32_16x16x32_bf16 v[128:131], v[28:31], a[152:155], v[128:131]
    ds_read_b64_tr_b16 v[20:21], v1 offset:4096
    v_mul_f32 v108, s76, v108
    v_mfma_f32_16x16x32_bf16 v[124:127], v[28:31], a[148:151], v[124:127]
    ds_read_b64_tr_b16 v[22:23], v1 offset:4608
    v_mul_f32 v109, s76, v109
    v_mfma_f32_16x16x32_bf16 v[124:127], v[32:35], a[164:167], v[124:127]
    ds_read_b64_tr_b16 v[24:25], v1 offset:8192
    v_cvt_pk_bf16_f32 v106, v108, v109
    v_mfma_f32_16x16x32_bf16 v[124:127], v[36:39], a[180:183], v[124:127]
    ds_read_b64_tr_b16 v[26:27], v1 offset:8704
    v_mul_f32 v110, s76, v110
    v_mfma_f32_16x16x32_bf16 v[120:123], v[36:39], a[176:179], v[120:123]
    buffer_load_dwordx4 v4, s[16:19], s60 offen  lds
    v_mfma_f32_16x16x32_bf16 v[120:123], v[32:35], a[160:163], v[120:123]
    s_add_u32 s60, s63, 3244416
    v_mul_f32 v111, s76, v111
    v_cvt_pk_bf16_f32 v107, v110, v111
    v_mfma_f32_16x16x32_bf16 v[120:123], v[28:31], a[144:147], v[120:123]
    s_waitcnt lgkmcnt(4)
    v_mul_f32 v112, s76, v112
    v_mul_f32 v113, s76, v113
    v_mfma_f32_16x16x32_bf16 v[136:139], v[16:19], a[0:3], 0
    s_waitcnt lgkmcnt(2)
    ds_read_b64_tr_b16 v[28:29], v1 offset:12288
    v_permlane16_swap_b32 v104, v106
    v_mfma_f32_16x16x32_bf16 v[136:139], v[20:23], a[16:19], v[136:139]
    s_waitcnt lgkmcnt(1)
    ds_read_b64_tr_b16 v[30:31], v1 offset:12800
    v_permlane16_swap_b32 v105, v107
    v_mfma_f32_16x16x32_bf16 v[136:139], v[24:27], a[32:35], v[136:139]
L_pg8:
    s_cbranch_execz L_pg12
    s_add_u32 m0, s55, 118784
    ds_read_b64_tr_b16 v[32:33], v1 offset:16384
    v_cvt_pk_bf16_f32 v112, v112, v113
    v_mfma_f32_16x16x32_bf16 v[140:143], v[24:27], a[36:39], 0
    ds_read_b64_tr_b16 v[34:35], v1 offset:16896
    v_mul_f32 v114, s76, v114
    v_mfma_f32_16x16x32_bf16 v[140:143], v[20:23], a[20:23], v[140:143]
    buffer_load_dwordx4 v4, s[16:19], s60 offen  lds
    v_mfma_f32_16x16x32_bf16 v[140:143], v[16:19], a[4:7], v[140:143]
    s_add_u32 s60, s63, 3539328
    ds_read_b64_tr_b16 v[36:37], v1 offset:20480
    v_mul_f32 v115, s76, v115
    v_mfma_f32_16x16x32_bf16 v[144:147], v[16:19], a[8:11], 0
    s_add_u32 m0, s55, 122880
    ds_read_b64_tr_b16 v[38:39], v1 offset:20992
    v_cvt_pk_bf16_f32 v113, v114, v115
    v_mfma_f32_16x16x32_bf16 v[144:147], v[20:23], a[24:27], v[144:147]
    buffer_store_dwordx4 v[104:107], v12, s[24:27], s68 offen sc1
    v_mfma_f32_16x16x32_bf16 v[144:147], v[24:27], a[40:43], v[144:147]
    v_mul_f32 v116, s76, v116
    v_mul_f32 v117, s76, v117
    v_mfma_f32_16x16x32_bf16 v[148:151], v[24:27], a[44:47], 0
    v_cvt_pk_bf16_f32 v114, v116, v117
    v_mul_f32 v118, s76, v118
    v_mfma_f32_16x16x32_bf16 v[148:151], v[20:23], a[28:31], v[148:151]
    v_mul_f32 v119, s76, v119
    v_cvt_pk_bf16_f32 v115, v118, v119
    v_mfma_f32_16x16x32_bf16 v[148:151], v[16:19], a[12:15], v[148:151]
    s_waitcnt lgkmcnt(4)
    v_mul_f32 v128, s76, v128
    v_mul_f32 v129, s76, v129
    v_mfma_f32_16x16x32_bf16 v[148:151], v[28:31], a[60:63], v[148:151]
    s_waitcnt lgkmcnt(2)
    ds_read_b64_tr_b16 v[16:17], v1 offset:24576
    v_permlane16_swap_b32 v112, v114
    v_mfma_f32_16x16x32_bf16 v[148:151], v[32:35], a[76:79], v[148:151]
    s_waitcnt lgkmcnt(1)
    ds_read_b64_tr_b16 v[18:19], v1 offset:25088
    v_permlane16_swap_b32 v113, v115
    v_mfma_f32_16x16x32_bf16 v[148:151], v[36:39], a[92:95], v[148:151]
    buffer_load_dwordx4 v4, s[16:19], s60 offen  lds
    v_mfma_f32_16x16x32_bf16 v[144:147], v[36:39], a[88:91], v[144:147]
    s_add_u32 s60, s63, 3834240
    ds_read_b64_tr_b16 v[20:21], v1 offset:28672
    v_cvt_pk_bf16_f32 v128, v128, v129
    v_mfma_f32_16x16x32_bf16 v[144:147], v[32:35], a[72:75], v[144:147]
    s_add_u32 m0, s55, 126976
    ds_read_b64_tr_b16 v[22:23], v1 offset:29184
    v_mul_f32 v130, s76, v130
    v_mfma_f32_16x16x32_bf16 v[144:147], v[28:31], a[56:59], v[144:147]
    ds_read_b64_tr_b16 v[24:25], v1 offset:32768
    v_mul_f32 v131, s76, v131
    v_mfma_f32_16x16x32_bf16 v[140:143], v[28:31], a[52:55], v[140:143]
    s_getpc_b64 s[88:89]
L_pc2:
    ds_read_b64_tr_b16 v[26:27], v1 offset:33280
    v_cvt_pk_bf16_f32 v129, v130, v131
    v_mfma_f32_16x16x32_bf16 v[140:143], v[32:35], a[68:71], v[140:143]
    buffer_load_dwordx4 v4, s[16:19], s60 offen  lds
    v_mfma_f32_16x16x32_bf16 v[140:143], v[36:39], a[84:87], v[140:143]
    s_add_u32 s60, s63, 4129152
    v_mov_b32 v229, s89
    v_mul_f32 v132, s76, v132
    v_mfma_f32_16x16x32_bf16 v[136:139], v[36:39], a[80:83], v[136:139]
    s_add_u32 m0, s55, 131072
    v_mul_f32 v133, s76, v133
    v_cvt_pk_bf16_f32 v130, v132, v133
    v_mfma_f32_16x16x32_bf16 v[136:139], v[32:35], a[64:67], v[136:139]
    s_lshr_b32 s3, s2, 3
    v_mul_f32 v134, s76, v134
    v_mul_f32 v135, s76, v135
    v_mfma_f32_16x16x32_bf16 v[136:139], v[28:31], a[48:51], v[136:139]
    s_waitcnt lgkmcnt(4)
    v_cvt_pk_bf16_f32 v131, v134, v135
    v_mul_f32 v120, s76, v120
    v_mfma_f32_16x16x32_bf16 v[136:139], v[16:19], a[96:99], v[136:139]
    s_waitcnt lgkmcnt(2)
    ds_read_b64_tr_b16 v[28:29], v2 offset:24576
    v_mul_f32 v121, s76, v121
    v_mfma_f32_16x16x32_bf16 v[136:139], v[20:23], a[112:115], v[136:139]
    s_waitcnt lgkmcnt(1)
    ds_read_b64_tr_b16 v[30:31], v2 offset:25088
    v_permlane16_swap_b32 v128, v130
    v_mfma_f32_16x16x32_bf16 v[136:139], v[24:27], a[128:131], v[136:139]
    buffer_load_dwordx4 v4, s[16:19], s60 offen  lds
    v_mfma_f32_16x16x32_bf16 v[140:143], v[24:27], a[132:135], v[140:143]
    s_add_u32 s60, s63, 4424064
    ds_read_b64_tr_b16 v[32:33], v2 offset:28672
    v_permlane16_swap_b32 v129, v131
    v_mfma_f32_16x16x32_bf16 v[140:143], v[20:23], a[116:119], v[140:143]
    s_add_u32 m0, s55, 135168
    ds_read_b64_tr_b16 v[34:35], v2 offset:29184
    v_cvt_pk_bf16_f32 v120, v120, v121
    v_mfma_f32_16x16x32_bf16 v[140:143], v[16:19], a[100:103], v[140:143]
    s_lshl_b32 s3, s3, 7
    ds_read_b64_tr_b16 v[36:37], v2 offset:32768
    v_mul_f32 v122, s76, v122
    v_mfma_f32_16x16x32_bf16 v[144:147], v[16:19], a[104:107], v[144:147]
    s_lshl_b32 s67, s54, 18
    ds_read_b64_tr_b16 v[38:39], v2 offset:33280
    v_mul_f32 v123, s76, v123
    v_mfma_f32_16x16x32_bf16 v[144:147], v[20:23], a[120:123], v[144:147]
    buffer_store_dwordx4 v[112:115], v12, s[24:27], s69 offen sc1
    v_mfma_f32_16x16x32_bf16 v[144:147], v[24:27], a[136:139], v[144:147]
    s_add_u32 s3, s3, s67
    v_cvt_pk_bf16_f32 v121, v122, v123
    v_mul_f32 v124, s76, v124
    v_mfma_f32_16x16x32_bf16 v[148:151], v[24:27], a[140:143], v[148:151]
    buffer_load_dwordx4 v4, s[16:19], s60 offen  lds
    v_mfma_f32_16x16x32_bf16 v[148:151], v[20:23], a[124:127], v[148:151]
    v_lshl_add_u32 v228, v0, 12, s3
    v_min_u32 v228, L_last-L_pc2-4, v228
    v_mfma_f32_16x16x32_bf16 v[148:151], v[16:19], a[108:111], v[148:151]
    s_waitcnt lgkmcnt(4)
    v_add_co_u32 v228, vcc, s88, v228
    v_mul_f32 v125, s76, v125
    v_mfma_f32_16x16x32_bf16 v[164:167], v[28:31], a[108:111], 0
    s_waitcnt lgkmcnt(2)
    ds_read_b64_tr_b16 v[16:17], v2 offset:12288
    v_cvt_pk_bf16_f32 v122, v124, v125
    v_mfma_f32_16x16x32_bf16 v[164:167], v[32:35], a[124:127], v[164:167]
    s_waitcnt lgkmcnt(1)
    ds_read_b64_tr_b16 v[18:19], v2 offset:12800
    v_addc_co_u32 v229, vcc, 0, v229, vcc
    v_mfma_f32_16x16x32_bf16 v[164:167], v[36:39], a[140:143], v[164:167]
    s_add_u32 s60, s63, 4718976
    ds_read_b64_tr_b16 v[20:21], v2 offset:16384
    v_mul_f32 v126, s76, v126
    v_mfma_f32_16x16x32_bf16 v[160:163], v[36:39], a[136:139], 0
    s_add_u32 m0, s55, 139264
    ds_read_b64_tr_b16 v[22:23], v2 offset:16896
    v_mul_f32 v127, s76, v127
    v_mfma_f32_16x16x32_bf16 v[160:163], v[32:35], a[120:123], v[160:163]
    ds_read_b64_tr_b16 v[24:25], v2 offset:20480
    v_cvt_pk_bf16_f32 v123, v126, v127
    v_mfma_f32_16x16x32_bf16 v[160:163], v[28:31], a[104:107], v[160:163]
    buffer_load_dwordx4 v4, s[16:19], s60 offen  lds
    v_mfma_f32_16x16x32_bf16 v[156:159], v[28:31], a[100:103], 0
    s_add_u32 s60, s63, 5013888
    ds_read_b64_tr_b16 v[26:27], v2 offset:20992
    v_permlane16_swap_b32 v120, v122
    v_mfma_f32_16x16x32_bf16 v[156:159], v[32:35], a[116:119], v[156:159]
    s_add_u32 m0, s55, 143360
    v_permlane16_swap_b32 v121, v123
    v_mov_b32 v218, -1
    v_mfma_f32_16x16x32_bf16 v[156:159], v[36:39], a[132:135], v[156:159]
    v_mov_b32 v219, -1
    v_lshlrev_b32 v221, 2, v0
    v_mfma_f32_16x16x32_bf16 v[152:155], v[36:39], a[128:131], 0
    v_mfma_f32_16x16x32_bf16 v[152:155], v[32:35], a[112:115], v[152:155]
    v_mfma_f32_16x16x32_bf16 v[152:155], v[28:31], a[96:99], v[152:155]
    s_waitcnt lgkmcnt(4)
    v_mfma_f32_16x16x32_bf16 v[152:155], v[16:19], a[48:51], v[152:155]
    s_waitcnt lgkmcnt(2)
    ds_read_b64_tr_b16 v[28:29], v2 offset:0
    v_mfma_f32_16x16x32_bf16 v[152:155], v[20:23], a[64:67], v[152:155]
    s_waitcnt lgkmcnt(1)
    ds_read_b64_tr_b16 v[30:31], v2 offset:512
    v_mfma_f32_16x16x32_bf16 v[152:155], v[24:27], a[80:83], v[152:155]
    buffer_load_dwordx4 v4, s[16:19], s60 offen  lds
    v_mfma_f32_16x16x32_bf16 v[156:159], v[24:27], a[84:87], v[156:159]
    ds_read_b64_tr_b16 v[32:33], v2 offset:4096
    v_mfma_f32_16x16x32_bf16 v[156:159], v[20:23], a[68:71], v[156:159]
    ds_read_b64_tr_b16 v[34:35], v2 offset:4608
    v_mfma_f32_16x16x32_bf16 v[156:159], v[16:19], a[52:55], v[156:159]
    ds_read_b64_tr_b16 v[36:37], v2 offset:8192
    v_mfma_f32_16x16x32_bf16 v[160:163], v[16:19], a[56:59], v[160:163]
    ds_read_b64_tr_b16 v[38:39], v2 offset:8704
    v_mfma_f32_16x16x32_bf16 v[160:163], v[20:23], a[72:75], v[160:163]
    v_add_u32 v1, 36864, v1
    v_add_u32 v2, 36864, v2
    v_mfma_f32_16x16x32_bf16 v[160:163], v[24:27], a[88:91], v[160:163]
    buffer_store_dwordx4 v[128:131], v13, s[24:27], s69 offen sc1
    v_mfma_f32_16x16x32_bf16 v[164:167], v[24:27], a[92:95], v[164:167]
    s_add_u32 s60, s62, 0
    v_mfma_f32_16x16x32_bf16 v[164:167], v[20:23], a[76:79], v[164:167]
    global_load_dword v254, v[228:229], off
    v_mfma_f32_16x16x32_bf16 v[164:167], v[16:19], a[60:63], v[164:167]
    s_waitcnt lgkmcnt(4)
    v_mfma_f32_16x16x32_bf16 v[164:167], v[28:31], a[12:15], v[164:167]
    s_waitcnt lgkmcnt(2)
    v_mfma_f32_16x16x32_bf16 v[164:167], v[32:35], a[28:31], v[164:167]
    s_waitcnt vmcnt(22) lgkmcnt(0)
    s_barrier
    v_mfma_f32_16x16x32_bf16 v[164:167], v[36:39], a[44:47], v[164:167]
    s_add_u32 m0, s55, 0
    ds_read_b64_tr_b16 v[16:17], v1 offset:0
    v_mfma_f32_16x16x32_bf16 v[160:163], v[36:39], a[40:43], v[160:163]
    buffer_load_dwordx4 v5, s[44:47], s60 offen  lds
    v_mfma_f32_16x16x32_bf16 v[160:163], v[32:35], a[24:27], v[160:163]
    s_add_u32 s60, s62, 110592
    ds_read_b64_tr_b16 v[18:19], v1 offset:512
    v_mfma_f32_16x16x32_bf16 v[160:163], v[28:31], a[8:11], v[160:163]
    s_add_u32 m0, s55, 4096
    ds_read_b64_tr_b16 v[20:21], v1 offset:4096
    v_mfma_f32_16x16x32_bf16 v[156:159], v[28:31], a[4:7], v[156:159]
    ds_read_b64_tr_b16 v[22:23], v1 offset:4608
    v_mfma_f32_16x16x32_bf16 v[156:159], v[32:35], a[20:23], v[156:159]
    ds_read_b64_tr_b16 v[24:25], v1 offset:8192
    v_mfma_f32_16x16x32_bf16 v[156:159], v[36:39], a[36:39], v[156:159]
    ds_read_b64_tr_b16 v[26:27], v1 offset:8704
    v_mfma_f32_16x16x32_bf16 v[152:155], v[36:39], a[32:35], v[152:155]
    buffer_load_dwordx4 v5, s[44:47], s60 offen  lds
    v_mfma_f32_16x16x32_bf16 v[152:155], v[32:35], a[16:19], v[152:155]
    s_add_u32 s60, s62, 221184
    v_mfma_f32_16x16x32_bf16 v[152:155], v[28:31], a[0:3], v[152:155]
    s_waitcnt lgkmcnt(4)
    v_mfma_f32_16x16x32_bf16 v[136:139], v[16:19], a[144:147], v[136:139]
    s_waitcnt lgkmcnt(2)
    ds_read_b64_tr_b16 v[28:29], v1 offset:12288
    v_mfma_f32_16x16x32_bf16 v[136:139], v[20:23], a[160:163], v[136:139]
    s_waitcnt lgkmcnt(1)
    ds_read_b64_tr_b16 v[30:31], v1 offset:12800
    v_mfma_f32_16x16x32_bf16 v[136:139], v[24:27], a[176:179], v[136:139]
    s_add_u32 m0, s55, 8192
    ds_read_b64_tr_b16 v[32:33], v1 offset:16384
    v_mfma_f32_16x16x32_bf16 v[140:143], v[24:27], a[180:183], v[140:143]
    ds_read_b64_tr_b16 v[34:35], v1 offset:16896
    v_mfma_f32_16x16x32_bf16 v[140:143], v[20:23], a[164:167], v[140:143]
    buffer_load_dwordx4 v5, s[44:47], s60 offen  lds
    v_mfma_f32_16x16x32_bf16 v[140:143], v[16:19], a[148:151], v[140:143]
    s_add_u32 s60, s62, 331776
    ds_read_b64_tr_b16 v[36:37], v1 offset:20480
    v_mfma_f32_16x16x32_bf16 v[144:147], v[16:19], a[152:155], v[144:147]
    s_add_u32 m0, s55, 12288
    ds_read_b64_tr_b16 v[38:39], v1 offset:20992
    v_mfma_f32_16x16x32_bf16 v[144:147], v[20:23], a[168:171], v[144:147]
    v_mfma_f32_16x16x32_bf16 v[144:147], v[24:27], a[184:187], v[144:147]
    buffer_store_dwordx4 v[120:123], v13, s[24:27], s68 offen sc1
    v_mfma_f32_16x16x32_bf16 v[148:151], v[24:27], a[188:191], v[148:151]
    v_lshrrev_b32 v10, 2, v0
    v_bfe_u32 v11, v0, 3, 2
    v_mfma_f32_16x16x32_bf16 v[148:151], v[20:23], a[172:175], v[148:151]
    v_and_b32 v12, 3, v0
    v_lshlrev_b32 v10, 7, v10
    v_mfma_f32_16x16x32_bf16 v[148:151], v[16:19], a[156:159], v[148:151]
    s_waitcnt lgkmcnt(4)
    v_lshl_add_u32 v10, v11, 5, v10
    v_lshl_add_u32 v10, v12, 3, v10
    v_mfma_f32_16x16x32_bf16 v[148:151], v[28:31], a[204:207], v[148:151]
    s_waitcnt lgkmcnt(2)
    ds_read_b64_tr_b16 v[16:17], v1 offset:24576
    v_xor_b32 v10, s58, v10
    v_mfma_f32_16x16x32_bf16 v[148:151], v[32:35], a[220:223], v[148:151]
    s_waitcnt lgkmcnt(1)
    ds_read_b64_tr_b16 v[18:19], v1 offset:25088
    v_add_u32 v3, 73728, v10
    v_mfma_f32_16x16x32_bf16 v[148:151], v[36:39], a[236:239], v[148:151]
    buffer_load_dwordx4 v5, s[44:47], s60 offen  lds
    v_mfma_f32_16x16x32_bf16 v[144:147], v[36:39], a[232:235], v[144:147]
    s_add_u32 s60, s62, 442368
    ds_read_b64_tr_b16 v[20:21], v1 offset:28672
    v_xor_b32 v6, 32, v3
    v_mfma_f32_16x16x32_bf16 v[144:147], v[32:35], a[216:219], v[144:147]
    s_add_u32 m0, s55, 16384
    ds_read_b64_tr_b16 v[22:23], v1 offset:29184
    v_add_u32 v10, s84, v3
    v_mfma_f32_16x16x32_bf16 v[144:147], v[28:31], a[200:203], v[144:147]
    ds_read_b64_tr_b16 v[24:25], v1 offset:32768
    v_add_u32 v11, s84, v6
    v_mfma_f32_16x16x32_bf16 v[140:143], v[28:31], a[196:199], v[140:143]
    ds_read_b64_tr_b16 v[26:27], v1 offset:33280
    v_add_u32 v12, s85, v3
    v_mfma_f32_16x16x32_bf16 v[140:143], v[32:35], a[212:215], v[140:143]
    buffer_load_dwordx4 v5, s[44:47], s60 offen  lds
    v_mfma_f32_16x16x32_bf16 v[140:143], v[36:39], a[228:231], v[140:143]
    s_add_u32 s60, s62, 552960
    v_add_u32 v13, s85, v6
    v_mfma_f32_16x16x32_bf16 v[136:139], v[36:39], a[224:227], v[136:139]
    s_add_u32 m0, s55, 20480
    v_mfma_f32_16x16x32_bf16 v[136:139], v[32:35], a[208:211], v[136:139]
    v_mfma_f32_16x16x32_bf16 v[136:139], v[28:31], a[192:195], v[136:139]
    s_waitcnt lgkmcnt(4)
    v_mfma_f32_16x16x32_bf16 v[136:139], v[16:19], a[240:243], v[136:139]
    s_waitcnt lgkmcnt(2)
    ds_read_b64_tr_b16 v[28:29], v2 offset:24576
    v_mfma_f32_16x16x32_bf16 v[136:139], v[20:23], v[40:43], v[136:139]
    s_waitcnt lgkmcnt(1)
    ds_read_b64_tr_b16 v[30:31], v2 offset:25088
    v_mfma_f32_16x16x32_bf16 v[136:139], v[24:27], v[56:59], v[136:139]
    buffer_load_dwordx4 v5, s[44:47], s60 offen  lds
    v_mfma_f32_16x16x32_bf16 v[140:143], v[24:27], v[60:63], v[140:143]
    s_add_u32 s60, s62, 663552
    ds_read_b64_tr_b16 v[32:33], v2 offset:28672
    v_mfma_f32_16x16x32_bf16 v[140:143], v[20:23], v[44:47], v[140:143]
    s_add_u32 m0, s55, 24576
    ds_read_b64_tr_b16 v[34:35], v2 offset:29184
    v_mfma_f32_16x16x32_bf16 v[140:143], v[16:19], a[244:247], v[140:143]
    ds_read_b64_tr_b16 v[36:37], v2 offset:32768
    v_mfma_f32_16x16x32_bf16 v[144:147], v[16:19], a[248:251], v[144:147]
    ds_read_b64_tr_b16 v[38:39], v2 offset:33280
    v_mul_f32 v248, v136, v136
    v_mfma_f32_16x16x32_bf16 v[144:147], v[20:23], v[48:51], v[144:147]
    v_fma_f32 v248, v248, s79, v252
    v_mul_f32 v248, v248, v136
    v_mfma_f32_16x16x32_bf16 v[144:147], v[24:27], v[64:67], v[144:147]
    v_exp_f32 v248, v248
    v_mfma_f32_16x16x32_bf16 v[148:151], v[24:27], v[68:71], v[148:151]
    buffer_load_dwordx4 v5, s[44:47], s60 offen  lds
    v_mfma_f32_16x16x32_bf16 v[148:151], v[20:23], v[52:55], v[148:151]
    v_add_f32 v248, 1.0, v248
    v_mul_f32 v249, v137, v137
    v_mfma_f32_16x16x32_bf16 v[148:151], v[16:19], a[252:255], v[148:151]
    s_waitcnt lgkmcnt(4)
    v_rcp_f32 v248, v248
    v_mfma_f32_16x16x32_bf16 v[164:167], v[28:31], a[252:255], v[164:167]
    s_waitcnt lgkmcnt(2)
    ds_read_b64_tr_b16 v[16:17], v2 offset:12288
    v_mul_f32 v136, v136, v248
    v_mfma_f32_16x16x32_bf16 v[164:167], v[32:35], v[52:55], v[164:167]
    s_waitcnt lgkmcnt(1)
    ds_read_b64_tr_b16 v[18:19], v2 offset:12800
    v_fma_f32 v249, v249, s79, v252
    v_mfma_f32_16x16x32_bf16 v[164:167], v[36:39], v[68:71], v[164:167]
    s_add_u32 s60, s62, 774144
    ds_read_b64_tr_b16 v[20:21], v2 offset:16384
    v_mul_f32 v249, v249, v137
    v_mfma_f32_16x16x32_bf16 v[160:163], v[36:39], v[64:67], v[160:163]
    s_add_u32 m0, s55, 28672
    ds_read_b64_tr_b16 v[22:23], v2 offset:16896
    v_mul_f32 v250, v138, v138
    v_mfma_f32_16x16x32_bf16 v[160:163], v[32:35], v[48:51], v[160:163]
    ds_read_b64_tr_b16 v[24:25], v2 offset:20480
    v_fma_f32 v250, v250, s79, v252
    v_mfma_f32_16x16x32_bf16 v[160:163], v[28:31], a[248:251], v[160:163]
    buffer_load_dwordx4 v5, s[44:47], s60 offen  lds
    v_mfma_f32_16x16x32_bf16 v[156:159], v[28:31], a[244:247], v[156:159]
    s_add_u32 s60, s62, 884736
    ds_read_b64_tr_b16 v[26:27], v2 offset:20992
    v_mul_f32 v250, v250, v138
    v_mfma_f32_16x16x32_bf16 v[156:159], v[32:35], v[44:47], v[156:159]
    s_add_u32 m0, s55, 32768
    v_exp_f32 v249, v249
    v_mfma_f32_16x16x32_bf16 v[156:159], v[36:39], v[60:63], v[156:159]
    v_exp_f32 v250, v250
    v_mfma_f32_16x16x32_bf16 v[152:155], v[36:39], v[56:59], v[152:155]
    v_add_f32 v249, 1.0, v249
    v_add_f32 v250, 1.0, v250
    v_mfma_f32_16x16x32_bf16 v[152:155], v[32:35], v[40:43], v[152:155]
    v_rcp_f32 v249, v249
    v_mfma_f32_16x16x32_bf16 v[152:155], v[28:31], a[240:243], v[152:155]
    s_waitcnt lgkmcnt(4)
    v_rcp_f32 v250, v250
    v_mfma_f32_16x16x32_bf16 v[152:155], v[16:19], a[192:195], v[152:155]
    s_waitcnt lgkmcnt(2)
    ds_read_b64_tr_b16 v[28:29], v2 offset:0
    v_mul_f32 v137, v137, v249
    v_mfma_f32_16x16x32_bf16 v[152:155], v[20:23], a[208:211], v[152:155]
    s_waitcnt lgkmcnt(1)
    ds_read_b64_tr_b16 v[30:31], v2 offset:512
    v_mul_f32 v138, v138, v250
    v_mfma_f32_16x16x32_bf16 v[152:155], v[24:27], a[224:227], v[152:155]
    buffer_load_dwordx4 v5, s[44:47], s60 offen  lds
    v_mfma_f32_16x16x32_bf16 v[156:159], v[24:27], a[228:231], v[156:159]
    ds_read_b64_tr_b16 v[32:33], v2 offset:4096
    v_mul_f32 v251, v139, v139
    v_mfma_f32_16x16x32_bf16 v[156:159], v[20:23], a[212:215], v[156:159]
    ds_read_b64_tr_b16 v[34:35], v2 offset:4608
    v_fma_f32 v251, v251, s79, v252
    v_mfma_f32_16x16x32_bf16 v[156:159], v[16:19], a[196:199], v[156:159]
    ds_read_b64_tr_b16 v[36:37], v2 offset:8192
    v_mul_f32 v251, v251, v139
    v_mfma_f32_16x16x32_bf16 v[160:163], v[16:19], a[200:203], v[160:163]
    ds_read_b64_tr_b16 v[38:39], v2 offset:8704
    v_mul_f32 v248, v140, v140
    v_mfma_f32_16x16x32_bf16 v[160:163], v[20:23], a[216:219], v[160:163]
    v_add_u32 v1, 36864, v1
    v_add_u32 v2, 36864, v2
    v_mfma_f32_16x16x32_bf16 v[160:163], v[24:27], a[232:235], v[160:163]
    s_add_u32 s60, s62, 995328
    v_exp_f32 v251, v251
    v_mfma_f32_16x16x32_bf16 v[164:167], v[24:27], a[236:239], v[164:167]
    s_add_u32 m0, s55, 36864
    v_add_f32 v251, 1.0, v251
    v_fma_f32 v248, v248, s79, v252
    v_mfma_f32_16x16x32_bf16 v[164:167], v[20:23], a[220:223], v[164:167]
    v_rcp_f32 v251, v251
    v_mfma_f32_16x16x32_bf16 v[164:167], v[16:19], a[204:207], v[164:167]
    s_waitcnt lgkmcnt(4)
    v_mul_f32 v139, v139, v251
    v_mul_f32 v248, v248, v140
    v_mfma_f32_16x16x32_bf16 v[164:167], v[28:31], a[156:159], v[164:167]
    s_waitcnt lgkmcnt(2)
    v_exp_f32 v248, v248
    v_mfma_f32_16x16x32_bf16 v[164:167], v[32:35], a[172:175], v[164:167]
    s_waitcnt vmcnt(23) lgkmcnt(0)
    s_barrier
    v_mfma_f32_16x16x32_bf16 v[164:167], v[36:39], a[188:191], v[164:167]
    buffer_load_dwordx4 v5, s[44:47], s60 offen  lds
    v_mfma_f32_16x16x32_bf16 v[160:163], v[36:39], a[184:187], v[160:163]
    s_add_u32 s60, s62, 1105920
    ds_read_b64_tr_b16 v[16:17], v1 offset:0
    v_add_f32 v248, 1.0, v248
    v_mfma_f32_16x16x32_bf16 v[160:163], v[32:35], a[168:171], v[160:163]
    s_add_u32 m0, s55, 40960
    ds_read_b64_tr_b16 v[18:19], v1 offset:512
    v_mul_f32 v249, v141, v141
    v_mfma_f32_16x16x32_bf16 v[160:163], v[28:31], a[152:155], v[160:163]
    ds_read_b64_tr_b16 v[20:21], v1 offset:4096
    v_fma_f32 v249, v249, s79, v252
    v_mfma_f32_16x16x32_bf16 v[156:159], v[28:31], a[148:151], v[156:159]
    ds_read_b64_tr_b16 v[22:23], v1 offset:4608
    v_mul_f32 v249, v249, v141
    v_mfma_f32_16x16x32_bf16 v[156:159], v[32:35], a[164:167], v[156:159]
    ds_read_b64_tr_b16 v[24:25], v1 offset:8192
    v_mul_f32 v250, v142, v142
    v_mfma_f32_16x16x32_bf16 v[156:159], v[36:39], a[180:183], v[156:159]
    ds_read_b64_tr_b16 v[26:27], v1 offset:8704
    v_fma_f32 v250, v250, s79, v252
    v_mfma_f32_16x16x32_bf16 v[152:155], v[36:39], a[176:179], v[152:155]
    buffer_load_dwordx4 v5, s[44:47], s60 offen  lds
    v_mfma_f32_16x16x32_bf16 v[152:155], v[32:35], a[160:163], v[152:155]
    s_add_u32 s60, s62, 1216512
    v_rcp_f32 v248, v248
    v_mfma_f32_16x16x32_bf16 v[152:155], v[28:31], a[144:147], v[152:155]
    s_waitcnt lgkmcnt(4)
    v_exp_f32 v249, v249
    v_mfma_f32_16x16x32_bf16 v[72:75], v[16:19], a[0:3], 0
    s_waitcnt lgkmcnt(2)
    ds_read_b64_tr_b16 v[28:29], v1 offset:12288
    v_mul_f32 v140, v140, v248
    v_mfma_f32_16x16x32_bf16 v[72:75], v[20:23], a[16:19], v[72:75]
    s_waitcnt lgkmcnt(1)
    ds_read_b64_tr_b16 v[30:31], v1 offset:12800
    v_add_f32 v249, 1.0, v249
    v_mfma_f32_16x16x32_bf16 v[72:75], v[24:27], a[32:35], v[72:75]
    s_add_u32 m0, s55, 45056
    ds_read_b64_tr_b16 v[32:33], v1 offset:16384
    v_mul_f32 v250, v250, v142
    v_mfma_f32_16x16x32_bf16 v[76:79], v[24:27], a[36:39], 0
    ds_read_b64_tr_b16 v[34:35], v1 offset:16896
    v_mul_f32 v251, v143, v143
    v_mfma_f32_16x16x32_bf16 v[76:79], v[20:23], a[20:23], v[76:79]
    buffer_load_dwordx4 v5, s[44:47], s60 offen  lds
    v_mfma_f32_16x16x32_bf16 v[76:79], v[16:19], a[4:7], v[76:79]
    s_add_u32 s60, s62, 1327104
    ds_read_b64_tr_b16 v[36:37], v1 offset:20480
    v_fma_f32 v251, v251, s79, v252
    v_mfma_f32_16x16x32_bf16 v[80:83], v[16:19], a[8:11], 0
    s_add_u32 m0, s55, 49152
    ds_read_b64_tr_b16 v[38:39], v1 offset:20992
    v_mul_f32 v251, v251, v143
    v_mfma_f32_16x16x32_bf16 v[80:83], v[20:23], a[24:27], v[80:83]
    buffer_store_dwordx4 v[216:219], v220, s[24:27], s86 offen sc1
    v_mfma_f32_16x16x32_bf16 v[80:83], v[24:27], a[40:43], v[80:83]
    v_rcp_f32 v249, v249
    v_mfma_f32_16x16x32_bf16 v[84:87], v[24:27], a[44:47], 0
    v_exp_f32 v250, v250
    v_mfma_f32_16x16x32_bf16 v[84:87], v[20:23], a[28:31], v[84:87]
    v_exp_f32 v251, v251
    v_mfma_f32_16x16x32_bf16 v[84:87], v[16:19], a[12:15], v[84:87]
    s_waitcnt lgkmcnt(4)
    v_mul_f32 v141, v141, v249
    v_add_f32 v250, 1.0, v250
    v_mfma_f32_16x16x32_bf16 v[84:87], v[28:31], a[60:63], v[84:87]
    s_waitcnt lgkmcnt(2)
    ds_read_b64_tr_b16 v[16:17], v1 offset:24576
    v_add_f32 v251, 1.0, v251
    v_mfma_f32_16x16x32_bf16 v[84:87], v[32:35], a[76:79], v[84:87]
    s_waitcnt lgkmcnt(1)
    ds_read_b64_tr_b16 v[18:19], v1 offset:25088
    v_mul_f32 v248, v144, v144
    v_mfma_f32_16x16x32_bf16 v[84:87], v[36:39], a[92:95], v[84:87]
    buffer_load_dwordx4 v5, s[44:47], s60 offen  lds
    v_mfma_f32_16x16x32_bf16 v[80:83], v[36:39], a[88:91], v[80:83]
    s_add_u32 s60, s62, 1437696
    ds_read_b64_tr_b16 v[20:21], v1 offset:28672
    v_fma_f32 v248, v248, s79, v252
    v_mfma_f32_16x16x32_bf16 v[80:83], v[32:35], a[72:75], v[80:83]
    s_add_u32 m0, s55, 53248
    ds_read_b64_tr_b16 v[22:23], v1 offset:29184
    v_mul_f32 v248, v248, v144
    v_mfma_f32_16x16x32_bf16 v[80:83], v[28:31], a[56:59], v[80:83]
    ds_read_b64_tr_b16 v[24:25], v1 offset:32768
    v_mul_f32 v249, v145, v145
    v_mfma_f32_16x16x32_bf16 v[76:79], v[28:31], a[52:55], v[76:79]
    ds_read_b64_tr_b16 v[26:27], v1 offset:33280
    v_fma_f32 v249, v249, s79, v252
    v_mfma_f32_16x16x32_bf16 v[76:79], v[32:35], a[68:71], v[76:79]
    buffer_load_dwordx4 v5, s[44:47], s60 offen  lds
    v_mfma_f32_16x16x32_bf16 v[76:79], v[36:39], a[84:87], v[76:79]
    s_add_u32 s60, s62, 1548288
    v_rcp_f32 v250, v250
    v_mfma_f32_16x16x32_bf16 v[72:75], v[36:39], a[80:83], v[72:75]
    s_add_u32 m0, s55, 57344
    v_rcp_f32 v251, v251
    v_mfma_f32_16x16x32_bf16 v[72:75], v[32:35], a[64:67], v[72:75]
    v_exp_f32 v248, v248
    v_mfma_f32_16x16x32_bf16 v[72:75], v[28:31], a[48:51], v[72:75]
    s_waitcnt lgkmcnt(4)
    v_mul_f32 v142, v142, v250
    v_mul_f32 v143, v143, v251
    v_mfma_f32_16x16x32_bf16 v[72:75], v[16:19], a[96:99], v[72:75]
    s_waitcnt lgkmcnt(2)
    ds_read_b64_tr_b16 v[28:29], v2 offset:24576
    v_add_f32 v248, 1.0, v248
    v_mfma_f32_16x16x32_bf16 v[72:75], v[20:23], a[112:115], v[72:75]
    s_waitcnt lgkmcnt(1)
    ds_read_b64_tr_b16 v[30:31], v2 offset:25088
    v_mul_f32 v249, v249, v145
    v_mfma_f32_16x16x32_bf16 v[72:75], v[24:27], a[128:131], v[72:75]
    buffer_load_dwordx4 v5, s[44:47], s60 offen  lds
    v_mfma_f32_16x16x32_bf16 v[76:79], v[24:27], a[132:135], v[76:79]
    s_add_u32 s60, s62, 1658880
    ds_read_b64_tr_b16 v[32:33], v2 offset:28672
    v_mul_f32 v250, v146, v146
    v_mfma_f32_16x16x32_bf16 v[76:79], v[20:23], a[116:119], v[76:79]
    s_add_u32 m0, s55, 61440
    ds_read_b64_tr_b16 v[34:35], v2 offset:29184
    v_fma_f32 v250, v250, s79, v252
    v_mfma_f32_16x16x32_bf16 v[76:79], v[16:19], a[100:103], v[76:79]
    ds_read_b64_tr_b16 v[36:37], v2 offset:32768
    v_mul_f32 v250, v250, v146
    v_mfma_f32_16x16x32_bf16 v[80:83], v[16:19], a[104:107], v[80:83]
    ds_read_b64_tr_b16 v[38:39], v2 offset:33280
    v_mul_f32 v251, v147, v147
    v_mfma_f32_16x16x32_bf16 v[80:83], v[20:23], a[120:123], v[80:83]
    buffer_store_dwordx4 v[216:219], v220, s[24:27], s86 offen offset:1024 sc1
    v_mfma_f32_16x16x32_bf16 v[80:83], v[24:27], a[136:139], v[80:83]
    v_rcp_f32 v248, v248
    v_mfma_f32_16x16x32_bf16 v[84:87], v[24:27], a[140:143], v[84:87]
    buffer_load_dwordx4 v5, s[44:47], s60 offen  lds
    v_mfma_f32_16x16x32_bf16 v[84:87], v[20:23], a[124:127], v[84:87]
    v_exp_f32 v249, v249
    v_mfma_f32_16x16x32_bf16 v[84:87], v[16:19], a[108:111], v[84:87]
    s_waitcnt lgkmcnt(4)
    v_exp_f32 v250, v250
    v_mfma_f32_16x16x32_bf16 v[100:103], v[28:31], a[108:111], 0
    s_waitcnt lgkmcnt(2)
    ds_read_b64_tr_b16 v[16:17], v2 offset:12288
    v_mul_f32 v144, v144, v248
    v_mfma_f32_16x16x32_bf16 v[100:103], v[32:35], a[124:127], v[100:103]
    s_waitcnt lgkmcnt(1)
    ds_read_b64_tr_b16 v[18:19], v2 offset:12800
    v_add_f32 v249, 1.0, v249
    v_mfma_f32_16x16x32_bf16 v[100:103], v[36:39], a[140:143], v[100:103]
    s_add_u32 s60, s62, 1769472
    ds_read_b64_tr_b16 v[20:21], v2 offset:16384
    v_add_f32 v250, 1.0, v250
    v_mfma_f32_16x16x32_bf16 v[96:99], v[36:39], a[136:139], 0
    s_add_u32 m0, s55, 65536
    ds_read_b64_tr_b16 v[22:23], v2 offset:16896
    v_fma_f32 v251, v251, s79, v252
    v_mfma_f32_16x16x32_bf16 v[96:99], v[32:35], a[120:123], v[96:99]
    ds_read_b64_tr_b16 v[24:25], v2 offset:20480
    v_mul_f32 v251, v251, v147
    v_mfma_f32_16x16x32_bf16 v[96:99], v[28:31], a[104:107], v[96:99]
    buffer_load_dwordx4 v5, s[44:47], s60 offen  lds
    v_mfma_f32_16x16x32_bf16 v[92:95], v[28:31], a[100:103], 0
    s_add_u32 s60, s62, 1880064
    ds_read_b64_tr_b16 v[26:27], v2 offset:20992
    v_mul_f32 v248, v148, v148
    v_mfma_f32_16x16x32_bf16 v[92:95], v[32:35], a[116:119], v[92:95]
    s_add_u32 m0, s55, 69632
    v_rcp_f32 v249, v249
    v_mfma_f32_16x16x32_bf16 v[92:95], v[36:39], a[132:135], v[92:95]
    v_rcp_f32 v250, v250
    v_mfma_f32_16x16x32_bf16 v[88:91], v[36:39], a[128:131], 0
    v_exp_f32 v251, v251
    v_mfma_f32_16x16x32_bf16 v[88:91], v[32:35], a[112:115], v[88:91]
    v_mul_f32 v145, v145, v249
    v_mul_f32 v146, v146, v250
    v_mfma_f32_16x16x32_bf16 v[88:91], v[28:31], a[96:99], v[88:91]
    s_waitcnt lgkmcnt(4)
    v_add_f32 v251, 1.0, v251
    v_fma_f32 v248, v248, s79, v252
    v_mfma_f32_16x16x32_bf16 v[88:91], v[16:19], a[48:51], v[88:91]
    s_waitcnt lgkmcnt(2)
    ds_read_b64_tr_b16 v[28:29], v2 offset:0
    v_mul_f32 v248, v248, v148
    v_mfma_f32_16x16x32_bf16 v[88:91], v[20:23], a[64:67], v[88:91]
    s_waitcnt lgkmcnt(1)
    ds_read_b64_tr_b16 v[30:31], v2 offset:512
    v_mul_f32 v249, v149, v149
    v_mfma_f32_16x16x32_bf16 v[88:91], v[24:27], a[80:83], v[88:91]
    buffer_load_dwordx4 v5, s[44:47], s60 offen  lds
    v_mfma_f32_16x16x32_bf16 v[92:95], v[24:27], a[84:87], v[92:95]
    ds_read_b64_tr_b16 v[32:33], v2 offset:4096
    v_fma_f32 v249, v249, s79, v252
    v_mfma_f32_16x16x32_bf16 v[92:95], v[20:23], a[68:71], v[92:95]
    ds_read_b64_tr_b16 v[34:35], v2 offset:4608
    v_mul_f32 v249, v249, v149
    v_mfma_f32_16x16x32_bf16 v[92:95], v[16:19], a[52:55], v[92:95]
    ds_read_b64_tr_b16 v[36:37], v2 offset:8192
    v_mul_f32 v250, v150, v150
    v_mfma_f32_16x16x32_bf16 v[96:99], v[16:19], a[56:59], v[96:99]
    ds_read_b64_tr_b16 v[38:39], v2 offset:8704
    v_fma_f32 v250, v250, s79, v252
    v_mfma_f32_16x16x32_bf16 v[96:99], v[20:23], a[72:75], v[96:99]
    v_add_u32 v1, 36864, v1
    v_add_u32 v2, 36864, v2
    v_mfma_f32_16x16x32_bf16 v[96:99], v[24:27], a[88:91], v[96:99]
    buffer_store_dword v216, v221, s[24:27], s86 offen offset:2048 sc1
    v_mfma_f32_16x16x32_bf16 v[100:103], v[24:27], a[92:95], v[100:103]
    s_add_u32 s60, s65, 0
    v_rcp_f32 v251, v251
    v_mfma_f32_16x16x32_bf16 v[100:103], v[20:23], a[76:79], v[100:103]
    s_add_u32 m0, s55, 73728
    v_exp_f32 v248, v248
    v_mfma_f32_16x16x32_bf16 v[100:103], v[16:19], a[60:63], v[100:103]
    s_waitcnt lgkmcnt(4)
    v_exp_f32 v249, v249
L_pg9:
    s_cbranch_execz L_tour_ret
    v_mfma_f32_16x16x32_bf16 v[100:103], v[28:31], a[12:15], v[100:103]
    s_waitcnt lgkmcnt(2)
    v_mul_f32 v147, v147, v251
    v_add_f32 v248, 1.0, v248
    v_mfma_f32_16x16x32_bf16 v[100:103], v[32:35], a[28:31], v[100:103]
    s_waitcnt vmcnt(24) lgkmcnt(0)
    s_barrier
    v_mfma_f32_16x16x32_bf16 v[100:103], v[36:39], a[44:47], v[100:103]
    buffer_load_dwordx4 v7, s[20:23], s60 offen  lds
    v_mfma_f32_16x16x32_bf16 v[96:99], v[36:39], a[40:43], v[96:99]
    s_add_u32 s60, s65, 36864
    ds_read_b64_tr_b16 v[16:17], v1 offset:0
    v_add_f32 v249, 1.0, v249
    v_mfma_f32_16x16x32_bf16 v[96:99], v[32:35], a[24:27], v[96:99]
    s_add_u32 m0, s55, 77824
    ds_read_b64_tr_b16 v[18:19], v1 offset:512
    v_mul_f32 v250, v250, v150
    v_mfma_f32_16x16x32_bf16 v[96:99], v[28:31], a[8:11], v[96:99]
    ds_read_b64_tr_b16 v[20:21], v1 offset:4096
    v_mul_f32 v251, v151, v151
    v_mfma_f32_16x16x32_bf16 v[92:95], v[28:31], a[4:7], v[92:95]
    ds_read_b64_tr_b16 v[22:23], v1 offset:4608
    v_fma_f32 v251, v251, s79, v252
    v_mfma_f32_16x16x32_bf16 v[92:95], v[32:35], a[20:23], v[92:95]
    ds_read_b64_tr_b16 v[24:25], v1 offset:8192
    v_mul_f32 v251, v251, v151
    v_mfma_f32_16x16x32_bf16 v[92:95], v[36:39], a[36:39], v[92:95]
    ds_read_b64_tr_b16 v[26:27], v1 offset:8704
    v_mfma_f32_16x16x32_bf16 v[88:91], v[36:39], a[32:35], v[88:91]
    buffer_load_dwordx4 v7, s[20:23], s60 offen  lds
    v_mfma_f32_16x16x32_bf16 v[88:91], v[32:35], a[16:19], v[88:91]
    s_add_u32 s60, s65, 73728
    v_rcp_f32 v248, v248
    v_mfma_f32_16x16x32_bf16 v[88:91], v[28:31], a[0:3], v[88:91]
    s_waitcnt lgkmcnt(4)
    v_rcp_f32 v249, v249
    v_mfma_f32_16x16x32_bf16 v[72:75], v[16:19], a[144:147], v[72:75]
    s_waitcnt lgkmcnt(2)
    ds_read_b64_tr_b16 v[28:29], v1 offset:12288
    v_mul_f32 v148, v148, v248
    v_mfma_f32_16x16x32_bf16 v[72:75], v[20:23], a[160:163], v[72:75]
    s_waitcnt lgkmcnt(1)
    ds_read_b64_tr_b16 v[30:31], v1 offset:12800
    v_mul_f32 v149, v149, v249
    v_mfma_f32_16x16x32_bf16 v[72:75], v[24:27], a[176:179], v[72:75]
    s_add_u32 m0, s55, 81920
    ds_read_b64_tr_b16 v[32:33], v1 offset:16384
    v_mul_f32 v248, v164, v164
    v_mfma_f32_16x16x32_bf16 v[76:79], v[24:27], a[180:183], v[76:79]
    ds_read_b64_tr_b16 v[34:35], v1 offset:16896
    v_fma_f32 v248, v248, s79, v252
    v_mfma_f32_16x16x32_bf16 v[76:79], v[20:23], a[164:167], v[76:79]
    buffer_load_dwordx4 v7, s[20:23], s60 offen  lds
    v_mfma_f32_16x16x32_bf16 v[76:79], v[16:19], a[148:151], v[76:79]
    s_add_u32 s60, s65, 110592
    ds_read_b64_tr_b16 v[36:37], v1 offset:20480
    v_mul_f32 v248, v248, v164
    v_mfma_f32_16x16x32_bf16 v[80:83], v[16:19], a[152:155], v[80:83]
    s_add_u32 m0, s55, 86016
    ds_read_b64_tr_b16 v[38:39], v1 offset:20992
    v_mul_f32 v249, v165, v165
    v_mfma_f32_16x16x32_bf16 v[80:83], v[20:23], a[168:171], v[80:83]
    v_exp_f32 v250, v250
    v_mfma_f32_16x16x32_bf16 v[80:83], v[24:27], a[184:187], v[80:83]
    v_exp_f32 v251, v251
    v_mfma_f32_16x16x32_bf16 v[84:87], v[24:27], a[188:191], v[84:87]
    v_exp_f32 v248, v248
    v_mfma_f32_16x16x32_bf16 v[84:87], v[20:23], a[172:175], v[84:87]
    v_add_f32 v250, 1.0, v250
    v_add_f32 v251, 1.0, v251
    v_mfma_f32_16x16x32_bf16 v[84:87], v[16:19], a[156:159], v[84:87]
    s_waitcnt lgkmcnt(4)
    v_rcp_f32 v250, v250
    v_mfma_f32_16x16x32_bf16 v[84:87], v[28:31], a[204:207], v[84:87]
    s_waitcnt lgkmcnt(2)
    ds_read_b64_tr_b16 v[16:17], v1 offset:24576
    v_mul_f32 v150, v150, v250
    v_mfma_f32_16x16x32_bf16 v[84:87], v[32:35], a[220:223], v[84:87]
    s_waitcnt lgkmcnt(1)
    ds_read_b64_tr_b16 v[18:19], v1 offset:25088
    v_add_f32 v248, 1.0, v248
    v_mfma_f32_16x16x32_bf16 v[84:87], v[36:39], a[236:239], v[84:87]
    buffer_load_dwordx4 v7, s[20:23], s60 offen  lds
    v_mfma_f32_16x16x32_bf16 v[80:83], v[36:39], a[232:235], v[80:83]
    s_add_u32 s60, s65, 147456
    ds_read_b64_tr_b16 v[20:21], v1 offset:28672
    v_fma_f32 v249, v249, s79, v252
    v_mfma_f32_16x16x32_bf16 v[80:83], v[32:35], a[216:219], v[80:83]
    s_add_u32 m0, s55, 90112
    ds_read_b64_tr_b16 v[22:23], v1 offset:29184
    v_mul_f32 v249, v249, v165
    v_mfma_f32_16x16x32_bf16 v[80:83], v[28:31], a[200:203], v[80:83]
    ds_read_b64_tr_b16 v[24:25], v1 offset:32768
    v_mul_f32 v250, v166, v166
    v_mfma_f32_16x16x32_bf16 v[76:79], v[28:31], a[196:199], v[76:79]
    ds_read_b64_tr_b16 v[26:27], v1 offset:33280
    v_fma_f32 v250, v250, s79, v252
    v_mfma_f32_16x16x32_bf16 v[76:79], v[32:35], a[212:215], v[76:79]
    buffer_load_dwordx4 v7, s[20:23], s60 offen  lds
    v_mfma_f32_16x16x32_bf16 v[76:79], v[36:39], a[228:231], v[76:79]
    s_add_u32 s60, s65, 184320
    v_rcp_f32 v251, v251
    v_mfma_f32_16x16x32_bf16 v[72:75], v[36:39], a[224:227], v[72:75]
    s_add_u32 m0, s55, 94208
    v_rcp_f32 v248, v248
    v_mfma_f32_16x16x32_bf16 v[72:75], v[32:35], a[208:211], v[72:75]
    v_exp_f32 v249, v249
    v_mfma_f32_16x16x32_bf16 v[72:75], v[28:31], a[192:195], v[72:75]
    s_waitcnt lgkmcnt(4)
    v_mul_f32 v151, v151, v251
    v_mul_f32 v164, v164, v248
    v_mfma_f32_16x16x32_bf16 v[72:75], v[16:19], a[240:243], v[72:75]
    s_waitcnt lgkmcnt(2)
    ds_read_b64_tr_b16 v[28:29], v2 offset:24576
    v_add_f32 v249, 1.0, v249
    v_mfma_f32_16x16x32_bf16 v[72:75], v[20:23], v[40:43], v[72:75]
    s_waitcnt lgkmcnt(1)
    ds_read_b64_tr_b16 v[30:31], v2 offset:25088
    v_mul_f32 v250, v250, v166
    v_mfma_f32_16x16x32_bf16 v[72:75], v[24:27], v[56:59], v[72:75]
    buffer_load_dwordx4 v7, s[20:23], s60 offen  lds
    v_mfma_f32_16x16x32_bf16 v[76:79], v[24:27], v[60:63], v[76:79]
    s_add_u32 s60, s65, 221184
    ds_read_b64_tr_b16 v[32:33], v2 offset:28672
    v_mul_f32 v251, v167, v167
    v_mfma_f32_16x16x32_bf16 v[76:79], v[20:23], v[44:47], v[76:79]
    s_add_u32 m0, s55, 98304
    ds_read_b64_tr_b16 v[34:35], v2 offset:29184
    v_fma_f32 v251, v251, s79, v252
    v_mfma_f32_16x16x32_bf16 v[76:79], v[16:19], a[244:247], v[76:79]
    ds_read_b64_tr_b16 v[36:37], v2 offset:32768
    v_mul_f32 v251, v251, v167
    v_mfma_f32_16x16x32_bf16 v[80:83], v[16:19], a[248:251], v[80:83]
    ds_read_b64_tr_b16 v[38:39], v2 offset:33280
    v_mul_f32 v72, v72, v136
    v_mfma_f32_16x16x32_bf16 v[80:83], v[20:23], v[48:51], v[80:83]
    v_rcp_f32 v249, v249
    v_mfma_f32_16x16x32_bf16 v[80:83], v[24:27], v[64:67], v[80:83]
    v_exp_f32 v250, v250
    v_mfma_f32_16x16x32_bf16 v[84:87], v[24:27], v[68:71], v[84:87]
    buffer_load_dwordx4 v7, s[20:23], s60 offen  lds
    v_mfma_f32_16x16x32_bf16 v[84:87], v[20:23], v[52:55], v[84:87]
    v_exp_f32 v251, v251
    v_mfma_f32_16x16x32_bf16 v[84:87], v[16:19], a[252:255], v[84:87]
    s_waitcnt lgkmcnt(4)
    v_mul_f32 v73, v73, v137
    v_mul_f32 v74, v74, v138
    v_mfma_f32_16x16x32_bf16 v[100:103], v[28:31], a[252:255], v[100:103]
    s_waitcnt lgkmcnt(2)
    ds_read_b64_tr_b16 v[16:17], v2 offset:12288
    v_mul_f32 v75, v75, v139
    v_mfma_f32_16x16x32_bf16 v[100:103], v[32:35], v[52:55], v[100:103]
    s_waitcnt lgkmcnt(1)
    ds_read_b64_tr_b16 v[18:19], v2 offset:12800
    v_mul_f32 v76, v76, v140
    v_mfma_f32_16x16x32_bf16 v[100:103], v[36:39], v[68:71], v[100:103]
    s_add_u32 s60, s65, 258048
    ds_read_b64_tr_b16 v[20:21], v2 offset:16384
    v_mul_f32 v77, v77, v141
    v_mfma_f32_16x16x32_bf16 v[96:99], v[36:39], v[64:67], v[96:99]
    s_add_u32 m0, s55, 102400
    ds_read_b64_tr_b16 v[22:23], v2 offset:16896
    v_mul_f32 v78, v78, v142
    v_mfma_f32_16x16x32_bf16 v[96:99], v[32:35], v[48:51], v[96:99]
    ds_read_b64_tr_b16 v[24:25], v2 offset:20480
    v_mul_f32 v79, v79, v143
    v_mfma_f32_16x16x32_bf16 v[96:99], v[28:31], a[248:251], v[96:99]
    buffer_load_dwordx4 v7, s[20:23], s60 offen  lds
    v_mfma_f32_16x16x32_bf16 v[92:95], v[28:31], a[244:247], v[92:95]
    s_add_u32 s60, s66, 0
    ds_read_b64_tr_b16 v[26:27], v2 offset:20992
    v_mul_f32 v80, v80, v144
    v_mfma_f32_16x16x32_bf16 v[92:95], v[32:35], v[44:47], v[92:95]
    s_add_u32 m0, s55, 106496
    v_mul_f32 v81, v81, v145
    v_mul_f32 v82, v82, v146
    v_mfma_f32_16x16x32_bf16 v[92:95], v[36:39], v[60:63], v[92:95]
    v_mul_f32 v83, v83, v147
    v_mul_f32 v84, v84, v148
    v_mfma_f32_16x16x32_bf16 v[88:91], v[36:39], v[56:59], v[88:91]
    v_mul_f32 v85, v85, v149
    v_mul_f32 v86, v86, v150
    v_mfma_f32_16x16x32_bf16 v[88:91], v[32:35], v[40:43], v[88:91]
    v_mul_f32 v87, v87, v151
    v_cvt_pk_bf16_f32 v216, v72, v73
    v_mfma_f32_16x16x32_bf16 v[88:91], v[28:31], a[240:243], v[88:91]
    s_waitcnt lgkmcnt(4)
    v_cvt_pk_bf16_f32 v217, v74, v75
    v_cvt_pk_bf16_f32 v220, v76, v77
    v_mfma_f32_16x16x32_bf16 v[88:91], v[16:19], a[192:195], v[88:91]
    s_waitcnt lgkmcnt(2)
    ds_read_b64_tr_b16 v[28:29], v2 offset:0
    v_cvt_pk_bf16_f32 v221, v78, v79
    v_mfma_f32_16x16x32_bf16 v[88:91], v[20:23], a[208:211], v[88:91]
    s_waitcnt lgkmcnt(1)
    ds_read_b64_tr_b16 v[30:31], v2 offset:512
    v_cvt_pk_bf16_f32 v224, v80, v81
    v_mfma_f32_16x16x32_bf16 v[88:91], v[24:27], a[224:227], v[88:91]
    buffer_load_dwordx4 v7, s[20:23], s60 offen  lds
    v_mfma_f32_16x16x32_bf16 v[92:95], v[24:27], a[228:231], v[92:95]
    ds_read_b64_tr_b16 v[32:33], v2 offset:4096
    v_cvt_pk_bf16_f32 v225, v82, v83
    v_mfma_f32_16x16x32_bf16 v[92:95], v[20:23], a[212:215], v[92:95]
    ds_read_b64_tr_b16 v[34:35], v2 offset:4608
    v_cvt_pk_bf16_f32 v228, v84, v85
    v_mfma_f32_16x16x32_bf16 v[92:95], v[16:19], a[196:199], v[92:95]
    ds_read_b64_tr_b16 v[36:37], v2 offset:8192
    v_cvt_pk_bf16_f32 v229, v86, v87
    v_mfma_f32_16x16x32_bf16 v[96:99], v[16:19], a[200:203], v[96:99]
    ds_read_b64_tr_b16 v[38:39], v2 offset:8704
    v_mul_f32 v165, v165, v249
    v_mfma_f32_16x16x32_bf16 v[96:99], v[20:23], a[216:219], v[96:99]
    v_add_u32 v1, 4294856704, v1
    v_add_u32 v2, 4294856704, v2
    v_mfma_f32_16x16x32_bf16 v[96:99], v[24:27], a[232:235], v[96:99]
    v_add_f32 v250, 1.0, v250
    v_add_f32 v251, 1.0, v251
    v_mfma_f32_16x16x32_bf16 v[100:103], v[24:27], a[236:239], v[100:103]
    v_rcp_f32 v250, v250
    v_mfma_f32_16x16x32_bf16 v[100:103], v[20:23], a[220:223], v[100:103]
    v_rcp_f32 v251, v251
    v_mfma_f32_16x16x32_bf16 v[100:103], v[16:19], a[204:207], v[100:103]
    s_waitcnt lgkmcnt(4)
    v_mul_f32 v166, v166, v250
    v_mul_f32 v167, v167, v251
    v_mfma_f32_16x16x32_bf16 v[100:103], v[28:31], a[156:159], v[100:103]
    s_waitcnt lgkmcnt(2)
    v_mul_f32 v248, v160, v160
    v_fma_f32 v248, v248, s79, v252
    v_mfma_f32_16x16x32_bf16 v[100:103], v[32:35], a[172:175], v[100:103]
    s_waitcnt vmcnt(21) lgkmcnt(0)
    s_barrier
    v_mfma_f32_16x16x32_bf16 v[100:103], v[36:39], a[188:191], v[100:103]
    buffer_load_dword v254, v14, s[20:23], 0 offen offset:256
    v_mfma_f32_16x16x32_bf16 v[96:99], v[36:39], a[184:187], v[96:99]
    buffer_load_dword v254, v14, s[20:23], 0 offen offset:512
    v_mfma_f32_16x16x32_bf16 v[96:99], v[32:35], a[168:171], v[96:99]
    ds_read_b64_tr_b16 v[16:17], v1 offset:0
    ds_read_b64_tr_b16 v[18:19], v1 offset:512
    v_mfma_f32_16x16x32_bf16 v[96:99], v[28:31], a[152:155], v[96:99]
    buffer_load_dword v254, v14, s[20:23], 0 offen offset:768
    v_mfma_f32_16x16x32_bf16 v[92:95], v[28:31], a[148:151], v[92:95]
    ds_read_b64_tr_b16 v[20:21], v1 offset:4096
    ds_read_b64_tr_b16 v[22:23], v1 offset:4608
    v_mfma_f32_16x16x32_bf16 v[92:95], v[32:35], a[164:167], v[92:95]
    buffer_load_dword v254, v14, s[20:23], 0 offen offset:1024
    v_mfma_f32_16x16x32_bf16 v[92:95], v[36:39], a[180:183], v[92:95]
    ds_read_b64_tr_b16 v[24:25], v1 offset:8192
    ds_read_b64_tr_b16 v[26:27], v1 offset:8704
    v_mfma_f32_16x16x32_bf16 v[88:91], v[36:39], a[176:179], v[88:91]
    buffer_load_dword v254, v15, s[36:39], 0 offen
    v_mfma_f32_16x16x32_bf16 v[88:91], v[32:35], a[160:163], v[88:91]
    ds_write_b128 v8, v[180:183] offset:39936
    v_mfma_f32_16x16x32_bf16 v[88:91], v[28:31], a[144:147], v[88:91]
    s_waitcnt lgkmcnt(5)
    v_mul_f32 v100, v100, v164
    v_mul_f32 v101, v101, v165
    s_cmp_ge_u32 s80, 9
    s_cbranch_scc1 L_Bqk
    v_mfma_f32_16x16x32_bf16 v[104:107], a[0:3], v[16:19], 0
    s_waitcnt lgkmcnt(3)
    ds_read_b64_tr_b16 v[28:29], v1 offset:12288
    v_and_b32 v253, 15, v0
    v_mfma_f32_16x16x32_bf16 v[104:107], a[16:19], v[20:23], v[104:107]
    s_waitcnt lgkmcnt(2)
    ds_read_b64_tr_b16 v[30:31], v1 offset:12800
    v_bfe_u32 v5, v0, 4, 1
    v_mfma_f32_16x16x32_bf16 v[104:107], a[32:35], v[24:27], v[104:107]
    ds_read_b64_tr_b16 v[32:33], v1 offset:16384
    v_lshrrev_b32 v14, 5, v0
    v_mfma_f32_16x16x32_bf16 v[108:111], a[36:39], v[24:27], 0
    ds_read_b64_tr_b16 v[34:35], v1 offset:16896
    v_lshl_add_u32 v5, v5, 1, v14
    v_mfma_f32_16x16x32_bf16 v[108:111], a[20:23], v[20:23], v[108:111]
    ds_read_b64_tr_b16 v[36:37], v1 offset:20480
    v_lshl_add_u32 v253, s78, 5, v253
    v_mfma_f32_16x16x32_bf16 v[108:111], a[4:7], v[16:19], v[108:111]
    ds_read_b64_tr_b16 v[38:39], v1 offset:20992
    v_mul_u32_u24 v5, 320, v5
    v_mfma_f32_16x16x32_bf16 v[112:115], a[8:11], v[16:19], 0
    ds_write_b128 v8, v[176:179] offset:38912
    v_mfma_f32_16x16x32_bf16 v[112:115], a[24:27], v[20:23], v[112:115]
    v_add_u32 v5, 4718592, v5
    v_mul_u32_u24 v14, 3641, v253
    v_mfma_f32_16x16x32_bf16 v[112:115], a[40:43], v[24:27], v[112:115]
    v_lshrrev_b32 v14, 16, v14
    v_mul_u32_u24 v14, 81632, v14
    v_mfma_f32_16x16x32_bf16 v[116:119], a[44:47], v[24:27], 0
    v_lshl_add_u32 v14, v253, 4, v14
    v_add_u32 v14, v5, v14
    v_mfma_f32_16x16x32_bf16 v[116:119], a[28:31], v[20:23], v[116:119]
    ds_write_b128 v8, v[172:175] offset:37888
    v_mfma_f32_16x16x32_bf16 v[116:119], a[12:15], v[16:19], v[116:119]
    s_waitcnt lgkmcnt(6)
    v_add_u32 v253, 16, v253
    v_mul_u32_u24 v15, 3641, v253
    v_mfma_f32_16x16x32_bf16 v[116:119], a[60:63], v[28:31], v[116:119]
    s_waitcnt lgkmcnt(4)
    ds_read_b64_tr_b16 v[16:17], v1 offset:24576
    v_lshrrev_b32 v15, 16, v15
    v_mfma_f32_16x16x32_bf16 v[116:119], a[76:79], v[32:35], v[116:119]
    s_waitcnt lgkmcnt(3)
    ds_read_b64_tr_b16 v[18:19], v1 offset:25088
    v_mul_u32_u24 v15, 81632, v15
    v_mfma_f32_16x16x32_bf16 v[116:119], a[92:95], v[36:39], v[116:119]
    ds_read_b64_tr_b16 v[20:21], v1 offset:28672
    v_lshl_add_u32 v15, v253, 4, v15
    v_mfma_f32_16x16x32_bf16 v[112:115], a[88:91], v[36:39], v[112:115]
    ds_read_b64_tr_b16 v[22:23], v1 offset:29184
    v_add_u32 v15, v5, v15
    v_mfma_f32_16x16x32_bf16 v[112:115], a[72:75], v[32:35], v[112:115]
    ds_read_b64_tr_b16 v[24:25], v1 offset:32768
    v_mul_f32 v102, v102, v166
    v_mfma_f32_16x16x32_bf16 v[112:115], a[56:59], v[28:31], v[112:115]
    ds_write_b128 v8, v[168:171] offset:36864
    v_mfma_f32_16x16x32_bf16 v[108:111], a[52:55], v[28:31], v[108:111]
    ds_read_b64_tr_b16 v[26:27], v1 offset:33280
    v_mul_f32 v103, v103, v167
    v_mfma_f32_16x16x32_bf16 v[108:111], a[68:71], v[32:35], v[108:111]
    v_cvt_pk_bf16_f32 v230, v100, v101
    v_cvt_pk_bf16_f32 v231, v102, v103
    v_mfma_f32_16x16x32_bf16 v[108:111], a[84:87], v[36:39], v[108:111]
    v_mul_f32 v248, v248, v160
    v_mul_f32 v249, v161, v161
    v_mfma_f32_16x16x32_bf16 v[104:107], a[80:83], v[36:39], v[104:107]
    ds_write_b128 v8, v[196:199] offset:3072
    v_mfma_f32_16x16x32_bf16 v[104:107], a[64:67], v[32:35], v[104:107]
    v_exp_f32 v248, v248
    v_mfma_f32_16x16x32_bf16 v[104:107], a[48:51], v[28:31], v[104:107]
    s_waitcnt lgkmcnt(6)
    v_add_f32 v248, 1.0, v248
    v_fma_f32 v249, v249, s79, v252
    v_mfma_f32_16x16x32_bf16 v[104:107], a[96:99], v[16:19], v[104:107]
    s_waitcnt lgkmcnt(4)
    ds_read_b64_tr_b16 v[28:29], v2 offset:24576
    v_mul_f32 v249, v249, v161
    v_mfma_f32_16x16x32_bf16 v[104:107], a[112:115], v[20:23], v[104:107]
    s_waitcnt lgkmcnt(2)
    ds_read_b64_tr_b16 v[30:31], v2 offset:25088
    v_mul_f32 v250, v162, v162
    v_mfma_f32_16x16x32_bf16 v[104:107], a[128:131], v[24:27], v[104:107]
    ds_read_b64_tr_b16 v[32:33], v2 offset:28672
    v_fma_f32 v250, v250, s79, v252
    v_mfma_f32_16x16x32_bf16 v[108:111], a[132:135], v[24:27], v[108:111]
    ds_write_b128 v8, v[192:195] offset:2048
    v_mfma_f32_16x16x32_bf16 v[108:111], a[116:119], v[20:23], v[108:111]
    ds_read_b64_tr_b16 v[34:35], v2 offset:29184
    v_mul_f32 v250, v250, v162
    v_mfma_f32_16x16x32_bf16 v[108:111], a[100:103], v[16:19], v[108:111]
    ds_read_b64_tr_b16 v[36:37], v2 offset:32768
    v_mul_f32 v251, v163, v163
    v_mfma_f32_16x16x32_bf16 v[112:115], a[104:107], v[16:19], v[112:115]
    ds_read_b64_tr_b16 v[38:39], v2 offset:33280
    v_fma_f32 v251, v251, s79, v252
    v_mfma_f32_16x16x32_bf16 v[112:115], a[120:123], v[20:23], v[112:115]
    ds_write_b128 v8, v[188:191] offset:1024
    v_mfma_f32_16x16x32_bf16 v[112:115], a[136:139], v[24:27], v[112:115]
    v_rcp_f32 v248, v248
    v_mfma_f32_16x16x32_bf16 v[116:119], a[140:143], v[24:27], v[116:119]
    v_exp_f32 v249, v249
    v_mfma_f32_16x16x32_bf16 v[116:119], a[124:127], v[20:23], v[116:119]
    v_exp_f32 v250, v250
    v_mfma_f32_16x16x32_bf16 v[116:119], a[108:111], v[16:19], v[116:119]
    s_waitcnt lgkmcnt(6)
    ds_write_b128 v8, v[184:187] offset:0
    v_mfma_f32_16x16x32_bf16 v[132:135], a[108:111], v[28:31], 0
    s_waitcnt lgkmcnt(4)
    ds_read_b64_tr_b16 v[16:17], v2 offset:12288
    v_mul_f32 v160, v160, v248
    v_mfma_f32_16x16x32_bf16 v[132:135], a[124:127], v[32:35], v[132:135]
    s_waitcnt lgkmcnt(3)
    ds_read_b64_tr_b16 v[18:19], v2 offset:12800
    v_mul_f32 v96, v96, v160
    v_mfma_f32_16x16x32_bf16 v[132:135], a[140:143], v[36:39], v[132:135]
    ds_read_b64_tr_b16 v[20:21], v2 offset:16384
    v_add_f32 v249, 1.0, v249
    v_mfma_f32_16x16x32_bf16 v[128:131], a[136:139], v[36:39], 0
    ds_read_b64_tr_b16 v[22:23], v2 offset:16896
    v_add_f32 v250, 1.0, v250
    v_mfma_f32_16x16x32_bf16 v[128:131], a[120:123], v[32:35], v[128:131]
    ds_read_b64_tr_b16 v[24:25], v2 offset:20480
    v_mul_f32 v251, v251, v163
    v_mfma_f32_16x16x32_bf16 v[128:131], a[104:107], v[28:31], v[128:131]
    ds_read_b64_tr_b16 v[26:27], v2 offset:20992
    v_mul_f32 v248, v156, v156
    v_mfma_f32_16x16x32_bf16 v[124:127], a[100:103], v[28:31], 0
    ds_write_b128 v8, v[212:215] offset:19456
    v_mfma_f32_16x16x32_bf16 v[124:127], a[116:119], v[32:35], v[124:127]
    v_rcp_f32 v249, v249
    v_mfma_f32_16x16x32_bf16 v[124:127], a[132:135], v[36:39], v[124:127]
    v_rcp_f32 v250, v250
    v_mfma_f32_16x16x32_bf16 v[120:123], a[128:131], v[36:39], 0
    v_exp_f32 v251, v251
    v_mfma_f32_16x16x32_bf16 v[120:123], a[112:115], v[32:35], v[120:123]
    ds_write_b128 v8, v[208:211] offset:18432
    v_mfma_f32_16x16x32_bf16 v[120:123], a[96:99], v[28:31], v[120:123]
    s_waitcnt lgkmcnt(6)
    v_mul_f32 v161, v161, v249
    v_mul_f32 v97, v97, v161
    v_mfma_f32_16x16x32_bf16 v[120:123], a[48:51], v[16:19], v[120:123]
    s_waitcnt lgkmcnt(4)
    ds_read_b64_tr_b16 v[28:29], v2 offset:0
    v_cvt_pk_bf16_f32 v226, v96, v97
    v_mfma_f32_16x16x32_bf16 v[120:123], a[64:67], v[20:23], v[120:123]
    s_waitcnt lgkmcnt(3)
    ds_read_b64_tr_b16 v[30:31], v2 offset:512
    v_mul_f32 v162, v162, v250
    v_mfma_f32_16x16x32_bf16 v[120:123], a[80:83], v[24:27], v[120:123]
    ds_read_b64_tr_b16 v[32:33], v2 offset:4096
    v_mul_f32 v98, v98, v162
    v_mfma_f32_16x16x32_bf16 v[124:127], a[84:87], v[24:27], v[124:127]
    ds_read_b64_tr_b16 v[34:35], v2 offset:4608
    v_add_f32 v251, 1.0, v251
    v_mfma_f32_16x16x32_bf16 v[124:127], a[68:71], v[20:23], v[124:127]
    ds_write_b128 v8, v[204:207] offset:17408
    v_mfma_f32_16x16x32_bf16 v[124:127], a[52:55], v[16:19], v[124:127]
    ds_read_b64_tr_b16 v[36:37], v2 offset:8192
    v_fma_f32 v248, v248, s79, v252
    v_mfma_f32_16x16x32_bf16 v[128:131], a[56:59], v[16:19], v[128:131]
    ds_read_b64_tr_b16 v[38:39], v2 offset:8704
    v_mul_f32 v248, v248, v156
    v_mfma_f32_16x16x32_bf16 v[128:131], a[72:75], v[20:23], v[128:131]
    v_add_u32 v1, 36864, v1
    v_add_u32 v2, 36864, v2
    v_mfma_f32_16x16x32_bf16 v[128:131], a[88:91], v[24:27], v[128:131]
    s_add_u32 s60, s65, 128
    ds_write_b128 v8, v[200:203] offset:16384
    v_mfma_f32_16x16x32_bf16 v[132:135], a[92:95], v[24:27], v[132:135]
    s_add_u32 m0, s55, 0
    v_rcp_f32 v251, v251
    v_mfma_f32_16x16x32_bf16 v[132:135], a[76:79], v[20:23], v[132:135]
    v_exp_f32 v248, v248
    v_mfma_f32_16x16x32_bf16 v[132:135], a[60:63], v[16:19], v[132:135]
    s_waitcnt lgkmcnt(6)
    v_mul_f32 v163, v163, v251
    v_mul_f32 v99, v99, v163
    v_mfma_f32_16x16x32_bf16 v[132:135], a[12:15], v[28:31], v[132:135]
    s_waitcnt lgkmcnt(4)
    v_cvt_pk_bf16_f32 v227, v98, v99
    v_add_f32 v248, 1.0, v248
    v_mfma_f32_16x16x32_bf16 v[132:135], a[28:31], v[32:35], v[132:135]
    s_waitcnt vmcnt(15) lgkmcnt(0)
    s_barrier
    v_mfma_f32_16x16x32_bf16 v[132:135], a[44:47], v[36:39], v[132:135]
    buffer_load_dwordx4 v7, s[20:23], s60 offen  lds
    v_mfma_f32_16x16x32_bf16 v[128:131], a[40:43], v[36:39], v[128:131]
    s_add_u32 s60, s65, 36992
    ds_read_b64_tr_b16 v[16:17], v1 offset:0
    v_mul_f32 v249, v157, v157
    v_mfma_f32_16x16x32_bf16 v[128:131], a[24:27], v[32:35], v[128:131]
    s_add_u32 m0, s55, 4096
    ds_read_b64_tr_b16 v[18:19], v1 offset:512
    v_fma_f32 v249, v249, s79, v252
    v_mfma_f32_16x16x32_bf16 v[128:131], a[8:11], v[28:31], v[128:131]
    ds_read_b64_tr_b16 v[20:21], v1 offset:4096
    v_mul_f32 v249, v249, v157
    v_mfma_f32_16x16x32_bf16 v[124:127], a[4:7], v[28:31], v[124:127]
    ds_read_b64_tr_b16 v[22:23], v1 offset:4608
    v_mul_f32 v250, v158, v158
    v_mfma_f32_16x16x32_bf16 v[124:127], a[20:23], v[32:35], v[124:127]
    ds_read_b64_tr_b16 v[24:25], v1 offset:8192
    v_fma_f32 v250, v250, s79, v252
    v_mfma_f32_16x16x32_bf16 v[124:127], a[36:39], v[36:39], v[124:127]
    ds_read_b64_tr_b16 v[26:27], v1 offset:8704
    v_mul_f32 v250, v250, v158
    v_mfma_f32_16x16x32_bf16 v[120:123], a[32:35], v[36:39], v[120:123]
    buffer_load_dwordx4 v7, s[20:23], s60 offen  lds
    v_mfma_f32_16x16x32_bf16 v[120:123], a[16:19], v[32:35], v[120:123]
    s_add_u32 s60, s65, 73856
    v_rcp_f32 v248, v248
    v_mfma_f32_16x16x32_bf16 v[120:123], a[0:3], v[28:31], v[120:123]
    s_waitcnt lgkmcnt(4)
    v_exp_f32 v249, v249
    v_mfma_f32_16x16x32_bf16 v[104:107], a[144:147], v[16:19], v[104:107]
    s_waitcnt lgkmcnt(2)
    ds_read_b64_tr_b16 v[28:29], v1 offset:12288
    v_mul_f32 v156, v156, v248
    v_mfma_f32_16x16x32_bf16 v[104:107], a[160:163], v[20:23], v[104:107]
    s_waitcnt lgkmcnt(1)
    ds_read_b64_tr_b16 v[30:31], v1 offset:12800
    v_mul_f32 v92, v92, v156
    v_mfma_f32_16x16x32_bf16 v[104:107], a[176:179], v[24:27], v[104:107]
    s_add_u32 m0, s55, 8192
    ds_read_b64_tr_b16 v[32:33], v1 offset:16384
    v_add_f32 v249, 1.0, v249
    v_mfma_f32_16x16x32_bf16 v[108:111], a[180:183], v[24:27], v[108:111]
    ds_read_b64_tr_b16 v[34:35], v1 offset:16896
    v_mul_f32 v251, v159, v159
    v_mfma_f32_16x16x32_bf16 v[108:111], a[164:167], v[20:23], v[108:111]
    buffer_load_dwordx4 v7, s[20:23], s60 offen  lds
    v_mfma_f32_16x16x32_bf16 v[108:111], a[148:151], v[16:19], v[108:111]
    s_add_u32 s60, s65, 110720
    ds_read_b64_tr_b16 v[36:37], v1 offset:20480
    v_fma_f32 v251, v251, s79, v252
    v_mfma_f32_16x16x32_bf16 v[112:115], a[152:155], v[16:19], v[112:115]
    s_add_u32 m0, s55, 12288
    ds_read_b64_tr_b16 v[38:39], v1 offset:20992
    v_mul_f32 v251, v251, v159
    v_mfma_f32_16x16x32_bf16 v[112:115], a[168:171], v[20:23], v[112:115]
    v_rcp_f32 v249, v249
    v_mfma_f32_16x16x32_bf16 v[112:115], a[184:187], v[24:27], v[112:115]
    v_exp_f32 v250, v250
    v_mfma_f32_16x16x32_bf16 v[116:119], a[188:191], v[24:27], v[116:119]
    ds_read_b128 a[0:3], v9 offset:36864
    v_mul_f32 v157, v157, v249
    v_mfma_f32_16x16x32_bf16 v[116:119], a[172:175], v[20:23], v[116:119]
    v_exp_f32 v251, v251
    v_mfma_f32_16x16x32_bf16 v[116:119], a[156:159], v[16:19], v[116:119]
    s_waitcnt lgkmcnt(5)
    v_mul_f32 v93, v93, v157
    v_cvt_pk_bf16_f32 v222, v92, v93
    v_mfma_f32_16x16x32_bf16 v[116:119], a[204:207], v[28:31], v[116:119]
    s_waitcnt lgkmcnt(3)
    ds_read_b64_tr_b16 v[16:17], v1 offset:24576
    v_add_f32 v250, 1.0, v250
    v_mfma_f32_16x16x32_bf16 v[116:119], a[220:223], v[32:35], v[116:119]
    s_waitcnt lgkmcnt(2)
    ds_read_b128 a[4:7], v9 offset:37888
    v_add_f32 v251, 1.0, v251
    v_mfma_f32_16x16x32_bf16 v[116:119], a[236:239], v[36:39], v[116:119]
    buffer_load_dwordx4 v7, s[20:23], s60 offen  lds
    v_mfma_f32_16x16x32_bf16 v[112:115], a[232:235], v[36:39], v[112:115]
    s_add_u32 s60, s65, 147584
    ds_read_b64_tr_b16 v[18:19], v1 offset:25088
    v_mul_f32 v248, v152, v152
    v_mfma_f32_16x16x32_bf16 v[112:115], a[216:219], v[32:35], v[112:115]
    s_add_u32 m0, s55, 16384
    ds_read_b64_tr_b16 v[20:21], v1 offset:28672
    v_fma_f32 v248, v248, s79, v252
    v_mfma_f32_16x16x32_bf16 v[112:115], a[200:203], v[28:31], v[112:115]
    ds_read_b128 a[8:11], v9 offset:38912
    v_mul_f32 v248, v248, v152
    v_mfma_f32_16x16x32_bf16 v[108:111], a[196:199], v[28:31], v[108:111]
    ds_read_b64_tr_b16 v[22:23], v1 offset:29184
    v_mul_f32 v249, v153, v153
    v_mfma_f32_16x16x32_bf16 v[108:111], a[212:215], v[32:35], v[108:111]
    buffer_load_dwordx4 v7, s[20:23], s60 offen  lds
    v_mfma_f32_16x16x32_bf16 v[108:111], a[228:231], v[36:39], v[108:111]
    s_add_u32 s60, s65, 184448
    ds_read_b64_tr_b16 v[24:25], v1 offset:32768
    ds_read_b64_tr_b16 v[26:27], v1 offset:33280
    v_mfma_f32_16x16x32_bf16 v[104:107], a[224:227], v[36:39], v[104:107]
    s_add_u32 m0, s55, 20480
    ds_read_b128 a[12:15], v9 offset:39936
    v_fma_f32 v249, v249, s79, v252
    v_mfma_f32_16x16x32_bf16 v[104:107], a[208:211], v[32:35], v[104:107]
    v_rcp_f32 v250, v250
    v_mfma_f32_16x16x32_bf16 v[104:107], a[192:195], v[28:31], v[104:107]
    s_waitcnt lgkmcnt(6)
    v_rcp_f32 v251, v251
    v_mfma_f32_16x16x32_bf16 v[104:107], a[240:243], v[16:19], v[104:107]
    s_waitcnt lgkmcnt(3)
    ds_read_b64_tr_b16 v[28:29], v2 offset:24576
    v_mul_f32 v158, v158, v250
    v_mfma_f32_16x16x32_bf16 v[104:107], v[40:43], v[20:23], v[104:107]
    s_waitcnt lgkmcnt(2)
    ds_read_b128 a[16:19], v9 offset:0
    v_mul_f32 v94, v94, v158
    v_mfma_f32_16x16x32_bf16 v[104:107], v[56:59], v[24:27], v[104:107]
    buffer_load_dwordx4 v7, s[20:23], s60 offen  lds
    v_mfma_f32_16x16x32_bf16 v[108:111], v[60:63], v[24:27], v[108:111]
    s_add_u32 s60, s65, 221312
    ds_read_b64_tr_b16 v[30:31], v2 offset:25088
    v_mul_f32 v159, v159, v251
    v_mfma_f32_16x16x32_bf16 v[108:111], v[44:47], v[20:23], v[108:111]
    s_add_u32 m0, s55, 24576
    ds_read_b64_tr_b16 v[32:33], v2 offset:28672
    v_mul_f32 v95, v95, v159
    v_mfma_f32_16x16x32_bf16 v[108:111], a[244:247], v[16:19], v[108:111]
    ds_read_b128 a[20:23], v9 offset:1024
    v_cvt_pk_bf16_f32 v223, v94, v95
    v_mfma_f32_16x16x32_bf16 v[112:115], a[248:251], v[16:19], v[112:115]
    ds_read_b64_tr_b16 v[34:35], v2 offset:29184
    v_mul_f32 v249, v249, v153
    v_mfma_f32_16x16x32_bf16 v[112:115], v[48:51], v[20:23], v[112:115]
    ds_read_b64_tr_b16 v[36:37], v2 offset:32768
    v_mul_f32 v250, v154, v154
    v_mfma_f32_16x16x32_bf16 v[112:115], v[64:67], v[24:27], v[112:115]
    ds_read_b64_tr_b16 v[38:39], v2 offset:33280
    v_fma_f32 v250, v250, s79, v252
    v_mfma_f32_16x16x32_bf16 v[116:119], v[68:71], v[24:27], v[116:119]
    ds_read_b128 a[24:27], v9 offset:2048
    v_mul_f32 v250, v250, v154
    v_mfma_f32_16x16x32_bf16 v[116:119], v[52:55], v[20:23], v[116:119]
    buffer_load_dwordx4 v7, s[20:23], s60 offen  lds
    v_mfma_f32_16x16x32_bf16 v[116:119], a[252:255], v[16:19], v[116:119]
    s_waitcnt lgkmcnt(6)
    v_cvt_pk_bf16_f32 v104, v104, v105
    v_cvt_pk_bf16_f32 v105, v106, v107
    v_mfma_f32_16x16x32_bf16 v[132:135], a[252:255], v[28:31], v[132:135]
    s_waitcnt lgkmcnt(3)
    ds_read_b64_tr_b16 v[16:17], v2 offset:12288
    v_mul_f32 v251, v155, v155
    v_mfma_f32_16x16x32_bf16 v[132:135], v[52:55], v[32:35], v[132:135]
    s_waitcnt lgkmcnt(2)
    ds_read_b128 a[28:31], v9 offset:3072
    v_cvt_pk_bf16_f32 v106, v108, v109
    v_mfma_f32_16x16x32_bf16 v[132:135], v[68:71], v[36:39], v[132:135]
    s_add_u32 s60, s65, 258176
    ds_read_b64_tr_b16 v[18:19], v2 offset:12800
    v_cvt_pk_bf16_f32 v107, v110, v111
    v_mfma_f32_16x16x32_bf16 v[128:131], v[64:67], v[36:39], v[128:131]
    s_add_u32 m0, s55, 28672
    ds_read_b64_tr_b16 v[20:21], v2 offset:16384
    v_fma_f32 v251, v251, s79, v252
    v_mfma_f32_16x16x32_bf16 v[128:131], v[48:51], v[32:35], v[128:131]
L_pg10:
    s_cbranch_execz L_tour_ret
    ds_read_b64_tr_b16 v[22:23], v2 offset:16896
    v_permlane16_swap_b32 v104, v106
    v_mfma_f32_16x16x32_bf16 v[128:131], a[248:251], v[28:31], v[128:131]
    ds_read_b128 a[32:35], v9 offset:16384
    v_permlane16_swap_b32 v105, v107
    v_mfma_f32_16x16x32_bf16 v[124:127], a[244:247], v[28:31], v[124:127]
    buffer_load_dwordx4 v7, s[20:23], s60 offen  lds
    v_mfma_f32_16x16x32_bf16 v[124:127], v[44:47], v[32:35], v[124:127]
    s_add_u32 s60, s66, 128
    ds_read_b64_tr_b16 v[24:25], v2 offset:20480
    v_cvt_pk_bf16_f32 v112, v112, v113
    v_mfma_f32_16x16x32_bf16 v[124:127], v[60:63], v[36:39], v[124:127]
    s_add_u32 m0, s55, 32768
    ds_read_b64_tr_b16 v[26:27], v2 offset:20992
    v_cvt_pk_bf16_f32 v113, v114, v115
    v_mfma_f32_16x16x32_bf16 v[120:123], v[56:59], v[36:39], v[120:123]
    ds_read_b128 a[36:39], v9 offset:17408
    v_cvt_pk_bf16_f32 v114, v116, v117
    v_mfma_f32_16x16x32_bf16 v[120:123], v[40:43], v[32:35], v[120:123]
    buffer_store_dwordx4 v[104:107], v14, s[48:51], s70 offen sc1
    v_mfma_f32_16x16x32_bf16 v[120:123], a[240:243], v[28:31], v[120:123]
    s_waitcnt lgkmcnt(6)
    v_cvt_pk_bf16_f32 v115, v118, v119
    v_mul_f32 v251, v251, v155
    v_mfma_f32_16x16x32_bf16 v[120:123], a[192:195], v[16:19], v[120:123]
    s_waitcnt lgkmcnt(4)
    ds_read_b64_tr_b16 v[28:29], v2 offset:0
    ds_read_b128 a[40:43], v9 offset:18432
    v_mfma_f32_16x16x32_bf16 v[120:123], a[208:211], v[20:23], v[120:123]
    s_waitcnt lgkmcnt(3)
    ds_read_b64_tr_b16 v[30:31], v2 offset:512
    v_permlane16_swap_b32 v112, v114
    v_mfma_f32_16x16x32_bf16 v[120:123], a[224:227], v[24:27], v[120:123]
    buffer_load_dwordx4 v7, s[20:23], s60 offen  lds
    v_mfma_f32_16x16x32_bf16 v[124:127], a[228:231], v[24:27], v[124:127]
    ds_read_b64_tr_b16 v[32:33], v2 offset:4096
    v_permlane16_swap_b32 v113, v115
    v_mfma_f32_16x16x32_bf16 v[124:127], a[212:215], v[20:23], v[124:127]
    ds_read_b64_tr_b16 v[34:35], v2 offset:4608
    ds_read_b128 a[44:47], v9 offset:19456
    v_mfma_f32_16x16x32_bf16 v[124:127], a[196:199], v[16:19], v[124:127]
    ds_read_b64_tr_b16 v[36:37], v2 offset:8192
    v_lshlrev_b32 v4, 4, v0
    v_mfma_f32_16x16x32_bf16 v[128:131], a[200:203], v[16:19], v[128:131]
    ds_read_b64_tr_b16 v[38:39], v2 offset:8704
    v_mfma_f32_16x16x32_bf16 v[128:131], a[216:219], v[20:23], v[128:131]
    buffer_store_dwordx4 v[112:115], v14, s[48:51], s71 offen sc1
    v_mfma_f32_16x16x32_bf16 v[128:131], a[232:235], v[24:27], v[128:131]
    v_exp_f32 v248, v248
    v_mfma_f32_16x16x32_bf16 v[132:135], a[236:239], v[24:27], v[132:135]
    v_exp_f32 v249, v249
    v_mfma_f32_16x16x32_bf16 v[132:135], a[220:223], v[20:23], v[132:135]
    v_exp_f32 v250, v250
    v_mfma_f32_16x16x32_bf16 v[132:135], a[204:207], v[16:19], v[132:135]
    s_waitcnt lgkmcnt(5)
    v_exp_f32 v251, v251
    v_mfma_f32_16x16x32_bf16 v[132:135], a[156:159], v[28:31], v[132:135]
    s_waitcnt lgkmcnt(3)
    v_add_f32 v248, 1.0, v248
    v_add_f32 v249, 1.0, v249
    v_mfma_f32_16x16x32_bf16 v[132:135], a[172:175], v[32:35], v[132:135]
    s_waitcnt vmcnt(16) lgkmcnt(0)
    s_barrier
    v_mfma_f32_16x16x32_bf16 v[132:135], a[188:191], v[36:39], v[132:135]
    ds_read_b64_tr_b16 v[16:17], v10 offset:0
    v_add_f32 v250, 1.0, v250
    v_mfma_f32_16x16x32_bf16 v[128:131], a[184:187], v[36:39], v[128:131]
    ds_read_b64_tr_b16 v[18:19], v10 offset:2048
    v_add_f32 v251, 1.0, v251
    v_mfma_f32_16x16x32_bf16 v[128:131], a[168:171], v[32:35], v[128:131]
    ds_read_b64_tr_b16 v[20:21], v10 offset:8192
    v_mfma_f32_16x16x32_bf16 v[128:131], a[152:155], v[28:31], v[128:131]
    ds_read_b64_tr_b16 v[22:23], v10 offset:10240
    v_mfma_f32_16x16x32_bf16 v[124:127], a[148:151], v[28:31], v[124:127]
    ds_read_b64_tr_b16 v[24:25], v10 offset:16384
    v_mfma_f32_16x16x32_bf16 v[124:127], a[164:167], v[32:35], v[124:127]
    ds_read_b64_tr_b16 v[26:27], v10 offset:18432
    v_mfma_f32_16x16x32_bf16 v[124:127], a[180:183], v[36:39], v[124:127]
    v_rcp_f32 v248, v248
    v_mfma_f32_16x16x32_bf16 v[120:123], a[176:179], v[36:39], v[120:123]
    v_rcp_f32 v249, v249
    v_mfma_f32_16x16x32_bf16 v[120:123], a[160:163], v[32:35], v[120:123]
    v_rcp_f32 v250, v250
    v_mfma_f32_16x16x32_bf16 v[120:123], a[144:147], v[28:31], v[120:123]
    s_waitcnt lgkmcnt(4)
    v_rcp_f32 v251, v251
L_Bdone:
    v_mfma_f32_16x16x32_bf16 v[136:139], v[16:19], v[168:171], 0
    s_waitcnt lgkmcnt(2)
    ds_read_b64_tr_b16 v[28:29], v3 offset:32768
    v_mul_f32 v152, v152, v248
    v_mfma_f32_16x16x32_bf16 v[136:139], v[20:23], v[184:187], v[136:139]
    s_waitcnt lgkmcnt(1)
    ds_read_b64_tr_b16 v[30:31], v3 offset:34816
    v_cvt_pk_bf16_f32 v128, v128, v129
    v_mfma_f32_16x16x32_bf16 v[136:139], v[24:27], v[200:203], v[136:139]
    ds_read_b64_tr_b16 v[32:33], v12 offset:0
    v_cvt_pk_bf16_f32 v129, v130, v131
    v_mfma_f32_16x16x32_bf16 v[140:143], v[24:27], v[204:207], 0
    ds_read_b64_tr_b16 v[34:35], v12 offset:2048
    v_cvt_pk_bf16_f32 v130, v132, v133
    v_mfma_f32_16x16x32_bf16 v[140:143], v[20:23], v[188:191], v[140:143]
    ds_read_b64_tr_b16 v[36:37], v12 offset:8192
    v_cvt_pk_bf16_f32 v131, v134, v135
    v_mfma_f32_16x16x32_bf16 v[140:143], v[16:19], v[172:175], v[140:143]
    ds_read_b64_tr_b16 v[38:39], v12 offset:10240
    v_mul_f32 v88, v88, v152
    v_mfma_f32_16x16x32_bf16 v[144:147], v[16:19], v[176:179], 0
    v_permlane16_swap_b32 v128, v130
    v_permlane16_swap_b32 v129, v131
    v_mfma_f32_16x16x32_bf16 v[144:147], v[20:23], v[192:195], v[144:147]
    buffer_store_dwordx4 v[128:131], v15, s[48:51], s71 offen sc1
    v_mfma_f32_16x16x32_bf16 v[144:147], v[24:27], v[208:211], v[144:147]
    v_cvt_pk_bf16_f32 v120, v120, v121
    v_cvt_pk_bf16_f32 v121, v122, v123
    v_mfma_f32_16x16x32_bf16 v[148:151], v[24:27], v[212:215], 0
    v_cvt_pk_bf16_f32 v122, v124, v125
    v_cvt_pk_bf16_f32 v123, v126, v127
    v_mfma_f32_16x16x32_bf16 v[148:151], v[20:23], v[196:199], v[148:151]
    ds_write_b128 v8, v[228:231] offset:39936
    v_mfma_f32_16x16x32_bf16 v[148:151], v[16:19], v[180:183], v[148:151]
    s_waitcnt lgkmcnt(5)
    v_permlane16_swap_b32 v120, v122
    v_permlane16_swap_b32 v121, v123
    v_mfma_f32_16x16x32_bf16 v[148:151], v[28:31], v[244:247], v[148:151]
    s_waitcnt lgkmcnt(3)
    ds_read_b64_tr_b16 v[16:17], v6 offset:32768
    v_mul_f32 v153, v153, v249
    v_mfma_f32_16x16x32_bf16 v[148:151], v[32:35], a[12:15], v[148:151]
    s_waitcnt lgkmcnt(2)
    ds_read_b64_tr_b16 v[18:19], v6 offset:34816
    v_mul_f32 v89, v89, v153
    v_mfma_f32_16x16x32_bf16 v[148:151], v[36:39], a[28:31], v[148:151]
    ds_read_b64_tr_b16 v[20:21], v13 offset:0
    v_cvt_pk_bf16_f32 v218, v88, v89
    v_mfma_f32_16x16x32_bf16 v[144:147], v[36:39], a[24:27], v[144:147]
    ds_read_b64_tr_b16 v[22:23], v13 offset:2048
    v_mul_f32 v154, v154, v250
    v_mfma_f32_16x16x32_bf16 v[144:147], v[32:35], a[8:11], v[144:147]
    ds_read_b64_tr_b16 v[24:25], v13 offset:8192
    v_mul_f32 v90, v90, v154
    v_mfma_f32_16x16x32_bf16 v[144:147], v[28:31], v[240:243], v[144:147]
    ds_read_b64_tr_b16 v[26:27], v13 offset:10240
    v_mul_f32 v155, v155, v251
    v_mfma_f32_16x16x32_bf16 v[140:143], v[28:31], v[236:239], v[140:143]
    buffer_store_dwordx4 v[120:123], v15, s[48:51], s70 offen sc1
    v_mfma_f32_16x16x32_bf16 v[140:143], v[32:35], a[4:7], v[140:143]
    ds_write_b128 v8, v[224:227] offset:38912
    v_mfma_f32_16x16x32_bf16 v[140:143], v[36:39], a[20:23], v[140:143]
    v_mul_f32 v91, v91, v155
    v_cvt_pk_bf16_f32 v219, v90, v91
    v_mfma_f32_16x16x32_bf16 v[136:139], v[36:39], a[16:19], v[136:139]
    v_mfma_f32_16x16x32_bf16 v[136:139], v[32:35], a[0:3], v[136:139]
    v_mfma_f32_16x16x32_bf16 v[136:139], v[28:31], v[232:235], v[136:139]
    s_waitcnt lgkmcnt(5)
    ds_write_b128 v8, v[220:223] offset:37888
    v_mfma_f32_16x16x32_bf16 v[152:155], v[16:19], v[232:235], 0
    s_waitcnt lgkmcnt(4)
    ds_read_b64_tr_b16 v[28:29], v11 offset:0
    v_mfma_f32_16x16x32_bf16 v[152:155], v[20:23], a[0:3], v[152:155]
    s_waitcnt lgkmcnt(3)
    ds_read_b64_tr_b16 v[30:31], v11 offset:2048
    v_mfma_f32_16x16x32_bf16 v[152:155], v[24:27], a[16:19], v[152:155]
    ds_read_b64_tr_b16 v[32:33], v11 offset:8192
    v_mfma_f32_16x16x32_bf16 v[156:159], v[24:27], a[20:23], 0
    ds_read_b64_tr_b16 v[34:35], v11 offset:10240
    v_mfma_f32_16x16x32_bf16 v[156:159], v[20:23], a[4:7], v[156:159]
    s_add_u32 s60, s65, 256
    ds_write_b128 v8, v[216:219] offset:36864
    v_mfma_f32_16x16x32_bf16 v[156:159], v[16:19], v[236:239], v[156:159]
    s_add_u32 m0, s55, 36864
    ds_read_b64_tr_b16 v[36:37], v11 offset:16384
    v_mfma_f32_16x16x32_bf16 v[160:163], v[16:19], v[240:243], 0
    ds_read_b64_tr_b16 v[38:39], v11 offset:18432
    v_mfma_f32_16x16x32_bf16 v[160:163], v[20:23], a[8:11], v[160:163]
    v_mfma_f32_16x16x32_bf16 v[160:163], v[24:27], a[24:27], v[160:163]
    s_waitcnt lgkmcnt(2)
    s_barrier
    v_mfma_f32_16x16x32_bf16 v[164:167], v[24:27], a[28:31], 0
    ds_read_b128 a[48:51], v9 offset:36864
    v_mfma_f32_16x16x32_bf16 v[164:167], v[20:23], a[12:15], v[164:167]
    buffer_load_dwordx4 v7, s[20:23], s60 offen  lds
    v_mfma_f32_16x16x32_bf16 v[164:167], v[16:19], v[244:247], v[164:167]
    ds_read_b128 a[52:55], v9 offset:37888
    v_mfma_f32_16x16x32_bf16 v[164:167], v[28:31], v[180:183], v[164:167]
    ds_read_b64_tr_b16 v[16:17], v12 offset:16384
    v_mfma_f32_16x16x32_bf16 v[164:167], v[32:35], v[196:199], v[164:167]
    s_waitcnt lgkmcnt(3)
    ds_read_b64_tr_b16 v[18:19], v12 offset:18432
    v_mfma_f32_16x16x32_bf16 v[164:167], v[36:39], v[212:215], v[164:167]
    s_add_u32 s60, s65, 37120
    ds_read_b64_tr_b16 v[20:21], v10 offset:24576
    v_mfma_f32_16x16x32_bf16 v[160:163], v[36:39], v[208:211], v[160:163]
    s_add_u32 m0, s55, 40960
    ds_read_b64_tr_b16 v[22:23], v10 offset:26624
    v_mfma_f32_16x16x32_bf16 v[160:163], v[32:35], v[192:195], v[160:163]
    buffer_load_dwordx4 v7, s[20:23], s60 offen  lds
    v_mfma_f32_16x16x32_bf16 v[160:163], v[28:31], v[176:179], v[160:163]
    s_add_u32 s60, s65, 73984
    ds_read_b64_tr_b16 v[24:25], v12 offset:24576
    ds_read_b128 a[56:59], v9 offset:38912
    v_mfma_f32_16x16x32_bf16 v[156:159], v[28:31], v[172:175], v[156:159]
    s_add_u32 m0, s55, 45056
    ds_read_b64_tr_b16 v[26:27], v12 offset:26624
    v_mfma_f32_16x16x32_bf16 v[156:159], v[32:35], v[188:191], v[156:159]
    ds_read_b128 a[60:63], v9 offset:39936
    v_mfma_f32_16x16x32_bf16 v[156:159], v[36:39], v[204:207], v[156:159]
    buffer_load_dwordx4 v7, s[20:23], s60 offen  lds
    v_mfma_f32_16x16x32_bf16 v[152:155], v[36:39], v[200:203], v[152:155]
    s_add_u32 s60, s65, 110848
    v_mfma_f32_16x16x32_bf16 v[152:155], v[32:35], v[184:187], v[152:155]
    s_add_u32 m0, s55, 49152
    v_mfma_f32_16x16x32_bf16 v[152:155], v[28:31], v[168:171], v[152:155]
    s_waitcnt lgkmcnt(6)
    v_mfma_f32_16x16x32_bf16 v[136:139], v[16:19], a[32:35], v[136:139]
    s_waitcnt lgkmcnt(4)
    ds_read_b64_tr_b16 v[28:29], v13 offset:16384
    v_mfma_f32_16x16x32_bf16 v[136:139], v[20:23], v[216:219], v[136:139]
    s_waitcnt lgkmcnt(2)
    s_waitcnt lgkmcnt(1)
    ds_read_b64_tr_b16 v[30:31], v13 offset:18432
    v_mfma_f32_16x16x32_bf16 v[136:139], v[24:27], a[48:51], v[136:139]
    buffer_load_dwordx4 v7, s[20:23], s60 offen  lds
    v_mfma_f32_16x16x32_bf16 v[140:143], v[24:27], a[52:55], v[140:143]
    s_add_u32 s60, s65, 147712
    ds_read_b64_tr_b16 v[32:33], v11 offset:24576
    v_mfma_f32_16x16x32_bf16 v[140:143], v[20:23], v[220:223], v[140:143]
    s_add_u32 m0, s55, 53248
    ds_read_b64_tr_b16 v[34:35], v11 offset:26624
    v_mfma_f32_16x16x32_bf16 v[140:143], v[16:19], a[36:39], v[140:143]
    ds_read_b64_tr_b16 v[36:37], v13 offset:24576
    v_mfma_f32_16x16x32_bf16 v[144:147], v[16:19], a[40:43], v[144:147]
    buffer_load_dwordx4 v7, s[20:23], s60 offen  lds
    v_mfma_f32_16x16x32_bf16 v[144:147], v[20:23], v[224:227], v[144:147]
    s_add_u32 s60, s65, 184576
    ds_read_b64_tr_b16 v[38:39], v13 offset:26624
    v_mfma_f32_16x16x32_bf16 v[144:147], v[24:27], a[56:59], v[144:147]
    s_add_u32 m0, s55, 57344
    v_add_u32 v10, 4294893568, v10
    v_add_u32 v11, 4294893568, v11
    v_mfma_f32_16x16x32_bf16 v[148:151], v[24:27], a[60:63], v[148:151]
    v_add_u32 v12, 4294893568, v12
    v_add_u32 v13, 4294893568, v13
    v_mfma_f32_16x16x32_bf16 v[148:151], v[20:23], v[228:231], v[148:151]
    v_add_u32 v3, 4294893568, v3
    v_add_u32 v6, 4294893568, v6
    v_mfma_f32_16x16x32_bf16 v[148:151], v[16:19], a[44:47], v[148:151]
    s_waitcnt lgkmcnt(4)
    v_cvt_pk_bf16_f32 v136, v136, v137
    v_cvt_pk_bf16_f32 v137, v138, v139
    v_mfma_f32_16x16x32_bf16 v[164:167], v[28:31], a[44:47], v[164:167]
    s_waitcnt lgkmcnt(2)
    v_mfma_f32_16x16x32_bf16 v[164:167], v[32:35], v[228:231], v[164:167]
    s_waitcnt vmcnt(8) lgkmcnt(0)
    s_barrier
    v_mfma_f32_16x16x32_bf16 v[164:167], v[36:39], a[60:63], v[164:167]
    buffer_load_dwordx4 v7, s[20:23], s60 offen  lds
    v_mfma_f32_16x16x32_bf16 v[160:163], v[36:39], a[56:59], v[160:163]
    s_add_u32 s60, s65, 221440
    ds_read_b64_tr_b16 v[16:17], v10 offset:0
    v_cvt_pk_bf16_f32 v138, v140, v141
    v_mfma_f32_16x16x32_bf16 v[160:163], v[32:35], v[224:227], v[160:163]
    s_add_u32 m0, s55, 61440
    ds_read_b64_tr_b16 v[18:19], v10 offset:2048
    v_cvt_pk_bf16_f32 v139, v142, v143
    v_mfma_f32_16x16x32_bf16 v[160:163], v[28:31], a[40:43], v[160:163]
    buffer_load_dwordx4 v7, s[20:23], s60 offen  lds
    v_mfma_f32_16x16x32_bf16 v[156:159], v[28:31], a[36:39], v[156:159]
    s_add_u32 s60, s65, 258304
    ds_read_b64_tr_b16 v[20:21], v10 offset:8192
    ds_read_b64_tr_b16 v[22:23], v10 offset:10240
    v_mfma_f32_16x16x32_bf16 v[156:159], v[32:35], v[220:223], v[156:159]
    s_add_u32 m0, s55, 65536
    ds_read_b64_tr_b16 v[24:25], v10 offset:16384
    v_cvt_pk_bf16_f32 v144, v144, v145
    v_mfma_f32_16x16x32_bf16 v[156:159], v[36:39], a[52:55], v[156:159]
    s_add_u32 s56, s82, 0
    ds_read_b64_tr_b16 v[26:27], v10 offset:18432
    v_cvt_pk_bf16_f32 v145, v146, v147
    v_mfma_f32_16x16x32_bf16 v[152:155], v[36:39], a[48:51], v[152:155]
    buffer_load_dwordx4 v7, s[20:23], s60 offen  lds
    v_mfma_f32_16x16x32_bf16 v[152:155], v[32:35], v[216:219], v[152:155]
    s_add_u32 s60, s66, 256
    v_cvt_pk_bf16_f32 v146, v148, v149
    v_cvt_pk_bf16_f32 v147, v150, v151
    v_mfma_f32_16x16x32_bf16 v[152:155], v[28:31], a[32:35], v[152:155]
    s_waitcnt lgkmcnt(4)
    v_mfma_f32_16x16x32_bf16 v[72:75], v[16:19], v[168:171], 0
    s_waitcnt lgkmcnt(2)
    s_and_b32 s88, s2, 3
    ds_read_b64_tr_b16 v[28:29], v3 offset:32768
    v_mfma_f32_16x16x32_bf16 v[72:75], v[20:23], v[184:187], v[72:75]
    s_waitcnt lgkmcnt(1)
    s_lshl_b32 s88, s88, 6
    ds_read_b64_tr_b16 v[30:31], v3 offset:34816
    v_mfma_f32_16x16x32_bf16 v[72:75], v[24:27], v[200:203], v[72:75]
    s_add_u32 m0, s55, 69632
    s_lshl_b32 s89, s54, 16
    ds_read_b64_tr_b16 v[32:33], v12 offset:0
    v_mfma_f32_16x16x32_bf16 v[76:79], v[24:27], v[204:207], 0
    buffer_load_dwordx4 v7, s[20:23], s60 offen  lds
    v_mfma_f32_16x16x32_bf16 v[76:79], v[20:23], v[188:191], v[76:79]
    s_add_u32 s60, s65, 384
    s_add_u32 s88, s88, s89
    ds_read_b64_tr_b16 v[34:35], v12 offset:2048
    v_mfma_f32_16x16x32_bf16 v[76:79], v[16:19], v[172:175], v[76:79]
    s_add_u32 m0, s55, 110592
    ds_read_b64_tr_b16 v[36:37], v12 offset:8192
    v_lshl_add_u32 v71, v0, 8, s88
    v_mfma_f32_16x16x32_bf16 v[80:83], v[16:19], v[176:179], 0
    s_and_b32 s88, s2, 7
    ds_read_b64_tr_b16 v[38:39], v12 offset:10240
    v_mov_b32 v70, 1
    v_mfma_f32_16x16x32_bf16 v[80:83], v[20:23], v[192:195], v[80:83]
    buffer_store_dwordx4 v[136:139], v4, s[24:27], s56 offen sc1
    v_mfma_f32_16x16x32_bf16 v[80:83], v[24:27], v[208:211], v[80:83]
    s_lshr_b32 s89, s2, 3
    v_cvt_pk_bf16_f32 v160, v160, v161
    v_cvt_pk_bf16_f32 v161, v162, v163
    v_mfma_f32_16x16x32_bf16 v[84:87], v[24:27], v[212:215], 0
    buffer_load_dwordx4 v7, s[20:23], s60 offen  lds
    v_mfma_f32_16x16x32_bf16 v[84:87], v[20:23], v[196:199], v[84:87]
    s_add_u32 s60, s65, 37248
    v_cvt_pk_bf16_f32 v162, v164, v165
    v_cvt_pk_bf16_f32 v163, v166, v167
    v_mfma_f32_16x16x32_bf16 v[84:87], v[16:19], v[180:183], v[84:87]
    s_waitcnt lgkmcnt(4)
    v_cvt_pk_bf16_f32 v152, v152, v153
    v_cvt_pk_bf16_f32 v153, v154, v155
    v_mfma_f32_16x16x32_bf16 v[84:87], v[28:31], v[244:247], v[84:87]
    s_waitcnt lgkmcnt(2)
    ds_read_b64_tr_b16 v[16:17], v12 offset:16384
    v_cvt_pk_bf16_f32 v154, v156, v157
    v_mfma_f32_16x16x32_bf16 v[84:87], v[32:35], a[12:15], v[84:87]
    s_waitcnt lgkmcnt(1)
    ds_read_b64_tr_b16 v[18:19], v12 offset:18432
    v_cvt_pk_bf16_f32 v155, v158, v159
    v_mfma_f32_16x16x32_bf16 v[84:87], v[36:39], a[28:31], v[84:87]
    s_add_u32 m0, s55, 114688
    s_and_b32 s1, s88, 1
    ds_read_b64_tr_b16 v[20:21], v10 offset:24576
    v_mfma_f32_16x16x32_bf16 v[80:83], v[36:39], a[24:27], v[80:83]
    s_lshl_b32 s1, s1, 3
    s_and_b32 s90, s89, 7
    ds_read_b64_tr_b16 v[22:23], v10 offset:26624
    v_mfma_f32_16x16x32_bf16 v[80:83], v[32:35], a[8:11], v[80:83]
    buffer_load_dwordx4 v7, s[20:23], s60 offen  lds
    v_mfma_f32_16x16x32_bf16 v[80:83], v[28:31], v[240:243], v[80:83]
    s_add_u32 s60, s65, 74112
    s_add_u32 s1, s1, s90
    ds_read_b64_tr_b16 v[24:25], v12 offset:24576
    v_mfma_f32_16x16x32_bf16 v[76:79], v[28:31], v[236:239], v[76:79]
    s_add_u32 m0, s55, 118784
    s_lshr_b32 s0, s88, 1
    ds_read_b64_tr_b16 v[26:27], v12 offset:26624
    v_mfma_f32_16x16x32_bf16 v[76:79], v[32:35], a[4:7], v[76:79]
    s_lshl_b32 s0, s0, 2
    s_lshr_b32 s89, s89, 3
    s_add_u32 s0, s0, s89
    v_mfma_f32_16x16x32_bf16 v[76:79], v[36:39], a[20:23], v[76:79]
    s_lshr_b32 s88, s54, 1
    s_and_b32 s89, s54, 1
    s_and_b32 s68, s1, 1
    v_mfma_f32_16x16x32_bf16 v[72:75], v[36:39], a[16:19], v[72:75]
    s_lshl_b32 s68, s68, 1
    s_add_u32 s68, s68, s88
    s_mul_i32 s90, s68, 5
    v_mfma_f32_16x16x32_bf16 v[72:75], v[32:35], a[0:3], v[72:75]
    s_add_u32 s56, s72, 0
    s_lshr_b32 s90, s90, 1
    s_lshl_b32 s90, s90, 9
    v_mfma_f32_16x16x32_bf16 v[72:75], v[28:31], v[232:235], v[72:75]
    s_waitcnt lgkmcnt(4)
    s_add_u32 s91, s68, 3
    v_add_u32 v64, s90, v4
    v_mfma_f32_16x16x32_bf16 v[72:75], v[16:19], a[32:35], v[72:75]
    s_waitcnt lgkmcnt(2)
    s_lshr_b32 s91, s91, 1
    ds_read_b64_tr_b16 v[28:29], v13 offset:16384
    v_mfma_f32_16x16x32_bf16 v[72:75], v[20:23], v[216:219], v[72:75]
    s_waitcnt lgkmcnt(1)
    s_lshl_b32 s91, s91, 10
    ds_read_b64_tr_b16 v[30:31], v13 offset:18432
    v_mfma_f32_16x16x32_bf16 v[72:75], v[24:27], a[48:51], v[72:75]
    buffer_load_dwordx4 v7, s[20:23], s60 offen  lds
    v_mfma_f32_16x16x32_bf16 v[76:79], v[24:27], a[52:55], v[76:79]
    s_add_u32 s60, s65, 110976
    s_lshr_b32 s90, s68, 1
    ds_read_b64_tr_b16 v[32:33], v11 offset:24576
    v_mfma_f32_16x16x32_bf16 v[76:79], v[20:23], v[220:223], v[76:79]
    s_add_u32 m0, s55, 122880
    s_lshl_b32 s90, s90, 3
    ds_read_b64_tr_b16 v[34:35], v11 offset:26624
    v_mfma_f32_16x16x32_bf16 v[76:79], v[16:19], a[36:39], v[76:79]
    s_add_u32 s91, s91, s90
    ds_read_b64_tr_b16 v[36:37], v13 offset:24576
    v_lshrrev_b32 v248, 5, v0
    v_mfma_f32_16x16x32_bf16 v[80:83], v[16:19], a[40:43], v[80:83]
    s_lshr_b32 s90, s1, 1
    ds_read_b64_tr_b16 v[38:39], v13 offset:26624
    v_lshl_add_u32 v250, v248, 12, v4
    v_mfma_f32_16x16x32_bf16 v[80:83], v[20:23], v[224:227], v[80:83]
    buffer_load_dwordx4 v7, s[20:23], s60 offen  lds
    v_mfma_f32_16x16x32_bf16 v[80:83], v[24:27], a[56:59], v[80:83]
    buffer_store_dwordx4 v[144:147], v4, s[24:27], s56 offen sc1
    v_mfma_f32_16x16x32_bf16 v[84:87], v[24:27], a[60:63], v[84:87]
    s_add_u32 s60, s65, 147840
    v_add_u32 v65, s91, v250
    v_lshl_add_u32 v249, s68, 1, v248
    v_mfma_f32_16x16x32_bf16 v[84:87], v[20:23], v[228:231], v[84:87]
    s_add_u32 m0, s55, 126976
    v_cvt_pk_bf16_f32 v72, v72, v73
    v_cvt_pk_bf16_f32 v73, v74, v75
    v_mfma_f32_16x16x32_bf16 v[84:87], v[16:19], a[44:47], v[84:87]
    s_waitcnt lgkmcnt(4)
    v_bfe_i32 v68, -5, v249, 1
    v_xor_b32 v249, 7, v249
    v_mfma_f32_16x16x32_bf16 v[100:103], v[28:31], a[44:47], 0
    s_waitcnt lgkmcnt(2)
    ds_read_b64_tr_b16 v[16:17], v6 offset:32768
    v_bfe_i32 v69, -5, v249, 1
    v_mfma_f32_16x16x32_bf16 v[100:103], v[32:35], v[228:231], v[100:103]
    s_waitcnt lgkmcnt(1)
    ds_read_b64_tr_b16 v[18:19], v6 offset:34816
    v_cvt_pk_bf16_f32 v74, v76, v77
    v_mfma_f32_16x16x32_bf16 v[100:103], v[36:39], a[60:63], v[100:103]
    buffer_load_dwordx4 v7, s[20:23], s60 offen  lds
    v_mfma_f32_16x16x32_bf16 v[96:99], v[36:39], a[56:59], 0
    s_add_u32 s60, s65, 184704
    ds_read_b64_tr_b16 v[20:21], v13 offset:0
    v_cvt_pk_bf16_f32 v75, v78, v79
    v_mfma_f32_16x16x32_bf16 v[96:99], v[32:35], v[224:227], v[96:99]
    s_add_u32 m0, s55, 131072
    ds_read_b64_tr_b16 v[22:23], v13 offset:2048
    v_cvt_pk_bf16_f32 v80, v80, v81
    v_mfma_f32_16x16x32_bf16 v[96:99], v[28:31], a[40:43], v[96:99]
    s_add_u32 s68, s68, 0x10000
    ds_read_b64_tr_b16 v[24:25], v13 offset:8192
    v_cvt_pk_bf16_f32 v81, v82, v83
    v_mfma_f32_16x16x32_bf16 v[92:95], v[28:31], a[36:39], 0
    s_bfe_i32 s3, 14, s68
    ds_read_b64_tr_b16 v[26:27], v13 offset:10240
    v_accvgpr_write_b32 a112, v80
    v_mfma_f32_16x16x32_bf16 v[92:95], v[32:35], v[220:223], v[92:95]
    s_bfe_i32 s68, 7, s68
    v_cvt_pk_bf16_f32 v82, v84, v85
    v_cvt_pk_bf16_f32 v83, v86, v87
    v_mfma_f32_16x16x32_bf16 v[92:95], v[36:39], a[52:55], v[92:95]
    s_mul_i32 s90, s90, 294912
    v_accvgpr_write_b32 a113, v81
    v_accvgpr_write_b32 a114, v82
    v_mfma_f32_16x16x32_bf16 v[88:91], v[36:39], a[48:51], 0
    buffer_load_dwordx4 v7, s[20:23], s60 offen  lds
    v_mfma_f32_16x16x32_bf16 v[88:91], v[32:35], v[216:219], v[88:91]
    s_mul_i32 s91, s89, 147456
    v_accvgpr_write_b32 a115, v83
    v_and_b32 v251, 15, v0
    v_mfma_f32_16x16x32_bf16 v[88:91], v[28:31], a[32:35], v[88:91]
    s_waitcnt lgkmcnt(4)
    v_bfe_u32 v252, v0, 4, 1
    v_lshlrev_b32 v252, 14, v252
    v_mfma_f32_16x16x32_bf16 v[88:91], v[16:19], v[232:235], v[88:91]
    s_waitcnt lgkmcnt(2)
    ds_read_b64_tr_b16 v[28:29], v11 offset:0
    v_lshl_add_u32 v252, v248, 8, v252
    v_mfma_f32_16x16x32_bf16 v[88:91], v[20:23], a[0:3], v[88:91]
    s_waitcnt lgkmcnt(1)
    ds_read_b64_tr_b16 v[30:31], v11 offset:2048
    v_lshl_add_u32 v118, v251, 4, v252
    v_mfma_f32_16x16x32_bf16 v[88:91], v[24:27], a[16:19], v[88:91]
    s_add_u32 s60, s65, 221568
    ds_read_b64_tr_b16 v[32:33], v11 offset:8192
    v_and_b32 v249, 31, v0
    v_mfma_f32_16x16x32_bf16 v[92:95], v[24:27], a[20:23], v[92:95]
    s_add_u32 m0, s55, 135168
    ds_read_b64_tr_b16 v[34:35], v11 offset:10240
    v_mul_u32_u24 v250, 320, v248
    v_mfma_f32_16x16x32_bf16 v[92:95], v[20:23], a[4:7], v[92:95]
    s_add_u32 s56, s72, 16384
    ds_read_b64_tr_b16 v[36:37], v11 offset:16384
    v_cmp_eq_u32 vcc, 22, v249
    v_mfma_f32_16x16x32_bf16 v[92:95], v[16:19], v[236:239], v[92:95]
    buffer_load_dwordx4 v7, s[20:23], s60 offen  lds
    v_mfma_f32_16x16x32_bf16 v[96:99], v[16:19], v[240:243], v[96:99]
    s_add_u32 s60, s65, 258432
    ds_read_b64_tr_b16 v[38:39], v11 offset:18432
    v_mov_b32 v252, 0x7fff0000
    v_mfma_f32_16x16x32_bf16 v[96:99], v[20:23], a[8:11], v[96:99]
    s_add_u32 m0, s55, 139264
    v_add_u32 v10, 36864, v10
    v_add_u32 v11, 36864, v11
    v_mfma_f32_16x16x32_bf16 v[96:99], v[24:27], a[24:27], v[96:99]
    s_add_u32 s64, s90, s91
    v_add_u32 v12, 36864, v12
    v_add_u32 v13, 36864, v13
    v_mfma_f32_16x16x32_bf16 v[100:103], v[24:27], a[28:31], v[100:103]
    s_add_u32 s64, s64, 2359296
    v_add_u32 v3, 36864, v3
    v_add_u32 v6, 36864, v6
    v_mfma_f32_16x16x32_bf16 v[100:103], v[20:23], a[12:15], v[100:103]
    buffer_store_dwordx4 v[160:163], v4, s[24:27], s56 offen sc1
    v_mfma_f32_16x16x32_bf16 v[100:103], v[16:19], v[244:247], v[100:103]
    s_waitcnt lgkmcnt(4)
    v_lshlrev_b32 v119, 2, v249
    v_cndmask_b32 v251, v249, 18, vcc
    v_mfma_f32_16x16x32_bf16 v[100:103], v[28:31], v[180:183], v[100:103]
    s_waitcnt lgkmcnt(2)
    s_waitcnt vmcnt(19)
    v_cmp_lt_u32 vcc, 18, v251
    v_mfma_f32_16x16x32_bf16 v[100:103], v[32:35], v[196:199], v[100:103]
    s_waitcnt vmcnt(10) lgkmcnt(0)
    s_barrier
    v_mfma_f32_16x16x32_bf16 v[100:103], v[36:39], v[212:215], v[100:103]
    buffer_load_dwordx4 v7, s[20:23], s60 offen  lds
    v_mfma_f32_16x16x32_bf16 v[96:99], v[36:39], v[208:211], v[96:99]
    buffer_atomic_add v70, v71, s[40:43], 0 offen
    v_mfma_f32_16x16x32_bf16 v[96:99], v[32:35], v[192:195], v[96:99]
    s_add_u32 s60, s66, 384
    ds_read_b64_tr_b16 v[16:17], v10 offset:0
    ds_read_b64_tr_b16 v[18:19], v10 offset:2048
    v_mfma_f32_16x16x32_bf16 v[96:99], v[28:31], v[176:179], v[96:99]
    s_add_u32 m0, s55, 143360
    ds_read_b64_tr_b16 v[20:21], v10 offset:8192
    v_lshlrev_b32 v71, 6, v0
    v_mfma_f32_16x16x32_bf16 v[92:95], v[28:31], v[172:175], v[92:95]
    s_lshl_b32 s91, s0, 1
    ds_read_b64_tr_b16 v[22:23], v10 offset:10240
    v_lshl_add_u32 v66, v251, 4, v250
    v_mfma_f32_16x16x32_bf16 v[92:95], v[32:35], v[188:191], v[92:95]
    buffer_load_dwordx4 v7, s[20:23], s60 offen  lds
    v_mfma_f32_16x16x32_bf16 v[92:95], v[36:39], v[204:207], v[92:95]
    s_add_u32 s60, s65, 512
    ds_read_b64_tr_b16 v[24:25], v10 offset:16384
    ds_read_b64_tr_b16 v[26:27], v10 offset:18432
    v_mfma_f32_16x16x32_bf16 v[88:91], v[36:39], v[200:203], v[88:91]
    s_add_u32 m0, s55, 73728
    v_mov_b32 v67, 0xdddddddd
    v_cndmask_b32 v66, v66, v252, vcc
    v_mfma_f32_16x16x32_bf16 v[88:91], v[32:35], v[184:187], v[88:91]
    s_add_u32 s91, s91, s89
    v_cmp_lt_u32 vcc, 31, v0
    v_lshlrev_b32 v135, 2, v0
    v_mfma_f32_16x16x32_bf16 v[88:91], v[28:31], v[168:171], v[88:91]
    s_waitcnt lgkmcnt(4)
    v_mov_b32 v134, 0x7fff0000
    v_writelane_b32 v134, 0, 0
    v_mfma_f32_16x16x32_bf16 v[136:139], v[16:19], v[168:171], 0
    s_waitcnt lgkmcnt(2)
    ds_read_b64_tr_b16 v[28:29], v3 offset:32768
    v_cndmask_b32 v119, v119, v252, vcc
    v_mfma_f32_16x16x32_bf16 v[136:139], v[20:23], v[184:187], v[136:139]
    s_waitcnt lgkmcnt(1)
    ds_read_b64_tr_b16 v[30:31], v3 offset:34816
    v_cvt_pk_bf16_f32 v96, v96, v97
    v_mfma_f32_16x16x32_bf16 v[136:139], v[24:27], v[200:203], v[136:139]
    buffer_load_dwordx4 v7, s[20:23], s60 offen  lds
    v_mfma_f32_16x16x32_bf16 v[140:143], v[24:27], v[204:207], 0
    s_mul_i32 s74, s91, 9216
    ds_read_b64_tr_b16 v[32:33], v12 offset:0
    v_cvt_pk_bf16_f32 v97, v98, v99
    v_mfma_f32_16x16x32_bf16 v[140:143], v[20:23], v[188:191], v[140:143]
    s_add_u32 s60, s65, 37376
    ds_read_b64_tr_b16 v[34:35], v12 offset:2048
    v_cvt_pk_bf16_f32 v98, v100, v101
    v_mfma_f32_16x16x32_bf16 v[140:143], v[16:19], v[172:175], v[140:143]
    s_add_u32 m0, s55, 77824
    ds_read_b64_tr_b16 v[36:37], v12 offset:8192
    v_cvt_pk_bf16_f32 v99, v102, v103
    v_mfma_f32_16x16x32_bf16 v[144:147], v[16:19], v[176:179], 0
    s_add_u32 s56, s82, 16384
    ds_read_b64_tr_b16 v[38:39], v12 offset:10240
    v_cmp_gt_u32 vcc, 8, v0
    v_mfma_f32_16x16x32_bf16 v[144:147], v[20:23], v[192:195], v[144:147]
    s_add_u32 s74, s74, s90
    v_cvt_pk_bf16_f32 v88, v88, v89
    v_cvt_pk_bf16_f32 v89, v90, v91
    v_mfma_f32_16x16x32_bf16 v[144:147], v[24:27], v[208:211], v[144:147]
    s_xor_b32 s73, s91, 1
    v_cvt_pk_bf16_f32 v90, v92, v93
    v_cvt_pk_bf16_f32 v91, v94, v95
L_pg11:
    s_cbranch_execz L_tour_ret
    v_mfma_f32_16x16x32_bf16 v[148:151], v[24:27], v[212:215], 0
    s_mul_i32 s73, s73, 9216
    s_add_u32 s73, s73, s90
    v_cndmask_b32 v135, v252, v135, vcc
    v_mfma_f32_16x16x32_bf16 v[148:151], v[20:23], v[196:199], v[148:151]
    buffer_load_dwordx4 v7, s[20:23], s60 offen  lds
    v_mfma_f32_16x16x32_bf16 v[148:151], v[16:19], v[180:183], v[148:151]
    s_waitcnt lgkmcnt(4)
    s_lshl_b32 s69, s91, 6
    s_add_u32 s69, s69, s1
    v_mfma_f32_16x16x32_bf16 v[148:151], v[28:31], v[244:247], v[148:151]
    s_waitcnt lgkmcnt(2)
    s_lshl_b32 s69, s69, 1
    ds_read_b64_tr_b16 v[16:17], v12 offset:16384
    v_mfma_f32_16x16x32_bf16 v[148:151], v[32:35], a[12:15], v[148:151]
    s_waitcnt lgkmcnt(1)
    s_add_u32 s69, s69, s88
    ds_read_b64_tr_b16 v[18:19], v12 offset:18432
    v_mfma_f32_16x16x32_bf16 v[148:151], v[36:39], a[28:31], v[148:151]
    s_add_u32 s60, s65, 74240
    s_lshl_b32 s69, s69, 9
    ds_read_b64_tr_b16 v[20:21], v10 offset:24576
    v_mfma_f32_16x16x32_bf16 v[144:147], v[36:39], a[24:27], v[144:147]
    s_add_u32 m0, s55, 81920
    s_add_u32 s69, s69, 7340032
    ds_read_b64_tr_b16 v[22:23], v10 offset:26624
    v_mfma_f32_16x16x32_bf16 v[144:147], v[32:35], a[8:11], v[144:147]
    s_lshl_b32 s91, s1, 1
    s_add_u32 s91, s91, s88
    ds_read_b64_tr_b16 v[24:25], v12 offset:24576
    v_mfma_f32_16x16x32_bf16 v[144:147], v[28:31], v[240:243], v[144:147]
    buffer_load_dwordx4 v7, s[20:23], s60 offen  lds
    v_mfma_f32_16x16x32_bf16 v[140:143], v[28:31], v[236:239], v[140:143]
    s_add_u32 s60, s65, 111104
    s_mul_i32 s67, s91, 81920
    ds_read_b64_tr_b16 v[26:27], v12 offset:26624
    v_mfma_f32_16x16x32_bf16 v[140:143], v[32:35], a[4:7], v[140:143]
    buffer_store_dwordx4 v[152:155], v4, s[24:27], s56 offen sc1
    v_mfma_f32_16x16x32_bf16 v[140:143], v[36:39], a[20:23], v[140:143]
    s_add_u32 m0, s55, 86016
    s_mul_i32 s91, s89, 40960
    s_add_u32 s67, s67, s91
    v_mfma_f32_16x16x32_bf16 v[136:139], v[36:39], a[16:19], v[136:139]
    s_add_u32 s67, s67, 4718592
    s_lshl_b32 s70, s0, 4
    s_add_u32 s70, s70, s1
    v_mfma_f32_16x16x32_bf16 v[136:139], v[32:35], a[0:3], v[136:139]
    s_lshl_b32 s70, s70, 2
    s_add_u32 s70, s70, s54
    s_lshl_b32 s70, s70, 8
    v_mfma_f32_16x16x32_bf16 v[136:139], v[28:31], v[232:235], v[136:139]
    s_waitcnt lgkmcnt(4)
    s_add_u32 s70, s70, 9437184
    s_mul_i32 s91, s54, 6144
    v_mfma_f32_16x16x32_bf16 v[136:139], v[16:19], a[32:35], v[136:139]
    s_waitcnt lgkmcnt(2)
    s_add_u32 s91, s91, 129024
    ds_read_b64_tr_b16 v[28:29], v13 offset:16384
    v_mfma_f32_16x16x32_bf16 v[136:139], v[20:23], v[216:219], v[136:139]
    s_waitcnt lgkmcnt(1)
    ds_read_b64_tr_b16 v[30:31], v13 offset:18432
    v_add_u32 v120, s91, v4
    v_mfma_f32_16x16x32_bf16 v[136:139], v[24:27], a[48:51], v[136:139]
    buffer_load_dwordx4 v7, s[20:23], s60 offen  lds
    v_mfma_f32_16x16x32_bf16 v[140:143], v[24:27], a[52:55], v[140:143]
    s_add_u32 s60, s65, 147968
    s_xor_b32 s90, s54, 1
    ds_read_b64_tr_b16 v[32:33], v11 offset:24576
    v_mfma_f32_16x16x32_bf16 v[140:143], v[20:23], v[220:223], v[140:143]
    s_add_u32 m0, s55, 90112
    s_mul_i32 s90, s90, 6144
    ds_read_b64_tr_b16 v[34:35], v11 offset:26624
    v_mfma_f32_16x16x32_bf16 v[140:143], v[16:19], a[36:39], v[140:143]
    s_add_u32 s90, s90, 129024
    s_mov_b32 s61, s64
    ds_read_b64_tr_b16 v[36:37], v13 offset:24576
    v_mfma_f32_16x16x32_bf16 v[144:147], v[16:19], a[40:43], v[144:147]
    s_mov_b32 s62, s67
    ds_read_b64_tr_b16 v[38:39], v13 offset:26624
    v_add_u32 v121, s90, v4
    v_mfma_f32_16x16x32_bf16 v[144:147], v[20:23], v[224:227], v[144:147]
    s_lshl_b32 s88, s52, 10
    s_lshl_b32 s89, s53, 3
    s_add_u32 s88, s88, s89
    v_mfma_f32_16x16x32_bf16 v[144:147], v[24:27], a[56:59], v[144:147]
    buffer_load_dwordx4 v7, s[20:23], s60 offen  lds
    v_mfma_f32_16x16x32_bf16 v[148:151], v[24:27], a[60:63], v[148:151]
    s_add_u32 s60, s65, 184832
    s_lshr_b32 s89, s53, 2
    s_mul_i32 s89, s89, 96
    v_mfma_f32_16x16x32_bf16 v[148:151], v[20:23], v[228:231], v[148:151]
    s_add_u32 m0, s55, 94208
    v_cvt_pk_bf16_f32 v136, v136, v137
    v_cvt_pk_bf16_f32 v137, v138, v139
    v_mfma_f32_16x16x32_bf16 v[148:151], v[16:19], a[44:47], v[148:151]
    s_waitcnt lgkmcnt(4)
    s_add_u32 s88, s88, s89
    s_lshr_b32 s89, s54, 1
    v_mfma_f32_16x16x32_bf16 v[164:167], v[28:31], a[44:47], 0
    s_waitcnt lgkmcnt(2)
    s_lshl_b32 s81, s89, 9
    ds_read_b64_tr_b16 v[16:17], v6 offset:32768
    v_mfma_f32_16x16x32_bf16 v[164:167], v[32:35], v[228:231], v[164:167]
    s_waitcnt lgkmcnt(1)
    ds_read_b64_tr_b16 v[18:19], v6 offset:34816
    v_cvt_pk_bf16_f32 v138, v140, v141
    v_mfma_f32_16x16x32_bf16 v[164:167], v[36:39], a[60:63], v[164:167]
    s_add_u32 s56, s82, 65536
    ds_read_b64_tr_b16 v[20:21], v13 offset:0
    v_cvt_pk_bf16_f32 v139, v142, v143
    v_mfma_f32_16x16x32_bf16 v[160:163], v[36:39], a[56:59], 0
    buffer_load_dwordx4 v7, s[20:23], s60 offen  lds
    v_mfma_f32_16x16x32_bf16 v[160:163], v[32:35], v[224:227], v[160:163]
    s_add_u32 s60, s65, 221696
    ds_read_b64_tr_b16 v[22:23], v13 offset:2048
    v_cvt_pk_bf16_f32 v144, v144, v145
    v_mfma_f32_16x16x32_bf16 v[160:163], v[28:31], a[40:43], v[160:163]
    s_add_u32 m0, s55, 98304
    ds_read_b64_tr_b16 v[24:25], v13 offset:8192
    v_cvt_pk_bf16_f32 v145, v146, v147
    v_mfma_f32_16x16x32_bf16 v[156:159], v[28:31], a[36:39], 0
    s_lshl_b32 s83, s89, 2
    ds_read_b64_tr_b16 v[26:27], v13 offset:10240
    v_accvgpr_write_b32 a116, v144
    v_mfma_f32_16x16x32_bf16 v[156:159], v[32:35], v[220:223], v[156:159]
    buffer_store_dwordx4 v[72:75], v4, s[24:27], s56 offen sc1
    v_mfma_f32_16x16x32_bf16 v[156:159], v[36:39], a[52:55], v[156:159]
    s_add_u32 s81, s81, s88
    v_cvt_pk_bf16_f32 v146, v148, v149
    v_cvt_pk_bf16_f32 v147, v150, v151
    v_mfma_f32_16x16x32_bf16 v[152:155], v[36:39], a[48:51], 0
    s_add_u32 s83, s83, s88
    v_accvgpr_write_b32 a117, v145
    v_accvgpr_write_b32 a118, v146
    v_mfma_f32_16x16x32_bf16 v[152:155], v[32:35], v[216:219], v[152:155]
    buffer_load_dwordx4 v7, s[20:23], s60 offen  lds
    v_mfma_f32_16x16x32_bf16 v[152:155], v[28:31], a[32:35], v[152:155]
    s_waitcnt lgkmcnt(4)
    s_and_b32 s89, s54, 1
    v_accvgpr_write_b32 a119, v147
    v_mfma_f32_16x16x32_bf16 v[152:155], v[16:19], v[232:235], v[152:155]
    s_waitcnt lgkmcnt(2)
    s_lshl_b32 s88, s89, 2
    ds_read_b64_tr_b16 v[28:29], v11 offset:0
    v_mfma_f32_16x16x32_bf16 v[152:155], v[20:23], a[0:3], v[152:155]
    s_waitcnt lgkmcnt(1)
    s_add_u32 s81, s81, s88
    ds_read_b64_tr_b16 v[30:31], v11 offset:2048
    v_mfma_f32_16x16x32_bf16 v[152:155], v[24:27], a[16:19], v[152:155]
    s_add_u32 s60, s65, 258560
    s_lshl_b32 s88, s89, 9
    ds_read_b64_tr_b16 v[32:33], v11 offset:8192
    v_mfma_f32_16x16x32_bf16 v[156:159], v[24:27], a[20:23], v[156:159]
    s_add_u32 m0, s55, 102400
    s_add_u32 s83, s83, s88
    ds_read_b64_tr_b16 v[34:35], v11 offset:10240
    v_mfma_f32_16x16x32_bf16 v[156:159], v[20:23], a[4:7], v[156:159]
    s_add_u32 s81, s81, 9699328
    s_add_u32 s83, s83, 9715712
    ds_read_b64_tr_b16 v[36:37], v11 offset:16384
    v_mfma_f32_16x16x32_bf16 v[156:159], v[16:19], v[236:239], v[156:159]
    s_lshr_b32 s88, s1, 2
    s_and_b32 s89, s1, 3
    ds_read_b64_tr_b16 v[38:39], v11 offset:18432
    v_mfma_f32_16x16x32_bf16 v[160:163], v[16:19], v[240:243], v[160:163]
    s_lshl_b32 s84, s0, 1
    v_add_u32 v10, 73728, v10
    v_add_u32 v11, 73728, v11
    v_mfma_f32_16x16x32_bf16 v[160:163], v[20:23], a[8:11], v[160:163]
    s_lshr_b32 s90, s89, 1
    v_add_u32 v12, 73728, v12
    v_add_u32 v13, 73728, v13
    v_mfma_f32_16x16x32_bf16 v[160:163], v[24:27], a[24:27], v[160:163]
    s_add_u32 s84, s84, s90
    v_add_u32 v3, 73728, v3
    v_add_u32 v6, 73728, v6
    v_mfma_f32_16x16x32_bf16 v[164:167], v[24:27], a[28:31], v[164:167]
    buffer_load_dwordx4 v7, s[20:23], s60 offen  lds
    v_mfma_f32_16x16x32_bf16 v[164:167], v[20:23], a[12:15], v[164:167]
    s_add_u32 s60, s66, 512
    s_lshl_b32 s84, s84, 2
    s_add_u32 s84, s84, s54
    v_mfma_f32_16x16x32_bf16 v[164:167], v[16:19], v[244:247], v[164:167]
    s_waitcnt lgkmcnt(4)
    s_lshl_b32 s84, s84, 7
    s_add_u32 s84, s84, 9699328
    v_mfma_f32_16x16x32_bf16 v[164:167], v[28:31], v[180:183], v[164:167]
    s_waitcnt lgkmcnt(2)
    s_add_u32 s85, s84, 16384
    s_mul_i32 s75, s54, 165888
    v_mfma_f32_16x16x32_bf16 v[164:167], v[32:35], v[196:199], v[164:167]
    s_waitcnt vmcnt(10) lgkmcnt(0)
    s_barrier
    v_mfma_f32_16x16x32_bf16 v[164:167], v[36:39], v[212:215], v[164:167]
    s_add_u32 m0, s55, 106496
    s_mul_i32 s90, s88, 288
    ds_read_b64_tr_b16 v[16:17], v10 offset:0
    v_mfma_f32_16x16x32_bf16 v[160:163], v[36:39], v[208:211], v[160:163]
    buffer_load_dwordx4 v7, s[20:23], s60 offen  lds
    v_mfma_f32_16x16x32_bf16 v[160:163], v[32:35], v[192:195], v[160:163]
    s_add_u32 s60, s65, 640
    s_add_u32 s75, s75, s90
    ds_read_b64_tr_b16 v[18:19], v10 offset:2048
    v_mfma_f32_16x16x32_bf16 v[160:163], v[28:31], v[176:179], v[160:163]
    s_add_u32 m0, s55, 0
    s_lshl_b32 s91, s0, 2
    ds_read_b64_tr_b16 v[20:21], v10 offset:8192
    v_mfma_f32_16x16x32_bf16 v[156:159], v[28:31], v[172:175], v[156:159]
    s_add_u32 s56, s72, 81920
    s_add_u32 s91, s91, s89
    ds_read_b64_tr_b16 v[22:23], v10 offset:10240
    v_mfma_f32_16x16x32_bf16 v[156:159], v[32:35], v[188:191], v[156:159]
    s_mul_i32 s78, s91, 36864
    s_add_u32 s78, s78, s90
    ds_read_b64_tr_b16 v[24:25], v10 offset:16384
    v_mfma_f32_16x16x32_bf16 v[156:159], v[36:39], v[204:207], v[156:159]
    buffer_load_dwordx4 v7, s[20:23], s60 offen  lds
    v_mfma_f32_16x16x32_bf16 v[152:155], v[36:39], v[200:203], v[152:155]
    s_add_u32 s60, s65, 37504
    s_lshl_b32 s71, s91, 2
    ds_read_b64_tr_b16 v[26:27], v10 offset:18432
    v_mfma_f32_16x16x32_bf16 v[152:155], v[32:35], v[184:187], v[152:155]
    buffer_store_dwordx4 v[96:99], v4, s[24:27], s56 offen sc1
    v_mfma_f32_16x16x32_bf16 v[152:155], v[28:31], v[168:171], v[152:155]
    s_waitcnt lgkmcnt(4)
    s_add_u32 s71, s71, s88
    s_mul_i32 s71, s71, 147456
    v_mfma_f32_16x16x32_bf16 v[72:75], v[16:19], v[168:171], 0
    s_waitcnt lgkmcnt(2)
    s_lshl_b32 s90, s54, 12
    ds_read_b64_tr_b16 v[28:29], v3 offset:32768
    v_mfma_f32_16x16x32_bf16 v[72:75], v[20:23], v[184:187], v[72:75]
    s_waitcnt lgkmcnt(1)
    ds_read_b64_tr_b16 v[30:31], v3 offset:34816
    v_cvt_pk_bf16_f32 v160, v160, v161
    v_mfma_f32_16x16x32_bf16 v[72:75], v[24:27], v[200:203], v[72:75]
    s_add_u32 m0, s55, 4096
    ds_read_b64_tr_b16 v[32:33], v12 offset:0
    v_cvt_pk_bf16_f32 v161, v162, v163
    v_mfma_f32_16x16x32_bf16 v[76:79], v[24:27], v[204:207], 0
    buffer_load_dwordx4 v7, s[20:23], s60 offen  lds
    v_mfma_f32_16x16x32_bf16 v[76:79], v[20:23], v[188:191], v[76:79]
    s_add_u32 s71, s71, s90
    ds_read_b64_tr_b16 v[34:35], v12 offset:2048
    v_cvt_pk_bf16_f32 v162, v164, v165
    v_mfma_f32_16x16x32_bf16 v[76:79], v[16:19], v[172:175], v[76:79]
    s_add_u32 s60, s65, 74368
    ds_read_b64_tr_b16 v[36:37], v12 offset:8192
    v_cvt_pk_bf16_f32 v163, v166, v167
    v_mfma_f32_16x16x32_bf16 v[80:83], v[16:19], v[176:179], 0
    s_add_u32 m0, s55, 8192
    s_add_u32 s71, s71, 9961472
    ds_read_b64_tr_b16 v[38:39], v12 offset:10240
    v_mfma_f32_16x16x32_bf16 v[80:83], v[20:23], v[192:195], v[80:83]
    s_mul_i32 s76, s54, 27648
    v_cvt_pk_bf16_f32 v152, v152, v153
    v_cvt_pk_bf16_f32 v153, v154, v155
    v_mfma_f32_16x16x32_bf16 v[80:83], v[24:27], v[208:211], v[80:83]
    s_mul_i32 s77, s54, 4608
    v_cvt_pk_bf16_f32 v154, v156, v157
    v_cvt_pk_bf16_f32 v155, v158, v159
    v_mfma_f32_16x16x32_bf16 v[84:87], v[24:27], v[212:215], 0
    s_lshl_b32 s79, s91, 15
    v_accvgpr_write_b32 a120, v152
    v_accvgpr_write_b32 a121, v153
    v_mfma_f32_16x16x32_bf16 v[84:87], v[20:23], v[196:199], v[84:87]
    s_add_u32 s79, s79, s90
    v_accvgpr_write_b32 a122, v154
    v_accvgpr_write_b32 a123, v155
    v_mfma_f32_16x16x32_bf16 v[84:87], v[16:19], v[180:183], v[84:87]
    s_waitcnt lgkmcnt(4)
    s_add_u32 s79, s79, 7340032
    s_lshl_b32 s80, s0, 14
    v_mfma_f32_16x16x32_bf16 v[84:87], v[28:31], v[244:247], v[84:87]
    s_waitcnt lgkmcnt(2)
    s_add_u32 s80, s80, s90
    ds_read_b64_tr_b16 v[16:17], v12 offset:16384
    v_mfma_f32_16x16x32_bf16 v[84:87], v[32:35], a[12:15], v[84:87]
    s_waitcnt lgkmcnt(1)
    s_lshl_b32 s89, s89, 7
    ds_read_b64_tr_b16 v[18:19], v12 offset:18432
    v_mfma_f32_16x16x32_bf16 v[84:87], v[36:39], a[28:31], v[84:87]
    buffer_load_dwordx4 v7, s[20:23], s60 offen  lds
    v_mfma_f32_16x16x32_bf16 v[80:83], v[36:39], a[24:27], v[80:83]
    s_add_u32 s60, s65, 111232
    s_add_u32 s80, s80, s89
    ds_read_b64_tr_b16 v[20:21], v10 offset:24576
    v_mfma_f32_16x16x32_bf16 v[80:83], v[32:35], a[8:11], v[80:83]
    s_add_u32 m0, s55, 12288
    s_add_u32 s80, s80, 9437184
    ds_read_b64_tr_b16 v[22:23], v10 offset:26624
    v_mfma_f32_16x16x32_bf16 v[80:83], v[28:31], v[240:243], v[80:83]
    s_mov_b32 s91, 2304
    s_mov_b32 s90, 18432
    ds_read_b64_tr_b16 v[24:25], v12 offset:24576
    v_mfma_f32_16x16x32_bf16 v[76:79], v[28:31], v[236:239], v[76:79]
    buffer_load_dwordx4 v7, s[20:23], s60 offen  lds
    v_mfma_f32_16x16x32_bf16 v[76:79], v[32:35], a[4:7], v[76:79]
    s_add_u32 s60, s65, 148096
    s_mul_i32 s88, s54, 144
    ds_read_b64_tr_b16 v[26:27], v12 offset:26624
    v_mfma_f32_16x16x32_bf16 v[76:79], v[36:39], a[20:23], v[76:79]
    s_add_u32 m0, s55, 16384
    v_add_u32 v248, 0, v0
    v_mul_u32_u24 v249, 3641, v248
    v_mfma_f32_16x16x32_bf16 v[72:75], v[36:39], a[16:19], v[72:75]
    s_add_u32 s56, s82, 81920
    v_lshrrev_b32 v249, 16, v249
    v_lshrrev_b32 v250, 4, v249
    v_mfma_f32_16x16x32_bf16 v[72:75], v[32:35], a[0:3], v[72:75]
    v_mul_u32_u24 v249, 864, v249
    v_lshl_add_u32 v249, v248, 4, v249
    v_mfma_f32_16x16x32_bf16 v[72:75], v[28:31], v[232:235], v[72:75]
    s_waitcnt lgkmcnt(4)
    v_mad_u32_u24 v104, v250, s91, v249
    v_add_u32 v248, 64, v0
    v_mfma_f32_16x16x32_bf16 v[72:75], v[16:19], a[32:35], v[72:75]
    s_waitcnt lgkmcnt(2)
    ds_read_b64_tr_b16 v[28:29], v13 offset:16384
    v_mul_u32_u24 v249, 3641, v248
    v_mfma_f32_16x16x32_bf16 v[72:75], v[20:23], v[216:219], v[72:75]
    s_waitcnt lgkmcnt(1)
    ds_read_b64_tr_b16 v[30:31], v13 offset:18432
    v_lshrrev_b32 v249, 16, v249
    v_mfma_f32_16x16x32_bf16 v[72:75], v[24:27], a[48:51], v[72:75]
    buffer_load_dwordx4 v7, s[20:23], s60 offen  lds
    v_mfma_f32_16x16x32_bf16 v[76:79], v[24:27], a[52:55], v[76:79]
    s_add_u32 s60, s65, 184960
    ds_read_b64_tr_b16 v[32:33], v11 offset:24576
    v_lshrrev_b32 v250, 4, v249
    v_mfma_f32_16x16x32_bf16 v[76:79], v[20:23], v[220:223], v[76:79]
    s_add_u32 m0, s55, 20480
    ds_read_b64_tr_b16 v[34:35], v11 offset:26624
    v_mul_u32_u24 v249, 864, v249
    v_mfma_f32_16x16x32_bf16 v[76:79], v[16:19], a[36:39], v[76:79]
    ds_read_b64_tr_b16 v[36:37], v13 offset:24576
    v_lshl_add_u32 v249, v248, 4, v249
    v_mfma_f32_16x16x32_bf16 v[80:83], v[16:19], a[40:43], v[80:83]
    ds_read_b64_tr_b16 v[38:39], v13 offset:26624
    v_mad_u32_u24 v105, v250, s91, v249
    v_mfma_f32_16x16x32_bf16 v[80:83], v[20:23], v[224:227], v[80:83]
    buffer_store_dwordx4 v[88:91], v4, s[24:27], s56 offen sc1
    v_mfma_f32_16x16x32_bf16 v[80:83], v[24:27], a[56:59], v[80:83]
    v_subrev_u32 v105, 1024, v105
    v_add_u32 v248, 128, v0
    v_mfma_f32_16x16x32_bf16 v[84:87], v[24:27], a[60:63], v[84:87]
    buffer_load_dwordx4 v7, s[20:23], s60 offen  lds
    v_mfma_f32_16x16x32_bf16 v[84:87], v[20:23], v[228:231], v[84:87]
    s_add_u32 s60, s65, 221824
    v_cvt_pk_bf16_f32 v72, v72, v73
    v_cvt_pk_bf16_f32 v73, v74, v75
    v_mfma_f32_16x16x32_bf16 v[84:87], v[16:19], a[44:47], v[84:87]
    s_waitcnt lgkmcnt(4)
    v_mul_u32_u24 v249, 3641, v248
    v_lshrrev_b32 v249, 16, v249
    v_mfma_f32_16x16x32_bf16 v[100:103], v[28:31], a[44:47], 0
    s_waitcnt lgkmcnt(2)
    ds_read_b64_tr_b16 v[16:17], v6 offset:32768
    v_lshrrev_b32 v250, 4, v249
    v_mfma_f32_16x16x32_bf16 v[100:103], v[32:35], v[228:231], v[100:103]
    s_waitcnt lgkmcnt(1)
    ds_read_b64_tr_b16 v[18:19], v6 offset:34816
    v_cvt_pk_bf16_f32 v74, v76, v77
    v_mfma_f32_16x16x32_bf16 v[100:103], v[36:39], a[60:63], v[100:103]
    s_add_u32 m0, s55, 24576
    ds_read_b64_tr_b16 v[20:21], v13 offset:0
    v_cvt_pk_bf16_f32 v75, v78, v79
    v_mfma_f32_16x16x32_bf16 v[96:99], v[36:39], a[56:59], 0
    ds_read_b64_tr_b16 v[22:23], v13 offset:2048
    v_mul_u32_u24 v249, 864, v249
    v_mfma_f32_16x16x32_bf16 v[96:99], v[32:35], v[224:227], v[96:99]
    buffer_load_dwordx4 v7, s[20:23], s60 offen  lds
    v_mfma_f32_16x16x32_bf16 v[96:99], v[28:31], a[40:43], v[96:99]
    s_add_u32 s60, s65, 258688
    ds_read_b64_tr_b16 v[24:25], v13 offset:8192
    v_cvt_pk_bf16_f32 v80, v80, v81
    v_mfma_f32_16x16x32_bf16 v[92:95], v[28:31], a[36:39], 0
    s_add_u32 m0, s55, 28672
    ds_read_b64_tr_b16 v[26:27], v13 offset:10240
    v_cvt_pk_bf16_f32 v81, v82, v83
    v_mfma_f32_16x16x32_bf16 v[92:95], v[32:35], v[220:223], v[92:95]
    v_cvt_pk_bf16_f32 v82, v84, v85
    v_cvt_pk_bf16_f32 v83, v86, v87
    v_mfma_f32_16x16x32_bf16 v[92:95], v[36:39], a[52:55], v[92:95]
    v_accvgpr_write_b32 a124, v80
    v_accvgpr_write_b32 a125, v81
    v_mfma_f32_16x16x32_bf16 v[88:91], v[36:39], a[48:51], 0
    v_accvgpr_write_b32 a126, v82
    v_accvgpr_write_b32 a127, v83
    v_mfma_f32_16x16x32_bf16 v[88:91], v[32:35], v[216:219], v[88:91]
    s_add_u32 s56, s82, 131072
    v_lshl_add_u32 v249, v248, 4, v249
    v_mad_u32_u24 v106, v250, s91, v249
    v_mfma_f32_16x16x32_bf16 v[88:91], v[28:31], a[32:35], v[88:91]
    s_waitcnt lgkmcnt(4)
    v_subrev_u32 v106, 2048, v106
    v_add_u32 v248, 192, v0
    v_mfma_f32_16x16x32_bf16 v[88:91], v[16:19], v[232:235], v[88:91]
    s_waitcnt lgkmcnt(2)
    ds_read_b64_tr_b16 v[28:29], v11 offset:0
    v_mul_u32_u24 v249, 3641, v248
    v_mfma_f32_16x16x32_bf16 v[88:91], v[20:23], a[0:3], v[88:91]
    s_waitcnt lgkmcnt(1)
    ds_read_b64_tr_b16 v[30:31], v11 offset:2048
    v_lshrrev_b32 v249, 16, v249
    v_mfma_f32_16x16x32_bf16 v[88:91], v[24:27], a[16:19], v[88:91]
    buffer_load_dwordx4 v7, s[20:23], s60 offen  lds
    v_mfma_f32_16x16x32_bf16 v[92:95], v[24:27], a[20:23], v[92:95]
    s_add_u32 s60, s66, 640
    ds_read_b64_tr_b16 v[32:33], v11 offset:8192
    v_lshrrev_b32 v250, 4, v249
    v_mfma_f32_16x16x32_bf16 v[92:95], v[20:23], a[4:7], v[92:95]
    s_add_u32 m0, s55, 32768
    ds_read_b64_tr_b16 v[34:35], v11 offset:10240
    v_mul_u32_u24 v249, 864, v249
    v_mfma_f32_16x16x32_bf16 v[92:95], v[16:19], v[236:239], v[92:95]
    ds_read_b64_tr_b16 v[36:37], v11 offset:16384
    v_lshl_add_u32 v249, v248, 4, v249
    v_mfma_f32_16x16x32_bf16 v[96:99], v[16:19], v[240:243], v[96:99]
    ds_read_b64_tr_b16 v[38:39], v11 offset:18432
    v_mad_u32_u24 v107, v250, s91, v249
    v_mfma_f32_16x16x32_bf16 v[96:99], v[20:23], a[8:11], v[96:99]
    v_add_u32 v10, 4294930432, v10
    v_add_u32 v11, 4294930432, v11
    v_mfma_f32_16x16x32_bf16 v[96:99], v[24:27], a[24:27], v[96:99]
    v_add_u32 v12, 4294930432, v12
    v_add_u32 v13, 4294930432, v13
    v_mfma_f32_16x16x32_bf16 v[100:103], v[24:27], a[28:31], v[100:103]
    v_add_u32 v3, 4294930432, v3
    v_add_u32 v6, 4294930432, v6
    v_mfma_f32_16x16x32_bf16 v[100:103], v[20:23], a[12:15], v[100:103]
    buffer_load_dwordx4 v7, s[20:23], s60 offen  lds
    v_mfma_f32_16x16x32_bf16 v[100:103], v[16:19], v[244:247], v[100:103]
    s_waitcnt lgkmcnt(4)
    v_add_u32 v248, 256, v0
    v_mul_u32_u24 v249, 3641, v248
    v_mfma_f32_16x16x32_bf16 v[100:103], v[28:31], v[180:183], v[100:103]
    s_waitcnt lgkmcnt(2)
    v_lshrrev_b32 v249, 16, v249
    v_lshrrev_b32 v250, 4, v249
    v_mfma_f32_16x16x32_bf16 v[100:103], v[32:35], v[196:199], v[100:103]
    s_waitcnt vmcnt(11) lgkmcnt(0)
    s_barrier
    v_mfma_f32_16x16x32_bf16 v[100:103], v[36:39], v[212:215], v[100:103]
    s_add_u32 s60, s65, 768
    ds_read_b64_tr_b16 v[16:17], v10 offset:0
    v_mul_u32_u24 v249, 864, v249
    v_mfma_f32_16x16x32_bf16 v[96:99], v[36:39], v[208:211], v[96:99]
    s_add_u32 m0, s55, 36864
    ds_read_b64_tr_b16 v[18:19], v10 offset:2048
    v_lshl_add_u32 v249, v248, 4, v249
    v_mfma_f32_16x16x32_bf16 v[96:99], v[32:35], v[192:195], v[96:99]
    buffer_load_dwordx4 v7, s[20:23], s60 offen  lds
    v_mfma_f32_16x16x32_bf16 v[96:99], v[28:31], v[176:179], v[96:99]
    s_add_u32 s60, s65, 37632
    ds_read_b64_tr_b16 v[20:21], v10 offset:8192
    v_mad_u32_u24 v108, v250, s91, v249
    v_mfma_f32_16x16x32_bf16 v[92:95], v[28:31], v[172:175], v[92:95]
    s_add_u32 m0, s55, 40960
    ds_read_b64_tr_b16 v[22:23], v10 offset:10240
    v_subrev_u32 v108, 1024, v108
    v_mfma_f32_16x16x32_bf16 v[92:95], v[32:35], v[188:191], v[92:95]
    ds_read_b64_tr_b16 v[24:25], v10 offset:16384
    v_add_u32 v248, 320, v0
    v_mfma_f32_16x16x32_bf16 v[92:95], v[36:39], v[204:207], v[92:95]
    ds_read_b64_tr_b16 v[26:27], v10 offset:18432
    v_mul_u32_u24 v249, 3641, v248
    v_mfma_f32_16x16x32_bf16 v[88:91], v[36:39], v[200:203], v[88:91]
    buffer_store_dwordx4 v[136:139], v4, s[24:27], s56 offen sc1
    v_mfma_f32_16x16x32_bf16 v[88:91], v[32:35], v[184:187], v[88:91]
    buffer_load_dwordx4 v7, s[20:23], s60 offen  lds
    v_mfma_f32_16x16x32_bf16 v[88:91], v[28:31], v[168:171], v[88:91]
    s_waitcnt lgkmcnt(4)
    v_lshrrev_b32 v249, 16, v249
    v_lshrrev_b32 v250, 4, v249
    v_mfma_f32_16x16x32_bf16 v[136:139], v[16:19], v[168:171], 0
    s_waitcnt lgkmcnt(2)
    ds_read_b64_tr_b16 v[28:29], v3 offset:32768
    v_mul_u32_u24 v249, 864, v249
    v_mfma_f32_16x16x32_bf16 v[136:139], v[20:23], v[184:187], v[136:139]
    s_waitcnt lgkmcnt(1)
    ds_read_b64_tr_b16 v[30:31], v3 offset:34816
    v_cvt_pk_bf16_f32 v96, v96, v97
    v_mfma_f32_16x16x32_bf16 v[136:139], v[24:27], v[200:203], v[136:139]
    s_add_u32 s60, s65, 74496
    ds_read_b64_tr_b16 v[32:33], v12 offset:0
    v_cvt_pk_bf16_f32 v97, v98, v99
    v_mfma_f32_16x16x32_bf16 v[140:143], v[24:27], v[204:207], 0
    s_add_u32 m0, s55, 45056
    ds_read_b64_tr_b16 v[34:35], v12 offset:2048
    v_cvt_pk_bf16_f32 v98, v100, v101
    v_mfma_f32_16x16x32_bf16 v[140:143], v[20:23], v[188:191], v[140:143]
    buffer_load_dwordx4 v7, s[20:23], s60 offen  lds
    v_mfma_f32_16x16x32_bf16 v[140:143], v[16:19], v[172:175], v[140:143]
    s_add_u32 s56, s72, 147456
    ds_read_b64_tr_b16 v[36:37], v12 offset:8192
    v_cvt_pk_bf16_f32 v99, v102, v103
    v_mfma_f32_16x16x32_bf16 v[144:147], v[16:19], v[176:179], 0
    s_add_u32 s60, s65, 111360
    ds_read_b64_tr_b16 v[38:39], v12 offset:10240
    v_lshl_add_u32 v249, v248, 4, v249
    v_mfma_f32_16x16x32_bf16 v[144:147], v[20:23], v[192:195], v[144:147]
    s_add_u32 m0, s55, 49152
    v_cvt_pk_bf16_f32 v88, v88, v89
    v_cvt_pk_bf16_f32 v89, v90, v91
    v_mfma_f32_16x16x32_bf16 v[144:147], v[24:27], v[208:211], v[144:147]
    buffer_store_dwordx4 v[160:163], v4, s[24:27], s56 offen sc1
    v_mfma_f32_16x16x32_bf16 v[148:151], v[24:27], v[212:215], 0
    v_cvt_pk_bf16_f32 v90, v92, v93
    v_cvt_pk_bf16_f32 v91, v94, v95
    v_mfma_f32_16x16x32_bf16 v[148:151], v[20:23], v[196:199], v[148:151]
    v_mad_u32_u24 v109, v250, s91, v249
    v_subrev_u32 v109, 2048, v109
    v_mfma_f32_16x16x32_bf16 v[148:151], v[16:19], v[180:183], v[148:151]
    s_waitcnt lgkmcnt(4)
    v_add_u32 v248, 384, v0
    v_mul_u32_u24 v249, 3641, v248
    v_mfma_f32_16x16x32_bf16 v[148:151], v[28:31], v[244:247], v[148:151]
    s_waitcnt lgkmcnt(2)
    ds_read_b64_tr_b16 v[16:17], v12 offset:16384
    v_lshrrev_b32 v249, 16, v249
    v_mfma_f32_16x16x32_bf16 v[148:151], v[32:35], a[12:15], v[148:151]
    s_waitcnt lgkmcnt(1)
    ds_read_b64_tr_b16 v[18:19], v12 offset:18432
    v_lshrrev_b32 v250, 4, v249
    v_mfma_f32_16x16x32_bf16 v[148:151], v[36:39], a[28:31], v[148:151]
    buffer_load_dwordx4 v7, s[20:23], s60 offen  lds
    v_mfma_f32_16x16x32_bf16 v[144:147], v[36:39], a[24:27], v[144:147]
    s_add_u32 s60, s65, 148224
    ds_read_b64_tr_b16 v[20:21], v10 offset:24576
    v_mul_u32_u24 v249, 864, v249
    v_mfma_f32_16x16x32_bf16 v[144:147], v[32:35], a[8:11], v[144:147]
    s_add_u32 m0, s55, 53248
    ds_read_b64_tr_b16 v[22:23], v10 offset:26624
    v_lshl_add_u32 v249, v248, 4, v249
    v_mfma_f32_16x16x32_bf16 v[144:147], v[28:31], v[240:243], v[144:147]
    ds_read_b64_tr_b16 v[24:25], v12 offset:24576
    v_mad_u32_u24 v110, v250, s91, v249
    v_mfma_f32_16x16x32_bf16 v[140:143], v[28:31], v[236:239], v[140:143]
    ds_read_b64_tr_b16 v[26:27], v12 offset:26624
    v_add_u32 v248, 448, v0
    v_mfma_f32_16x16x32_bf16 v[140:143], v[32:35], a[4:7], v[140:143]
    buffer_load_dwordx4 v7, s[20:23], s60 offen  lds
    v_mfma_f32_16x16x32_bf16 v[140:143], v[36:39], a[20:23], v[140:143]
    s_add_u32 s60, s65, 185088
    v_mul_u32_u24 v249, 3641, v248
    v_lshrrev_b32 v249, 16, v249
    v_mfma_f32_16x16x32_bf16 v[136:139], v[36:39], a[16:19], v[136:139]
    s_add_u32 m0, s55, 57344
    v_lshrrev_b32 v250, 4, v249
    v_mul_u32_u24 v249, 864, v249
    v_mfma_f32_16x16x32_bf16 v[136:139], v[32:35], a[0:3], v[136:139]
    v_lshl_add_u32 v249, v248, 4, v249
    v_mad_u32_u24 v111, v250, s91, v249
    v_mfma_f32_16x16x32_bf16 v[136:139], v[28:31], v[232:235], v[136:139]
    s_waitcnt lgkmcnt(4)
    v_subrev_u32 v111, 1024, v111
    v_add_u32 v248, 512, v0
    v_mfma_f32_16x16x32_bf16 v[136:139], v[16:19], a[32:35], v[136:139]
    s_waitcnt lgkmcnt(2)
    ds_read_b64_tr_b16 v[28:29], v13 offset:16384
    v_mul_u32_u24 v249, 3641, v248
    v_mfma_f32_16x16x32_bf16 v[136:139], v[20:23], v[216:219], v[136:139]
    s_waitcnt lgkmcnt(1)
    ds_read_b64_tr_b16 v[30:31], v13 offset:18432
    v_lshrrev_b32 v249, 16, v249
    v_mfma_f32_16x16x32_bf16 v[136:139], v[24:27], a[48:51], v[136:139]
    buffer_load_dwordx4 v7, s[20:23], s60 offen  lds
    v_mfma_f32_16x16x32_bf16 v[140:143], v[24:27], a[52:55], v[140:143]
    ds_read_b64_tr_b16 v[32:33], v11 offset:24576
    v_lshrrev_b32 v250, 4, v249
    v_mfma_f32_16x16x32_bf16 v[140:143], v[20:23], v[220:223], v[140:143]
    s_add_u32 s60, s65, 221952
L_pg12:
    s_cbranch_execz L_tour_ret
    ds_read_b64_tr_b16 v[34:35], v11 offset:26624
    v_mul_u32_u24 v249, 864, v249
    v_mfma_f32_16x16x32_bf16 v[140:143], v[16:19], a[36:39], v[140:143]
    s_add_u32 m0, s55, 61440
    ds_read_b64_tr_b16 v[36:37], v13 offset:24576
    v_lshl_add_u32 v249, v248, 4, v249
    v_mfma_f32_16x16x32_bf16 v[144:147], v[16:19], a[40:43], v[144:147]
    s_add_u32 s56, s82, 196608
    ds_read_b64_tr_b16 v[38:39], v13 offset:26624
    v_mad_u32_u24 v112, v250, s91, v249
    v_mfma_f32_16x16x32_bf16 v[144:147], v[20:23], v[224:227], v[144:147]
    v_subrev_u32 v112, 2048, v112
    v_add_u32 v248, 0, v0
    v_mfma_f32_16x16x32_bf16 v[144:147], v[24:27], a[56:59], v[144:147]
    v_mul_u32_u24 v249, 3641, v248
    v_lshrrev_b32 v249, 16, v249
    v_mfma_f32_16x16x32_bf16 v[148:151], v[24:27], a[60:63], v[148:151]
    v_lshrrev_b32 v250, 1, v249
    v_mul_u32_u24 v249, 864, v249
    v_mfma_f32_16x16x32_bf16 v[148:151], v[20:23], v[228:231], v[148:151]
    buffer_load_dwordx4 v7, s[20:23], s60 offen  lds
    v_mfma_f32_16x16x32_bf16 v[148:151], v[16:19], a[44:47], v[148:151]
    s_waitcnt lgkmcnt(4)
    v_cvt_pk_bf16_f32 v136, v136, v137
    v_cvt_pk_bf16_f32 v137, v138, v139
    v_mfma_f32_16x16x32_bf16 v[164:167], v[28:31], a[44:47], 0
    s_waitcnt lgkmcnt(2)
    ds_read_b64_tr_b16 v[16:17], v6 offset:32768
    v_lshl_add_u32 v249, v248, 4, v249
    v_mfma_f32_16x16x32_bf16 v[164:167], v[32:35], v[228:231], v[164:167]
    s_waitcnt lgkmcnt(1)
    ds_read_b64_tr_b16 v[18:19], v6 offset:34816
    v_cvt_pk_bf16_f32 v138, v140, v141
    v_mfma_f32_16x16x32_bf16 v[164:167], v[36:39], a[60:63], v[164:167]
    s_add_u32 s60, s65, 258816
    ds_read_b64_tr_b16 v[20:21], v13 offset:0
    v_cvt_pk_bf16_f32 v139, v142, v143
    v_mfma_f32_16x16x32_bf16 v[160:163], v[36:39], a[56:59], 0
    s_add_u32 m0, s55, 65536
    ds_read_b64_tr_b16 v[22:23], v13 offset:2048
    v_mad_u32_u24 v113, v250, s90, v249
    v_mfma_f32_16x16x32_bf16 v[160:163], v[32:35], v[224:227], v[160:163]
    ds_read_b64_tr_b16 v[24:25], v13 offset:8192
    v_cvt_pk_bf16_f32 v144, v144, v145
    v_mfma_f32_16x16x32_bf16 v[160:163], v[28:31], a[40:43], v[160:163]
    buffer_load_dwordx4 v7, s[20:23], s60 offen  lds
    v_mfma_f32_16x16x32_bf16 v[156:159], v[28:31], a[36:39], 0
    s_add_u32 s60, s66, 768
    ds_read_b64_tr_b16 v[26:27], v13 offset:10240
    v_cvt_pk_bf16_f32 v145, v146, v147
    v_mfma_f32_16x16x32_bf16 v[156:159], v[32:35], v[220:223], v[156:159]
    buffer_store_dwordx4 v[72:75], v4, s[24:27], s56 offen sc1
    v_mfma_f32_16x16x32_bf16 v[156:159], v[36:39], a[52:55], v[156:159]
    s_add_u32 m0, s55, 69632
    v_cvt_pk_bf16_f32 v146, v148, v149
    v_cvt_pk_bf16_f32 v147, v150, v151
    v_mfma_f32_16x16x32_bf16 v[152:155], v[36:39], a[48:51], 0
    v_accvgpr_write_b32 a128, v144
    v_accvgpr_write_b32 a129, v145
    v_mfma_f32_16x16x32_bf16 v[152:155], v[32:35], v[216:219], v[152:155]
    v_accvgpr_write_b32 a130, v146
    v_accvgpr_write_b32 a131, v147
    v_mfma_f32_16x16x32_bf16 v[152:155], v[28:31], a[32:35], v[152:155]
    s_waitcnt lgkmcnt(4)
    v_add_u32 v248, 64, v0
    v_mul_u32_u24 v249, 3641, v248
    v_mfma_f32_16x16x32_bf16 v[152:155], v[16:19], v[232:235], v[152:155]
    s_waitcnt lgkmcnt(2)
    ds_read_b64_tr_b16 v[28:29], v11 offset:0
    v_lshrrev_b32 v249, 16, v249
    v_mfma_f32_16x16x32_bf16 v[152:155], v[20:23], a[0:3], v[152:155]
    s_waitcnt lgkmcnt(1)
    ds_read_b64_tr_b16 v[30:31], v11 offset:2048
    v_lshrrev_b32 v250, 1, v249
    v_mfma_f32_16x16x32_bf16 v[152:155], v[24:27], a[16:19], v[152:155]
    buffer_load_dwordx4 v7, s[20:23], s60 offen  lds
    v_mfma_f32_16x16x32_bf16 v[156:159], v[24:27], a[20:23], v[156:159]
    s_add_u32 s60, s65, 896
    ds_read_b64_tr_b16 v[32:33], v11 offset:8192
    v_mul_u32_u24 v249, 864, v249
    v_mfma_f32_16x16x32_bf16 v[156:159], v[20:23], a[4:7], v[156:159]
    s_add_u32 m0, s55, 110592
    ds_read_b64_tr_b16 v[34:35], v11 offset:10240
    v_lshl_add_u32 v249, v248, 4, v249
    v_mfma_f32_16x16x32_bf16 v[156:159], v[16:19], v[236:239], v[156:159]
    ds_read_b64_tr_b16 v[36:37], v11 offset:16384
    v_mad_u32_u24 v114, v250, s90, v249
    v_mfma_f32_16x16x32_bf16 v[160:163], v[16:19], v[240:243], v[160:163]
    ds_read_b64_tr_b16 v[38:39], v11 offset:18432
    v_subrev_u32 v114, 1024, v114
    v_mfma_f32_16x16x32_bf16 v[160:163], v[20:23], a[8:11], v[160:163]
    v_add_u32 v10, 4294893568, v10
    v_add_u32 v11, 4294893568, v11
    v_mfma_f32_16x16x32_bf16 v[160:163], v[24:27], a[24:27], v[160:163]
    v_add_u32 v12, 4294893568, v12
    v_add_u32 v13, 4294893568, v13
    v_mfma_f32_16x16x32_bf16 v[164:167], v[24:27], a[28:31], v[164:167]
    v_add_u32 v3, 4294893568, v3
    v_add_u32 v6, 4294893568, v6
    v_mfma_f32_16x16x32_bf16 v[164:167], v[20:23], a[12:15], v[164:167]
    buffer_load_dwordx4 v7, s[20:23], s60 offen  lds
    v_mfma_f32_16x16x32_bf16 v[164:167], v[16:19], v[244:247], v[164:167]
    s_waitcnt lgkmcnt(4)
    v_add_u32 v248, 128, v0
    v_mul_u32_u24 v249, 3641, v248
    v_mfma_f32_16x16x32_bf16 v[164:167], v[28:31], v[180:183], v[164:167]
    s_waitcnt lgkmcnt(2)
    v_lshrrev_b32 v249, 16, v249
    v_lshrrev_b32 v250, 1, v249
    v_mfma_f32_16x16x32_bf16 v[164:167], v[32:35], v[196:199], v[164:167]
    s_waitcnt vmcnt(13) lgkmcnt(0)
    s_barrier
    v_mfma_f32_16x16x32_bf16 v[164:167], v[36:39], v[212:215], v[164:167]
    s_add_u32 s60, s65, 37760
    ds_read_b64_tr_b16 v[16:17], v10 offset:0
    v_mul_u32_u24 v249, 864, v249
    v_mfma_f32_16x16x32_bf16 v[160:163], v[36:39], v[208:211], v[160:163]
    s_add_u32 m0, s55, 114688
    ds_read_b64_tr_b16 v[18:19], v10 offset:2048
    v_lshl_add_u32 v249, v248, 4, v249
    v_mfma_f32_16x16x32_bf16 v[160:163], v[32:35], v[192:195], v[160:163]
    buffer_load_dwordx4 v7, s[20:23], s60 offen  lds
    v_mfma_f32_16x16x32_bf16 v[160:163], v[28:31], v[176:179], v[160:163]
    s_add_u32 s60, s65, 74624
    ds_read_b64_tr_b16 v[20:21], v10 offset:8192
    v_mad_u32_u24 v115, v250, s90, v249
    v_mfma_f32_16x16x32_bf16 v[156:159], v[28:31], v[172:175], v[156:159]
    s_add_u32 m0, s55, 118784
    ds_read_b64_tr_b16 v[22:23], v10 offset:10240
    v_subrev_u32 v115, 2048, v115
    v_mfma_f32_16x16x32_bf16 v[156:159], v[32:35], v[188:191], v[156:159]
    s_add_u32 s56, s72, 212992
    ds_read_b64_tr_b16 v[24:25], v10 offset:16384
    v_add_u32 v248, 192, v0
    v_mfma_f32_16x16x32_bf16 v[156:159], v[36:39], v[204:207], v[156:159]
    ds_read_b64_tr_b16 v[26:27], v10 offset:18432
    v_mul_u32_u24 v249, 3641, v248
    v_mfma_f32_16x16x32_bf16 v[152:155], v[36:39], v[200:203], v[152:155]
    buffer_store_dwordx4 v[96:99], v4, s[24:27], s56 offen sc1
    v_mfma_f32_16x16x32_bf16 v[152:155], v[32:35], v[184:187], v[152:155]
    buffer_load_dwordx4 v7, s[20:23], s60 offen  lds
    v_mfma_f32_16x16x32_bf16 v[152:155], v[28:31], v[168:171], v[152:155]
    s_waitcnt lgkmcnt(4)
    v_lshrrev_b32 v249, 16, v249
    v_lshrrev_b32 v250, 1, v249
    v_mfma_f32_16x16x32_bf16 v[72:75], v[16:19], v[168:171], 0
    s_waitcnt lgkmcnt(2)
    ds_read_b64_tr_b16 v[28:29], v3 offset:32768
    v_mul_u32_u24 v249, 864, v249
    v_mfma_f32_16x16x32_bf16 v[72:75], v[20:23], v[184:187], v[72:75]
    s_waitcnt lgkmcnt(1)
    ds_read_b64_tr_b16 v[30:31], v3 offset:34816
    v_cvt_pk_bf16_f32 v160, v160, v161
    v_mfma_f32_16x16x32_bf16 v[72:75], v[24:27], v[200:203], v[72:75]
    s_add_u32 s60, s65, 111488
    ds_read_b64_tr_b16 v[32:33], v12 offset:0
    v_cvt_pk_bf16_f32 v161, v162, v163
    v_mfma_f32_16x16x32_bf16 v[76:79], v[24:27], v[204:207], 0
    s_add_u32 m0, s55, 122880
    ds_read_b64_tr_b16 v[34:35], v12 offset:2048
    v_cvt_pk_bf16_f32 v162, v164, v165
    v_mfma_f32_16x16x32_bf16 v[76:79], v[20:23], v[188:191], v[76:79]
    ds_read_b64_tr_b16 v[36:37], v12 offset:8192
    v_cvt_pk_bf16_f32 v163, v166, v167
    v_mfma_f32_16x16x32_bf16 v[76:79], v[16:19], v[172:175], v[76:79]
    buffer_load_dwordx4 v7, s[20:23], s60 offen  lds
    v_mfma_f32_16x16x32_bf16 v[80:83], v[16:19], v[176:179], 0
    ds_read_b64_tr_b16 v[38:39], v12 offset:10240
    v_lshl_add_u32 v249, v248, 4, v249
    v_mfma_f32_16x16x32_bf16 v[80:83], v[20:23], v[192:195], v[80:83]
    s_add_u32 s60, s65, 148352
    v_cvt_pk_bf16_f32 v152, v152, v153
    v_cvt_pk_bf16_f32 v153, v154, v155
    v_mfma_f32_16x16x32_bf16 v[80:83], v[24:27], v[208:211], v[80:83]
    s_add_u32 m0, s55, 126976
    v_cvt_pk_bf16_f32 v154, v156, v157
    v_cvt_pk_bf16_f32 v155, v158, v159
    v_mfma_f32_16x16x32_bf16 v[84:87], v[24:27], v[212:215], 0
    v_accvgpr_write_b32 a132, v152
    v_accvgpr_write_b32 a133, v153
    v_mfma_f32_16x16x32_bf16 v[84:87], v[20:23], v[196:199], v[84:87]
    v_accvgpr_write_b32 a134, v154
    v_accvgpr_write_b32 a135, v155
    v_mfma_f32_16x16x32_bf16 v[84:87], v[16:19], v[180:183], v[84:87]
    s_waitcnt lgkmcnt(4)
    v_mad_u32_u24 v116, v250, s90, v249
    v_subrev_u32 v116, 3072, v116
    v_mfma_f32_16x16x32_bf16 v[84:87], v[28:31], v[244:247], v[84:87]
    s_waitcnt lgkmcnt(2)
    ds_read_b64_tr_b16 v[16:17], v12 offset:16384
    v_add_u32 v248, 224, v0
    v_mfma_f32_16x16x32_bf16 v[84:87], v[32:35], a[12:15], v[84:87]
    s_waitcnt lgkmcnt(1)
    ds_read_b64_tr_b16 v[18:19], v12 offset:18432
    v_mul_u32_u24 v249, 3641, v248
    v_mfma_f32_16x16x32_bf16 v[84:87], v[36:39], a[28:31], v[84:87]
    buffer_load_dwordx4 v7, s[20:23], s60 offen  lds
    v_mfma_f32_16x16x32_bf16 v[80:83], v[36:39], a[24:27], v[80:83]
    s_add_u32 s60, s65, 185216
    ds_read_b64_tr_b16 v[20:21], v10 offset:24576
    v_lshrrev_b32 v249, 16, v249
    v_mfma_f32_16x16x32_bf16 v[80:83], v[32:35], a[8:11], v[80:83]
    s_add_u32 m0, s55, 131072
    ds_read_b64_tr_b16 v[22:23], v10 offset:26624
    v_lshrrev_b32 v250, 1, v249
    v_mfma_f32_16x16x32_bf16 v[80:83], v[28:31], v[240:243], v[80:83]
    s_add_u32 s56, s82, 212992
    ds_read_b64_tr_b16 v[24:25], v12 offset:24576
    v_mul_u32_u24 v249, 864, v249
    v_mfma_f32_16x16x32_bf16 v[76:79], v[28:31], v[236:239], v[76:79]
    ds_read_b64_tr_b16 v[26:27], v12 offset:26624
    v_lshl_add_u32 v249, v248, 4, v249
    v_mfma_f32_16x16x32_bf16 v[76:79], v[32:35], a[4:7], v[76:79]
    v_mad_u32_u24 v117, v250, s90, v249
    v_subrev_u32 v117, 3584, v117
    v_mfma_f32_16x16x32_bf16 v[76:79], v[36:39], a[20:23], v[76:79]
    buffer_load_dwordx4 v7, s[20:23], s60 offen  lds
    v_mfma_f32_16x16x32_bf16 v[72:75], v[36:39], a[16:19], v[72:75]
    buffer_store_dwordx4 v[88:91], v4, s[24:27], s56 offen sc1
    v_mfma_f32_16x16x32_bf16 v[72:75], v[32:35], a[0:3], v[72:75]
    s_add_u32 s60, s65, 222080
    v_bfe_u32 v248, v0, 2, 2
    v_lshrrev_b32 v249, 4, v0
    v_mfma_f32_16x16x32_bf16 v[72:75], v[28:31], v[232:235], v[72:75]
    s_waitcnt lgkmcnt(4)
    v_cmp_eq_u32 vcc, v248, v249
    v_and_b32 v250, 1, v0
    v_mfma_f32_16x16x32_bf16 v[72:75], v[16:19], a[32:35], v[72:75]
    s_waitcnt lgkmcnt(2)
    ds_read_b64_tr_b16 v[28:29], v13 offset:16384
    v_lshlrev_b32 v250, 4, v250
    v_mfma_f32_16x16x32_bf16 v[72:75], v[20:23], v[216:219], v[72:75]
    s_waitcnt lgkmcnt(1)
    ds_read_b64_tr_b16 v[30:31], v13 offset:18432
    v_mov_b32 v251, 0x3f80
    v_mfma_f32_16x16x32_bf16 v[72:75], v[24:27], a[48:51], v[72:75]
    s_add_u32 m0, s55, 135168
    ds_read_b64_tr_b16 v[32:33], v11 offset:24576
    v_lshlrev_b32 v250, v250, v251
    v_mfma_f32_16x16x32_bf16 v[76:79], v[24:27], a[52:55], v[76:79]
    buffer_load_dwordx4 v7, s[20:23], s60 offen  lds
    v_mfma_f32_16x16x32_bf16 v[76:79], v[20:23], v[220:223], v[76:79]
    ds_read_b64_tr_b16 v[34:35], v11 offset:26624
    v_cndmask_b32 v250, 0, v250, vcc
    v_mfma_f32_16x16x32_bf16 v[76:79], v[16:19], a[36:39], v[76:79]
    s_add_u32 s60, s65, 258944
    ds_read_b64_tr_b16 v[36:37], v13 offset:24576
    v_and_b32 v251, 2, v0
    v_mfma_f32_16x16x32_bf16 v[80:83], v[16:19], a[40:43], v[80:83]
    s_add_u32 m0, s55, 139264
    ds_read_b64_tr_b16 v[38:39], v13 offset:26624
    v_cmp_eq_u32 vcc, 0, v251
    v_mfma_f32_16x16x32_bf16 v[80:83], v[20:23], v[224:227], v[80:83]
    v_lshrrev_b32 v252, 2, v0
    v_lshrrev_b32 v251, 5, v0
    v_mfma_f32_16x16x32_bf16 v[80:83], v[24:27], a[56:59], v[80:83]
    v_cndmask_b32 v128, 0, v250, vcc
    v_cndmask_b32 v129, v250, 0, vcc
    v_mfma_f32_16x16x32_bf16 v[84:87], v[24:27], a[60:63], v[84:87]
    v_lshl_add_u32 v251, v251, 3, v252
    v_and_b32 v248, 3, v0
    v_mfma_f32_16x16x32_bf16 v[84:87], v[20:23], v[228:231], v[84:87]
    v_cvt_pk_bf16_f32 v72, v72, v73
    v_cvt_pk_bf16_f32 v73, v74, v75
    v_mfma_f32_16x16x32_bf16 v[84:87], v[16:19], a[44:47], v[84:87]
    s_waitcnt lgkmcnt(4)
    v_lshlrev_b32 v248, 3, v248
    v_mul_u32_u24 v251, 288, v251
    v_mfma_f32_16x16x32_bf16 v[100:103], v[28:31], a[44:47], 0
    s_waitcnt lgkmcnt(2)
    ds_read_b64_tr_b16 v[16:17], v6 offset:32768
    v_add3_u32 v130, v251, v248, s76
    v_mfma_f32_16x16x32_bf16 v[100:103], v[32:35], v[228:231], v[100:103]
    s_waitcnt lgkmcnt(1)
    ds_read_b64_tr_b16 v[18:19], v6 offset:34816
    v_cvt_pk_bf16_f32 v74, v76, v77
    v_mfma_f32_16x16x32_bf16 v[100:103], v[36:39], a[60:63], v[100:103]
    buffer_load_dwordx4 v7, s[20:23], s60 offen  lds
    v_mfma_f32_16x16x32_bf16 v[96:99], v[36:39], a[56:59], 0
    s_add_u32 s60, s66, 896
    ds_read_b64_tr_b16 v[20:21], v13 offset:0
    v_cvt_pk_bf16_f32 v75, v78, v79
    v_mfma_f32_16x16x32_bf16 v[96:99], v[32:35], v[224:227], v[96:99]
    s_add_u32 m0, s55, 143360
    ds_read_b64_tr_b16 v[22:23], v13 offset:2048
    v_cvt_pk_bf16_f32 v80, v80, v81
    v_mfma_f32_16x16x32_bf16 v[96:99], v[28:31], a[40:43], v[96:99]
    ds_read_b64_tr_b16 v[24:25], v13 offset:8192
    v_cvt_pk_bf16_f32 v81, v82, v83
    v_mfma_f32_16x16x32_bf16 v[92:95], v[28:31], a[36:39], 0
    buffer_load_dwordx4 v7, s[20:23], s60 offen  lds
    v_mfma_f32_16x16x32_bf16 v[92:95], v[32:35], v[220:223], v[92:95]
    s_add_u32 s60, s65, 1024
    ds_read_b64_tr_b16 v[26:27], v13 offset:10240
    v_cvt_pk_bf16_f32 v82, v84, v85
    v_mfma_f32_16x16x32_bf16 v[92:95], v[36:39], a[52:55], v[92:95]
    s_add_u32 m0, s55, 73728
    v_cvt_pk_bf16_f32 v83, v86, v87
    v_mul_u32_u24 v252, 288, v252
    v_mfma_f32_16x16x32_bf16 v[88:91], v[36:39], a[48:51], 0
    s_add_u32 s56, s82, 262144
    v_add3_u32 v131, v252, v248, s77
    v_add_u32 v131, 110592, v131
    v_mfma_f32_16x16x32_bf16 v[88:91], v[32:35], v[216:219], v[88:91]
    v_and_b32 v248, 15, v0
    v_mul_u32_u24 v250, 288, v248
    v_mfma_f32_16x16x32_bf16 v[88:91], v[28:31], a[32:35], v[88:91]
    s_waitcnt lgkmcnt(4)
    v_lshrrev_b32 v251, 5, v0
    v_lshl_add_u32 v250, v251, 4, v250
    v_mfma_f32_16x16x32_bf16 v[88:91], v[16:19], v[232:235], v[88:91]
    s_waitcnt lgkmcnt(2)
    ds_read_b64_tr_b16 v[28:29], v11 offset:0
    v_and_b32 v251, 1, v249
    v_mfma_f32_16x16x32_bf16 v[88:91], v[20:23], a[0:3], v[88:91]
    s_waitcnt lgkmcnt(1)
    ds_read_b64_tr_b16 v[30:31], v11 offset:2048
    v_mul_u32_u24 v251, 9856, v251
    v_mfma_f32_16x16x32_bf16 v[88:91], v[24:27], a[16:19], v[88:91]
    buffer_load_dwordx4 v7, s[20:23], s60 offen  lds
    v_mfma_f32_16x16x32_bf16 v[92:95], v[24:27], a[20:23], v[92:95]
    s_add_u32 s60, s65, 37888
    ds_read_b64_tr_b16 v[32:33], v11 offset:8192
    v_add3_u32 v132, v251, v250, s76
    v_mfma_f32_16x16x32_bf16 v[92:95], v[20:23], a[4:7], v[92:95]
    s_add_u32 m0, s55, 77824
    ds_read_b64_tr_b16 v[34:35], v11 offset:10240
    v_lshlrev_b32 v248, 2, v248
    v_mfma_f32_16x16x32_bf16 v[92:95], v[16:19], v[236:239], v[92:95]
    ds_read_b64_tr_b16 v[36:37], v11 offset:16384
    v_lshl_add_u32 v133, v249, 10, v248
    v_mfma_f32_16x16x32_bf16 v[96:99], v[16:19], v[240:243], v[96:99]
    ds_read_b64_tr_b16 v[38:39], v11 offset:18432
    v_add_u32 v248, s88, v0
    v_mfma_f32_16x16x32_bf16 v[96:99], v[20:23], a[8:11], v[96:99]
    v_add_u32 v10, 36864, v10
    v_add_u32 v11, 36864, v11
    v_mfma_f32_16x16x32_bf16 v[96:99], v[24:27], a[24:27], v[96:99]
    v_add_u32 v12, 36864, v12
    v_add_u32 v13, 36864, v13
    v_mfma_f32_16x16x32_bf16 v[100:103], v[24:27], a[28:31], v[100:103]
    v_add_u32 v3, 36864, v3
    v_add_u32 v6, 36864, v6
    v_mfma_f32_16x16x32_bf16 v[100:103], v[20:23], a[12:15], v[100:103]
    buffer_load_dwordx4 v7, s[20:23], s60 offen  lds
    v_mfma_f32_16x16x32_bf16 v[100:103], v[16:19], v[244:247], v[100:103]
    s_waitcnt lgkmcnt(4)
    v_mul_u32_u24 v249, 3641, v248
    v_lshrrev_b32 v249, 16, v249
    v_mfma_f32_16x16x32_bf16 v[100:103], v[28:31], v[180:183], v[100:103]
    s_waitcnt lgkmcnt(2)
    v_add_lshl_u32 v122, v248, 0, 4
    v_mul_u32_u24 v250, 864, v249
    v_mfma_f32_16x16x32_bf16 v[100:103], v[32:35], v[196:199], v[100:103]
    s_waitcnt vmcnt(13) lgkmcnt(0)
    s_barrier
    v_mfma_f32_16x16x32_bf16 v[100:103], v[36:39], v[212:215], v[100:103]
    s_add_u32 s60, s65, 74752
    ds_read_b64_tr_b16 v[16:17], v10 offset:0
    v_lshl_add_u32 v125, v248, 4, v250
    v_mfma_f32_16x16x32_bf16 v[96:99], v[36:39], v[208:211], v[96:99]
    s_add_u32 m0, s55, 81920
    ds_read_b64_tr_b16 v[18:19], v10 offset:2048
    v_add_u32 v248, 64, v248
    v_mfma_f32_16x16x32_bf16 v[96:99], v[32:35], v[192:195], v[96:99]
    buffer_load_dwordx4 v7, s[20:23], s60 offen  lds
    v_mfma_f32_16x16x32_bf16 v[96:99], v[28:31], v[176:179], v[96:99]
    s_add_u32 s60, s65, 111616
    ds_read_b64_tr_b16 v[20:21], v10 offset:8192
    v_mul_u32_u24 v249, 3641, v248
    v_mfma_f32_16x16x32_bf16 v[92:95], v[28:31], v[172:175], v[92:95]
    s_add_u32 m0, s55, 86016
    ds_read_b64_tr_b16 v[22:23], v10 offset:10240
    v_lshrrev_b32 v249, 16, v249
    v_mfma_f32_16x16x32_bf16 v[92:95], v[32:35], v[188:191], v[92:95]
    ds_read_b64_tr_b16 v[24:25], v10 offset:16384
    v_add_lshl_u32 v123, v248, 0, 4
    v_mfma_f32_16x16x32_bf16 v[92:95], v[36:39], v[204:207], v[92:95]
    ds_read_b64_tr_b16 v[26:27], v10 offset:18432
    v_mul_u32_u24 v250, 864, v249
    v_mfma_f32_16x16x32_bf16 v[88:91], v[36:39], v[200:203], v[88:91]
    buffer_store_dwordx4 v[136:139], v4, s[24:27], s56 offen sc1
    v_mfma_f32_16x16x32_bf16 v[88:91], v[32:35], v[184:187], v[88:91]
    s_add_u32 s56, s72, 278528
    v_lshl_add_u32 v126, v248, 4, v250
    v_add_u32 v248, 64, v248
    v_mfma_f32_16x16x32_bf16 v[88:91], v[28:31], v[168:171], v[88:91]
    s_waitcnt lgkmcnt(4)
    v_mul_u32_u24 v249, 3641, v248
    v_lshrrev_b32 v249, 16, v249
    v_mfma_f32_16x16x32_bf16 v[136:139], v[16:19], v[168:171], 0
    s_waitcnt lgkmcnt(2)
    ds_read_b64_tr_b16 v[28:29], v3 offset:32768
    v_add_lshl_u32 v124, v248, 0, 4
    v_mfma_f32_16x16x32_bf16 v[136:139], v[20:23], v[184:187], v[136:139]
    s_waitcnt lgkmcnt(1)
    ds_read_b64_tr_b16 v[30:31], v3 offset:34816
    v_cvt_pk_bf16_f32 v96, v96, v97
    v_mfma_f32_16x16x32_bf16 v[136:139], v[24:27], v[200:203], v[136:139]
    buffer_load_dwordx4 v7, s[20:23], s60 offen  lds
    v_mfma_f32_16x16x32_bf16 v[140:143], v[24:27], v[204:207], 0
    s_add_u32 s60, s65, 148480
    ds_read_b64_tr_b16 v[32:33], v12 offset:0
    v_cvt_pk_bf16_f32 v97, v98, v99
    v_mfma_f32_16x16x32_bf16 v[140:143], v[20:23], v[188:191], v[140:143]
    s_add_u32 m0, s55, 90112
    ds_read_b64_tr_b16 v[34:35], v12 offset:2048
    v_cvt_pk_bf16_f32 v98, v100, v101
    v_mfma_f32_16x16x32_bf16 v[140:143], v[16:19], v[172:175], v[140:143]
    ds_read_b64_tr_b16 v[36:37], v12 offset:8192
    v_cvt_pk_bf16_f32 v99, v102, v103
    v_mfma_f32_16x16x32_bf16 v[144:147], v[16:19], v[176:179], 0
    buffer_load_dwordx4 v7, s[20:23], s60 offen  lds
    v_mfma_f32_16x16x32_bf16 v[144:147], v[20:23], v[192:195], v[144:147]
    ds_read_b64_tr_b16 v[38:39], v12 offset:10240
    v_cvt_pk_bf16_f32 v88, v88, v89
    v_mfma_f32_16x16x32_bf16 v[144:147], v[24:27], v[208:211], v[144:147]
    buffer_store_dwordx4 v[160:163], v4, s[24:27], s56 offen sc1
    v_mfma_f32_16x16x32_bf16 v[148:151], v[24:27], v[212:215], 0
    s_add_u32 s60, s65, 185344
    v_cvt_pk_bf16_f32 v89, v90, v91
    v_cvt_pk_bf16_f32 v90, v92, v93
    v_mfma_f32_16x16x32_bf16 v[148:151], v[20:23], v[196:199], v[148:151]
    s_add_u32 m0, s55, 94208
    v_cvt_pk_bf16_f32 v91, v94, v95
    v_accvgpr_write_b32 a136, v88
    v_mfma_f32_16x16x32_bf16 v[148:151], v[16:19], v[180:183], v[148:151]
    s_waitcnt lgkmcnt(4)
    v_accvgpr_write_b32 a137, v89
    v_accvgpr_write_b32 a138, v90
    v_mfma_f32_16x16x32_bf16 v[148:151], v[28:31], v[244:247], v[148:151]
    s_waitcnt lgkmcnt(2)
    ds_read_b64_tr_b16 v[16:17], v12 offset:16384
    v_accvgpr_write_b32 a139, v91
    v_mfma_f32_16x16x32_bf16 v[148:151], v[32:35], a[12:15], v[148:151]
    s_waitcnt lgkmcnt(1)
    ds_read_b64_tr_b16 v[18:19], v12 offset:18432
    v_mul_u32_u24 v250, 864, v249
    v_mfma_f32_16x16x32_bf16 v[148:151], v[36:39], a[28:31], v[148:151]
    buffer_load_dwordx4 v7, s[20:23], s60 offen  lds
    v_mfma_f32_16x16x32_bf16 v[144:147], v[36:39], a[24:27], v[144:147]
    s_add_u32 s60, s65, 222208
    ds_read_b64_tr_b16 v[20:21], v10 offset:24576
    v_lshl_add_u32 v127, v248, 4, v250
    v_mfma_f32_16x16x32_bf16 v[144:147], v[32:35], a[8:11], v[144:147]
    s_add_u32 m0, s55, 98304
    ds_read_b64_tr_b16 v[22:23], v10 offset:26624
    v_cmp_lt_u32 vcc, 15, v0
    v_mfma_f32_16x16x32_bf16 v[144:147], v[28:31], v[240:243], v[144:147]
    ds_read_b64_tr_b16 v[24:25], v12 offset:24576
    v_mov_b32 v249, 0x7fff0000
    v_mfma_f32_16x16x32_bf16 v[140:143], v[28:31], v[236:239], v[140:143]
    ds_read_b64_tr_b16 v[26:27], v12 offset:26624
    v_cndmask_b32 v127, v127, v249, vcc
    v_mfma_f32_16x16x32_bf16 v[140:143], v[32:35], a[4:7], v[140:143]
    v_mfma_f32_16x16x32_bf16 v[140:143], v[36:39], a[20:23], v[140:143]
    v_mfma_f32_16x16x32_bf16 v[136:139], v[36:39], a[16:19], v[136:139]
    buffer_load_dwordx4 v7, s[20:23], s60 offen  lds
    v_mfma_f32_16x16x32_bf16 v[136:139], v[32:35], a[0:3], v[136:139]
    s_add_u32 s60, s65, 259072
    v_mfma_f32_16x16x32_bf16 v[136:139], v[28:31], v[232:235], v[136:139]
    s_waitcnt lgkmcnt(4)
    v_mfma_f32_16x16x32_bf16 v[136:139], v[16:19], a[32:35], v[136:139]
    s_waitcnt lgkmcnt(2)
    ds_read_b64_tr_b16 v[28:29], v13 offset:16384
    v_mfma_f32_16x16x32_bf16 v[136:139], v[20:23], v[216:219], v[136:139]
    s_waitcnt lgkmcnt(1)
    ds_read_b64_tr_b16 v[30:31], v13 offset:18432
    v_mfma_f32_16x16x32_bf16 v[136:139], v[24:27], a[48:51], v[136:139]
    s_add_u32 m0, s55, 102400
    ds_read_b64_tr_b16 v[32:33], v11 offset:24576
    v_mfma_f32_16x16x32_bf16 v[140:143], v[24:27], a[52:55], v[140:143]
    s_add_u32 s56, s82, 327680
    ds_read_b64_tr_b16 v[34:35], v11 offset:26624
    v_mfma_f32_16x16x32_bf16 v[140:143], v[20:23], v[220:223], v[140:143]
    buffer_load_dwordx4 v7, s[20:23], s60 offen  lds
    v_mfma_f32_16x16x32_bf16 v[140:143], v[16:19], a[36:39], v[140:143]
    ds_read_b64_tr_b16 v[36:37], v13 offset:24576
    v_mfma_f32_16x16x32_bf16 v[144:147], v[16:19], a[40:43], v[144:147]
    buffer_load_dword v70, v71, s[40:43], 0 offen sc1
    v_mfma_f32_16x16x32_bf16 v[144:147], v[20:23], v[224:227], v[144:147]
    s_add_u32 s60, s66, 1024
    ds_read_b64_tr_b16 v[38:39], v13 offset:26624
    v_mfma_f32_16x16x32_bf16 v[144:147], v[24:27], a[56:59], v[144:147]
    buffer_store_dwordx4 v[72:75], v4, s[24:27], s56 offen sc1
    v_mfma_f32_16x16x32_bf16 v[148:151], v[24:27], a[60:63], v[148:151]
    s_add_u32 m0, s55, 106496
    v_mfma_f32_16x16x32_bf16 v[148:151], v[20:23], v[228:231], v[148:151]
    v_cvt_pk_bf16_f32 v136, v136, v137
    v_cvt_pk_bf16_f32 v137, v138, v139
    v_mfma_f32_16x16x32_bf16 v[148:151], v[16:19], a[44:47], v[148:151]
    s_waitcnt lgkmcnt(4)
    v_mfma_f32_16x16x32_bf16 v[164:167], v[28:31], a[44:47], 0
    s_waitcnt lgkmcnt(2)
    ds_read_b64_tr_b16 v[16:17], v6 offset:32768
    v_mfma_f32_16x16x32_bf16 v[164:167], v[32:35], v[228:231], v[164:167]
    s_waitcnt lgkmcnt(1)
    ds_read_b64_tr_b16 v[18:19], v6 offset:34816
    v_cvt_pk_bf16_f32 v138, v140, v141
    v_mfma_f32_16x16x32_bf16 v[164:167], v[36:39], a[60:63], v[164:167]
    buffer_load_dwordx4 v7, s[20:23], s60 offen  lds
    v_mfma_f32_16x16x32_bf16 v[160:163], v[36:39], a[56:59], 0
    ds_read_b64_tr_b16 v[20:21], v13 offset:0
    v_cvt_pk_bf16_f32 v139, v142, v143
    v_mfma_f32_16x16x32_bf16 v[160:163], v[32:35], v[224:227], v[160:163]
    ds_read_b64_tr_b16 v[22:23], v13 offset:2048
    v_cvt_pk_bf16_f32 v144, v144, v145
    v_mfma_f32_16x16x32_bf16 v[160:163], v[28:31], a[40:43], v[160:163]
    ds_read_b64_tr_b16 v[24:25], v13 offset:8192
    v_cvt_pk_bf16_f32 v145, v146, v147
    v_mfma_f32_16x16x32_bf16 v[156:159], v[28:31], a[36:39], 0
    ds_read_b64_tr_b16 v[26:27], v13 offset:10240
    v_mfma_f32_16x16x32_bf16 v[156:159], v[32:35], v[220:223], v[156:159]
    v_cvt_pk_bf16_f32 v146, v148, v149
    v_cvt_pk_bf16_f32 v147, v150, v151
    v_mfma_f32_16x16x32_bf16 v[156:159], v[36:39], a[52:55], v[156:159]
    v_mfma_f32_16x16x32_bf16 v[152:155], v[36:39], a[48:51], 0
    v_mfma_f32_16x16x32_bf16 v[152:155], v[32:35], v[216:219], v[152:155]
    v_mfma_f32_16x16x32_bf16 v[152:155], v[28:31], a[32:35], v[152:155]
    s_waitcnt lgkmcnt(4)
    v_mfma_f32_16x16x32_bf16 v[152:155], v[16:19], v[232:235], v[152:155]
    s_waitcnt lgkmcnt(2)
    ds_read_b64_tr_b16 v[28:29], v11 offset:0
    v_mfma_f32_16x16x32_bf16 v[152:155], v[20:23], a[0:3], v[152:155]
    s_waitcnt lgkmcnt(1)
    ds_read_b64_tr_b16 v[30:31], v11 offset:2048
    v_mfma_f32_16x16x32_bf16 v[152:155], v[24:27], a[16:19], v[152:155]
    ds_read_b64_tr_b16 v[32:33], v11 offset:8192
    v_mfma_f32_16x16x32_bf16 v[156:159], v[24:27], a[20:23], v[156:159]
    ds_read_b64_tr_b16 v[34:35], v11 offset:10240
    v_mfma_f32_16x16x32_bf16 v[156:159], v[20:23], a[4:7], v[156:159]
    ds_read_b64_tr_b16 v[36:37], v11 offset:16384
    v_mfma_f32_16x16x32_bf16 v[156:159], v[16:19], v[236:239], v[156:159]
    ds_read_b64_tr_b16 v[38:39], v11 offset:18432
    v_mfma_f32_16x16x32_bf16 v[160:163], v[16:19], v[240:243], v[160:163]
    s_add_u32 s56, s72, 327680
    v_add_u32 v10, 73728, v10
    v_add_u32 v11, 73728, v11
    v_mfma_f32_16x16x32_bf16 v[160:163], v[20:23], a[8:11], v[160:163]
    v_add_u32 v12, 73728, v12
    v_add_u32 v13, 73728, v13
    v_mfma_f32_16x16x32_bf16 v[160:163], v[24:27], a[24:27], v[160:163]
    v_add_u32 v3, 73728, v3
    v_add_u32 v6, 73728, v6
    v_mfma_f32_16x16x32_bf16 v[164:167], v[24:27], a[28:31], v[164:167]
    v_mfma_f32_16x16x32_bf16 v[164:167], v[20:23], a[12:15], v[164:167]
    v_mfma_f32_16x16x32_bf16 v[164:167], v[16:19], v[244:247], v[164:167]
    s_waitcnt lgkmcnt(4)
    v_mfma_f32_16x16x32_bf16 v[164:167], v[28:31], v[180:183], v[164:167]
    s_waitcnt lgkmcnt(2)
    v_mfma_f32_16x16x32_bf16 v[164:167], v[32:35], v[196:199], v[164:167]
    s_waitcnt vmcnt(13) lgkmcnt(0)
    s_barrier
    v_mfma_f32_16x16x32_bf16 v[164:167], v[36:39], v[212:215], v[164:167]
L_pg13:
    s_cbranch_execz L_tour_ret
    ds_read_b64_tr_b16 v[16:17], v10 offset:0
    v_mfma_f32_16x16x32_bf16 v[160:163], v[36:39], v[208:211], v[160:163]
    ds_read_b64_tr_b16 v[18:19], v10 offset:2048
    v_mfma_f32_16x16x32_bf16 v[160:163], v[32:35], v[192:195], v[160:163]
    ds_read_b64_tr_b16 v[20:21], v10 offset:8192
    v_mfma_f32_16x16x32_bf16 v[160:163], v[28:31], v[176:179], v[160:163]
    ds_read_b64_tr_b16 v[22:23], v10 offset:10240
    v_mfma_f32_16x16x32_bf16 v[156:159], v[28:31], v[172:175], v[156:159]
    ds_read_b64_tr_b16 v[24:25], v10 offset:16384
    v_mfma_f32_16x16x32_bf16 v[156:159], v[32:35], v[188:191], v[156:159]
    ds_read_b64_tr_b16 v[26:27], v10 offset:18432
    v_mfma_f32_16x16x32_bf16 v[156:159], v[36:39], v[204:207], v[156:159]
    buffer_store_dwordx4 v[80:83], v4, s[24:27], s56 offen sc1
    v_mfma_f32_16x16x32_bf16 v[152:155], v[36:39], v[200:203], v[152:155]
    v_mfma_f32_16x16x32_bf16 v[152:155], v[32:35], v[184:187], v[152:155]
    v_mfma_f32_16x16x32_bf16 v[152:155], v[28:31], v[168:171], v[152:155]
    s_waitcnt lgkmcnt(4)
    v_mfma_f32_16x16x32_bf16 v[72:75], v[16:19], v[168:171], 0
    s_waitcnt lgkmcnt(2)
    ds_read_b64_tr_b16 v[28:29], v3 offset:32768
    v_mfma_f32_16x16x32_bf16 v[72:75], v[20:23], v[184:187], v[72:75]
    s_waitcnt lgkmcnt(1)
    ds_read_b64_tr_b16 v[30:31], v3 offset:34816
    v_cvt_pk_bf16_f32 v160, v160, v161
    v_mfma_f32_16x16x32_bf16 v[72:75], v[24:27], v[200:203], v[72:75]
    ds_read_b64_tr_b16 v[32:33], v12 offset:0
    v_cvt_pk_bf16_f32 v161, v162, v163
    v_mfma_f32_16x16x32_bf16 v[76:79], v[24:27], v[204:207], 0
    ds_read_b64_tr_b16 v[34:35], v12 offset:2048
    v_cvt_pk_bf16_f32 v162, v164, v165
    v_mfma_f32_16x16x32_bf16 v[76:79], v[20:23], v[188:191], v[76:79]
    ds_read_b64_tr_b16 v[36:37], v12 offset:8192
    v_cvt_pk_bf16_f32 v163, v166, v167
    v_mfma_f32_16x16x32_bf16 v[76:79], v[16:19], v[172:175], v[76:79]
    ds_read_b64_tr_b16 v[38:39], v12 offset:10240
    v_mfma_f32_16x16x32_bf16 v[80:83], v[16:19], v[176:179], 0
    s_add_u32 s56, s72, 344064
    v_mfma_f32_16x16x32_bf16 v[80:83], v[20:23], v[192:195], v[80:83]
    v_cvt_pk_bf16_f32 v152, v152, v153
    v_cvt_pk_bf16_f32 v153, v154, v155
    v_mfma_f32_16x16x32_bf16 v[80:83], v[24:27], v[208:211], v[80:83]
    v_cvt_pk_bf16_f32 v154, v156, v157
    v_cvt_pk_bf16_f32 v155, v158, v159
    v_mfma_f32_16x16x32_bf16 v[84:87], v[24:27], v[212:215], 0
    v_accvgpr_write_b32 a140, v152
    v_accvgpr_write_b32 a141, v153
    v_mfma_f32_16x16x32_bf16 v[84:87], v[20:23], v[196:199], v[84:87]
    v_accvgpr_write_b32 a142, v154
    v_accvgpr_write_b32 a143, v155
    v_mfma_f32_16x16x32_bf16 v[84:87], v[16:19], v[180:183], v[84:87]
    s_waitcnt lgkmcnt(4)
    v_mfma_f32_16x16x32_bf16 v[84:87], v[28:31], v[244:247], v[84:87]
    s_waitcnt lgkmcnt(2)
    ds_read_b64_tr_b16 v[16:17], v12 offset:16384
    v_mfma_f32_16x16x32_bf16 v[84:87], v[32:35], a[12:15], v[84:87]
    s_waitcnt lgkmcnt(1)
    ds_read_b64_tr_b16 v[18:19], v12 offset:18432
    v_mfma_f32_16x16x32_bf16 v[84:87], v[36:39], a[28:31], v[84:87]
    ds_read_b64_tr_b16 v[20:21], v10 offset:24576
    v_mfma_f32_16x16x32_bf16 v[80:83], v[36:39], a[24:27], v[80:83]
    ds_read_b64_tr_b16 v[22:23], v10 offset:26624
    v_mfma_f32_16x16x32_bf16 v[80:83], v[32:35], a[8:11], v[80:83]
    ds_read_b64_tr_b16 v[24:25], v12 offset:24576
    v_mfma_f32_16x16x32_bf16 v[80:83], v[28:31], v[240:243], v[80:83]
    ds_read_b64_tr_b16 v[26:27], v12 offset:26624
    v_mfma_f32_16x16x32_bf16 v[76:79], v[28:31], v[236:239], v[76:79]
    buffer_store_dwordx4 v[96:99], v4, s[24:27], s56 offen sc1
    v_mfma_f32_16x16x32_bf16 v[76:79], v[32:35], a[4:7], v[76:79]
    v_mfma_f32_16x16x32_bf16 v[76:79], v[36:39], a[20:23], v[76:79]
    s_waitcnt vmcnt(4)
    v_cmp_le_u32 s[86:87], 64, v70
    s_nop 0
    s_cmp_eq_u32 s86, 15
    s_cbranch_scc0 L_spinA
L_backA:
    v_mfma_f32_16x16x32_bf16 v[72:75], v[36:39], a[16:19], v[72:75]
    buffer_load_dwordx2 v[56:57], v65, s[24:27], s73 offen sc1
    v_mfma_f32_16x16x32_bf16 v[72:75], v[32:35], a[0:3], v[72:75]
    v_mfma_f32_16x16x32_bf16 v[72:75], v[28:31], v[232:235], v[72:75]
    s_waitcnt lgkmcnt(4)
    v_mfma_f32_16x16x32_bf16 v[72:75], v[16:19], a[32:35], v[72:75]
    s_waitcnt lgkmcnt(2)
    ds_read_b64_tr_b16 v[28:29], v13 offset:16384
    v_mfma_f32_16x16x32_bf16 v[72:75], v[20:23], v[216:219], v[72:75]
    s_waitcnt lgkmcnt(1)
    ds_read_b64_tr_b16 v[30:31], v13 offset:18432
    v_mfma_f32_16x16x32_bf16 v[72:75], v[24:27], a[48:51], v[72:75]
    buffer_load_dwordx4 v[40:43], v64, s[24:27], s73 offen sc1
    v_mfma_f32_16x16x32_bf16 v[76:79], v[24:27], a[52:55], v[76:79]
    s_add_u32 s73, s73, 4608
    ds_read_b64_tr_b16 v[32:33], v11 offset:24576
    v_mfma_f32_16x16x32_bf16 v[76:79], v[20:23], v[220:223], v[76:79]
    ds_read_b64_tr_b16 v[34:35], v11 offset:26624
    v_mfma_f32_16x16x32_bf16 v[76:79], v[16:19], a[36:39], v[76:79]
    ds_read_b64_tr_b16 v[36:37], v13 offset:24576
    v_mfma_f32_16x16x32_bf16 v[80:83], v[16:19], a[40:43], v[80:83]
    s_add_u32 s56, s82, 393216
    ds_read_b64_tr_b16 v[38:39], v13 offset:26624
    v_mfma_f32_16x16x32_bf16 v[80:83], v[20:23], v[224:227], v[80:83]
    buffer_load_dwordx4 v[44:47], v64, s[24:27], s73 offen sc1
    v_mfma_f32_16x16x32_bf16 v[80:83], v[24:27], a[56:59], v[80:83]
    v_mfma_f32_16x16x32_bf16 v[84:87], v[24:27], a[60:63], v[84:87]
    v_mfma_f32_16x16x32_bf16 v[84:87], v[20:23], v[228:231], v[84:87]
    v_cvt_pk_bf16_f32 v72, v72, v73
    v_cvt_pk_bf16_f32 v73, v74, v75
    v_mfma_f32_16x16x32_bf16 v[84:87], v[16:19], a[44:47], v[84:87]
    s_waitcnt lgkmcnt(4)
    v_accvgpr_write_b32 a144, v72
    v_accvgpr_write_b32 a145, v73
    v_mfma_f32_16x16x32_bf16 v[100:103], v[28:31], a[44:47], 0
    s_waitcnt lgkmcnt(2)
    ds_read_b64_tr_b16 v[16:17], v6 offset:32768
    v_mfma_f32_16x16x32_bf16 v[100:103], v[32:35], v[228:231], v[100:103]
    s_waitcnt lgkmcnt(1)
    ds_read_b64_tr_b16 v[18:19], v6 offset:34816
    v_cvt_pk_bf16_f32 v74, v76, v77
    v_mfma_f32_16x16x32_bf16 v[100:103], v[36:39], a[60:63], v[100:103]
    buffer_load_dwordx2 v[60:61], v65, s[24:27], s61 offen sc1
    v_mfma_f32_16x16x32_bf16 v[96:99], v[36:39], a[56:59], 0
    ds_read_b64_tr_b16 v[20:21], v13 offset:0
    v_cvt_pk_bf16_f32 v75, v78, v79
    v_mfma_f32_16x16x32_bf16 v[96:99], v[32:35], v[224:227], v[96:99]
    ds_read_b64_tr_b16 v[22:23], v13 offset:2048
    v_cvt_pk_bf16_f32 v80, v80, v81
    v_mfma_f32_16x16x32_bf16 v[96:99], v[28:31], a[40:43], v[96:99]
    ds_read_b64_tr_b16 v[24:25], v13 offset:8192
    v_cvt_pk_bf16_f32 v81, v82, v83
    v_mfma_f32_16x16x32_bf16 v[92:95], v[28:31], a[36:39], 0
    ds_read_b64_tr_b16 v[26:27], v13 offset:10240
    v_accvgpr_write_b32 a146, v74
    v_mfma_f32_16x16x32_bf16 v[92:95], v[32:35], v[220:223], v[92:95]
    buffer_load_dwordx4 a[64:67], v64, s[24:27], s61 offen sc1
    v_mfma_f32_16x16x32_bf16 v[92:95], v[36:39], a[52:55], v[92:95]
    s_add_u32 s61, s61, 4608
    v_cvt_pk_bf16_f32 v82, v84, v85
    v_cvt_pk_bf16_f32 v83, v86, v87
    v_mfma_f32_16x16x32_bf16 v[88:91], v[36:39], a[48:51], 0
    buffer_store_dwordx4 v[136:139], v4, s[24:27], s56 offen sc1
    v_mfma_f32_16x16x32_bf16 v[88:91], v[32:35], v[216:219], v[88:91]
    v_accvgpr_write_b32 a147, v75
    v_accvgpr_write_b32 a148, v80
    v_mfma_f32_16x16x32_bf16 v[88:91], v[28:31], a[32:35], v[88:91]
    s_waitcnt lgkmcnt(4)
    v_accvgpr_write_b32 a149, v81
    v_accvgpr_write_b32 a150, v82
    v_mfma_f32_16x16x32_bf16 v[88:91], v[16:19], v[232:235], v[88:91]
    s_waitcnt lgkmcnt(2)
    ds_read_b64_tr_b16 v[28:29], v11 offset:0
    v_accvgpr_write_b32 a151, v83
    v_mfma_f32_16x16x32_bf16 v[88:91], v[20:23], a[0:3], v[88:91]
    s_waitcnt lgkmcnt(1)
    ds_read_b64_tr_b16 v[30:31], v11 offset:2048
    v_mfma_f32_16x16x32_bf16 v[88:91], v[24:27], a[16:19], v[88:91]
    buffer_load_dwordx2 v[58:59], v65, s[24:27], s74 offen sc1
    v_mfma_f32_16x16x32_bf16 v[92:95], v[24:27], a[20:23], v[92:95]
    ds_read_b64_tr_b16 v[32:33], v11 offset:8192
    v_mfma_f32_16x16x32_bf16 v[92:95], v[20:23], a[4:7], v[92:95]
    ds_read_b64_tr_b16 v[34:35], v11 offset:10240
    v_mfma_f32_16x16x32_bf16 v[92:95], v[16:19], v[236:239], v[92:95]
    ds_read_b64_tr_b16 v[36:37], v11 offset:16384
    v_mfma_f32_16x16x32_bf16 v[96:99], v[16:19], v[240:243], v[96:99]
    s_add_u32 s56, s72, 393216
    ds_read_b64_tr_b16 v[38:39], v11 offset:18432
    v_mfma_f32_16x16x32_bf16 v[96:99], v[20:23], a[8:11], v[96:99]
    v_add_u32 v10, 4294930432, v10
    v_add_u32 v11, 4294930432, v11
    v_mfma_f32_16x16x32_bf16 v[96:99], v[24:27], a[24:27], v[96:99]
    v_add_u32 v12, 4294930432, v12
    v_add_u32 v13, 4294930432, v13
    v_mfma_f32_16x16x32_bf16 v[100:103], v[24:27], a[28:31], v[100:103]
    v_add_u32 v3, 4294930432, v3
    v_add_u32 v6, 4294930432, v6
    v_mfma_f32_16x16x32_bf16 v[100:103], v[20:23], a[12:15], v[100:103]
    buffer_load_dwordx4 v[48:51], v64, s[24:27], s74 offen sc1
    v_mfma_f32_16x16x32_bf16 v[100:103], v[16:19], v[244:247], v[100:103]
    s_waitcnt lgkmcnt(4)
    s_add_u32 s74, s74, 4608
    v_mfma_f32_16x16x32_bf16 v[100:103], v[28:31], v[180:183], v[100:103]
    s_waitcnt lgkmcnt(2)
    v_mfma_f32_16x16x32_bf16 v[100:103], v[32:35], v[196:199], v[100:103]
    s_waitcnt vmcnt(10) lgkmcnt(0)
    s_barrier
    v_mfma_f32_16x16x32_bf16 v[100:103], v[36:39], v[212:215], v[100:103]
    ds_read_b64_tr_b16 v[16:17], v10 offset:0
    v_mfma_f32_16x16x32_bf16 v[96:99], v[36:39], v[208:211], v[96:99]
    buffer_load_dwordx4 v[52:55], v64, s[24:27], s74 offen sc1
    v_mfma_f32_16x16x32_bf16 v[96:99], v[32:35], v[192:195], v[96:99]
    ds_read_b64_tr_b16 v[18:19], v10 offset:2048
    v_mfma_f32_16x16x32_bf16 v[96:99], v[28:31], v[176:179], v[96:99]
    ds_read_b64_tr_b16 v[20:21], v10 offset:8192
    v_mfma_f32_16x16x32_bf16 v[92:95], v[28:31], v[172:175], v[92:95]
    ds_read_b64_tr_b16 v[22:23], v10 offset:10240
    v_mfma_f32_16x16x32_bf16 v[92:95], v[32:35], v[188:191], v[92:95]
    ds_read_b64_tr_b16 v[24:25], v10 offset:16384
    v_mfma_f32_16x16x32_bf16 v[92:95], v[36:39], v[204:207], v[92:95]
    buffer_load_dwordx4 a[80:83], v66, s[24:27], s62 offen offset:0 sc1
    v_mfma_f32_16x16x32_bf16 v[88:91], v[36:39], v[200:203], v[88:91]
    ds_read_b64_tr_b16 v[26:27], v10 offset:18432
    v_mfma_f32_16x16x32_bf16 v[88:91], v[32:35], v[184:187], v[88:91]
    buffer_store_dwordx4 v[144:147], v4, s[24:27], s56 offen sc1
    v_mfma_f32_16x16x32_bf16 v[88:91], v[28:31], v[168:171], v[88:91]
    s_waitcnt lgkmcnt(4)
    v_mfma_f32_16x16x32_bf16 v[136:139], v[16:19], v[168:171], 0
    s_waitcnt lgkmcnt(2)
    ds_read_b64_tr_b16 v[28:29], v3 offset:32768
    v_mfma_f32_16x16x32_bf16 v[136:139], v[20:23], v[184:187], v[136:139]
    s_waitcnt lgkmcnt(1)
    ds_read_b64_tr_b16 v[30:31], v3 offset:34816
    v_cvt_pk_bf16_f32 v96, v96, v97
    v_mfma_f32_16x16x32_bf16 v[136:139], v[24:27], v[200:203], v[136:139]
    buffer_load_dwordx4 a[84:87], v66, s[24:27], s62 offen offset:640 sc1
    v_mfma_f32_16x16x32_bf16 v[140:143], v[24:27], v[204:207], 0
    s_add_u32 s62, s62, 1280
    ds_read_b64_tr_b16 v[32:33], v12 offset:0
    v_cvt_pk_bf16_f32 v97, v98, v99
    v_mfma_f32_16x16x32_bf16 v[140:143], v[20:23], v[188:191], v[140:143]
    ds_read_b64_tr_b16 v[34:35], v12 offset:2048
    v_cvt_pk_bf16_f32 v98, v100, v101
    v_mfma_f32_16x16x32_bf16 v[140:143], v[16:19], v[172:175], v[140:143]
    ds_read_b64_tr_b16 v[36:37], v12 offset:8192
    v_cvt_pk_bf16_f32 v99, v102, v103
    v_mfma_f32_16x16x32_bf16 v[144:147], v[16:19], v[176:179], 0
    s_add_u32 s56, s72, 409600
    ds_read_b64_tr_b16 v[38:39], v12 offset:10240
    v_accvgpr_write_b32 a152, v96
    v_mfma_f32_16x16x32_bf16 v[144:147], v[20:23], v[192:195], v[144:147]
    buffer_load_dwordx4 a[68:71], v64, s[24:27], s61 offen sc1
    v_mfma_f32_16x16x32_bf16 v[144:147], v[24:27], v[208:211], v[144:147]
    s_add_u32 s61, s61, 4608
    v_cvt_pk_bf16_f32 v88, v88, v89
    v_cvt_pk_bf16_f32 v89, v90, v91
    v_mfma_f32_16x16x32_bf16 v[148:151], v[24:27], v[212:215], 0
    v_cvt_pk_bf16_f32 v90, v92, v93
    v_cvt_pk_bf16_f32 v91, v94, v95
    v_mfma_f32_16x16x32_bf16 v[148:151], v[20:23], v[196:199], v[148:151]
    v_accvgpr_write_b32 a153, v97
    v_accvgpr_write_b32 a154, v98
    v_mfma_f32_16x16x32_bf16 v[148:151], v[16:19], v[180:183], v[148:151]
    s_waitcnt lgkmcnt(4)
    v_accvgpr_write_b32 a155, v99
    v_accvgpr_write_b32 a156, v88
    v_mfma_f32_16x16x32_bf16 v[148:151], v[28:31], v[244:247], v[148:151]
    s_waitcnt lgkmcnt(2)
    ds_read_b64_tr_b16 v[16:17], v12 offset:16384
    v_accvgpr_write_b32 a157, v89
    v_mfma_f32_16x16x32_bf16 v[148:151], v[32:35], a[12:15], v[148:151]
    s_waitcnt lgkmcnt(1)
    ds_read_b64_tr_b16 v[18:19], v12 offset:18432
    v_accvgpr_write_b32 a158, v90
    v_mfma_f32_16x16x32_bf16 v[148:151], v[36:39], a[28:31], v[148:151]
    buffer_load_dwordx4 a[88:91], v66, s[24:27], s62 offen offset:0 sc1
    v_mfma_f32_16x16x32_bf16 v[144:147], v[36:39], a[24:27], v[144:147]
    ds_read_b64_tr_b16 v[20:21], v10 offset:24576
    v_accvgpr_write_b32 a159, v91
    v_mfma_f32_16x16x32_bf16 v[144:147], v[32:35], a[8:11], v[144:147]
    ds_read_b64_tr_b16 v[22:23], v10 offset:26624
    v_mov_b32 v72, 0
    v_mfma_f32_16x16x32_bf16 v[144:147], v[28:31], v[240:243], v[144:147]
    ds_read_b64_tr_b16 v[24:25], v12 offset:24576
    v_mov_b32 v73, 0
    v_mfma_f32_16x16x32_bf16 v[140:143], v[28:31], v[236:239], v[140:143]
    ds_read_b64_tr_b16 v[26:27], v12 offset:26624
    v_mov_b32 v74, 0
    v_mfma_f32_16x16x32_bf16 v[140:143], v[32:35], a[4:7], v[140:143]
    buffer_load_dwordx4 a[92:95], v66, s[24:27], s62 offen offset:640 sc1
    v_mfma_f32_16x16x32_bf16 v[140:143], v[36:39], a[20:23], v[140:143]
    s_add_u32 s62, s62, 1280
    v_mov_b32 v75, 0
    v_mov_b32 v76, 0
    v_mfma_f32_16x16x32_bf16 v[136:139], v[36:39], a[16:19], v[136:139]
    buffer_store_dwordx4 v[160:163], v4, s[24:27], s56 offen sc1
    v_mfma_f32_16x16x32_bf16 v[136:139], v[32:35], a[0:3], v[136:139]
    v_mov_b32 v77, 0
    v_mov_b32 v78, 0
    v_mfma_f32_16x16x32_bf16 v[136:139], v[28:31], v[232:235], v[136:139]
    s_waitcnt lgkmcnt(4)
    v_mov_b32 v79, 0
    v_mov_b32 v80, 0
    v_mfma_f32_16x16x32_bf16 v[136:139], v[16:19], a[32:35], v[136:139]
    s_waitcnt lgkmcnt(2)
    ds_read_b64_tr_b16 v[28:29], v13 offset:16384
    v_mov_b32 v81, 0
    v_mfma_f32_16x16x32_bf16 v[136:139], v[20:23], v[216:219], v[136:139]
    s_waitcnt lgkmcnt(1)
    ds_read_b64_tr_b16 v[30:31], v13 offset:18432
    v_mov_b32 v82, 0
    v_mfma_f32_16x16x32_bf16 v[136:139], v[24:27], a[48:51], v[136:139]
    buffer_load_dwordx2 v[62:63], v65, s[24:27], s61 offen sc1
    v_mfma_f32_16x16x32_bf16 v[140:143], v[24:27], a[52:55], v[140:143]
    ds_read_b64_tr_b16 v[32:33], v11 offset:24576
    v_mov_b32 v83, 0
    v_mfma_f32_16x16x32_bf16 v[140:143], v[20:23], v[220:223], v[140:143]
    ds_read_b64_tr_b16 v[34:35], v11 offset:26624
    v_mov_b32 v88, 0
    v_mfma_f32_16x16x32_bf16 v[140:143], v[16:19], a[36:39], v[140:143]
    ds_read_b64_tr_b16 v[36:37], v13 offset:24576
    v_mov_b32 v89, 0
    v_mfma_f32_16x16x32_bf16 v[144:147], v[16:19], a[40:43], v[144:147]
    ds_read_b64_tr_b16 v[38:39], v13 offset:26624
    v_mov_b32 v90, 0
    v_mfma_f32_16x16x32_bf16 v[144:147], v[20:23], v[224:227], v[144:147]
    buffer_load_dwordx4 a[72:75], v64, s[24:27], s61 offen sc1
    v_mfma_f32_16x16x32_bf16 v[144:147], v[24:27], a[56:59], v[144:147]
    s_add_u32 s61, s61, 4608
    v_mov_b32 v91, 0
    v_mov_b32 v92, 0
    v_mfma_f32_16x16x32_bf16 v[148:151], v[24:27], a[60:63], v[148:151]
    v_mov_b32 v93, 0
    v_mov_b32 v94, 0
    v_mfma_f32_16x16x32_bf16 v[148:151], v[20:23], v[228:231], v[148:151]
    v_cvt_pk_bf16_f32 v136, v136, v137
    v_cvt_pk_bf16_f32 v137, v138, v139
    v_mfma_f32_16x16x32_bf16 v[148:151], v[16:19], a[44:47], v[148:151]
    s_waitcnt lgkmcnt(4)
    v_mov_b32 v95, 0
    v_mov_b32 v96, 0
    v_mfma_f32_16x16x32_bf16 v[164:167], v[28:31], a[44:47], 0
    s_waitcnt lgkmcnt(2)
    ds_read_b64_tr_b16 v[16:17], v6 offset:32768
    v_mov_b32 v97, 0
    v_mfma_f32_16x16x32_bf16 v[164:167], v[32:35], v[228:231], v[164:167]
    s_waitcnt lgkmcnt(1)
    ds_read_b64_tr_b16 v[18:19], v6 offset:34816
    v_cvt_pk_bf16_f32 v138, v140, v141
    v_mfma_f32_16x16x32_bf16 v[164:167], v[36:39], a[60:63], v[164:167]
    buffer_load_dwordx4 a[96:99], v66, s[24:27], s62 offen offset:0 sc1
    v_mfma_f32_16x16x32_bf16 v[160:163], v[36:39], a[56:59], 0
    ds_read_b64_tr_b16 v[20:21], v13 offset:0
    v_cvt_pk_bf16_f32 v139, v142, v143
    v_mfma_f32_16x16x32_bf16 v[160:163], v[32:35], v[224:227], v[160:163]
    ds_read_b64_tr_b16 v[22:23], v13 offset:2048
    v_cvt_pk_bf16_f32 v144, v144, v145
    v_mfma_f32_16x16x32_bf16 v[160:163], v[28:31], a[40:43], v[160:163]
    ds_read_b64_tr_b16 v[24:25], v13 offset:8192
    v_cvt_pk_bf16_f32 v145, v146, v147
    v_mfma_f32_16x16x32_bf16 v[156:159], v[28:31], a[36:39], 0
    ds_read_b64_tr_b16 v[26:27], v13 offset:10240
    v_mov_b32 v98, 0
    v_mfma_f32_16x16x32_bf16 v[156:159], v[32:35], v[220:223], v[156:159]
    buffer_load_dwordx4 a[100:103], v66, s[24:27], s62 offen offset:640 sc1
    v_mfma_f32_16x16x32_bf16 v[156:159], v[36:39], a[52:55], v[156:159]
    s_add_u32 s62, s62, 1280
    v_cvt_pk_bf16_f32 v146, v148, v149
    v_cvt_pk_bf16_f32 v147, v150, v151
    v_mfma_f32_16x16x32_bf16 v[152:155], v[36:39], a[48:51], 0
    v_mov_b32 v99, 0
    v_mfma_f32_16x16x32_bf16 v[152:155], v[32:35], v[216:219], v[152:155]
    v_mfma_f32_16x16x32_bf16 v[152:155], v[28:31], a[32:35], v[152:155]
    s_waitcnt lgkmcnt(4)
    v_mfma_f32_16x16x32_bf16 v[152:155], v[16:19], v[232:235], v[152:155]
    s_waitcnt lgkmcnt(2)
    ds_read_b64_tr_b16 v[28:29], v11 offset:0
    v_mfma_f32_16x16x32_bf16 v[152:155], v[20:23], a[0:3], v[152:155]
    s_waitcnt lgkmcnt(1)
    ds_read_b64_tr_b16 v[30:31], v11 offset:2048
    v_mfma_f32_16x16x32_bf16 v[152:155], v[24:27], a[16:19], v[152:155]
    buffer_load_dwordx4 a[76:79], v64, s[24:27], s61 offen sc1
    v_mfma_f32_16x16x32_bf16 v[156:159], v[24:27], a[20:23], v[156:159]
    s_add_u32 s61, s61, 4608
    ds_read_b64_tr_b16 v[32:33], v11 offset:8192
    v_mfma_f32_16x16x32_bf16 v[156:159], v[20:23], a[4:7], v[156:159]
    ds_read_b64_tr_b16 v[34:35], v11 offset:10240
    v_mfma_f32_16x16x32_bf16 v[156:159], v[16:19], v[236:239], v[156:159]
    ds_read_b64_tr_b16 v[36:37], v11 offset:16384
    v_mfma_f32_16x16x32_bf16 v[160:163], v[16:19], v[240:243], v[160:163]
    ds_read_b64_tr_b16 v[38:39], v11 offset:18432
    v_mfma_f32_16x16x32_bf16 v[160:163], v[20:23], a[8:11], v[160:163]
    buffer_load_dwordx4 a[104:107], v66, s[24:27], s62 offen offset:0 sc1
    v_mfma_f32_16x16x32_bf16 v[160:163], v[24:27], a[24:27], v[160:163]
    v_mfma_f32_16x16x32_bf16 v[164:167], v[24:27], a[28:31], v[164:167]
    v_mfma_f32_16x16x32_bf16 v[164:167], v[20:23], a[12:15], v[164:167]
    v_mfma_f32_16x16x32_bf16 v[164:167], v[16:19], v[244:247], v[164:167]
    s_waitcnt lgkmcnt(4)
    v_mfma_f32_16x16x32_bf16 v[164:167], v[28:31], v[180:183], v[164:167]
    s_waitcnt lgkmcnt(2)
    s_waitcnt vmcnt(13)
    v_mfma_f32_16x16x32_bf16 v[164:167], v[32:35], v[196:199], v[164:167]
    s_waitcnt lgkmcnt(0)
    v_and_b32 v40, v68, v40
    v_and_b32 v43, v69, v43
    v_mfma_f32_16x16x32_bf16 v[164:167], v[36:39], v[212:215], v[164:167]
    buffer_load_dwordx4 a[108:111], v66, s[24:27], s62 offen offset:640 sc1
    v_mfma_f32_16x16x32_bf16 v[160:163], v[36:39], v[208:211], v[160:163]
    s_add_u32 s62, s62, 1280
    v_and_b32 v56, s68, v56
    v_and_b32 v44, v68, v44
    v_mfma_f32_16x16x32_bf16 v[160:163], v[32:35], v[192:195], v[160:163]
    v_and_b32 v47, v69, v47
    v_and_b32 v57, s3, v57
    v_mfma_f32_16x16x32_bf16 v[160:163], v[28:31], v[176:179], v[160:163]
    v_and_b32 v48, v68, v48
    v_and_b32 v51, v69, v51
    v_mfma_f32_16x16x32_bf16 v[156:159], v[28:31], v[172:175], v[156:159]
    v_and_b32 v58, s68, v58
    v_and_b32 v52, v68, v52
    v_mfma_f32_16x16x32_bf16 v[156:159], v[32:35], v[188:191], v[156:159]
    v_and_b32 v55, v69, v55
    v_and_b32 v59, s3, v59
    v_mfma_f32_16x16x32_bf16 v[156:159], v[36:39], v[204:207], v[156:159]
    v_mfma_f32_16x16x32_bf16 v[152:155], v[36:39], v[200:203], v[152:155]
    v_mfma_f32_16x16x32_bf16 v[152:155], v[32:35], v[184:187], v[152:155]
    v_mfma_f32_16x16x32_bf16 v[152:155], v[28:31], v[168:171], v[152:155]
    v_mfma_f32_32x32x4_2b_bf16 v[168:199], v[60:61], v[56:57], 0 cbsz:1 abid:0
    buffer_load_dwordx2 v[32:33], v65, s[24:27], s61 offen sc1
    v_mov_b32 v16, 0
    v_mov_b32 v17, 0
    v_mov_b32 v18, 0
    v_mov_b32 v19, 0
    v_mov_b32 v20, 0
    v_mov_b32 v21, 0
    v_mov_b32 v22, 0
    v_mov_b32 v23, 0
    v_mov_b32 v24, 0
    v_mov_b32 v25, 0
    v_mov_b32 v26, 0
    v_mov_b32 v27, 0
    v_mov_b32 v232, 0
    v_mov_b32 v233, 0
    v_mov_b32 v234, 0
    v_mov_b32 v235, 0
    v_mov_b32 v236, 0
    v_mfma_f32_32x32x16_bf16 v[168:183], a[64:67], v[40:43], v[168:183]
    v_mov_b32 v237, 0
    v_mov_b32 v238, 0
    v_mov_b32 v239, 0
    v_mov_b32 v240, 0
    v_mov_b32 v241, 0
    v_mov_b32 v242, 0
    v_mfma_f32_32x32x16_bf16 v[184:199], a[64:67], v[44:47], v[184:199]
    v_mov_b32 v243, 0
    v_cvt_pk_bf16_f32 v160, v160, v161
    v_cvt_pk_bf16_f32 v161, v162, v163
    v_cvt_pk_bf16_f32 v162, v164, v165
    v_cvt_pk_bf16_f32 v163, v166, v167
    v_cvt_pk_bf16_f32 v152, v152, v153
    v_cvt_pk_bf16_f32 v153, v154, v155
    v_cvt_pk_bf16_f32 v154, v156, v157
    v_cvt_pk_bf16_f32 v155, v158, v159
    s_barrier
    v_exp_f32 v168, v168
    v_exp_f32 v169, v169
    s_waitcnt vmcnt(12)
    s_add_u32 s56, s72, 65536
    v_exp_f32 v170, v170
    v_exp_f32 v171, v171
    v_exp_f32 v172, v172
    v_mfma_f32_32x32x4_2b_bf16 v[200:231], v[60:61], v[58:59], 0 cbsz:1 abid:0
    v_exp_f32 v173, v173
    v_exp_f32 v174, v174
    v_exp_f32 v175, v175
    v_exp_f32 v176, v176
    v_exp_f32 v177, v177
    v_exp_f32 v178, v178
    v_exp_f32 v179, v179
    v_exp_f32 v180, v180
    v_smfmac_f32_32x32x32_bf16 v[72:87], a[80:83], v[168:175], v67
    buffer_store_dwordx4 a[112:115], v4, s[24:27], s56 offen sc1
    v_exp_f32 v181, v181
    v_exp_f32 v182, v182
    v_exp_f32 v183, v183
    v_exp_f32 v184, v184
    v_exp_f32 v185, v185
    v_exp_f32 v186, v186
    v_smfmac_f32_32x32x32_bf16 v[72:87], a[84:87], v[176:183], v67
    s_add_u32 s56, s72, 131072
    v_exp_f32 v187, v187
    v_exp_f32 v188, v188
    v_exp_f32 v189, v189
    v_mfma_f32_32x32x16_bf16 v[200:215], a[64:67], v[48:51], v[200:215]
    v_exp_f32 v190, v190
    v_exp_f32 v191, v191
    v_exp_f32 v192, v192
    v_mfma_f32_32x32x16_bf16 v[216:231], a[64:67], v[52:55], v[216:231]
    v_exp_f32 v193, v193
    v_exp_f32 v194, v194
    v_exp_f32 v195, v195
    v_smfmac_f32_32x32x32_bf16 v[88:103], a[80:83], v[184:191], v67
    v_exp_f32 v196, v196
    v_exp_f32 v197, v197
    v_exp_f32 v198, v198
    v_exp_f32 v199, v199
    v_exp_f32 v200, v200
    v_exp_f32 v201, v201
    v_smfmac_f32_32x32x32_bf16 v[88:103], a[84:87], v[192:199], v67
    s_waitcnt vmcnt(12)
    v_exp_f32 v202, v202
    v_exp_f32 v203, v203
    v_exp_f32 v204, v204
    v_mfma_f32_32x32x4_2b_bf16 v[168:199], v[60:61], v[56:57], 0 cbsz:1 abid:1
    v_exp_f32 v205, v205
    v_exp_f32 v206, v206
    v_exp_f32 v207, v207
    v_exp_f32 v208, v208
    v_exp_f32 v209, v209
    v_exp_f32 v210, v210
    v_exp_f32 v211, v211
    v_exp_f32 v212, v212
    v_smfmac_f32_32x32x32_bf16 v[16:31], a[80:83], v[200:207], v67
    buffer_load_dwordx4 a[64:67], v64, s[24:27], s61 offen sc1
    buffer_store_dwordx4 a[116:119], v4, s[24:27], s56 offen sc1
    v_exp_f32 v213, v213
    v_exp_f32 v214, v214
    v_exp_f32 v215, v215
    v_exp_f32 v216, v216
    v_exp_f32 v217, v217
    v_exp_f32 v218, v218
    v_smfmac_f32_32x32x32_bf16 v[16:31], a[84:87], v[208:215], v67
    s_add_u32 s61, s61, 4608
    s_add_u32 s56, s82, 147456
    v_exp_f32 v219, v219
    v_exp_f32 v220, v220
    v_exp_f32 v221, v221
    v_mfma_f32_32x32x16_bf16 v[168:183], a[68:71], v[40:43], v[168:183]
    v_exp_f32 v222, v222
    v_exp_f32 v223, v223
    v_exp_f32 v224, v224
    v_mfma_f32_32x32x16_bf16 v[184:199], a[68:71], v[44:47], v[184:199]
    v_exp_f32 v225, v225
    v_exp_f32 v226, v226
    v_exp_f32 v227, v227
    v_smfmac_f32_32x32x32_bf16 v[232:247], a[80:83], v[216:223], v67
    v_exp_f32 v228, v228
    v_exp_f32 v229, v229
    v_exp_f32 v230, v230
    v_exp_f32 v231, v231
    v_exp_f32 v168, v168
    v_exp_f32 v169, v169
    v_smfmac_f32_32x32x32_bf16 v[232:247], a[84:87], v[224:231], v67
    s_waitcnt vmcnt(12)
    v_exp_f32 v170, v170
    v_exp_f32 v171, v171
    v_exp_f32 v172, v172
    v_mfma_f32_32x32x4_2b_bf16 v[200:231], v[60:61], v[58:59], 0 cbsz:1 abid:1
    v_exp_f32 v173, v173
    v_exp_f32 v174, v174
    v_exp_f32 v175, v175
    v_exp_f32 v176, v176
    v_exp_f32 v177, v177
    v_exp_f32 v178, v178
    v_exp_f32 v179, v179
    v_exp_f32 v180, v180
    v_smfmac_f32_32x32x32_bf16 v[72:87], a[88:91], v[168:175], v67
    buffer_load_dwordx4 a[80:83], v66, s[24:27], s62 offen offset:0 sc1
    buffer_load_dwordx4 a[84:87], v66, s[24:27], s62 offen offset:640 sc1
    buffer_store_dwordx4 a[120:123], v4, s[24:27], s56 offen sc1
    v_exp_f32 v181, v181
    v_exp_f32 v182, v182
    v_exp_f32 v183, v183
    v_exp_f32 v184, v184
    v_exp_f32 v185, v185
    v_exp_f32 v186, v186
    v_smfmac_f32_32x32x32_bf16 v[72:87], a[92:95], v[176:183], v67
    s_add_u32 s62, s62, 1280
    s_add_u32 s88, s64, 27648
    v_exp_f32 v187, v187
    v_exp_f32 v188, v188
    v_exp_f32 v189, v189
    v_mfma_f32_32x32x16_bf16 v[200:215], a[68:71], v[48:51], v[200:215]
    v_exp_f32 v190, v190
    v_exp_f32 v191, v191
    v_exp_f32 v192, v192
    v_mfma_f32_32x32x16_bf16 v[216:231], a[68:71], v[52:55], v[216:231]
    v_exp_f32 v193, v193
    v_exp_f32 v194, v194
    v_exp_f32 v195, v195
    v_smfmac_f32_32x32x32_bf16 v[88:103], a[88:91], v[184:191], v67
    s_add_u32 s56, s72, 196608
    v_exp_f32 v196, v196
    v_exp_f32 v197, v197
    v_exp_f32 v198, v198
    v_exp_f32 v199, v199
    v_exp_f32 v200, v200
    v_exp_f32 v201, v201
    v_smfmac_f32_32x32x32_bf16 v[88:103], a[92:95], v[192:199], v67
    s_waitcnt vmcnt(12)
    v_exp_f32 v202, v202
    v_exp_f32 v203, v203
    v_exp_f32 v204, v204
    v_mfma_f32_32x32x4_2b_bf16 v[168:199], v[62:63], v[56:57], 0 cbsz:1 abid:0
    v_exp_f32 v205, v205
    v_exp_f32 v206, v206
    v_exp_f32 v207, v207
    v_exp_f32 v208, v208
    v_exp_f32 v209, v209
    v_exp_f32 v210, v210
    v_exp_f32 v211, v211
    v_exp_f32 v212, v212
    v_smfmac_f32_32x32x32_bf16 v[16:31], a[88:91], v[200:207], v67
    buffer_load_dwordx2 v[60:61], v65, s[24:27], s88 offen sc1
    buffer_load_dwordx4 a[68:71], v64, s[24:27], s61 offen sc1
    buffer_store_dwordx4 a[124:127], v4, s[24:27], s56 offen sc1
    v_exp_f32 v213, v213
    v_exp_f32 v214, v214
    v_exp_f32 v215, v215
    v_exp_f32 v216, v216
    v_exp_f32 v217, v217
    v_exp_f32 v218, v218
    v_smfmac_f32_32x32x32_bf16 v[16:31], a[92:95], v[208:215], v67
    s_add_u32 s61, s61, 4608
    s_add_u32 s56, s72, 262144
    v_exp_f32 v219, v219
    v_exp_f32 v220, v220
    v_exp_f32 v221, v221
    v_mfma_f32_32x32x16_bf16 v[168:183], a[72:75], v[40:43], v[168:183]
    v_exp_f32 v222, v222
    v_exp_f32 v223, v223
    v_exp_f32 v224, v224
    v_mfma_f32_32x32x16_bf16 v[184:199], a[72:75], v[44:47], v[184:199]
    v_exp_f32 v225, v225
    v_exp_f32 v226, v226
    v_exp_f32 v227, v227
    v_smfmac_f32_32x32x32_bf16 v[232:247], a[88:91], v[216:223], v67
    v_exp_f32 v228, v228
    v_exp_f32 v229, v229
    v_exp_f32 v230, v230
    v_exp_f32 v231, v231
    v_exp_f32 v168, v168
    v_exp_f32 v169, v169
    v_smfmac_f32_32x32x32_bf16 v[232:247], a[92:95], v[224:231], v67
    s_waitcnt vmcnt(13)
    v_exp_f32 v170, v170
    v_exp_f32 v171, v171
    v_exp_f32 v172, v172
    v_mfma_f32_32x32x4_2b_bf16 v[200:231], v[62:63], v[58:59], 0 cbsz:1 abid:0
    v_exp_f32 v173, v173
    v_exp_f32 v174, v174
    v_exp_f32 v175, v175
    v_exp_f32 v176, v176
    v_exp_f32 v177, v177
    v_exp_f32 v178, v178
    v_exp_f32 v179, v179
    v_exp_f32 v180, v180
    v_smfmac_f32_32x32x32_bf16 v[72:87], a[96:99], v[168:175], v67
    buffer_load_dwordx4 a[88:91], v66, s[24:27], s62 offen offset:0 sc1
    buffer_load_dwordx4 a[92:95], v66, s[24:27], s62 offen offset:640 sc1
    buffer_store_dwordx4 a[128:131], v4, s[24:27], s56 offen sc1
    v_exp_f32 v181, v181
L_pg14:
    s_cbranch_execz L_tour_ret
    v_exp_f32 v182, v182
    v_exp_f32 v183, v183
    v_exp_f32 v184, v184
    v_exp_f32 v185, v185
    v_exp_f32 v186, v186
    v_smfmac_f32_32x32x32_bf16 v[72:87], a[100:103], v[176:183], v67
    s_add_u32 s62, s62, 1280
    s_add_u32 s56, s82, 278528
    v_exp_f32 v187, v187
    v_exp_f32 v188, v188
    v_exp_f32 v189, v189
    v_mfma_f32_32x32x16_bf16 v[200:215], a[72:75], v[48:51], v[200:215]
    v_exp_f32 v190, v190
    v_exp_f32 v191, v191
    v_exp_f32 v192, v192
    v_mfma_f32_32x32x16_bf16 v[216:231], a[72:75], v[52:55], v[216:231]
    v_exp_f32 v193, v193
    v_exp_f32 v194, v194
    v_exp_f32 v195, v195
    v_smfmac_f32_32x32x32_bf16 v[88:103], a[96:99], v[184:191], v67
    v_exp_f32 v196, v196
    v_exp_f32 v197, v197
    v_exp_f32 v198, v198
    v_exp_f32 v199, v199
    v_exp_f32 v200, v200
    v_exp_f32 v201, v201
    v_smfmac_f32_32x32x32_bf16 v[88:103], a[100:103], v[192:199], v67
    s_waitcnt vmcnt(15)
    v_exp_f32 v202, v202
    v_exp_f32 v203, v203
    v_exp_f32 v204, v204
    v_mfma_f32_32x32x4_2b_bf16 v[168:199], v[62:63], v[56:57], 0 cbsz:1 abid:1
    v_exp_f32 v205, v205
    v_exp_f32 v206, v206
    v_exp_f32 v207, v207
    v_exp_f32 v208, v208
    v_exp_f32 v209, v209
    v_exp_f32 v210, v210
    v_exp_f32 v211, v211
    v_exp_f32 v212, v212
    v_smfmac_f32_32x32x32_bf16 v[16:31], a[96:99], v[200:207], v67
    buffer_load_dwordx4 a[72:75], v64, s[24:27], s61 offen sc1
    buffer_store_dwordx4 a[132:135], v4, s[24:27], s56 offen sc1
    v_exp_f32 v213, v213
    v_exp_f32 v214, v214
    v_exp_f32 v215, v215
    v_exp_f32 v216, v216
    v_exp_f32 v217, v217
    v_exp_f32 v218, v218
    v_smfmac_f32_32x32x32_bf16 v[16:31], a[100:103], v[208:215], v67
    s_add_u32 s61, s61, 4608
    s_add_u32 s56, s82, 344064
    v_exp_f32 v219, v219
    v_exp_f32 v220, v220
    v_exp_f32 v221, v221
    v_mfma_f32_32x32x16_bf16 v[168:183], a[76:79], v[40:43], v[168:183]
    v_exp_f32 v222, v222
    v_exp_f32 v223, v223
    v_exp_f32 v224, v224
    v_mfma_f32_32x32x16_bf16 v[184:199], a[76:79], v[44:47], v[184:199]
    v_exp_f32 v225, v225
    v_exp_f32 v226, v226
    v_exp_f32 v227, v227
    v_smfmac_f32_32x32x32_bf16 v[232:247], a[96:99], v[216:223], v67
    v_exp_f32 v228, v228
    v_exp_f32 v229, v229
    v_exp_f32 v230, v230
    v_exp_f32 v231, v231
    v_exp_f32 v168, v168
    v_exp_f32 v169, v169
    v_smfmac_f32_32x32x32_bf16 v[232:247], a[100:103], v[224:231], v67
    s_waitcnt vmcnt(15)
    v_exp_f32 v170, v170
    v_exp_f32 v171, v171
    v_exp_f32 v172, v172
    v_mfma_f32_32x32x4_2b_bf16 v[200:231], v[62:63], v[58:59], 0 cbsz:1 abid:1
    v_exp_f32 v173, v173
    v_exp_f32 v174, v174
    v_exp_f32 v175, v175
    v_exp_f32 v176, v176
    v_exp_f32 v177, v177
    v_exp_f32 v178, v178
    v_exp_f32 v179, v179
    v_exp_f32 v180, v180
    v_smfmac_f32_32x32x32_bf16 v[72:87], a[104:107], v[168:175], v67
    buffer_load_dwordx4 a[96:99], v66, s[24:27], s62 offen offset:0 sc1
    buffer_load_dwordx4 a[100:103], v66, s[24:27], s62 offen offset:640 sc1
    buffer_store_dwordx4 a[136:139], v4, s[24:27], s56 offen sc1
    v_exp_f32 v181, v181
    v_exp_f32 v182, v182
    v_exp_f32 v183, v183
    v_exp_f32 v184, v184
    v_exp_f32 v185, v185
    v_exp_f32 v186, v186
    v_smfmac_f32_32x32x32_bf16 v[72:87], a[108:111], v[176:183], v67
    s_add_u32 s62, s62, 1280
    s_add_u32 s88, s64, 36864
    v_exp_f32 v187, v187
    v_exp_f32 v188, v188
    v_exp_f32 v189, v189
    v_mfma_f32_32x32x16_bf16 v[200:215], a[76:79], v[48:51], v[200:215]
    v_exp_f32 v190, v190
    v_exp_f32 v191, v191
    v_exp_f32 v192, v192
    v_mfma_f32_32x32x16_bf16 v[216:231], a[76:79], v[52:55], v[216:231]
    v_exp_f32 v193, v193
    v_exp_f32 v194, v194
    v_exp_f32 v195, v195
    v_smfmac_f32_32x32x32_bf16 v[88:103], a[104:107], v[184:191], v67
    s_add_u32 s56, s82, 409600
    v_exp_f32 v196, v196
    v_exp_f32 v197, v197
    v_exp_f32 v198, v198
    v_exp_f32 v199, v199
    v_exp_f32 v200, v200
    v_exp_f32 v201, v201
    v_smfmac_f32_32x32x32_bf16 v[88:103], a[108:111], v[192:199], v67
    s_waitcnt vmcnt(15)
    v_exp_f32 v202, v202
    v_exp_f32 v203, v203
    v_exp_f32 v204, v204
    v_mfma_f32_32x32x4_2b_bf16 v[168:199], v[32:33], v[56:57], 0 cbsz:1 abid:0
    v_exp_f32 v205, v205
    v_exp_f32 v206, v206
    v_exp_f32 v207, v207
    v_exp_f32 v208, v208
    v_exp_f32 v209, v209
    v_exp_f32 v210, v210
    v_exp_f32 v211, v211
    v_exp_f32 v212, v212
    v_smfmac_f32_32x32x32_bf16 v[16:31], a[104:107], v[200:207], v67
    buffer_load_dwordx2 v[62:63], v65, s[24:27], s88 offen sc1
    buffer_load_dwordx4 a[76:79], v64, s[24:27], s61 offen sc1
    buffer_store_dwordx4 a[140:143], v4, s[24:27], s56 offen sc1
    v_exp_f32 v213, v213
    v_exp_f32 v214, v214
    v_exp_f32 v215, v215
    v_exp_f32 v216, v216
    v_exp_f32 v217, v217
    v_exp_f32 v218, v218
    v_smfmac_f32_32x32x32_bf16 v[16:31], a[108:111], v[208:215], v67
    s_add_u32 s61, s61, 4608
    s_add_u32 s56, s82, 458752
    v_exp_f32 v219, v219
    v_exp_f32 v220, v220
    v_exp_f32 v221, v221
    v_mfma_f32_32x32x16_bf16 v[168:183], a[64:67], v[40:43], v[168:183]
    v_exp_f32 v222, v222
    v_exp_f32 v223, v223
    v_exp_f32 v224, v224
    v_mfma_f32_32x32x16_bf16 v[184:199], a[64:67], v[44:47], v[184:199]
    v_exp_f32 v225, v225
    v_exp_f32 v226, v226
    v_exp_f32 v227, v227
    v_smfmac_f32_32x32x32_bf16 v[232:247], a[104:107], v[216:223], v67
    v_exp_f32 v228, v228
    v_exp_f32 v229, v229
    v_exp_f32 v230, v230
    v_exp_f32 v231, v231
    v_exp_f32 v168, v168
    v_exp_f32 v169, v169
    v_smfmac_f32_32x32x32_bf16 v[232:247], a[108:111], v[224:231], v67
    s_waitcnt vmcnt(15)
    v_exp_f32 v170, v170
    v_exp_f32 v171, v171
    v_exp_f32 v172, v172
    v_mfma_f32_32x32x4_2b_bf16 v[200:231], v[32:33], v[58:59], 0 cbsz:1 abid:0
    v_exp_f32 v173, v173
    v_exp_f32 v174, v174
    v_exp_f32 v175, v175
    v_exp_f32 v176, v176
    v_exp_f32 v177, v177
    v_exp_f32 v178, v178
    v_exp_f32 v179, v179
    v_exp_f32 v180, v180
    v_smfmac_f32_32x32x32_bf16 v[72:87], a[80:83], v[168:175], v67
    buffer_load_dwordx4 a[104:107], v66, s[24:27], s62 offen offset:0 sc1
    buffer_load_dwordx4 a[108:111], v66, s[24:27], s62 offen offset:640 sc1
    buffer_store_dwordx4 a[144:147], v4, s[24:27], s56 offen sc1
    v_exp_f32 v181, v181
    v_exp_f32 v182, v182
    v_exp_f32 v183, v183
    v_exp_f32 v184, v184
    v_exp_f32 v185, v185
    v_exp_f32 v186, v186
    v_smfmac_f32_32x32x32_bf16 v[72:87], a[84:87], v[176:183], v67
    s_add_u32 s62, s62, 1280
    s_add_u32 s56, s72, 458752
    v_exp_f32 v187, v187
    v_exp_f32 v188, v188
    v_exp_f32 v189, v189
    v_mfma_f32_32x32x16_bf16 v[200:215], a[64:67], v[48:51], v[200:215]
    v_exp_f32 v190, v190
    v_exp_f32 v191, v191
    v_exp_f32 v192, v192
    v_mfma_f32_32x32x16_bf16 v[216:231], a[64:67], v[52:55], v[216:231]
    v_exp_f32 v193, v193
    v_exp_f32 v194, v194
    v_exp_f32 v195, v195
    v_smfmac_f32_32x32x32_bf16 v[88:103], a[80:83], v[184:191], v67
    v_exp_f32 v196, v196
    v_exp_f32 v197, v197
    v_exp_f32 v198, v198
    v_exp_f32 v199, v199
    v_exp_f32 v200, v200
    v_exp_f32 v201, v201
    v_smfmac_f32_32x32x32_bf16 v[88:103], a[84:87], v[192:199], v67
    s_waitcnt vmcnt(15)
    v_exp_f32 v202, v202
    v_exp_f32 v203, v203
    v_exp_f32 v204, v204
    v_mfma_f32_32x32x4_2b_bf16 v[168:199], v[32:33], v[56:57], 0 cbsz:1 abid:1
    v_exp_f32 v205, v205
    v_exp_f32 v206, v206
    v_exp_f32 v207, v207
    v_exp_f32 v208, v208
    v_exp_f32 v209, v209
    v_exp_f32 v210, v210
    v_exp_f32 v211, v211
    v_exp_f32 v212, v212
    v_smfmac_f32_32x32x32_bf16 v[16:31], a[80:83], v[200:207], v67
    buffer_load_dwordx4 a[64:67], v64, s[24:27], s61 offen sc1
    buffer_store_dwordx4 a[148:151], v4, s[24:27], s56 offen sc1
    v_exp_f32 v213, v213
    v_exp_f32 v214, v214
    v_exp_f32 v215, v215
    v_exp_f32 v216, v216
    v_exp_f32 v217, v217
    v_exp_f32 v218, v218
    v_smfmac_f32_32x32x32_bf16 v[16:31], a[84:87], v[208:215], v67
    s_add_u32 s61, s61, 4608
    s_add_u32 s56, s72, 475136
    v_exp_f32 v219, v219
    v_exp_f32 v220, v220
    v_exp_f32 v221, v221
    v_mfma_f32_32x32x16_bf16 v[168:183], a[68:71], v[40:43], v[168:183]
    v_exp_f32 v222, v222
    v_exp_f32 v223, v223
    v_exp_f32 v224, v224
    v_mfma_f32_32x32x16_bf16 v[184:199], a[68:71], v[44:47], v[184:199]
    v_exp_f32 v225, v225
    v_exp_f32 v226, v226
    v_exp_f32 v227, v227
    v_smfmac_f32_32x32x32_bf16 v[232:247], a[80:83], v[216:223], v67
    v_exp_f32 v228, v228
    v_exp_f32 v229, v229
    v_exp_f32 v230, v230
    v_exp_f32 v231, v231
    v_exp_f32 v168, v168
    v_exp_f32 v169, v169
    v_smfmac_f32_32x32x32_bf16 v[232:247], a[84:87], v[224:231], v67
    s_waitcnt vmcnt(14)
    v_exp_f32 v170, v170
    v_exp_f32 v171, v171
    v_exp_f32 v172, v172
    v_mfma_f32_32x32x4_2b_bf16 v[200:231], v[32:33], v[58:59], 0 cbsz:1 abid:1
    v_exp_f32 v173, v173
    v_exp_f32 v174, v174
    v_exp_f32 v175, v175
    v_exp_f32 v176, v176
    v_exp_f32 v177, v177
    v_exp_f32 v178, v178
    v_exp_f32 v179, v179
    v_exp_f32 v180, v180
    v_smfmac_f32_32x32x32_bf16 v[72:87], a[88:91], v[168:175], v67
    buffer_load_dwordx4 a[80:83], v66, s[24:27], s62 offen offset:0 sc1
    buffer_load_dwordx4 a[84:87], v66, s[24:27], s62 offen offset:640 sc1
    buffer_store_dwordx4 a[152:155], v4, s[24:27], s56 offen sc1
    v_exp_f32 v181, v181
    v_exp_f32 v182, v182
    v_exp_f32 v183, v183
    v_exp_f32 v184, v184
    v_exp_f32 v185, v185
    v_exp_f32 v186, v186
    v_smfmac_f32_32x32x32_bf16 v[72:87], a[92:95], v[176:183], v67
    s_add_u32 s62, s62, 1280
    s_add_u32 s88, s64, 46080
    v_exp_f32 v187, v187
    v_exp_f32 v188, v188
    v_exp_f32 v189, v189
    v_mfma_f32_32x32x16_bf16 v[200:215], a[68:71], v[48:51], v[200:215]
    v_exp_f32 v190, v190
    v_exp_f32 v191, v191
    v_exp_f32 v192, v192
    v_mfma_f32_32x32x16_bf16 v[216:231], a[68:71], v[52:55], v[216:231]
    v_exp_f32 v193, v193
    v_exp_f32 v194, v194
    v_exp_f32 v195, v195
    v_smfmac_f32_32x32x32_bf16 v[88:103], a[88:91], v[184:191], v67
    s_add_u32 s56, s82, 475136
    v_exp_f32 v196, v196
    v_exp_f32 v197, v197
    v_exp_f32 v198, v198
    v_exp_f32 v199, v199
    v_exp_f32 v200, v200
    v_exp_f32 v201, v201
    v_smfmac_f32_32x32x32_bf16 v[88:103], a[92:95], v[192:199], v67
    s_waitcnt vmcnt(15)
    v_exp_f32 v202, v202
    v_exp_f32 v203, v203
    v_exp_f32 v204, v204
    v_mfma_f32_32x32x4_2b_bf16 v[168:199], v[60:61], v[56:57], 0 cbsz:1 abid:0
    v_exp_f32 v205, v205
    v_exp_f32 v206, v206
    v_exp_f32 v207, v207
    v_exp_f32 v208, v208
    v_exp_f32 v209, v209
    v_exp_f32 v210, v210
    v_exp_f32 v211, v211
    v_exp_f32 v212, v212
    v_smfmac_f32_32x32x32_bf16 v[16:31], a[88:91], v[200:207], v67
    buffer_load_dwordx2 v[32:33], v65, s[24:27], s88 offen sc1
    buffer_load_dwordx4 a[68:71], v64, s[24:27], s61 offen sc1
    buffer_store_dwordx4 a[156:159], v4, s[24:27], s56 offen sc1
    v_exp_f32 v213, v213
    v_exp_f32 v214, v214
    v_exp_f32 v215, v215
    v_exp_f32 v216, v216
    v_exp_f32 v217, v217
    v_exp_f32 v218, v218
    v_smfmac_f32_32x32x32_bf16 v[16:31], a[92:95], v[208:215], v67
    s_add_u32 s61, s61, 4608
    s_add_u32 s56, s82, 524288
    v_exp_f32 v219, v219
    v_exp_f32 v220, v220
    v_exp_f32 v221, v221
    v_mfma_f32_32x32x16_bf16 v[168:183], a[72:75], v[40:43], v[168:183]
    v_exp_f32 v222, v222
    v_exp_f32 v223, v223
    v_exp_f32 v224, v224
    v_mfma_f32_32x32x16_bf16 v[184:199], a[72:75], v[44:47], v[184:199]
    v_exp_f32 v225, v225
    v_exp_f32 v226, v226
    v_exp_f32 v227, v227
    v_smfmac_f32_32x32x32_bf16 v[232:247], a[88:91], v[216:223], v67
    v_exp_f32 v228, v228
    v_exp_f32 v229, v229
    v_exp_f32 v230, v230
    v_exp_f32 v231, v231
    v_exp_f32 v168, v168
    v_exp_f32 v169, v169
    v_smfmac_f32_32x32x32_bf16 v[232:247], a[92:95], v[224:231], v67
    s_waitcnt vmcnt(15)
    v_exp_f32 v170, v170
    v_exp_f32 v171, v171
    v_exp_f32 v172, v172
    v_mfma_f32_32x32x4_2b_bf16 v[200:231], v[60:61], v[58:59], 0 cbsz:1 abid:0
    v_exp_f32 v173, v173
    v_exp_f32 v174, v174
    v_exp_f32 v175, v175
    v_exp_f32 v176, v176
    v_exp_f32 v177, v177
    v_exp_f32 v178, v178
    v_exp_f32 v179, v179
    v_exp_f32 v180, v180
    v_smfmac_f32_32x32x32_bf16 v[72:87], a[96:99], v[168:175], v67
    buffer_load_dwordx4 a[88:91], v66, s[24:27], s62 offen offset:0 sc1
    buffer_load_dwordx4 a[92:95], v66, s[24:27], s62 offen offset:640 sc1
    buffer_store_dwordx4 v[136:139], v4, s[24:27], s56 offen sc1
    v_exp_f32 v181, v181
    v_exp_f32 v182, v182
    v_exp_f32 v183, v183
    v_exp_f32 v184, v184
    v_exp_f32 v185, v185
    v_exp_f32 v186, v186
    v_smfmac_f32_32x32x32_bf16 v[72:87], a[100:103], v[176:183], v67
    s_add_u32 s62, s62, 1280
    s_add_u32 s56, s72, 524288
    v_exp_f32 v187, v187
    v_exp_f32 v188, v188
    v_exp_f32 v189, v189
    v_mfma_f32_32x32x16_bf16 v[200:215], a[72:75], v[48:51], v[200:215]
    v_exp_f32 v190, v190
    v_exp_f32 v191, v191
    v_exp_f32 v192, v192
    v_mfma_f32_32x32x16_bf16 v[216:231], a[72:75], v[52:55], v[216:231]
    v_exp_f32 v193, v193
    v_exp_f32 v194, v194
    v_exp_f32 v195, v195
    v_smfmac_f32_32x32x32_bf16 v[88:103], a[96:99], v[184:191], v67
    v_exp_f32 v196, v196
    v_exp_f32 v197, v197
    v_exp_f32 v198, v198
    v_exp_f32 v199, v199
    v_exp_f32 v200, v200
    v_exp_f32 v201, v201
    v_smfmac_f32_32x32x32_bf16 v[88:103], a[100:103], v[192:199], v67
    s_waitcnt vmcnt(15)
    v_exp_f32 v202, v202
    v_exp_f32 v203, v203
    v_exp_f32 v204, v204
    v_mfma_f32_32x32x4_2b_bf16 v[168:199], v[60:61], v[56:57], 0 cbsz:1 abid:1
    v_exp_f32 v205, v205
    v_exp_f32 v206, v206
    v_exp_f32 v207, v207
    v_exp_f32 v208, v208
    v_exp_f32 v209, v209
    v_exp_f32 v210, v210
    v_exp_f32 v211, v211
    v_exp_f32 v212, v212
    v_smfmac_f32_32x32x32_bf16 v[16:31], a[96:99], v[200:207], v67
    buffer_load_dwordx4 a[72:75], v64, s[24:27], s61 offen sc1
    buffer_store_dwordx4 v[144:147], v4, s[24:27], s56 offen sc1
    v_exp_f32 v213, v213
    v_exp_f32 v214, v214
    v_exp_f32 v215, v215
    v_exp_f32 v216, v216
    v_exp_f32 v217, v217
    v_exp_f32 v218, v218
    v_smfmac_f32_32x32x32_bf16 v[16:31], a[100:103], v[208:215], v67
    s_add_u32 s61, s61, 4608
    s_add_u32 s89, s75, 18432
    v_exp_f32 v219, v219
    v_exp_f32 v220, v220
    v_exp_f32 v221, v221
    v_mfma_f32_32x32x16_bf16 v[168:183], a[76:79], v[40:43], v[168:183]
    v_exp_f32 v222, v222
    v_exp_f32 v223, v223
    v_exp_f32 v224, v224
    v_mfma_f32_32x32x16_bf16 v[184:199], a[76:79], v[44:47], v[184:199]
    v_exp_f32 v225, v225
    v_exp_f32 v226, v226
    v_exp_f32 v227, v227
    v_smfmac_f32_32x32x32_bf16 v[232:247], a[96:99], v[216:223], v67
    s_add_u32 m0, s77, 110592
    s_add_u32 s56, s72, 540672
    v_exp_f32 v228, v228
    v_exp_f32 v229, v229
    v_exp_f32 v230, v230
    v_exp_f32 v231, v231
    v_exp_f32 v168, v168
    v_exp_f32 v169, v169
    v_smfmac_f32_32x32x32_bf16 v[232:247], a[100:103], v[224:231], v67
    s_waitcnt vmcnt(14)
    v_exp_f32 v170, v170
    v_exp_f32 v171, v171
    v_exp_f32 v172, v172
    v_mfma_f32_32x32x4_2b_bf16 v[200:231], v[60:61], v[58:59], 0 cbsz:1 abid:1
    v_exp_f32 v173, v173
    v_exp_f32 v174, v174
    v_exp_f32 v175, v175
    v_exp_f32 v176, v176
    v_exp_f32 v177, v177
    v_exp_f32 v178, v178
    v_exp_f32 v179, v179
    v_exp_f32 v180, v180
    v_smfmac_f32_32x32x32_bf16 v[72:87], a[104:107], v[168:175], v67
    buffer_load_dwordx4 a[96:99], v66, s[24:27], s62 offen offset:0 sc1
    buffer_load_dwordx4 a[100:103], v66, s[24:27], s62 offen offset:640 sc1
    buffer_load_dwordx4 v113, s[36:39], s89 offen offset:0 lds
    buffer_load_dwordx4 v114, s[36:39], s89 offen offset:1024 lds
    buffer_load_dwordx4 v115, s[36:39], s89 offen offset:2048 lds
    buffer_store_dwordx4 v[160:163], v4, s[24:27], s56 offen sc1
    v_exp_f32 v181, v181
    v_exp_f32 v182, v182
    v_exp_f32 v183, v183
    v_exp_f32 v184, v184
    v_exp_f32 v185, v185
    v_exp_f32 v186, v186
    v_smfmac_f32_32x32x32_bf16 v[72:87], a[108:111], v[176:183], v67
    s_add_u32 s62, s62, 1280
    s_add_u32 s88, s64, 55296
    v_exp_f32 v187, v187
    v_exp_f32 v188, v188
    v_exp_f32 v189, v189
    v_mfma_f32_32x32x16_bf16 v[200:215], a[76:79], v[48:51], v[200:215]
    v_exp_f32 v190, v190
    v_exp_f32 v191, v191
    v_exp_f32 v192, v192
    v_mfma_f32_32x32x16_bf16 v[216:231], a[76:79], v[52:55], v[216:231]
    v_exp_f32 v193, v193
    v_exp_f32 v194, v194
    v_exp_f32 v195, v195
    v_smfmac_f32_32x32x32_bf16 v[88:103], a[104:107], v[184:191], v67
    s_add_u32 s56, s82, 540672
    v_exp_f32 v196, v196
    v_exp_f32 v197, v197
    v_exp_f32 v198, v198
    v_exp_f32 v199, v199
    v_exp_f32 v200, v200
    v_exp_f32 v201, v201
    v_smfmac_f32_32x32x32_bf16 v[88:103], a[108:111], v[192:199], v67
    s_waitcnt vmcnt(18)
    v_exp_f32 v202, v202
    v_exp_f32 v203, v203
    v_exp_f32 v204, v204
    v_mfma_f32_32x32x4_2b_bf16 v[168:199], v[62:63], v[56:57], 0 cbsz:1 abid:0
    v_exp_f32 v205, v205
    v_exp_f32 v206, v206
    v_exp_f32 v207, v207
    v_exp_f32 v208, v208
    v_exp_f32 v209, v209
    v_exp_f32 v210, v210
    v_exp_f32 v211, v211
    v_exp_f32 v212, v212
    v_smfmac_f32_32x32x32_bf16 v[16:31], a[104:107], v[200:207], v67
    buffer_load_dwordx2 v[60:61], v65, s[24:27], s88 offen sc1
    buffer_load_dwordx4 a[76:79], v64, s[24:27], s61 offen sc1
    buffer_load_dwordx4 v116, s[36:39], s89 offen offset:3072 lds
    buffer_load_dwordx4 v117, s[36:39], s89 offen offset:3584 lds
    buffer_store_dwordx4 v[152:155], v4, s[24:27], s56 offen sc1
    v_exp_f32 v213, v213
    v_exp_f32 v214, v214
    v_exp_f32 v215, v215
    v_exp_f32 v216, v216
    v_exp_f32 v217, v217
    v_exp_f32 v218, v218
    v_smfmac_f32_32x32x32_bf16 v[16:31], a[108:111], v[208:215], v67
    s_add_u32 s61, s61, 4608
    s_add_u32 s89, s75, 0
    v_exp_f32 v219, v219
    v_exp_f32 v220, v220
    v_exp_f32 v221, v221
    v_mfma_f32_32x32x16_bf16 v[168:183], a[64:67], v[40:43], v[168:183]
    v_exp_f32 v222, v222
    v_exp_f32 v223, v223
    v_exp_f32 v224, v224
    v_mfma_f32_32x32x16_bf16 v[184:199], a[64:67], v[44:47], v[184:199]
    v_exp_f32 v225, v225
    v_exp_f32 v226, v226
    v_exp_f32 v227, v227
    v_smfmac_f32_32x32x32_bf16 v[232:247], a[104:107], v[216:223], v67
    s_add_u32 m0, s76, 0
    v_exp_f32 v228, v228
    v_exp_f32 v229, v229
    v_exp_f32 v230, v230
    v_exp_f32 v231, v231
    v_exp_f32 v168, v168
    v_exp_f32 v169, v169
    v_smfmac_f32_32x32x32_bf16 v[232:247], a[108:111], v[224:231], v67
    s_waitcnt vmcnt(20)
    v_exp_f32 v170, v170
    v_exp_f32 v171, v171
    v_exp_f32 v172, v172
    v_mfma_f32_32x32x4_2b_bf16 v[200:231], v[62:63], v[58:59], 0 cbsz:1 abid:0
    v_exp_f32 v173, v173
    v_exp_f32 v174, v174
    v_exp_f32 v175, v175
    v_exp_f32 v176, v176
    v_exp_f32 v177, v177
    v_exp_f32 v178, v178
    v_exp_f32 v179, v179
    v_exp_f32 v180, v180
    v_smfmac_f32_32x32x32_bf16 v[72:87], a[80:83], v[168:175], v67
    buffer_load_dwordx4 a[104:107], v66, s[24:27], s62 offen offset:0 sc1
    buffer_load_dwordx4 a[108:111], v66, s[24:27], s62 offen offset:640 sc1
    buffer_load_dwordx4 v104, s[36:39], s89 offen offset:0 lds
    buffer_load_dwordx4 v105, s[36:39], s89 offen offset:1024 lds
    v_exp_f32 v181, v181
    v_exp_f32 v182, v182
    v_exp_f32 v183, v183
    v_exp_f32 v184, v184
    v_exp_f32 v185, v185
    v_exp_f32 v186, v186
    v_smfmac_f32_32x32x32_bf16 v[72:87], a[84:87], v[176:183], v67
    s_add_u32 s62, s62, 1280
    v_exp_f32 v187, v187
    v_exp_f32 v188, v188
    v_exp_f32 v189, v189
    v_mfma_f32_32x32x16_bf16 v[200:215], a[64:67], v[48:51], v[200:215]
    v_exp_f32 v190, v190
    v_exp_f32 v191, v191
    v_exp_f32 v192, v192
    v_mfma_f32_32x32x16_bf16 v[216:231], a[64:67], v[52:55], v[216:231]
    v_exp_f32 v193, v193
    v_exp_f32 v194, v194
    v_exp_f32 v195, v195
    v_smfmac_f32_32x32x32_bf16 v[88:103], a[80:83], v[184:191], v67
    v_exp_f32 v196, v196
    v_exp_f32 v197, v197
    v_exp_f32 v198, v198
    v_exp_f32 v199, v199
    v_exp_f32 v200, v200
    v_exp_f32 v201, v201
    v_smfmac_f32_32x32x32_bf16 v[88:103], a[84:87], v[192:199], v67
    s_waitcnt vmcnt(21)
    v_exp_f32 v202, v202
    v_exp_f32 v203, v203
    v_exp_f32 v204, v204
    v_mfma_f32_32x32x4_2b_bf16 v[168:199], v[62:63], v[56:57], 0 cbsz:1 abid:1
    v_exp_f32 v205, v205
    v_exp_f32 v206, v206
    v_exp_f32 v207, v207
    v_exp_f32 v208, v208
    v_exp_f32 v209, v209
    v_exp_f32 v210, v210
    v_exp_f32 v211, v211
    v_exp_f32 v212, v212
    v_smfmac_f32_32x32x32_bf16 v[16:31], a[80:83], v[200:207], v67
    buffer_load_dwordx4 a[64:67], v64, s[24:27], s61 offen sc1
    buffer_load_dwordx4 v106, s[36:39], s89 offen offset:2048 lds
    v_exp_f32 v213, v213
    v_exp_f32 v214, v214
    v_exp_f32 v215, v215
    v_exp_f32 v216, v216
    v_exp_f32 v217, v217
    v_exp_f32 v218, v218
    v_smfmac_f32_32x32x32_bf16 v[16:31], a[84:87], v[208:215], v67
    s_add_u32 s61, s61, 4608
    s_add_u32 m0, s76, 3072
    v_exp_f32 v219, v219
    v_exp_f32 v220, v220
    v_exp_f32 v221, v221
    v_mfma_f32_32x32x16_bf16 v[168:183], a[68:71], v[40:43], v[168:183]
    v_exp_f32 v222, v222
    v_exp_f32 v223, v223
    v_exp_f32 v224, v224
    v_mfma_f32_32x32x16_bf16 v[184:199], a[68:71], v[44:47], v[184:199]
    v_exp_f32 v225, v225
    v_exp_f32 v226, v226
    v_exp_f32 v227, v227
    v_smfmac_f32_32x32x32_bf16 v[232:247], a[80:83], v[216:223], v67
    v_exp_f32 v228, v228
    v_exp_f32 v229, v229
    v_exp_f32 v230, v230
    v_exp_f32 v231, v231
    v_exp_f32 v168, v168
    v_exp_f32 v169, v169
    v_smfmac_f32_32x32x32_bf16 v[232:247], a[84:87], v[224:231], v67
    s_waitcnt vmcnt(20)
    v_exp_f32 v170, v170
    v_exp_f32 v171, v171
    v_exp_f32 v172, v172
    v_mfma_f32_32x32x4_2b_bf16 v[200:231], v[62:63], v[58:59], 0 cbsz:1 abid:1
    v_exp_f32 v173, v173
    v_exp_f32 v174, v174
    v_exp_f32 v175, v175
    v_exp_f32 v176, v176
    v_exp_f32 v177, v177
    v_exp_f32 v178, v178
    v_exp_f32 v179, v179
    v_exp_f32 v180, v180
    v_smfmac_f32_32x32x32_bf16 v[72:87], a[88:91], v[168:175], v67
    buffer_load_dwordx4 a[80:83], v66, s[24:27], s62 offen offset:0 sc1
    buffer_load_dwordx4 a[84:87], v66, s[24:27], s62 offen offset:640 sc1
    buffer_load_dwordx4 v107, s[36:39], s89 offen offset:0 lds
    buffer_load_dwordx4 v108, s[36:39], s89 offen offset:1024 lds
    buffer_load_dwordx4 v109, s[36:39], s89 offen offset:2048 lds
    v_exp_f32 v181, v181
    v_exp_f32 v182, v182
    v_exp_f32 v183, v183
    v_exp_f32 v184, v184
    v_exp_f32 v185, v185
    v_exp_f32 v186, v186
    v_smfmac_f32_32x32x32_bf16 v[72:87], a[92:95], v[176:183], v67
    s_add_u32 s62, s62, 1280
    s_add_u32 s88, s64, 64512
    v_exp_f32 v187, v187
    v_exp_f32 v188, v188
    v_exp_f32 v189, v189
    v_mfma_f32_32x32x16_bf16 v[200:215], a[68:71], v[48:51], v[200:215]
    v_exp_f32 v190, v190
    v_exp_f32 v191, v191
    v_exp_f32 v192, v192
    v_mfma_f32_32x32x16_bf16 v[216:231], a[68:71], v[52:55], v[216:231]
    v_exp_f32 v193, v193
    v_exp_f32 v194, v194
    v_exp_f32 v195, v195
    v_smfmac_f32_32x32x32_bf16 v[88:103], a[88:91], v[184:191], v67
    s_add_u32 m0, s76, 6144
    v_exp_f32 v196, v196
    v_exp_f32 v197, v197
    v_exp_f32 v198, v198
    v_exp_f32 v199, v199
    v_exp_f32 v200, v200
    v_exp_f32 v201, v201
    v_smfmac_f32_32x32x32_bf16 v[88:103], a[92:95], v[192:199], v67
    s_waitcnt vmcnt(23)
    v_exp_f32 v202, v202
    v_exp_f32 v203, v203
    v_exp_f32 v204, v204
    v_mfma_f32_32x32x4_2b_bf16 v[168:199], v[32:33], v[56:57], 0 cbsz:1 abid:0
    v_exp_f32 v205, v205
    v_exp_f32 v206, v206
    v_exp_f32 v207, v207
    v_exp_f32 v208, v208
    v_exp_f32 v209, v209
    v_exp_f32 v210, v210
    v_exp_f32 v211, v211
    v_exp_f32 v212, v212
    v_smfmac_f32_32x32x32_bf16 v[16:31], a[88:91], v[200:207], v67
    buffer_load_dwordx2 v[62:63], v65, s[24:27], s88 offen sc1
    buffer_load_dwordx4 a[68:71], v64, s[24:27], s61 offen sc1
    buffer_load_dwordx4 v110, s[36:39], s89 offen offset:0 lds
    buffer_load_dwordx4 v111, s[36:39], s89 offen offset:1024 lds
    buffer_load_dwordx4 v112, s[36:39], s89 offen offset:2048 lds
    v_exp_f32 v213, v213
    v_exp_f32 v214, v214
    v_exp_f32 v215, v215
    v_exp_f32 v216, v216
    v_exp_f32 v217, v217
    v_exp_f32 v218, v218
    v_smfmac_f32_32x32x32_bf16 v[16:31], a[92:95], v[208:215], v67
    s_add_u32 s61, s61, 4608
    s_add_u32 s89, s75, 41472
    v_exp_f32 v219, v219
    v_exp_f32 v220, v220
    v_exp_f32 v221, v221
    v_mfma_f32_32x32x16_bf16 v[168:183], a[72:75], v[40:43], v[168:183]
    v_exp_f32 v222, v222
    v_exp_f32 v223, v223
    v_exp_f32 v224, v224
    v_mfma_f32_32x32x16_bf16 v[184:199], a[72:75], v[44:47], v[184:199]
    v_exp_f32 v225, v225
    v_exp_f32 v226, v226
    v_exp_f32 v227, v227
    v_smfmac_f32_32x32x32_bf16 v[232:247], a[88:91], v[216:223], v67
    s_add_u32 m0, s76, 9216
    v_exp_f32 v228, v228
    v_exp_f32 v229, v229
    v_exp_f32 v230, v230
    v_exp_f32 v231, v231
    v_exp_f32 v168, v168
    v_exp_f32 v169, v169
    v_smfmac_f32_32x32x32_bf16 v[232:247], a[92:95], v[224:231], v67
    s_waitcnt vmcnt(25)
    v_exp_f32 v170, v170
    v_exp_f32 v171, v171
    v_exp_f32 v172, v172
    v_mfma_f32_32x32x4_2b_bf16 v[200:231], v[32:33], v[58:59], 0 cbsz:1 abid:0
    v_exp_f32 v173, v173
    v_exp_f32 v174, v174
    v_exp_f32 v175, v175
    v_exp_f32 v176, v176
    v_exp_f32 v177, v177
    v_exp_f32 v178, v178
    v_exp_f32 v179, v179
    v_exp_f32 v180, v180
    v_smfmac_f32_32x32x32_bf16 v[72:87], a[96:99], v[168:175], v67
    buffer_load_dwordx4 a[88:91], v66, s[24:27], s62 offen offset:0 sc1
    buffer_load_dwordx4 a[92:95], v66, s[24:27], s62 offen offset:640 sc1
    buffer_load_dwordx4 v104, s[36:39], s89 offen offset:0 lds
    buffer_load_dwordx4 v105, s[36:39], s89 offen offset:1024 lds
    v_exp_f32 v181, v181
    v_exp_f32 v182, v182
    v_exp_f32 v183, v183
    v_exp_f32 v184, v184
    v_exp_f32 v185, v185
    v_exp_f32 v186, v186
    v_smfmac_f32_32x32x32_bf16 v[72:87], a[100:103], v[176:183], v67
    s_add_u32 s62, s62, 1280
    v_exp_f32 v187, v187
    v_exp_f32 v188, v188
    v_exp_f32 v189, v189
    v_mfma_f32_32x32x16_bf16 v[200:215], a[72:75], v[48:51], v[200:215]
    v_exp_f32 v190, v190
    v_exp_f32 v191, v191
    v_exp_f32 v192, v192
    v_mfma_f32_32x32x16_bf16 v[216:231], a[72:75], v[52:55], v[216:231]
    v_exp_f32 v193, v193
    v_exp_f32 v194, v194
    v_exp_f32 v195, v195
    v_smfmac_f32_32x32x32_bf16 v[88:103], a[96:99], v[184:191], v67
    v_exp_f32 v196, v196
    v_exp_f32 v197, v197
    v_exp_f32 v198, v198
    v_exp_f32 v199, v199
    v_exp_f32 v200, v200
    v_exp_f32 v201, v201
    v_smfmac_f32_32x32x32_bf16 v[88:103], a[100:103], v[192:199], v67
    s_waitcnt vmcnt(23)
    v_exp_f32 v202, v202
    v_exp_f32 v203, v203
    v_exp_f32 v204, v204
    v_mfma_f32_32x32x4_2b_bf16 v[168:199], v[32:33], v[56:57], 0 cbsz:1 abid:1
    v_exp_f32 v205, v205
    v_exp_f32 v206, v206
    v_exp_f32 v207, v207
    v_exp_f32 v208, v208
    v_exp_f32 v209, v209
    v_exp_f32 v210, v210
    v_exp_f32 v211, v211
    v_exp_f32 v212, v212
    v_smfmac_f32_32x32x32_bf16 v[16:31], a[96:99], v[200:207], v67
    buffer_load_dwordx4 a[72:75], v64, s[24:27], s61 offen sc1
    buffer_load_dwordx4 v106, s[36:39], s89 offen offset:2048 lds
    v_exp_f32 v213, v213
    v_exp_f32 v214, v214
    v_exp_f32 v215, v215
    v_exp_f32 v216, v216
    v_exp_f32 v217, v217
    v_exp_f32 v218, v218
    v_smfmac_f32_32x32x32_bf16 v[16:31], a[100:103], v[208:215], v67
    s_add_u32 s61, s61, 4608
    s_add_u32 m0, s76, 12288
    v_exp_f32 v219, v219
    v_exp_f32 v220, v220
    v_exp_f32 v221, v221
    v_mfma_f32_32x32x16_bf16 v[168:183], a[76:79], v[40:43], v[168:183]
    v_exp_f32 v222, v222
    v_exp_f32 v223, v223
    v_exp_f32 v224, v224
    v_mfma_f32_32x32x16_bf16 v[184:199], a[76:79], v[44:47], v[184:199]
    v_exp_f32 v225, v225
    v_exp_f32 v226, v226
    v_exp_f32 v227, v227
    v_smfmac_f32_32x32x32_bf16 v[232:247], a[96:99], v[216:223], v67
    s_waitcnt vmcnt(22)
    v_exp_f32 v228, v228
    v_exp_f32 v229, v229
    v_exp_f32 v230, v230
    v_exp_f32 v231, v231
    v_exp_f32 v168, v168
L_pg15:
    s_cbranch_execz L_tour_ret
    v_exp_f32 v169, v169
    v_smfmac_f32_32x32x32_bf16 v[232:247], a[100:103], v[224:231], v67
    s_waitcnt vmcnt(20)
    v_exp_f32 v170, v170
    v_exp_f32 v171, v171
    v_exp_f32 v172, v172
    v_mfma_f32_32x32x4_2b_bf16 v[200:231], v[32:33], v[58:59], 0 cbsz:1 abid:1
    v_exp_f32 v173, v173
    v_exp_f32 v174, v174
    v_exp_f32 v175, v175
    v_exp_f32 v176, v176
    v_exp_f32 v177, v177
    v_exp_f32 v178, v178
    v_exp_f32 v179, v179
    v_exp_f32 v180, v180
    v_smfmac_f32_32x32x32_bf16 v[72:87], a[104:107], v[168:175], v67
    buffer_load_dwordx4 a[96:99], v66, s[24:27], s62 offen offset:0 sc1
    buffer_load_dwordx4 a[100:103], v66, s[24:27], s62 offen offset:640 sc1
    buffer_load_dwordx4 v107, s[36:39], s89 offen offset:0 lds
    buffer_load_dwordx4 v108, s[36:39], s89 offen offset:1024 lds
    buffer_load_dwordx4 v109, s[36:39], s89 offen offset:2048 lds
    buffer_store_dword v67, v134, s[24:27], s81 offen sc1
    v_exp_f32 v181, v181
    v_exp_f32 v182, v182
    v_exp_f32 v183, v183
    v_exp_f32 v184, v184
    v_exp_f32 v185, v185
    v_exp_f32 v186, v186
    v_smfmac_f32_32x32x32_bf16 v[72:87], a[108:111], v[176:183], v67
    s_add_u32 s62, s62, 1280
    s_add_u32 s88, s64, 73728
    v_exp_f32 v187, v187
    v_exp_f32 v188, v188
    v_exp_f32 v189, v189
    v_mfma_f32_32x32x16_bf16 v[200:215], a[76:79], v[48:51], v[200:215]
    v_exp_f32 v190, v190
    v_exp_f32 v191, v191
    v_exp_f32 v192, v192
    v_mfma_f32_32x32x16_bf16 v[216:231], a[76:79], v[52:55], v[216:231]
    v_exp_f32 v193, v193
    v_exp_f32 v194, v194
    v_exp_f32 v195, v195
    v_smfmac_f32_32x32x32_bf16 v[88:103], a[104:107], v[184:191], v67
    s_add_u32 m0, s76, 15360
    v_exp_f32 v196, v196
    v_exp_f32 v197, v197
    v_exp_f32 v198, v198
    v_exp_f32 v199, v199
    v_exp_f32 v200, v200
    v_exp_f32 v201, v201
    v_smfmac_f32_32x32x32_bf16 v[88:103], a[108:111], v[192:199], v67
    s_waitcnt vmcnt(23)
    v_exp_f32 v202, v202
    v_exp_f32 v203, v203
    v_exp_f32 v204, v204
    v_mfma_f32_32x32x4_2b_bf16 v[168:199], v[60:61], v[56:57], 0 cbsz:1 abid:0
    v_exp_f32 v205, v205
    v_exp_f32 v206, v206
    v_exp_f32 v207, v207
    v_exp_f32 v208, v208
    v_exp_f32 v209, v209
    v_exp_f32 v210, v210
    v_exp_f32 v211, v211
    v_exp_f32 v212, v212
    v_smfmac_f32_32x32x32_bf16 v[16:31], a[104:107], v[200:207], v67
    buffer_load_dwordx2 v[32:33], v65, s[24:27], s88 offen sc1
    buffer_load_dwordx4 a[76:79], v64, s[24:27], s61 offen sc1
    buffer_load_dwordx4 v110, s[36:39], s89 offen offset:0 lds
    buffer_load_dwordx4 v111, s[36:39], s89 offen offset:1024 lds
    v_exp_f32 v213, v213
    v_exp_f32 v214, v214
    v_exp_f32 v215, v215
    v_exp_f32 v216, v216
    v_exp_f32 v217, v217
    v_exp_f32 v218, v218
    v_smfmac_f32_32x32x32_bf16 v[16:31], a[108:111], v[208:215], v67
    s_add_u32 s61, s61, 4608
    v_exp_f32 v219, v219
    v_exp_f32 v220, v220
    v_exp_f32 v221, v221
    v_mfma_f32_32x32x16_bf16 v[168:183], a[64:67], v[40:43], v[168:183]
    v_exp_f32 v222, v222
    v_exp_f32 v223, v223
    v_exp_f32 v224, v224
    v_mfma_f32_32x32x16_bf16 v[184:199], a[64:67], v[44:47], v[184:199]
    v_exp_f32 v225, v225
    v_exp_f32 v226, v226
    v_exp_f32 v227, v227
    v_smfmac_f32_32x32x32_bf16 v[232:247], a[104:107], v[216:223], v67
    v_exp_f32 v228, v228
    v_exp_f32 v229, v229
    v_exp_f32 v230, v230
    v_exp_f32 v231, v231
    v_exp_f32 v168, v168
    v_exp_f32 v169, v169
    v_smfmac_f32_32x32x32_bf16 v[232:247], a[108:111], v[224:231], v67
    s_waitcnt vmcnt(24)
    s_waitcnt vmcnt(16)
    v_exp_f32 v170, v170
    v_exp_f32 v171, v171
    v_exp_f32 v172, v172
    v_mfma_f32_32x32x4_2b_bf16 v[200:231], v[60:61], v[58:59], 0 cbsz:1 abid:0
    v_exp_f32 v173, v173
    v_exp_f32 v174, v174
    v_exp_f32 v175, v175
    v_exp_f32 v176, v176
    v_exp_f32 v177, v177
    v_exp_f32 v178, v178
    v_exp_f32 v179, v179
    v_exp_f32 v180, v180
    v_smfmac_f32_32x32x32_bf16 v[72:87], a[80:83], v[168:175], v67
    buffer_load_dwordx4 a[104:107], v66, s[24:27], s62 offen offset:0 sc1
    buffer_load_dwordx4 a[108:111], v66, s[24:27], s62 offen offset:640 sc1
    buffer_load_dwordx4 v112, s[36:39], s89 offen offset:2048 lds
    v_exp_f32 v181, v181
    v_exp_f32 v182, v182
    v_exp_f32 v183, v183
    v_exp_f32 v184, v184
    v_exp_f32 v185, v185
    v_exp_f32 v186, v186
    v_smfmac_f32_32x32x32_bf16 v[72:87], a[84:87], v[176:183], v67
    s_add_u32 s62, s62, 1280
    s_add_u32 s89, s75, 82944
    v_exp_f32 v187, v187
    v_exp_f32 v188, v188
    v_exp_f32 v189, v189
    v_mfma_f32_32x32x16_bf16 v[200:215], a[64:67], v[48:51], v[200:215]
    ds_read_b64_tr_b16 a[0:1], v130 offset:0
    ds_read_b64_tr_b16 a[2:3], v130 offset:2304
    v_exp_f32 v190, v190
    v_exp_f32 v191, v191
    v_exp_f32 v192, v192
    v_mfma_f32_32x32x16_bf16 v[216:231], a[64:67], v[52:55], v[216:231]
    ds_read_b64_tr_b16 a[4:5], v130 offset:32
    ds_read_b64_tr_b16 a[6:7], v130 offset:2336
    v_exp_f32 v193, v193
    v_exp_f32 v194, v194
    v_exp_f32 v195, v195
    v_smfmac_f32_32x32x32_bf16 v[88:103], a[80:83], v[184:191], v67
    s_add_u32 m0, s76, 18432
    v_exp_f32 v196, v196
    v_exp_f32 v197, v197
    v_exp_f32 v198, v198
    v_exp_f32 v199, v199
    v_exp_f32 v200, v200
    v_exp_f32 v201, v201
    v_smfmac_f32_32x32x32_bf16 v[88:103], a[84:87], v[192:199], v67
    v_exp_f32 v202, v202
    v_exp_f32 v203, v203
    v_exp_f32 v204, v204
    v_mfma_f32_32x32x4_2b_bf16 v[168:199], v[60:61], v[56:57], 0 cbsz:1 abid:1
    v_exp_f32 v205, v205
    v_exp_f32 v206, v206
    v_exp_f32 v207, v207
    v_exp_f32 v208, v208
    v_exp_f32 v209, v209
    v_exp_f32 v210, v210
    v_exp_f32 v211, v211
    v_exp_f32 v212, v212
    v_smfmac_f32_32x32x32_bf16 v[16:31], a[80:83], v[200:207], v67
    buffer_load_dwordx4 a[64:67], v64, s[24:27], s61 offen sc1
    buffer_load_dwordx4 v104, s[36:39], s89 offen offset:0 lds
    buffer_load_dwordx4 v105, s[36:39], s89 offen offset:1024 lds
    buffer_load_dwordx4 v106, s[36:39], s89 offen offset:2048 lds
    v_exp_f32 v213, v213
    v_exp_f32 v214, v214
    v_exp_f32 v215, v215
    v_exp_f32 v216, v216
    v_exp_f32 v217, v217
    v_exp_f32 v218, v218
    v_smfmac_f32_32x32x32_bf16 v[16:31], a[84:87], v[208:215], v67
    s_add_u32 s61, s61, 4608
    s_add_u32 m0, s76, 21504
    v_exp_f32 v219, v219
    v_exp_f32 v220, v220
    v_exp_f32 v221, v221
    v_mfma_f32_32x32x16_bf16 v[168:183], a[68:71], v[40:43], v[168:183]
    ds_read_b64_tr_b16 a[8:9], v130 offset:64
    ds_read_b64_tr_b16 a[10:11], v130 offset:2368
    v_exp_f32 v222, v222
    v_exp_f32 v223, v223
    v_exp_f32 v224, v224
    v_mfma_f32_32x32x16_bf16 v[184:199], a[68:71], v[44:47], v[184:199]
    ds_read_b64_tr_b16 a[12:13], v130 offset:96
    ds_read_b64_tr_b16 a[14:15], v130 offset:2400
    v_exp_f32 v225, v225
    v_exp_f32 v226, v226
    v_exp_f32 v227, v227
    v_smfmac_f32_32x32x32_bf16 v[232:247], a[80:83], v[216:223], v67
    v_exp_f32 v228, v228
    v_exp_f32 v229, v229
    v_exp_f32 v230, v230
    v_exp_f32 v231, v231
    v_exp_f32 v168, v168
    v_exp_f32 v169, v169
    v_smfmac_f32_32x32x32_bf16 v[232:247], a[84:87], v[224:231], v67
    s_waitcnt vmcnt(21)
    v_exp_f32 v170, v170
    v_exp_f32 v171, v171
    v_exp_f32 v172, v172
    v_mfma_f32_32x32x4_2b_bf16 v[200:231], v[60:61], v[58:59], 0 cbsz:1 abid:1
    v_exp_f32 v173, v173
    v_exp_f32 v174, v174
    v_exp_f32 v175, v175
    v_exp_f32 v176, v176
    v_exp_f32 v177, v177
    v_exp_f32 v178, v178
    v_exp_f32 v179, v179
    v_exp_f32 v180, v180
    v_smfmac_f32_32x32x32_bf16 v[72:87], a[88:91], v[168:175], v67
    buffer_load_dwordx4 a[80:83], v66, s[24:27], s62 offen offset:0 sc1
    buffer_load_dwordx4 a[84:87], v66, s[24:27], s62 offen offset:640 sc1
    buffer_load_dwordx4 v107, s[36:39], s89 offen offset:0 lds
    buffer_load_dwordx4 v108, s[36:39], s89 offen offset:1024 lds
    v_exp_f32 v181, v181
    v_exp_f32 v182, v182
    v_exp_f32 v183, v183
    v_exp_f32 v184, v184
    v_exp_f32 v185, v185
    v_exp_f32 v186, v186
    v_smfmac_f32_32x32x32_bf16 v[72:87], a[92:95], v[176:183], v67
    s_add_u32 s62, s62, 1280
    s_add_u32 s88, s64, 82944
    v_exp_f32 v187, v187
    v_exp_f32 v188, v188
    v_exp_f32 v189, v189
    v_mfma_f32_32x32x16_bf16 v[200:215], a[68:71], v[48:51], v[200:215]
    ds_read_b64_tr_b16 a[16:17], v130 offset:128
    ds_read_b64_tr_b16 a[18:19], v130 offset:2432
    v_exp_f32 v190, v190
    v_exp_f32 v191, v191
    v_exp_f32 v192, v192
    v_mfma_f32_32x32x16_bf16 v[216:231], a[68:71], v[52:55], v[216:231]
    ds_read_b64_tr_b16 a[20:21], v130 offset:160
    ds_read_b64_tr_b16 a[22:23], v130 offset:2464
    v_exp_f32 v193, v193
    v_exp_f32 v194, v194
    v_exp_f32 v195, v195
    v_smfmac_f32_32x32x32_bf16 v[88:103], a[88:91], v[184:191], v67
    v_exp_f32 v196, v196
    v_exp_f32 v197, v197
    v_exp_f32 v198, v198
    v_exp_f32 v199, v199
    v_exp_f32 v200, v200
    v_exp_f32 v201, v201
    v_smfmac_f32_32x32x32_bf16 v[88:103], a[92:95], v[192:199], v67
    s_waitcnt vmcnt(22)
    v_exp_f32 v202, v202
    v_exp_f32 v203, v203
    v_exp_f32 v204, v204
    v_mfma_f32_32x32x4_2b_bf16 v[168:199], v[62:63], v[56:57], 0 cbsz:1 abid:0
    v_exp_f32 v205, v205
    v_exp_f32 v206, v206
    v_exp_f32 v207, v207
    v_exp_f32 v208, v208
    v_exp_f32 v209, v209
    v_exp_f32 v210, v210
    v_exp_f32 v211, v211
    v_exp_f32 v212, v212
    v_smfmac_f32_32x32x32_bf16 v[16:31], a[88:91], v[200:207], v67
    buffer_load_dwordx2 v[60:61], v65, s[24:27], s88 offen sc1
    buffer_load_dwordx4 a[68:71], v64, s[24:27], s61 offen sc1
    buffer_load_dwordx4 v109, s[36:39], s89 offen offset:2048 lds
    v_exp_f32 v213, v213
    v_exp_f32 v214, v214
    v_exp_f32 v215, v215
    v_exp_f32 v216, v216
    v_exp_f32 v217, v217
    v_exp_f32 v218, v218
    v_smfmac_f32_32x32x32_bf16 v[16:31], a[92:95], v[208:215], v67
    s_add_u32 s61, s61, 4608
    s_add_u32 m0, s76, 24576
    v_exp_f32 v219, v219
    v_exp_f32 v220, v220
    v_exp_f32 v221, v221
    v_mfma_f32_32x32x16_bf16 v[168:183], a[72:75], v[40:43], v[168:183]
    ds_read_b64_tr_b16 a[24:25], v130 offset:192
    ds_read_b64_tr_b16 a[26:27], v130 offset:2496
    v_exp_f32 v222, v222
    v_exp_f32 v223, v223
    v_exp_f32 v224, v224
    v_mfma_f32_32x32x16_bf16 v[184:199], a[72:75], v[44:47], v[184:199]
    ds_read_b64_tr_b16 a[28:29], v130 offset:224
    ds_read_b64_tr_b16 a[30:31], v130 offset:2528
    v_exp_f32 v225, v225
    v_exp_f32 v226, v226
    v_exp_f32 v227, v227
    v_smfmac_f32_32x32x32_bf16 v[232:247], a[88:91], v[216:223], v67
    v_exp_f32 v228, v228
    v_exp_f32 v229, v229
    v_exp_f32 v230, v230
    v_exp_f32 v231, v231
    v_exp_f32 v168, v168
    v_exp_f32 v169, v169
    v_smfmac_f32_32x32x32_bf16 v[232:247], a[92:95], v[224:231], v67
    s_waitcnt vmcnt(22)
    v_exp_f32 v170, v170
    v_exp_f32 v171, v171
    v_exp_f32 v172, v172
    v_mfma_f32_32x32x4_2b_bf16 v[200:231], v[62:63], v[58:59], 0 cbsz:1 abid:0
    v_exp_f32 v173, v173
    v_exp_f32 v174, v174
    v_exp_f32 v175, v175
    v_exp_f32 v176, v176
    v_exp_f32 v177, v177
    v_exp_f32 v178, v178
    v_exp_f32 v179, v179
    v_exp_f32 v180, v180
    v_smfmac_f32_32x32x32_bf16 v[72:87], a[96:99], v[168:175], v67
    buffer_load_dwordx4 a[88:91], v66, s[24:27], s62 offen offset:0 sc1
    buffer_load_dwordx4 a[92:95], v66, s[24:27], s62 offen offset:640 sc1
    buffer_load_dwordx4 v110, s[36:39], s89 offen offset:0 lds
    buffer_load_dwordx4 v111, s[36:39], s89 offen offset:1024 lds
    buffer_load_dwordx4 v112, s[36:39], s89 offen offset:2048 lds
    v_exp_f32 v181, v181
    v_exp_f32 v182, v182
    v_exp_f32 v183, v183
    v_exp_f32 v184, v184
    v_exp_f32 v185, v185
    v_exp_f32 v186, v186
    v_smfmac_f32_32x32x32_bf16 v[72:87], a[100:103], v[176:183], v67
    s_add_u32 s62, s62, 1280
    v_exp_f32 v187, v187
    v_exp_f32 v188, v188
    v_exp_f32 v189, v189
    v_mfma_f32_32x32x16_bf16 v[200:215], a[72:75], v[48:51], v[200:215]
    ds_read_b64_tr_b16 a[32:33], v130 offset:256
    ds_read_b64_tr_b16 a[34:35], v130 offset:2560
    v_exp_f32 v190, v190
    v_exp_f32 v191, v191
    v_exp_f32 v192, v192
    v_mfma_f32_32x32x16_bf16 v[216:231], a[72:75], v[52:55], v[216:231]
    v_exp_f32 v193, v193
    v_exp_f32 v194, v194
    v_exp_f32 v195, v195
    v_smfmac_f32_32x32x32_bf16 v[88:103], a[96:99], v[184:191], v67
    v_exp_f32 v196, v196
    v_exp_f32 v197, v197
    v_exp_f32 v198, v198
    v_exp_f32 v199, v199
    v_exp_f32 v200, v200
    v_exp_f32 v201, v201
    v_smfmac_f32_32x32x32_bf16 v[88:103], a[100:103], v[192:199], v67
    s_waitcnt vmcnt(21)
    v_exp_f32 v202, v202
    v_exp_f32 v203, v203
    v_exp_f32 v204, v204
    v_mfma_f32_32x32x4_2b_bf16 v[168:199], v[62:63], v[56:57], 0 cbsz:1 abid:1
    v_exp_f32 v205, v205
    v_exp_f32 v206, v206
    v_exp_f32 v207, v207
    v_exp_f32 v208, v208
    v_exp_f32 v209, v209
    v_exp_f32 v210, v210
    v_exp_f32 v211, v211
    v_exp_f32 v212, v212
    v_smfmac_f32_32x32x32_bf16 v[16:31], a[96:99], v[200:207], v67
    buffer_load_dwordx4 a[72:75], v64, s[24:27], s61 offen sc1
    v_exp_f32 v213, v213
    v_exp_f32 v214, v214
    v_exp_f32 v215, v215
    v_exp_f32 v216, v216
    v_exp_f32 v217, v217
    v_exp_f32 v218, v218
    v_smfmac_f32_32x32x32_bf16 v[16:31], a[100:103], v[208:215], v67
    s_add_u32 s61, s61, 4608
    s_waitcnt lgkmcnt(0)
    v_exp_f32 v219, v219
    v_exp_f32 v220, v220
    v_exp_f32 v221, v221
    v_mfma_f32_32x32x16_bf16 v[168:183], a[76:79], v[40:43], v[168:183]
    v_exp_f32 v222, v222
    v_exp_f32 v223, v223
    v_exp_f32 v224, v224
    v_mfma_f32_32x32x16_bf16 v[184:199], a[76:79], v[44:47], v[184:199]
    v_exp_f32 v225, v225
    v_exp_f32 v226, v226
    v_exp_f32 v227, v227
    v_smfmac_f32_32x32x32_bf16 v[232:247], a[96:99], v[216:223], v67
    s_add_u32 s89, s75, 124416
    s_add_u32 m0, s76, 0
    v_exp_f32 v228, v228
    v_exp_f32 v229, v229
    v_exp_f32 v230, v230
    v_exp_f32 v231, v231
    v_exp_f32 v168, v168
    v_exp_f32 v169, v169
    v_smfmac_f32_32x32x32_bf16 v[232:247], a[100:103], v[224:231], v67
    s_waitcnt vmcnt(18)
    v_exp_f32 v170, v170
    v_exp_f32 v171, v171
    v_exp_f32 v172, v172
    v_mfma_f32_32x32x4_2b_bf16 v[200:231], v[62:63], v[58:59], 0 cbsz:1 abid:1
    v_exp_f32 v173, v173
    v_exp_f32 v174, v174
    v_exp_f32 v175, v175
    v_exp_f32 v176, v176
    v_exp_f32 v177, v177
    v_exp_f32 v178, v178
    v_exp_f32 v179, v179
    v_exp_f32 v180, v180
    v_smfmac_f32_32x32x32_bf16 v[72:87], a[104:107], v[168:175], v67
    buffer_load_dwordx4 a[96:99], v66, s[24:27], s62 offen offset:0 sc1
    buffer_load_dwordx4 a[100:103], v66, s[24:27], s62 offen offset:640 sc1
    buffer_load_dwordx4 v104, s[36:39], s89 offen offset:0 lds
    buffer_load_dwordx4 v105, s[36:39], s89 offen offset:1024 lds
    buffer_load_dword v70, v135, s[24:27], s84 offen sc1
    v_exp_f32 v181, v181
    v_exp_f32 v182, v182
    v_exp_f32 v183, v183
    v_exp_f32 v184, v184
    v_exp_f32 v185, v185
    v_exp_f32 v186, v186
    v_smfmac_f32_32x32x32_bf16 v[72:87], a[108:111], v[176:183], v67
    s_add_u32 s62, s62, 1280
    s_add_u32 s88, s64, 92160
    v_exp_f32 v187, v187
    v_exp_f32 v188, v188
    v_exp_f32 v189, v189
    v_mfma_f32_32x32x16_bf16 v[200:215], a[76:79], v[48:51], v[200:215]
    v_exp_f32 v190, v190
    v_exp_f32 v191, v191
    v_exp_f32 v192, v192
    v_mfma_f32_32x32x16_bf16 v[216:231], a[76:79], v[52:55], v[216:231]
    v_exp_f32 v193, v193
    v_exp_f32 v194, v194
    v_exp_f32 v195, v195
    v_smfmac_f32_32x32x32_bf16 v[88:103], a[104:107], v[184:191], v67
    v_exp_f32 v196, v196
    v_exp_f32 v197, v197
    v_exp_f32 v198, v198
    v_exp_f32 v199, v199
    v_exp_f32 v200, v200
    v_exp_f32 v201, v201
    v_smfmac_f32_32x32x32_bf16 v[88:103], a[108:111], v[192:199], v67
    s_waitcnt vmcnt(21)
    v_exp_f32 v202, v202
    v_exp_f32 v203, v203
    v_exp_f32 v204, v204
    v_mfma_f32_32x32x4_2b_bf16 v[168:199], v[32:33], v[56:57], 0 cbsz:1 abid:0
    v_exp_f32 v205, v205
    v_exp_f32 v206, v206
    v_exp_f32 v207, v207
    v_exp_f32 v208, v208
    v_exp_f32 v209, v209
    v_exp_f32 v210, v210
    v_exp_f32 v211, v211
    v_exp_f32 v212, v212
    v_smfmac_f32_32x32x32_bf16 v[16:31], a[104:107], v[200:207], v67
    buffer_load_dwordx2 v[62:63], v65, s[24:27], s88 offen sc1
    buffer_load_dwordx4 a[76:79], v64, s[24:27], s61 offen sc1
    buffer_load_dwordx4 v106, s[36:39], s89 offen offset:2048 lds
    v_exp_f32 v213, v213
    v_exp_f32 v214, v214
    v_exp_f32 v215, v215
    v_exp_f32 v216, v216
    v_exp_f32 v217, v217
    v_exp_f32 v218, v218
    v_smfmac_f32_32x32x32_bf16 v[16:31], a[108:111], v[208:215], v67
    s_add_u32 s61, s61, 4608
    s_add_u32 m0, s76, 3072
    v_exp_f32 v219, v219
    v_exp_f32 v220, v220
    v_exp_f32 v221, v221
    v_mfma_f32_32x32x16_bf16 v[168:183], a[64:67], v[40:43], v[168:183]
    v_exp_f32 v222, v222
    v_exp_f32 v223, v223
    v_exp_f32 v224, v224
    v_mfma_f32_32x32x16_bf16 v[184:199], a[64:67], v[44:47], v[184:199]
    v_exp_f32 v225, v225
    v_exp_f32 v226, v226
    v_exp_f32 v227, v227
    v_smfmac_f32_32x32x32_bf16 v[232:247], a[104:107], v[216:223], v67
    v_exp_f32 v228, v228
    v_exp_f32 v229, v229
    v_exp_f32 v230, v230
    v_exp_f32 v231, v231
    v_exp_f32 v168, v168
    v_exp_f32 v169, v169
    v_smfmac_f32_32x32x32_bf16 v[232:247], a[108:111], v[224:231], v67
    s_waitcnt vmcnt(19)
    v_exp_f32 v170, v170
    v_exp_f32 v171, v171
    v_exp_f32 v172, v172
    v_mfma_f32_32x32x4_2b_bf16 v[200:231], v[32:33], v[58:59], 0 cbsz:1 abid:0
    v_exp_f32 v173, v173
    v_exp_f32 v174, v174
    v_exp_f32 v175, v175
    v_exp_f32 v176, v176
    v_exp_f32 v177, v177
    v_exp_f32 v178, v178
    v_exp_f32 v179, v179
    v_exp_f32 v180, v180
    v_smfmac_f32_32x32x32_bf16 v[72:87], a[80:83], v[168:175], v67
    buffer_load_dwordx4 a[104:107], v66, s[24:27], s62 offen offset:0 sc1
    buffer_load_dwordx4 a[108:111], v66, s[24:27], s62 offen offset:640 sc1
    buffer_load_dwordx4 v107, s[36:39], s89 offen offset:0 lds
    buffer_load_dwordx4 v108, s[36:39], s89 offen offset:1024 lds
    buffer_load_dwordx4 v109, s[36:39], s89 offen offset:2048 lds
    v_exp_f32 v181, v181
    v_exp_f32 v182, v182
    v_exp_f32 v183, v183
    v_exp_f32 v184, v184
    v_exp_f32 v185, v185
    v_exp_f32 v186, v186
    v_smfmac_f32_32x32x32_bf16 v[72:87], a[84:87], v[176:183], v67
    s_add_u32 s62, s62, 1280
    s_add_u32 m0, s76, 6144
    v_exp_f32 v187, v187
    v_exp_f32 v188, v188
    v_exp_f32 v189, v189
    v_mfma_f32_32x32x16_bf16 v[200:215], a[64:67], v[48:51], v[200:215]
    v_exp_f32 v190, v190
    v_exp_f32 v191, v191
    v_exp_f32 v192, v192
    v_mfma_f32_32x32x16_bf16 v[216:231], a[64:67], v[52:55], v[216:231]
    v_exp_f32 v193, v193
    v_exp_f32 v194, v194
    v_exp_f32 v195, v195
    v_smfmac_f32_32x32x32_bf16 v[88:103], a[80:83], v[184:191], v67
    v_exp_f32 v196, v196
    v_exp_f32 v197, v197
    v_exp_f32 v198, v198
    v_exp_f32 v199, v199
    v_exp_f32 v200, v200
    v_exp_f32 v201, v201
    v_smfmac_f32_32x32x32_bf16 v[88:103], a[84:87], v[192:199], v67
    s_waitcnt vmcnt(20)
    v_exp_f32 v202, v202
    v_exp_f32 v203, v203
    v_exp_f32 v204, v204
    v_mfma_f32_32x32x4_2b_bf16 v[168:199], v[32:33], v[56:57], 0 cbsz:1 abid:1
    v_exp_f32 v205, v205
    v_exp_f32 v206, v206
    v_exp_f32 v207, v207
    v_exp_f32 v208, v208
    v_exp_f32 v209, v209
    v_exp_f32 v210, v210
    v_exp_f32 v211, v211
    v_exp_f32 v212, v212
    v_smfmac_f32_32x32x32_bf16 v[16:31], a[80:83], v[200:207], v67
    buffer_load_dwordx4 a[64:67], v64, s[24:27], s61 offen sc1
    buffer_load_dwordx4 v110, s[36:39], s89 offen offset:0 lds
    v_exp_f32 v213, v213
    v_exp_f32 v214, v214
    v_exp_f32 v215, v215
    v_exp_f32 v216, v216
    v_exp_f32 v217, v217
    v_exp_f32 v218, v218
    v_smfmac_f32_32x32x32_bf16 v[16:31], a[84:87], v[208:215], v67
    s_add_u32 s61, s61, 4608
    v_exp_f32 v219, v219
    v_exp_f32 v220, v220
    v_exp_f32 v221, v221
    v_mfma_f32_32x32x16_bf16 v[168:183], a[68:71], v[40:43], v[168:183]
    v_exp_f32 v222, v222
    v_exp_f32 v223, v223
    v_exp_f32 v224, v224
    v_mfma_f32_32x32x16_bf16 v[184:199], a[68:71], v[44:47], v[184:199]
    v_exp_f32 v225, v225
    v_exp_f32 v226, v226
    v_exp_f32 v227, v227
    v_smfmac_f32_32x32x32_bf16 v[232:247], a[80:83], v[216:223], v67
    v_exp_f32 v228, v228
    v_exp_f32 v229, v229
    v_exp_f32 v230, v230
    v_exp_f32 v231, v231
    s_waitcnt vmcnt(10)
    v_cmp_eq_u32 s[86:87], v67, v70
    s_nop 0
    s_cmp_eq_u32 s86, 255
    s_cbranch_scc0 L_spinB
L_backB:
    v_exp_f32 v168, v168
    v_exp_f32 v169, v169
    v_smfmac_f32_32x32x32_bf16 v[232:247], a[84:87], v[224:231], v67
    v_exp_f32 v170, v170
    v_exp_f32 v171, v171
    v_exp_f32 v172, v172
    v_mfma_f32_32x32x4_2b_bf16 v[200:231], v[32:33], v[58:59], 0 cbsz:1 abid:1
    v_exp_f32 v173, v173
    v_exp_f32 v174, v174
    v_exp_f32 v175, v175
    v_exp_f32 v176, v176
    v_exp_f32 v177, v177
    v_exp_f32 v178, v178
    v_exp_f32 v179, v179
    v_exp_f32 v180, v180
    v_smfmac_f32_32x32x32_bf16 v[72:87], a[88:91], v[168:175], v67
    buffer_load_dwordx4 a[80:83], v66, s[24:27], s62 offen offset:0 sc1
    buffer_load_dwordx4 a[84:87], v66, s[24:27], s62 offen offset:640 sc1
    buffer_load_dwordx4 v111, s[36:39], s89 offen offset:1024 lds
    buffer_load_dwordx4 v112, s[36:39], s89 offen offset:2048 lds
    v_exp_f32 v181, v181
    v_exp_f32 v182, v182
    v_exp_f32 v183, v183
    v_exp_f32 v184, v184
    v_exp_f32 v185, v185
    v_exp_f32 v186, v186
    v_smfmac_f32_32x32x32_bf16 v[72:87], a[92:95], v[176:183], v67
    s_add_u32 s62, s62, 1280
    s_add_u32 s88, s64, 101376
    v_exp_f32 v187, v187
    v_exp_f32 v188, v188
    v_exp_f32 v189, v189
    v_mfma_f32_32x32x16_bf16 v[200:215], a[68:71], v[48:51], v[200:215]
    v_exp_f32 v190, v190
    v_exp_f32 v191, v191
    v_exp_f32 v192, v192
    v_mfma_f32_32x32x16_bf16 v[216:231], a[68:71], v[52:55], v[216:231]
    v_exp_f32 v193, v193
    v_exp_f32 v194, v194
    v_exp_f32 v195, v195
    v_smfmac_f32_32x32x32_bf16 v[88:103], a[88:91], v[184:191], v67
    v_exp_f32 v196, v196
    v_exp_f32 v197, v197
    v_exp_f32 v198, v198
    v_exp_f32 v199, v199
    v_exp_f32 v200, v200
    v_exp_f32 v201, v201
    v_smfmac_f32_32x32x32_bf16 v[88:103], a[92:95], v[192:199], v67
    v_exp_f32 v202, v202
    v_exp_f32 v203, v203
    v_exp_f32 v204, v204
    v_mfma_f32_32x32x4_2b_bf16 v[168:199], v[60:61], v[56:57], 0 cbsz:1 abid:0
    v_exp_f32 v205, v205
    v_exp_f32 v206, v206
    v_exp_f32 v207, v207
    v_exp_f32 v208, v208
    v_exp_f32 v209, v209
    v_exp_f32 v210, v210
    v_exp_f32 v211, v211
    v_exp_f32 v212, v212
    v_smfmac_f32_32x32x32_bf16 v[16:31], a[88:91], v[200:207], v67
    buffer_load_dwordx2 v[32:33], v65, s[24:27], s88 offen sc1
    buffer_load_dwordx4 a[68:71], v64, s[24:27], s61 offen sc1
    buffer_load_dwordx4 a[36:39], v125, s[4:7], s78 offen
    buffer_load_dwordx4 a[40:43], v126, s[4:7], s78 offen
    v_exp_f32 v213, v213
    v_exp_f32 v214, v214
    v_exp_f32 v215, v215
    v_exp_f32 v216, v216
    v_exp_f32 v217, v217
    v_exp_f32 v218, v218
    v_smfmac_f32_32x32x32_bf16 v[16:31], a[92:95], v[208:215], v67
    s_add_u32 s61, s61, 4608
    v_exp_f32 v219, v219
    v_exp_f32 v220, v220
    v_exp_f32 v221, v221
    v_mfma_f32_32x32x16_bf16 v[168:183], a[72:75], v[40:43], v[168:183]
    v_exp_f32 v222, v222
    v_exp_f32 v223, v223
    v_exp_f32 v224, v224
    v_mfma_f32_32x32x16_bf16 v[184:199], a[72:75], v[44:47], v[184:199]
    v_exp_f32 v225, v225
    v_exp_f32 v226, v226
    v_exp_f32 v227, v227
    v_smfmac_f32_32x32x32_bf16 v[232:247], a[88:91], v[216:223], v67
    v_exp_f32 v228, v228
    v_exp_f32 v229, v229
    v_exp_f32 v230, v230
    v_exp_f32 v231, v231
    v_exp_f32 v168, v168
    v_exp_f32 v169, v169
    v_smfmac_f32_32x32x32_bf16 v[232:247], a[92:95], v[224:231], v67
    v_exp_f32 v170, v170
    v_exp_f32 v171, v171
    v_exp_f32 v172, v172
    v_mfma_f32_32x32x4_2b_bf16 v[200:231], v[60:61], v[58:59], 0 cbsz:1 abid:0
    v_exp_f32 v173, v173
    v_exp_f32 v174, v174
    v_exp_f32 v175, v175
    v_exp_f32 v176, v176
    v_exp_f32 v177, v177
    v_exp_f32 v178, v178
    v_exp_f32 v179, v179
    v_exp_f32 v180, v180
    v_smfmac_f32_32x32x32_bf16 v[72:87], a[96:99], v[168:175], v67
    buffer_load_dwordx4 a[88:91], v66, s[24:27], s62 offen offset:0 sc1
    buffer_load_dwordx4 a[92:95], v66, s[24:27], s62 offen offset:640 sc1
    buffer_load_dwordx4 a[44:47], v127, s[4:7], s78 offen
    v_exp_f32 v181, v181
    v_exp_f32 v182, v182
    v_exp_f32 v183, v183
    v_exp_f32 v184, v184
    v_exp_f32 v185, v185
    v_exp_f32 v186, v186
    v_smfmac_f32_32x32x32_bf16 v[72:87], a[100:103], v[176:183], v67
    s_add_u32 s62, s62, 1280
    s_add_u32 s60, s71, 0
    v_exp_f32 v187, v187
    v_exp_f32 v188, v188
    v_exp_f32 v189, v189
    v_mfma_f32_32x32x16_bf16 v[200:215], a[72:75], v[48:51], v[200:215]
    v_exp_f32 v190, v190
    v_exp_f32 v191, v191
    v_exp_f32 v192, v192
    v_mfma_f32_32x32x16_bf16 v[216:231], a[72:75], v[52:55], v[216:231]
    v_exp_f32 v193, v193
    v_exp_f32 v194, v194
    v_exp_f32 v195, v195
    v_smfmac_f32_32x32x32_bf16 v[88:103], a[96:99], v[184:191], v67
    v_exp_f32 v196, v196
    v_exp_f32 v197, v197
    v_exp_f32 v198, v198
    v_exp_f32 v199, v199
    v_exp_f32 v200, v200
    v_exp_f32 v201, v201
    v_smfmac_f32_32x32x32_bf16 v[88:103], a[100:103], v[192:199], v67
    s_waitcnt vmcnt(19)
    v_exp_f32 v202, v202
    v_exp_f32 v203, v203
    v_exp_f32 v204, v204
    v_mfma_f32_32x32x4_2b_bf16 v[168:199], v[60:61], v[56:57], 0 cbsz:1 abid:1
    v_exp_f32 v205, v205
    v_exp_f32 v206, v206
    v_exp_f32 v207, v207
    v_exp_f32 v208, v208
    v_exp_f32 v209, v209
    v_exp_f32 v210, v210
    v_exp_f32 v211, v211
    v_exp_f32 v212, v212
    v_smfmac_f32_32x32x32_bf16 v[16:31], a[96:99], v[200:207], v67
    buffer_load_dwordx4 a[72:75], v64, s[24:27], s61 offen sc1
    buffer_load_dwordx4 a[112:115], v4, s[24:27], s60 offen offset:0 sc1
    buffer_load_dwordx4 a[116:119], v4, s[24:27], s60 offen offset:1024 sc1
    v_exp_f32 v213, v213
    v_exp_f32 v214, v214
    v_exp_f32 v215, v215
    v_exp_f32 v216, v216
    v_exp_f32 v217, v217
    v_exp_f32 v218, v218
    v_smfmac_f32_32x32x32_bf16 v[16:31], a[100:103], v[208:215], v67
    s_add_u32 s61, s61, 4608
    v_exp_f32 v219, v219
    v_exp_f32 v220, v220
    v_exp_f32 v221, v221
    v_mfma_f32_32x32x16_bf16 v[168:183], a[76:79], v[40:43], v[168:183]
    v_exp_f32 v222, v222
    v_exp_f32 v223, v223
    v_exp_f32 v224, v224
    v_mfma_f32_32x32x16_bf16 v[184:199], a[76:79], v[44:47], v[184:199]
    v_exp_f32 v225, v225
    v_exp_f32 v226, v226
    v_exp_f32 v227, v227
    v_smfmac_f32_32x32x32_bf16 v[232:247], a[96:99], v[216:223], v67
    v_exp_f32 v228, v228
    v_exp_f32 v229, v229
    v_exp_f32 v230, v230
    v_exp_f32 v231, v231
    v_exp_f32 v168, v168
    v_exp_f32 v169, v169
    v_smfmac_f32_32x32x32_bf16 v[232:247], a[100:103], v[224:231], v67
    s_waitcnt vmcnt(19)
    v_exp_f32 v170, v170
    v_exp_f32 v171, v171
    v_exp_f32 v172, v172
    v_mfma_f32_32x32x4_2b_bf16 v[200:231], v[60:61], v[58:59], 0 cbsz:1 abid:1
    v_exp_f32 v173, v173
    v_exp_f32 v174, v174
    v_exp_f32 v175, v175
    v_exp_f32 v176, v176
    v_exp_f32 v177, v177
    v_exp_f32 v178, v178
    v_exp_f32 v179, v179
    v_exp_f32 v180, v180
    v_smfmac_f32_32x32x32_bf16 v[72:87], a[104:107], v[168:175], v67
    buffer_load_dwordx4 a[96:99], v66, s[24:27], s62 offen offset:0 sc1
    buffer_load_dwordx4 a[100:103], v66, s[24:27], s62 offen offset:640 sc1
    buffer_load_dwordx4 a[120:123], v4, s[24:27], s60 offen offset:2048 sc1
    v_exp_f32 v181, v181
    v_exp_f32 v182, v182
    v_exp_f32 v183, v183
    v_exp_f32 v184, v184
    v_exp_f32 v185, v185
    v_exp_f32 v186, v186
    v_smfmac_f32_32x32x32_bf16 v[72:87], a[108:111], v[176:183], v67
    s_add_u32 s62, s62, 1280
    s_add_u32 s88, s64, 110592
    v_exp_f32 v187, v187
    v_exp_f32 v188, v188
    v_exp_f32 v189, v189
    v_mfma_f32_32x32x16_bf16 v[200:215], a[76:79], v[48:51], v[200:215]
    v_exp_f32 v190, v190
    v_exp_f32 v191, v191
    v_exp_f32 v192, v192
    v_mfma_f32_32x32x16_bf16 v[216:231], a[76:79], v[52:55], v[216:231]
    v_exp_f32 v193, v193
    v_exp_f32 v194, v194
    v_exp_f32 v195, v195
    v_smfmac_f32_32x32x32_bf16 v[88:103], a[104:107], v[184:191], v67
    v_exp_f32 v196, v196
    v_exp_f32 v197, v197
L_pg16:
    s_cbranch_execz L_tour_ret
    v_exp_f32 v198, v198
    v_exp_f32 v199, v199
    v_exp_f32 v200, v200
    v_exp_f32 v201, v201
    v_smfmac_f32_32x32x32_bf16 v[88:103], a[108:111], v[192:199], v67
    s_waitcnt vmcnt(18)
    v_exp_f32 v202, v202
    v_exp_f32 v203, v203
    v_exp_f32 v204, v204
    v_mfma_f32_32x32x4_2b_bf16 v[168:199], v[62:63], v[56:57], 0 cbsz:1 abid:0
    v_exp_f32 v205, v205
    v_exp_f32 v206, v206
    v_exp_f32 v207, v207
    v_exp_f32 v208, v208
    v_exp_f32 v209, v209
    v_exp_f32 v210, v210
    v_exp_f32 v211, v211
    v_exp_f32 v212, v212
    v_smfmac_f32_32x32x32_bf16 v[16:31], a[104:107], v[200:207], v67
    buffer_load_dwordx2 v[60:61], v65, s[24:27], s88 offen sc1
    buffer_load_dwordx4 a[76:79], v64, s[24:27], s61 offen sc1
    buffer_load_dwordx4 a[124:127], v4, s[24:27], s60 offen offset:3072 sc1
    v_exp_f32 v213, v213
    v_exp_f32 v214, v214
    v_exp_f32 v215, v215
    v_exp_f32 v216, v216
    v_exp_f32 v217, v217
    v_exp_f32 v218, v218
    v_smfmac_f32_32x32x32_bf16 v[16:31], a[108:111], v[208:215], v67
    s_add_u32 s61, s61, 4608
    s_add_u32 s60, s71, 16384
    v_exp_f32 v219, v219
    v_exp_f32 v220, v220
    v_exp_f32 v221, v221
    v_mfma_f32_32x32x16_bf16 v[168:183], a[64:67], v[40:43], v[168:183]
    v_exp_f32 v222, v222
    v_exp_f32 v223, v223
    v_exp_f32 v224, v224
    v_mfma_f32_32x32x16_bf16 v[184:199], a[64:67], v[44:47], v[184:199]
    v_exp_f32 v225, v225
    v_exp_f32 v226, v226
    v_exp_f32 v227, v227
    v_smfmac_f32_32x32x32_bf16 v[232:247], a[104:107], v[216:223], v67
    v_exp_f32 v228, v228
    v_exp_f32 v229, v229
    v_exp_f32 v230, v230
    v_exp_f32 v231, v231
    v_exp_f32 v168, v168
    v_exp_f32 v169, v169
    v_smfmac_f32_32x32x32_bf16 v[232:247], a[108:111], v[224:231], v67
    s_waitcnt vmcnt(18)
    v_exp_f32 v170, v170
    v_exp_f32 v171, v171
    v_exp_f32 v172, v172
    v_mfma_f32_32x32x4_2b_bf16 v[200:231], v[62:63], v[58:59], 0 cbsz:1 abid:0
    v_exp_f32 v173, v173
    v_exp_f32 v174, v174
    v_exp_f32 v175, v175
    v_exp_f32 v176, v176
    v_exp_f32 v177, v177
    v_exp_f32 v178, v178
    v_exp_f32 v179, v179
    v_exp_f32 v180, v180
    v_smfmac_f32_32x32x32_bf16 v[72:87], a[80:83], v[168:175], v67
    buffer_load_dwordx4 a[104:107], v66, s[24:27], s62 offen offset:0 sc1
    buffer_load_dwordx4 a[108:111], v66, s[24:27], s62 offen offset:640 sc1
    buffer_load_dwordx4 a[128:131], v4, s[24:27], s60 offen offset:0 sc1
    buffer_load_dwordx4 a[132:135], v4, s[24:27], s60 offen offset:1024 sc1
    v_exp_f32 v181, v181
    v_exp_f32 v182, v182
    v_exp_f32 v183, v183
    v_exp_f32 v184, v184
    v_exp_f32 v185, v185
    v_exp_f32 v186, v186
    v_smfmac_f32_32x32x32_bf16 v[72:87], a[84:87], v[176:183], v67
    s_add_u32 s62, s62, 1280
    v_exp_f32 v187, v187
    v_exp_f32 v188, v188
    v_exp_f32 v189, v189
    v_mfma_f32_32x32x16_bf16 v[200:215], a[64:67], v[48:51], v[200:215]
    v_exp_f32 v190, v190
    v_exp_f32 v191, v191
    v_exp_f32 v192, v192
    v_mfma_f32_32x32x16_bf16 v[216:231], a[64:67], v[52:55], v[216:231]
    v_exp_f32 v193, v193
    v_exp_f32 v194, v194
    v_exp_f32 v195, v195
    v_smfmac_f32_32x32x32_bf16 v[88:103], a[80:83], v[184:191], v67
    v_exp_f32 v196, v196
    v_exp_f32 v197, v197
    v_exp_f32 v198, v198
    v_exp_f32 v199, v199
    v_exp_f32 v200, v200
    v_exp_f32 v201, v201
    v_smfmac_f32_32x32x32_bf16 v[88:103], a[84:87], v[192:199], v67
    s_waitcnt vmcnt(18)
    v_exp_f32 v202, v202
    v_exp_f32 v203, v203
    v_exp_f32 v204, v204
    v_mfma_f32_32x32x4_2b_bf16 v[168:199], v[62:63], v[56:57], 0 cbsz:1 abid:1
    v_exp_f32 v205, v205
    v_exp_f32 v206, v206
    v_exp_f32 v207, v207
    v_exp_f32 v208, v208
    v_exp_f32 v209, v209
    v_exp_f32 v210, v210
    v_exp_f32 v211, v211
    v_exp_f32 v212, v212
    v_smfmac_f32_32x32x32_bf16 v[16:31], a[80:83], v[200:207], v67
    buffer_load_dwordx4 a[64:67], v64, s[24:27], s61 offen sc1
    buffer_load_dwordx4 a[136:139], v4, s[24:27], s60 offen offset:2048 sc1
    buffer_load_dwordx4 a[140:143], v4, s[24:27], s60 offen offset:3072 sc1
    v_exp_f32 v213, v213
    v_exp_f32 v214, v214
    v_exp_f32 v215, v215
    v_exp_f32 v216, v216
    v_exp_f32 v217, v217
    v_exp_f32 v218, v218
    v_smfmac_f32_32x32x32_bf16 v[16:31], a[84:87], v[208:215], v67
    s_add_u32 s61, s61, 4608
    s_add_u32 s60, s71, 32768
    v_exp_f32 v219, v219
    v_exp_f32 v220, v220
    v_exp_f32 v221, v221
    v_mfma_f32_32x32x16_bf16 v[168:183], a[68:71], v[40:43], v[168:183]
    v_exp_f32 v222, v222
    v_exp_f32 v223, v223
    v_exp_f32 v224, v224
    v_mfma_f32_32x32x16_bf16 v[184:199], a[68:71], v[44:47], v[184:199]
    v_exp_f32 v225, v225
    v_exp_f32 v226, v226
    v_exp_f32 v227, v227
    v_smfmac_f32_32x32x32_bf16 v[232:247], a[80:83], v[216:223], v67
    v_exp_f32 v228, v228
    v_exp_f32 v229, v229
    v_exp_f32 v230, v230
    v_exp_f32 v231, v231
    v_exp_f32 v168, v168
    v_exp_f32 v169, v169
    v_smfmac_f32_32x32x32_bf16 v[232:247], a[84:87], v[224:231], v67
    s_waitcnt vmcnt(17)
    v_exp_f32 v170, v170
    v_exp_f32 v171, v171
    v_exp_f32 v172, v172
    v_mfma_f32_32x32x4_2b_bf16 v[200:231], v[62:63], v[58:59], 0 cbsz:1 abid:1
    v_exp_f32 v173, v173
    v_exp_f32 v174, v174
    v_exp_f32 v175, v175
    v_exp_f32 v176, v176
    v_exp_f32 v177, v177
    v_exp_f32 v178, v178
    v_exp_f32 v179, v179
    v_exp_f32 v180, v180
    v_smfmac_f32_32x32x32_bf16 v[72:87], a[88:91], v[168:175], v67
    buffer_load_dwordx4 a[80:83], v66, s[24:27], s62 offen offset:0 sc1
    buffer_load_dwordx4 a[84:87], v66, s[24:27], s62 offen offset:640 sc1
    buffer_load_dwordx4 a[144:147], v4, s[24:27], s60 offen offset:0 sc1
    v_exp_f32 v181, v181
    v_exp_f32 v182, v182
    v_exp_f32 v183, v183
    v_exp_f32 v184, v184
    v_exp_f32 v185, v185
    v_exp_f32 v186, v186
    v_smfmac_f32_32x32x32_bf16 v[72:87], a[92:95], v[176:183], v67
    s_add_u32 s62, s62, 1280
    s_add_u32 s88, s64, 119808
    v_exp_f32 v187, v187
    v_exp_f32 v188, v188
    v_exp_f32 v189, v189
    v_mfma_f32_32x32x16_bf16 v[200:215], a[68:71], v[48:51], v[200:215]
    v_exp_f32 v190, v190
    v_exp_f32 v191, v191
    v_exp_f32 v192, v192
    v_mfma_f32_32x32x16_bf16 v[216:231], a[68:71], v[52:55], v[216:231]
    v_exp_f32 v193, v193
    v_exp_f32 v194, v194
    v_exp_f32 v195, v195
    v_smfmac_f32_32x32x32_bf16 v[88:103], a[88:91], v[184:191], v67
    v_exp_f32 v196, v196
    v_exp_f32 v197, v197
    v_exp_f32 v198, v198
    v_exp_f32 v199, v199
    v_exp_f32 v200, v200
    v_exp_f32 v201, v201
    v_smfmac_f32_32x32x32_bf16 v[88:103], a[92:95], v[192:199], v67
    s_waitcnt vmcnt(18)
    v_exp_f32 v202, v202
    v_exp_f32 v203, v203
    v_exp_f32 v204, v204
    v_mfma_f32_32x32x4_2b_bf16 v[168:199], v[32:33], v[56:57], 0 cbsz:1 abid:0
    v_exp_f32 v205, v205
    v_exp_f32 v206, v206
    v_exp_f32 v207, v207
    v_exp_f32 v208, v208
    v_exp_f32 v209, v209
    v_exp_f32 v210, v210
    v_exp_f32 v211, v211
    v_exp_f32 v212, v212
    v_smfmac_f32_32x32x32_bf16 v[16:31], a[88:91], v[200:207], v67
    buffer_load_dwordx2 v[62:63], v65, s[24:27], s88 offen sc1
    buffer_load_dwordx4 a[68:71], v64, s[24:27], s61 offen sc1
    buffer_load_dwordx4 a[148:151], v4, s[24:27], s60 offen offset:1024 sc1
    buffer_load_dwordx4 a[152:155], v4, s[24:27], s60 offen offset:2048 sc1
    v_exp_f32 v213, v213
    v_exp_f32 v214, v214
    v_exp_f32 v215, v215
    v_exp_f32 v216, v216
    v_exp_f32 v217, v217
    v_exp_f32 v218, v218
    v_smfmac_f32_32x32x32_bf16 v[16:31], a[92:95], v[208:215], v67
    s_add_u32 s61, s61, 4608
    v_exp_f32 v219, v219
    v_exp_f32 v220, v220
    v_exp_f32 v221, v221
    v_mfma_f32_32x32x16_bf16 v[168:183], a[72:75], v[40:43], v[168:183]
    v_exp_f32 v222, v222
    v_exp_f32 v223, v223
    v_exp_f32 v224, v224
    v_mfma_f32_32x32x16_bf16 v[184:199], a[72:75], v[44:47], v[184:199]
    v_exp_f32 v225, v225
    v_exp_f32 v226, v226
    v_exp_f32 v227, v227
    v_smfmac_f32_32x32x32_bf16 v[232:247], a[88:91], v[216:223], v67
    v_exp_f32 v228, v228
    v_exp_f32 v229, v229
    v_exp_f32 v230, v230
    v_exp_f32 v231, v231
    v_exp_f32 v168, v168
    v_exp_f32 v169, v169
    v_smfmac_f32_32x32x32_bf16 v[232:247], a[92:95], v[224:231], v67
    s_waitcnt vmcnt(18)
    v_exp_f32 v170, v170
    v_exp_f32 v171, v171
    v_exp_f32 v172, v172
    v_mfma_f32_32x32x4_2b_bf16 v[200:231], v[32:33], v[58:59], 0 cbsz:1 abid:0
    v_exp_f32 v173, v173
    v_exp_f32 v174, v174
    v_exp_f32 v175, v175
    v_exp_f32 v176, v176
    v_exp_f32 v177, v177
    v_exp_f32 v178, v178
    v_exp_f32 v179, v179
    v_exp_f32 v180, v180
    v_smfmac_f32_32x32x32_bf16 v[72:87], a[96:99], v[168:175], v67
    buffer_load_dwordx4 a[88:91], v66, s[24:27], s62 offen offset:0 sc1
    buffer_load_dwordx4 a[92:95], v66, s[24:27], s62 offen offset:640 sc1
    buffer_load_dwordx4 a[156:159], v4, s[24:27], s60 offen offset:3072 sc1
    v_exp_f32 v181, v181
    v_exp_f32 v182, v182
    v_exp_f32 v183, v183
    v_exp_f32 v184, v184
    v_exp_f32 v185, v185
    v_exp_f32 v186, v186
    v_smfmac_f32_32x32x32_bf16 v[72:87], a[100:103], v[176:183], v67
    s_add_u32 s62, s62, 1280
    s_add_u32 s60, s71, 49152
    v_exp_f32 v187, v187
    v_exp_f32 v188, v188
    v_exp_f32 v189, v189
    v_mfma_f32_32x32x16_bf16 v[200:215], a[72:75], v[48:51], v[200:215]
    v_exp_f32 v190, v190
    v_exp_f32 v191, v191
    v_exp_f32 v192, v192
    v_mfma_f32_32x32x16_bf16 v[216:231], a[72:75], v[52:55], v[216:231]
    v_exp_f32 v193, v193
    v_exp_f32 v194, v194
    v_exp_f32 v195, v195
    v_smfmac_f32_32x32x32_bf16 v[88:103], a[96:99], v[184:191], v67
    v_exp_f32 v196, v196
    v_exp_f32 v197, v197
    v_exp_f32 v198, v198
    v_exp_f32 v199, v199
    v_exp_f32 v200, v200
    v_exp_f32 v201, v201
    v_smfmac_f32_32x32x32_bf16 v[88:103], a[100:103], v[192:199], v67
    s_waitcnt vmcnt(18)
    v_exp_f32 v202, v202
    v_exp_f32 v203, v203
    v_exp_f32 v204, v204
    v_mfma_f32_32x32x4_2b_bf16 v[168:199], v[32:33], v[56:57], 0 cbsz:1 abid:1
    v_exp_f32 v205, v205
    v_exp_f32 v206, v206
    v_exp_f32 v207, v207
    v_exp_f32 v208, v208
    v_exp_f32 v209, v209
    v_exp_f32 v210, v210
    v_exp_f32 v211, v211
    v_exp_f32 v212, v212
    v_smfmac_f32_32x32x32_bf16 v[16:31], a[96:99], v[200:207], v67
    buffer_load_dwordx4 a[72:75], v64, s[24:27], s61 offen sc1
    buffer_load_dwordx4 a[160:163], v4, s[24:27], s60 offen offset:0 sc1
    v_exp_f32 v213, v213
    v_exp_f32 v214, v214
    v_exp_f32 v215, v215
    v_exp_f32 v216, v216
    v_exp_f32 v217, v217
    v_exp_f32 v218, v218
    v_smfmac_f32_32x32x32_bf16 v[16:31], a[100:103], v[208:215], v67
    s_add_u32 s61, s61, 4608
    v_exp_f32 v219, v219
    v_exp_f32 v220, v220
    v_exp_f32 v221, v221
    v_mfma_f32_32x32x16_bf16 v[168:183], a[76:79], v[40:43], v[168:183]
    v_exp_f32 v222, v222
    v_exp_f32 v223, v223
    v_exp_f32 v224, v224
    v_mfma_f32_32x32x16_bf16 v[184:199], a[76:79], v[44:47], v[184:199]
    v_exp_f32 v225, v225
    v_exp_f32 v226, v226
    v_exp_f32 v227, v227
    v_smfmac_f32_32x32x32_bf16 v[232:247], a[96:99], v[216:223], v67
    v_exp_f32 v228, v228
    v_exp_f32 v229, v229
    v_exp_f32 v230, v230
    v_exp_f32 v231, v231
    v_exp_f32 v168, v168
    v_exp_f32 v169, v169
    v_smfmac_f32_32x32x32_bf16 v[232:247], a[100:103], v[224:231], v67
    s_waitcnt vmcnt(17)
    v_exp_f32 v170, v170
    v_exp_f32 v171, v171
    v_exp_f32 v172, v172
    v_mfma_f32_32x32x4_2b_bf16 v[200:231], v[32:33], v[58:59], 0 cbsz:1 abid:1
    v_exp_f32 v173, v173
    v_exp_f32 v174, v174
    v_exp_f32 v175, v175
    v_exp_f32 v176, v176
    v_exp_f32 v177, v177
    v_exp_f32 v178, v178
    v_exp_f32 v179, v179
    v_exp_f32 v180, v180
    v_smfmac_f32_32x32x32_bf16 v[72:87], a[104:107], v[168:175], v67
    buffer_load_dwordx4 a[96:99], v66, s[24:27], s62 offen offset:0 sc1
    buffer_load_dwordx4 a[100:103], v66, s[24:27], s62 offen offset:640 sc1
    buffer_load_dwordx4 a[164:167], v4, s[24:27], s60 offen offset:1024 sc1
    buffer_load_dwordx4 a[168:171], v4, s[24:27], s60 offen offset:2048 sc1
    v_exp_f32 v181, v181
    v_exp_f32 v182, v182
    v_exp_f32 v183, v183
    v_exp_f32 v184, v184
    v_exp_f32 v185, v185
    v_exp_f32 v186, v186
    v_smfmac_f32_32x32x32_bf16 v[72:87], a[108:111], v[176:183], v67
    s_add_u32 s62, s62, 1280
    s_add_u32 s88, s64, 129024
    v_exp_f32 v187, v187
    v_exp_f32 v188, v188
    v_exp_f32 v189, v189
    v_mfma_f32_32x32x16_bf16 v[200:215], a[76:79], v[48:51], v[200:215]
    v_exp_f32 v190, v190
    v_exp_f32 v191, v191
    v_exp_f32 v192, v192
    v_mfma_f32_32x32x16_bf16 v[216:231], a[76:79], v[52:55], v[216:231]
    v_exp_f32 v193, v193
    v_exp_f32 v194, v194
    v_exp_f32 v195, v195
    v_smfmac_f32_32x32x32_bf16 v[88:103], a[104:107], v[184:191], v67
    v_exp_f32 v196, v196
    v_exp_f32 v197, v197
    v_exp_f32 v198, v198
    v_exp_f32 v199, v199
    v_exp_f32 v200, v200
    v_exp_f32 v201, v201
    v_smfmac_f32_32x32x32_bf16 v[88:103], a[108:111], v[192:199], v67
    s_waitcnt vmcnt(18)
    v_exp_f32 v202, v202
    v_exp_f32 v203, v203
    v_exp_f32 v204, v204
    v_mfma_f32_32x32x4_2b_bf16 v[168:199], v[60:61], v[56:57], 0 cbsz:1 abid:0
    v_exp_f32 v205, v205
    v_exp_f32 v206, v206
    v_exp_f32 v207, v207
    v_exp_f32 v208, v208
    v_exp_f32 v209, v209
    v_exp_f32 v210, v210
    v_exp_f32 v211, v211
    v_exp_f32 v212, v212
    v_smfmac_f32_32x32x32_bf16 v[16:31], a[104:107], v[200:207], v67
    buffer_load_dwordx2 v[32:33], v65, s[24:27], s88 offen sc1
    buffer_load_dwordx4 a[76:79], v64, s[24:27], s61 offen sc1
    buffer_load_dwordx4 a[172:175], v4, s[24:27], s60 offen offset:3072 sc1
    v_exp_f32 v213, v213
    v_exp_f32 v214, v214
    v_exp_f32 v215, v215
    v_exp_f32 v216, v216
    v_exp_f32 v217, v217
    v_exp_f32 v218, v218
    v_smfmac_f32_32x32x32_bf16 v[16:31], a[108:111], v[208:215], v67
    s_add_u32 s61, s61, 4608
    s_add_u32 s60, s71, 65536
    v_exp_f32 v219, v219
    v_exp_f32 v220, v220
    v_exp_f32 v221, v221
    v_mfma_f32_32x32x16_bf16 v[168:183], a[64:67], v[40:43], v[168:183]
    v_exp_f32 v222, v222
    v_exp_f32 v223, v223
    v_exp_f32 v224, v224
    v_mfma_f32_32x32x16_bf16 v[184:199], a[64:67], v[44:47], v[184:199]
    v_exp_f32 v225, v225
    v_exp_f32 v226, v226
    v_exp_f32 v227, v227
    v_smfmac_f32_32x32x32_bf16 v[232:247], a[104:107], v[216:223], v67
    v_exp_f32 v228, v228
    v_exp_f32 v229, v229
    v_exp_f32 v230, v230
    v_exp_f32 v231, v231
    v_exp_f32 v168, v168
    v_exp_f32 v169, v169
    v_smfmac_f32_32x32x32_bf16 v[232:247], a[108:111], v[224:231], v67
    s_waitcnt vmcnt(17)
    v_exp_f32 v170, v170
    v_exp_f32 v171, v171
    v_exp_f32 v172, v172
    v_mfma_f32_32x32x4_2b_bf16 v[200:231], v[60:61], v[58:59], 0 cbsz:1 abid:0
    v_exp_f32 v173, v173
    v_exp_f32 v174, v174
    v_exp_f32 v175, v175
    v_exp_f32 v176, v176
    v_exp_f32 v177, v177
    v_exp_f32 v178, v178
    v_exp_f32 v179, v179
    v_exp_f32 v180, v180
    v_smfmac_f32_32x32x32_bf16 v[72:87], a[80:83], v[168:175], v67
    buffer_load_dwordx4 a[104:107], v66, s[24:27], s62 offen offset:0 sc1
    buffer_load_dwordx4 a[108:111], v66, s[24:27], s62 offen offset:640 sc1
    buffer_load_dwordx4 a[176:179], v4, s[24:27], s60 offen offset:0 sc1
    buffer_load_dwordx4 a[180:183], v4, s[24:27], s60 offen offset:1024 sc1
    v_exp_f32 v181, v181
    v_exp_f32 v182, v182
    v_exp_f32 v183, v183
    v_exp_f32 v184, v184
    v_exp_f32 v185, v185
    v_exp_f32 v186, v186
    v_smfmac_f32_32x32x32_bf16 v[72:87], a[84:87], v[176:183], v67
    s_add_u32 s62, s62, 1280
    v_exp_f32 v187, v187
    v_exp_f32 v188, v188
    v_exp_f32 v189, v189
    v_mfma_f32_32x32x16_bf16 v[200:215], a[64:67], v[48:51], v[200:215]
    v_exp_f32 v190, v190
    v_exp_f32 v191, v191
    v_exp_f32 v192, v192
    v_mfma_f32_32x32x16_bf16 v[216:231], a[64:67], v[52:55], v[216:231]
    v_exp_f32 v193, v193
    v_exp_f32 v194, v194
    v_exp_f32 v195, v195
    v_smfmac_f32_32x32x32_bf16 v[88:103], a[80:83], v[184:191], v67
    v_exp_f32 v196, v196
    v_exp_f32 v197, v197
    v_exp_f32 v198, v198
    v_exp_f32 v199, v199
    v_exp_f32 v200, v200
    v_exp_f32 v201, v201
    v_smfmac_f32_32x32x32_bf16 v[88:103], a[84:87], v[192:199], v67
    s_waitcnt vmcnt(18)
    v_exp_f32 v202, v202
    v_exp_f32 v203, v203
    v_exp_f32 v204, v204
    v_mfma_f32_32x32x4_2b_bf16 v[168:199], v[60:61], v[56:57], 0 cbsz:1 abid:1
    v_exp_f32 v205, v205
    v_exp_f32 v206, v206
    v_exp_f32 v207, v207
    v_exp_f32 v208, v208
    v_exp_f32 v209, v209
    v_exp_f32 v210, v210
    v_exp_f32 v211, v211
    v_exp_f32 v212, v212
    v_smfmac_f32_32x32x32_bf16 v[16:31], a[80:83], v[200:207], v67
    buffer_load_dwordx4 a[64:67], v64, s[24:27], s61 offen sc1
    buffer_load_dwordx4 a[184:187], v4, s[24:27], s60 offen offset:2048 sc1
    v_exp_f32 v213, v213
    v_exp_f32 v214, v214
    v_exp_f32 v215, v215
    v_exp_f32 v216, v216
    v_exp_f32 v217, v217
    v_exp_f32 v218, v218
    v_smfmac_f32_32x32x32_bf16 v[16:31], a[84:87], v[208:215], v67
    s_add_u32 s61, s61, 4608
    v_exp_f32 v219, v219
    v_exp_f32 v220, v220
    v_exp_f32 v221, v221
    v_mfma_f32_32x32x16_bf16 v[168:183], a[68:71], v[40:43], v[168:183]
    v_exp_f32 v222, v222
    v_exp_f32 v223, v223
    v_exp_f32 v224, v224
    v_mfma_f32_32x32x16_bf16 v[184:199], a[68:71], v[44:47], v[184:199]
    v_exp_f32 v225, v225
    v_exp_f32 v226, v226
    v_exp_f32 v227, v227
    v_smfmac_f32_32x32x32_bf16 v[232:247], a[80:83], v[216:223], v67
    v_exp_f32 v228, v228
    v_exp_f32 v229, v229
    v_exp_f32 v230, v230
    v_exp_f32 v231, v231
    v_exp_f32 v168, v168
    v_exp_f32 v169, v169
    v_smfmac_f32_32x32x32_bf16 v[232:247], a[84:87], v[224:231], v67
    s_waitcnt vmcnt(16)
    v_exp_f32 v170, v170
    v_exp_f32 v171, v171
    v_exp_f32 v172, v172
    v_mfma_f32_32x32x4_2b_bf16 v[200:231], v[60:61], v[58:59], 0 cbsz:1 abid:1
    v_exp_f32 v173, v173
    v_exp_f32 v174, v174
    v_exp_f32 v175, v175
    v_exp_f32 v176, v176
    v_exp_f32 v177, v177
    v_exp_f32 v178, v178
    v_exp_f32 v179, v179
    v_exp_f32 v180, v180
    v_smfmac_f32_32x32x32_bf16 v[72:87], a[88:91], v[168:175], v67
    buffer_load_dwordx4 a[80:83], v66, s[24:27], s62 offen offset:0 sc1
    buffer_load_dwordx4 a[84:87], v66, s[24:27], s62 offen offset:640 sc1
    buffer_load_dwordx4 a[188:191], v4, s[24:27], s60 offen offset:3072 sc1
    v_exp_f32 v181, v181
    v_exp_f32 v182, v182
    v_exp_f32 v183, v183
    v_exp_f32 v184, v184
    v_exp_f32 v185, v185
    v_exp_f32 v186, v186
    v_smfmac_f32_32x32x32_bf16 v[72:87], a[92:95], v[176:183], v67
    s_add_u32 s62, s62, 1280
    s_add_u32 s88, s64, 138240
    v_exp_f32 v187, v187
    v_exp_f32 v188, v188
    v_exp_f32 v189, v189
    v_mfma_f32_32x32x16_bf16 v[200:215], a[68:71], v[48:51], v[200:215]
    v_exp_f32 v190, v190
    v_exp_f32 v191, v191
    v_exp_f32 v192, v192
    v_mfma_f32_32x32x16_bf16 v[216:231], a[68:71], v[52:55], v[216:231]
    v_exp_f32 v193, v193
    v_exp_f32 v194, v194
    v_exp_f32 v195, v195
    v_smfmac_f32_32x32x32_bf16 v[88:103], a[88:91], v[184:191], v67
    s_add_u32 s60, s71, 81920
    v_exp_f32 v196, v196
    v_exp_f32 v197, v197
    v_exp_f32 v198, v198
    v_exp_f32 v199, v199
    v_exp_f32 v200, v200
    v_exp_f32 v201, v201
    v_smfmac_f32_32x32x32_bf16 v[88:103], a[92:95], v[192:199], v67
    s_waitcnt vmcnt(17)
    v_exp_f32 v202, v202
    v_exp_f32 v203, v203
    v_exp_f32 v204, v204
    v_mfma_f32_32x32x4_2b_bf16 v[168:199], v[62:63], v[56:57], 0 cbsz:1 abid:0
    v_exp_f32 v205, v205
    v_exp_f32 v206, v206
    v_exp_f32 v207, v207
    v_exp_f32 v208, v208
    v_exp_f32 v209, v209
    v_exp_f32 v210, v210
    v_exp_f32 v211, v211
    v_exp_f32 v212, v212
    v_smfmac_f32_32x32x32_bf16 v[16:31], a[88:91], v[200:207], v67
    buffer_load_dwordx2 v[60:61], v65, s[24:27], s88 offen sc1
    buffer_load_dwordx4 a[68:71], v64, s[24:27], s61 offen sc1
    buffer_load_dwordx4 a[192:195], v4, s[24:27], s60 offen offset:0 sc1
    buffer_load_dwordx4 a[196:199], v4, s[24:27], s60 offen offset:1024 sc1
    v_exp_f32 v213, v213
    v_exp_f32 v214, v214
    v_exp_f32 v215, v215
    v_exp_f32 v216, v216
    v_exp_f32 v217, v217
    v_exp_f32 v218, v218
    v_smfmac_f32_32x32x32_bf16 v[16:31], a[92:95], v[208:215], v67
    s_add_u32 s61, s61, 4608
    v_exp_f32 v219, v219
    v_exp_f32 v220, v220
    v_exp_f32 v221, v221
    v_mfma_f32_32x32x16_bf16 v[168:183], a[72:75], v[40:43], v[168:183]
    v_exp_f32 v222, v222
    v_exp_f32 v223, v223
    v_exp_f32 v224, v224
    v_mfma_f32_32x32x16_bf16 v[184:199], a[72:75], v[44:47], v[184:199]
    v_exp_f32 v225, v225
    v_exp_f32 v226, v226
    v_exp_f32 v227, v227
    v_smfmac_f32_32x32x32_bf16 v[232:247], a[88:91], v[216:223], v67
    v_exp_f32 v228, v228
    v_exp_f32 v229, v229
    v_exp_f32 v230, v230
    v_exp_f32 v231, v231
    v_exp_f32 v168, v168
    v_exp_f32 v169, v169
    v_smfmac_f32_32x32x32_bf16 v[232:247], a[92:95], v[224:231], v67
    s_waitcnt vmcnt(18)
    v_exp_f32 v170, v170
    v_exp_f32 v171, v171
    v_exp_f32 v172, v172
    v_mfma_f32_32x32x4_2b_bf16 v[200:231], v[62:63], v[58:59], 0 cbsz:1 abid:0
    v_exp_f32 v173, v173
    v_exp_f32 v174, v174
    v_exp_f32 v175, v175
    v_exp_f32 v176, v176
    v_exp_f32 v177, v177
    v_exp_f32 v178, v178
    v_exp_f32 v179, v179
    v_exp_f32 v180, v180
    v_smfmac_f32_32x32x32_bf16 v[72:87], a[96:99], v[168:175], v67
    buffer_load_dwordx4 a[88:91], v66, s[24:27], s62 offen offset:0 sc1
    buffer_load_dwordx4 a[92:95], v66, s[24:27], s62 offen offset:640 sc1
    buffer_load_dwordx4 a[200:203], v4, s[24:27], s60 offen offset:2048 sc1
    buffer_load_dwordx4 a[204:207], v4, s[24:27], s60 offen offset:3072 sc1
    v_exp_f32 v181, v181
    v_exp_f32 v182, v182
    v_exp_f32 v183, v183
    v_exp_f32 v184, v184
    v_exp_f32 v185, v185
    v_exp_f32 v186, v186
    v_smfmac_f32_32x32x32_bf16 v[72:87], a[100:103], v[176:183], v67
    s_add_u32 s62, s62, 1280
    s_add_u32 s60, s71, 98304
    v_exp_f32 v187, v187
    v_exp_f32 v188, v188
    v_exp_f32 v189, v189
    v_mfma_f32_32x32x16_bf16 v[200:215], a[72:75], v[48:51], v[200:215]
    v_exp_f32 v190, v190
    v_exp_f32 v191, v191
    v_exp_f32 v192, v192
    v_mfma_f32_32x32x16_bf16 v[216:231], a[72:75], v[52:55], v[216:231]
    v_exp_f32 v193, v193
    v_exp_f32 v194, v194
    v_exp_f32 v195, v195
    v_smfmac_f32_32x32x32_bf16 v[88:103], a[96:99], v[184:191], v67
    v_exp_f32 v196, v196
    v_exp_f32 v197, v197
    v_exp_f32 v198, v198
    v_exp_f32 v199, v199
    v_exp_f32 v200, v200
    v_exp_f32 v201, v201
    v_smfmac_f32_32x32x32_bf16 v[88:103], a[100:103], v[192:199], v67
    s_waitcnt vmcnt(18)
    v_exp_f32 v202, v202
    v_exp_f32 v203, v203
    v_exp_f32 v204, v204
    v_mfma_f32_32x32x4_2b_bf16 v[168:199], v[62:63], v[56:57], 0 cbsz:1 abid:1
    v_exp_f32 v205, v205
    v_exp_f32 v206, v206
    v_exp_f32 v207, v207
    v_exp_f32 v208, v208
    v_exp_f32 v209, v209
    v_exp_f32 v210, v210
    v_exp_f32 v211, v211
    v_exp_f32 v212, v212
    v_smfmac_f32_32x32x32_bf16 v[16:31], a[96:99], v[200:207], v67
    buffer_load_dwordx4 a[72:75], v64, s[24:27], s61 offen sc1
    buffer_load_dwordx4 a[208:211], v4, s[24:27], s60 offen offset:0 sc1
    v_exp_f32 v213, v213
    v_exp_f32 v214, v214
    v_exp_f32 v215, v215
    v_exp_f32 v216, v216
    v_exp_f32 v217, v217
    v_exp_f32 v218, v218
    v_smfmac_f32_32x32x32_bf16 v[16:31], a[100:103], v[208:215], v67
    s_add_u32 s61, s61, 4608
    v_exp_f32 v219, v219
    v_exp_f32 v220, v220
    v_exp_f32 v221, v221
    v_mfma_f32_32x32x16_bf16 v[168:183], a[76:79], v[40:43], v[168:183]
    v_exp_f32 v222, v222
    v_exp_f32 v223, v223
    v_exp_f32 v224, v224
    v_mfma_f32_32x32x16_bf16 v[184:199], a[76:79], v[44:47], v[184:199]
    v_exp_f32 v225, v225
    v_exp_f32 v226, v226
    v_exp_f32 v227, v227
    v_smfmac_f32_32x32x32_bf16 v[232:247], a[96:99], v[216:223], v67
    v_exp_f32 v228, v228
    v_exp_f32 v229, v229
    v_exp_f32 v230, v230
    v_exp_f32 v231, v231
    v_exp_f32 v168, v168
    v_exp_f32 v169, v169
    v_smfmac_f32_32x32x32_bf16 v[232:247], a[100:103], v[224:231], v67
    s_waitcnt vmcnt(17)
    v_exp_f32 v170, v170
    v_exp_f32 v171, v171
    v_exp_f32 v172, v172
    v_mfma_f32_32x32x4_2b_bf16 v[200:231], v[62:63], v[58:59], 0 cbsz:1 abid:1
    v_exp_f32 v173, v173
    v_exp_f32 v174, v174
    v_exp_f32 v175, v175
    v_exp_f32 v176, v176
    v_exp_f32 v177, v177
    v_exp_f32 v178, v178
    v_exp_f32 v179, v179
    v_exp_f32 v180, v180
    v_smfmac_f32_32x32x32_bf16 v[72:87], a[104:107], v[168:175], v67
    buffer_load_dwordx4 a[96:99], v66, s[24:27], s62 offen offset:0 sc1
    buffer_load_dwordx4 a[100:103], v66, s[24:27], s62 offen offset:640 sc1
    buffer_load_dwordx4 a[212:215], v4, s[24:27], s60 offen offset:1024 sc1
    v_exp_f32 v181, v181
    v_exp_f32 v182, v182
    v_exp_f32 v183, v183
    v_exp_f32 v184, v184
    v_exp_f32 v185, v185
    v_exp_f32 v186, v186
    v_smfmac_f32_32x32x32_bf16 v[72:87], a[108:111], v[176:183], v67
    s_add_u32 s62, s62, 1280
    v_exp_f32 v187, v187
    v_exp_f32 v188, v188
    v_exp_f32 v189, v189
    v_mfma_f32_32x32x16_bf16 v[200:215], a[76:79], v[48:51], v[200:215]
    v_exp_f32 v190, v190
    v_exp_f32 v191, v191
    v_exp_f32 v192, v192
    v_mfma_f32_32x32x16_bf16 v[216:231], a[76:79], v[52:55], v[216:231]
    v_exp_f32 v193, v193
    v_exp_f32 v194, v194
    v_exp_f32 v195, v195
    v_smfmac_f32_32x32x32_bf16 v[88:103], a[104:107], v[184:191], v67
    v_exp_f32 v196, v196
    v_exp_f32 v197, v197
    v_exp_f32 v198, v198
    v_exp_f32 v199, v199
    v_exp_f32 v200, v200
    v_exp_f32 v201, v201
    v_smfmac_f32_32x32x32_bf16 v[88:103], a[108:111], v[192:199], v67
    s_waitcnt vmcnt(17)
    v_exp_f32 v202, v202
    v_exp_f32 v203, v203
    v_exp_f32 v204, v204
    v_mfma_f32_32x32x4_2b_bf16 v[168:199], v[32:33], v[56:57], 0 cbsz:1 abid:0
    v_exp_f32 v205, v205
    v_exp_f32 v206, v206
    v_exp_f32 v207, v207
    v_exp_f32 v208, v208
    v_exp_f32 v209, v209
    v_exp_f32 v210, v210
    v_exp_f32 v211, v211
    v_exp_f32 v212, v212
    v_smfmac_f32_32x32x32_bf16 v[16:31], a[104:107], v[200:207], v67
    buffer_load_dwordx4 a[76:79], v64, s[24:27], s61 offen sc1
    buffer_load_dwordx4 a[216:219], v4, s[24:27], s60 offen offset:2048 sc1
    buffer_load_dwordx4 a[220:223], v4, s[24:27], s60 offen offset:3072 sc1
    v_exp_f32 v213, v213
    v_exp_f32 v214, v214
    v_exp_f32 v215, v215
    v_exp_f32 v216, v216
    v_exp_f32 v217, v217
    v_exp_f32 v218, v218
    v_smfmac_f32_32x32x32_bf16 v[16:31], a[108:111], v[208:215], v67
    s_add_u32 s61, s61, 4608
    s_add_u32 s60, s71, 114688
    v_exp_f32 v219, v219
    v_exp_f32 v220, v220
    v_exp_f32 v221, v221
    v_mfma_f32_32x32x16_bf16 v[168:183], a[64:67], v[40:43], v[168:183]
    v_exp_f32 v222, v222
    v_exp_f32 v223, v223
    v_exp_f32 v224, v224
    v_mfma_f32_32x32x16_bf16 v[184:199], a[64:67], v[44:47], v[184:199]
    v_exp_f32 v225, v225
    v_exp_f32 v226, v226
    v_exp_f32 v227, v227
    v_smfmac_f32_32x32x32_bf16 v[232:247], a[104:107], v[216:223], v67
    v_exp_f32 v228, v228
    v_exp_f32 v229, v229
    v_exp_f32 v230, v230
    v_exp_f32 v231, v231
    v_exp_f32 v168, v168
    v_exp_f32 v169, v169
    v_smfmac_f32_32x32x32_bf16 v[232:247], a[108:111], v[224:231], v67
    s_waitcnt vmcnt(17)
    v_exp_f32 v170, v170
    v_exp_f32 v171, v171
    v_exp_f32 v172, v172
    v_mfma_f32_32x32x4_2b_bf16 v[200:231], v[32:33], v[58:59], 0 cbsz:1 abid:0
    v_exp_f32 v173, v173
    v_exp_f32 v174, v174
    v_exp_f32 v175, v175
    v_exp_f32 v176, v176
    v_exp_f32 v177, v177
    v_exp_f32 v178, v178
    v_exp_f32 v179, v179
    v_exp_f32 v180, v180
    v_smfmac_f32_32x32x32_bf16 v[72:87], a[80:83], v[168:175], v67
    buffer_load_dwordx4 a[104:107], v66, s[24:27], s62 offen offset:0 sc1
    buffer_load_dwordx4 a[108:111], v66, s[24:27], s62 offen offset:640 sc1
    buffer_load_dwordx4 a[224:227], v4, s[24:27], s60 offen offset:0 sc1
    v_exp_f32 v181, v181
    v_exp_f32 v182, v182
    v_exp_f32 v183, v183
    v_exp_f32 v184, v184
    v_exp_f32 v185, v185
    v_exp_f32 v186, v186
    v_smfmac_f32_32x32x32_bf16 v[72:87], a[84:87], v[176:183], v67
    s_add_u32 s62, s62, 1280
    v_exp_f32 v187, v187
    v_exp_f32 v188, v188
    v_exp_f32 v189, v189
    v_mfma_f32_32x32x16_bf16 v[200:215], a[64:67], v[48:51], v[200:215]
    v_exp_f32 v190, v190
    v_exp_f32 v191, v191
    v_exp_f32 v192, v192
    v_mfma_f32_32x32x16_bf16 v[216:231], a[64:67], v[52:55], v[216:231]
    v_exp_f32 v193, v193
    v_exp_f32 v194, v194
    v_exp_f32 v195, v195
    v_smfmac_f32_32x32x32_bf16 v[88:103], a[80:83], v[184:191], v67
    v_exp_f32 v196, v196
    v_exp_f32 v197, v197
    v_exp_f32 v198, v198
    v_exp_f32 v199, v199
    v_exp_f32 v200, v200
    v_exp_f32 v201, v201
    v_smfmac_f32_32x32x32_bf16 v[88:103], a[84:87], v[192:199], v67
    s_waitcnt vmcnt(17)
L_pg17:
    s_cbranch_execz L_tour_ret
    v_exp_f32 v202, v202
    v_exp_f32 v203, v203
    v_exp_f32 v204, v204
    v_mfma_f32_32x32x4_2b_bf16 v[168:199], v[32:33], v[56:57], 0 cbsz:1 abid:1
    v_exp_f32 v205, v205
    v_exp_f32 v206, v206
    v_exp_f32 v207, v207
    v_exp_f32 v208, v208
    v_exp_f32 v209, v209
    v_exp_f32 v210, v210
    v_exp_f32 v211, v211
    v_exp_f32 v212, v212
    v_smfmac_f32_32x32x32_bf16 v[16:31], a[80:83], v[200:207], v67
    buffer_load_dwordx4 a[228:231], v4, s[24:27], s60 offen offset:1024 sc1
    buffer_load_dwordx4 a[232:235], v4, s[24:27], s60 offen offset:2048 sc1
    v_exp_f32 v213, v213
    v_exp_f32 v214, v214
    v_exp_f32 v215, v215
    v_exp_f32 v216, v216
    v_exp_f32 v217, v217
    v_exp_f32 v218, v218
    v_smfmac_f32_32x32x32_bf16 v[16:31], a[84:87], v[208:215], v67
    v_exp_f32 v219, v219
    v_exp_f32 v220, v220
    v_exp_f32 v221, v221
    v_mfma_f32_32x32x16_bf16 v[168:183], a[68:71], v[40:43], v[168:183]
    v_exp_f32 v222, v222
    v_exp_f32 v223, v223
    v_exp_f32 v224, v224
    v_mfma_f32_32x32x16_bf16 v[184:199], a[68:71], v[44:47], v[184:199]
    v_exp_f32 v225, v225
    v_exp_f32 v226, v226
    v_exp_f32 v227, v227
    v_smfmac_f32_32x32x32_bf16 v[232:247], a[80:83], v[216:223], v67
    v_exp_f32 v228, v228
    v_exp_f32 v229, v229
    v_exp_f32 v230, v230
    v_exp_f32 v231, v231
    v_exp_f32 v168, v168
    v_exp_f32 v169, v169
    v_smfmac_f32_32x32x32_bf16 v[232:247], a[84:87], v[224:231], v67
    s_waitcnt vmcnt(15)
    v_exp_f32 v170, v170
    v_exp_f32 v171, v171
    v_exp_f32 v172, v172
    v_mfma_f32_32x32x4_2b_bf16 v[200:231], v[32:33], v[58:59], 0 cbsz:1 abid:1
    v_exp_f32 v173, v173
    v_exp_f32 v174, v174
    v_exp_f32 v175, v175
    v_exp_f32 v176, v176
    v_exp_f32 v177, v177
    v_exp_f32 v178, v178
    v_exp_f32 v179, v179
    v_exp_f32 v180, v180
    v_smfmac_f32_32x32x32_bf16 v[72:87], a[88:91], v[168:175], v67
    buffer_load_dwordx4 a[236:239], v4, s[24:27], s60 offen offset:3072 sc1
    v_exp_f32 v181, v181
    v_exp_f32 v182, v182
    v_exp_f32 v183, v183
    v_exp_f32 v184, v184
    v_exp_f32 v185, v185
    v_exp_f32 v186, v186
    v_smfmac_f32_32x32x32_bf16 v[72:87], a[92:95], v[176:183], v67
    s_add_u32 s60, s71, 131072
    v_exp_f32 v187, v187
    v_exp_f32 v188, v188
    v_exp_f32 v189, v189
    v_mfma_f32_32x32x16_bf16 v[200:215], a[68:71], v[48:51], v[200:215]
    v_exp_f32 v190, v190
    v_exp_f32 v191, v191
    v_exp_f32 v192, v192
    v_mfma_f32_32x32x16_bf16 v[216:231], a[68:71], v[52:55], v[216:231]
    v_exp_f32 v193, v193
    v_exp_f32 v194, v194
    v_exp_f32 v195, v195
    v_smfmac_f32_32x32x32_bf16 v[88:103], a[88:91], v[184:191], v67
    v_exp_f32 v196, v196
    v_exp_f32 v197, v197
    v_exp_f32 v198, v198
    v_exp_f32 v199, v199
    v_exp_f32 v200, v200
    v_exp_f32 v201, v201
    v_smfmac_f32_32x32x32_bf16 v[88:103], a[92:95], v[192:199], v67
    s_waitcnt vmcnt(13)
    v_exp_f32 v202, v202
    v_exp_f32 v203, v203
    v_exp_f32 v204, v204
    v_mfma_f32_32x32x4_2b_bf16 v[168:199], v[60:61], v[56:57], 0 cbsz:1 abid:0
    v_exp_f32 v205, v205
    v_exp_f32 v206, v206
    v_exp_f32 v207, v207
    v_exp_f32 v208, v208
    v_exp_f32 v209, v209
    v_exp_f32 v210, v210
    v_exp_f32 v211, v211
    v_exp_f32 v212, v212
    v_smfmac_f32_32x32x32_bf16 v[16:31], a[88:91], v[200:207], v67
    buffer_load_dwordx4 a[240:243], v4, s[24:27], s60 offen offset:0 sc1
    buffer_load_dwordx4 a[244:247], v4, s[24:27], s60 offen offset:1024 sc1
    v_exp_f32 v213, v213
    v_exp_f32 v214, v214
    v_exp_f32 v215, v215
    v_exp_f32 v216, v216
    v_exp_f32 v217, v217
    v_exp_f32 v218, v218
    v_smfmac_f32_32x32x32_bf16 v[16:31], a[92:95], v[208:215], v67
    v_exp_f32 v219, v219
    v_exp_f32 v220, v220
    v_exp_f32 v221, v221
    v_mfma_f32_32x32x16_bf16 v[168:183], a[72:75], v[40:43], v[168:183]
    v_exp_f32 v222, v222
    v_exp_f32 v223, v223
    v_exp_f32 v224, v224
    v_mfma_f32_32x32x16_bf16 v[184:199], a[72:75], v[44:47], v[184:199]
    v_exp_f32 v225, v225
    v_exp_f32 v226, v226
    v_exp_f32 v227, v227
    v_smfmac_f32_32x32x32_bf16 v[232:247], a[88:91], v[216:223], v67
    v_exp_f32 v228, v228
    v_exp_f32 v229, v229
    v_exp_f32 v230, v230
    v_exp_f32 v231, v231
    v_exp_f32 v168, v168
    v_exp_f32 v169, v169
    v_smfmac_f32_32x32x32_bf16 v[232:247], a[92:95], v[224:231], v67
    s_waitcnt vmcnt(12)
    v_exp_f32 v170, v170
    v_exp_f32 v171, v171
    v_exp_f32 v172, v172
    v_mfma_f32_32x32x4_2b_bf16 v[200:231], v[60:61], v[58:59], 0 cbsz:1 abid:0
    v_exp_f32 v173, v173
    v_exp_f32 v174, v174
    v_exp_f32 v175, v175
    v_exp_f32 v176, v176
    v_exp_f32 v177, v177
    v_exp_f32 v178, v178
    v_exp_f32 v179, v179
    v_exp_f32 v180, v180
    v_smfmac_f32_32x32x32_bf16 v[72:87], a[96:99], v[168:175], v67
    buffer_load_dwordx4 a[248:251], v4, s[24:27], s60 offen offset:2048 sc1
    v_exp_f32 v181, v181
    v_exp_f32 v182, v182
    v_exp_f32 v183, v183
    v_exp_f32 v184, v184
    v_exp_f32 v185, v185
    v_exp_f32 v186, v186
    v_smfmac_f32_32x32x32_bf16 v[72:87], a[100:103], v[176:183], v67
    v_exp_f32 v187, v187
    v_exp_f32 v188, v188
    v_exp_f32 v189, v189
    v_mfma_f32_32x32x16_bf16 v[200:215], a[72:75], v[48:51], v[200:215]
    v_exp_f32 v190, v190
    v_exp_f32 v191, v191
    v_exp_f32 v192, v192
    v_mfma_f32_32x32x16_bf16 v[216:231], a[72:75], v[52:55], v[216:231]
    v_exp_f32 v193, v193
    v_exp_f32 v194, v194
    v_exp_f32 v195, v195
    v_smfmac_f32_32x32x32_bf16 v[88:103], a[96:99], v[184:191], v67
    v_exp_f32 v196, v196
    v_exp_f32 v197, v197
    v_exp_f32 v198, v198
    v_exp_f32 v199, v199
    v_exp_f32 v200, v200
    v_exp_f32 v201, v201
    v_smfmac_f32_32x32x32_bf16 v[88:103], a[100:103], v[192:199], v67
    s_waitcnt vmcnt(11)
    v_exp_f32 v202, v202
    v_exp_f32 v203, v203
    v_exp_f32 v204, v204
    v_mfma_f32_32x32x4_2b_bf16 v[168:199], v[60:61], v[56:57], 0 cbsz:1 abid:1
    v_exp_f32 v205, v205
    v_exp_f32 v206, v206
    v_exp_f32 v207, v207
    v_exp_f32 v208, v208
    v_exp_f32 v209, v209
    v_exp_f32 v210, v210
    v_exp_f32 v211, v211
    v_exp_f32 v212, v212
    v_smfmac_f32_32x32x32_bf16 v[16:31], a[96:99], v[200:207], v67
    buffer_load_dwordx4 a[252:255], v4, s[24:27], s60 offen offset:3072 sc1
    v_exp_f32 v213, v213
    v_exp_f32 v214, v214
    v_exp_f32 v215, v215
    v_exp_f32 v216, v216
    v_exp_f32 v217, v217
    v_exp_f32 v218, v218
    v_smfmac_f32_32x32x32_bf16 v[16:31], a[100:103], v[208:215], v67
    v_exp_f32 v219, v219
    v_exp_f32 v220, v220
    v_exp_f32 v221, v221
    v_mfma_f32_32x32x16_bf16 v[168:183], a[76:79], v[40:43], v[168:183]
    v_exp_f32 v222, v222
    v_exp_f32 v223, v223
    v_exp_f32 v224, v224
    v_mfma_f32_32x32x16_bf16 v[184:199], a[76:79], v[44:47], v[184:199]
    v_exp_f32 v225, v225
    v_exp_f32 v226, v226
    v_exp_f32 v227, v227
    v_smfmac_f32_32x32x32_bf16 v[232:247], a[96:99], v[216:223], v67
    v_exp_f32 v228, v228
    v_exp_f32 v229, v229
    v_exp_f32 v230, v230
    v_exp_f32 v231, v231
    v_exp_f32 v168, v168
    v_exp_f32 v169, v169
    v_smfmac_f32_32x32x32_bf16 v[232:247], a[100:103], v[224:231], v67
    s_waitcnt vmcnt(8)
    v_exp_f32 v170, v170
    v_exp_f32 v171, v171
    v_exp_f32 v172, v172
    v_mfma_f32_32x32x4_2b_bf16 v[200:231], v[60:61], v[58:59], 0 cbsz:1 abid:1
    v_exp_f32 v173, v173
    v_exp_f32 v174, v174
    v_exp_f32 v175, v175
    v_exp_f32 v176, v176
    v_exp_f32 v177, v177
    v_exp_f32 v178, v178
    v_exp_f32 v179, v179
    v_exp_f32 v180, v180
    v_smfmac_f32_32x32x32_bf16 v[72:87], a[104:107], v[168:175], v67
    v_exp_f32 v181, v181
    v_exp_f32 v182, v182
    v_exp_f32 v183, v183
    v_exp_f32 v184, v184
    v_exp_f32 v185, v185
    v_exp_f32 v186, v186
    v_smfmac_f32_32x32x32_bf16 v[72:87], a[108:111], v[176:183], v67
    v_exp_f32 v187, v187
    v_exp_f32 v188, v188
    v_exp_f32 v189, v189
    v_mfma_f32_32x32x16_bf16 v[200:215], a[76:79], v[48:51], v[200:215]
    v_exp_f32 v190, v190
    v_exp_f32 v191, v191
    v_exp_f32 v192, v192
    v_mfma_f32_32x32x16_bf16 v[216:231], a[76:79], v[52:55], v[216:231]
    v_exp_f32 v193, v193
    v_exp_f32 v194, v194
    v_exp_f32 v195, v195
    v_smfmac_f32_32x32x32_bf16 v[88:103], a[104:107], v[184:191], v67
    v_exp_f32 v196, v196
    v_exp_f32 v197, v197
    v_exp_f32 v198, v198
    v_exp_f32 v199, v199
    v_exp_f32 v200, v200
    v_exp_f32 v201, v201
    v_smfmac_f32_32x32x32_bf16 v[88:103], a[108:111], v[192:199], v67
    buffer_store_dword v67, v134, s[24:27], s83 offen sc1
    ds_write_b128 v120, v[72:75] offset:0
    ds_write_b128 v120, v[76:79] offset:1024
    v_exp_f32 v202, v202
    v_exp_f32 v203, v203
    v_exp_f32 v204, v204
    v_exp_f32 v205, v205
    v_exp_f32 v206, v206
    v_exp_f32 v207, v207
    v_exp_f32 v208, v208
    v_exp_f32 v209, v209
    v_exp_f32 v210, v210
    v_exp_f32 v211, v211
    v_exp_f32 v212, v212
    v_smfmac_f32_32x32x32_bf16 v[16:31], a[104:107], v[200:207], v67
    ds_write_b128 v120, v[80:83] offset:2048
    v_exp_f32 v213, v213
    v_exp_f32 v214, v214
    v_exp_f32 v215, v215
    v_exp_f32 v216, v216
    v_exp_f32 v217, v217
    v_exp_f32 v218, v218
    v_smfmac_f32_32x32x32_bf16 v[16:31], a[108:111], v[208:215], v67
    ds_write_b128 v120, v[88:91] offset:3072
    ds_write_b128 v120, v[92:95] offset:4096
    v_exp_f32 v219, v219
    v_exp_f32 v220, v220
    v_exp_f32 v221, v221
    ds_write_b128 v120, v[96:99] offset:5120
    v_exp_f32 v222, v222
    v_exp_f32 v223, v223
    v_exp_f32 v224, v224
    v_exp_f32 v225, v225
    v_exp_f32 v226, v226
    v_exp_f32 v227, v227
    v_smfmac_f32_32x32x32_bf16 v[232:247], a[104:107], v[216:223], v67
    s_waitcnt lgkmcnt(0)
    s_barrier
    ds_read_b128 v[144:147], v121 offset:0
    ds_read_b128 v[148:151], v121 offset:1024
    ds_read_b128 v[152:155], v121 offset:2048
    ds_read_b128 v[156:159], v121 offset:3072
    ds_read_b128 v[160:163], v121 offset:4096
    ds_read_b128 v[164:167], v121 offset:5120
    v_exp_f32 v228, v228
    v_exp_f32 v229, v229
    v_exp_f32 v230, v230
    v_exp_f32 v231, v231
    s_nop 1
    v_smfmac_f32_32x32x32_bf16 v[232:247], a[108:111], v[224:231], v67
    v_mov_b32 v138, 0
    v_mov_b32 v139, 0
    s_waitcnt lgkmcnt(0)
    v_add_f32 v26, v26, v154
    v_pk_add_f32 v[16:17], v[16:17], v[144:145]
    v_pk_add_f32 v[18:19], v[18:19], v[146:147]
    v_pk_add_f32 v[20:21], v[20:21], v[148:149]
    v_pk_add_f32 v[22:23], v[22:23], v[150:151]
    v_pk_add_f32 v[24:25], v[24:25], v[152:153]
    v_pk_fma_f32 v[136:137], v[16:17], v[138:139], v[138:139]
    v_pk_fma_f32 v[136:137], v[18:19], v[138:139], v[136:137]
    v_pk_fma_f32 v[136:137], v[20:21], v[138:139], v[136:137]
    v_pk_fma_f32 v[136:137], v[22:23], v[138:139], v[136:137]
    v_pk_fma_f32 v[136:137], v[24:25], v[138:139], v[136:137]
    v_add_f32 v242, v242, v166
    v_pk_add_f32 v[232:233], v[232:233], v[156:157]
    v_pk_add_f32 v[234:235], v[234:235], v[158:159]
    v_pk_add_f32 v[236:237], v[236:237], v[160:161]
    v_pk_add_f32 v[238:239], v[238:239], v[162:163]
    v_pk_add_f32 v[240:241], v[240:241], v[164:165]
    v_pk_fma_f32 v[136:137], v[232:233], v[138:139], v[136:137]
    v_pk_fma_f32 v[136:137], v[234:235], v[138:139], v[136:137]
    v_pk_fma_f32 v[136:137], v[236:237], v[138:139], v[136:137]
    v_pk_fma_f32 v[136:137], v[238:239], v[138:139], v[136:137]
    v_pk_fma_f32 v[136:137], v[240:241], v[138:139], v[136:137]
    v_add_f32 v136, v136, v137
    v_min_f32 v137, v26, v242
    v_add_f32 v136, v136, v26
    v_cmp_nlt_f32 vcc, 0x2b800000, v137
    v_add_f32 v136, v136, v242
    s_mov_b64 s[88:89], vcc
    v_cmp_ngt_f32 vcc, 0x53800000, v136
    s_add_u32 s90, s69, 32768
    s_or_b64 vcc, vcc, s[88:89]
    s_cbranch_scc1 L_slow
L_norm:
    v_rcp_f32 v26, v26
    v_rcp_f32 v242, v242
    v_pk_mul_f32 v[16:17], v[16:17], v[26:27] op_sel_hi:[1,0]
    v_pk_mul_f32 v[18:19], v[18:19], v[26:27] op_sel_hi:[1,0]
    v_pk_mul_f32 v[20:21], v[20:21], v[26:27] op_sel_hi:[1,0]
    v_pk_mul_f32 v[22:23], v[22:23], v[26:27] op_sel_hi:[1,0]
    v_pk_mul_f32 v[24:25], v[24:25], v[26:27] op_sel_hi:[1,0]
    v_cvt_pk_bf16_f32 v88, v16, v17
    v_cvt_pk_bf16_f32 v89, v18, v19
    v_cvt_pk_bf16_f32 v90, v20, v21
    v_cvt_pk_bf16_f32 v91, v22, v23
    v_cvt_pk_bf16_f32 v92, v24, v25
    buffer_store_dwordx4 v[88:91], v118, s[24:27], s69 offen sc1
    buffer_store_dword v92, v119, s[24:27], s70 offen offset:0 sc1
    v_pk_mul_f32 v[232:233], v[232:233], v[242:243] op_sel_hi:[1,0]
    v_pk_mul_f32 v[234:235], v[234:235], v[242:243] op_sel_hi:[1,0]
    v_pk_mul_f32 v[236:237], v[236:237], v[242:243] op_sel_hi:[1,0]
    v_pk_mul_f32 v[238:239], v[238:239], v[242:243] op_sel_hi:[1,0]
    v_pk_mul_f32 v[240:241], v[240:241], v[242:243] op_sel_hi:[1,0]
    v_cvt_pk_bf16_f32 v96, v232, v233
    v_cvt_pk_bf16_f32 v97, v234, v235
    v_cvt_pk_bf16_f32 v98, v236, v237
    v_cvt_pk_bf16_f32 v99, v238, v239
    v_cvt_pk_bf16_f32 v100, v240, v241
    buffer_store_dwordx4 v[96:99], v118, s[24:27], s90 offen sc1
    buffer_store_dword v100, v119, s[24:27], s70 offen offset:128 sc1
    v_accvgpr_read_b32 v76, a36
    v_accvgpr_read_b32 v77, a37
    v_accvgpr_read_b32 v78, a38
    v_accvgpr_read_b32 v79, a39
    v_accvgpr_read_b32 v80, a40
    v_accvgpr_read_b32 v81, a41
    v_accvgpr_read_b32 v82, a42
    v_accvgpr_read_b32 v83, a43
    v_accvgpr_read_b32 v84, a44
    v_accvgpr_read_b32 v85, a45
    v_accvgpr_read_b32 v86, a46
    v_accvgpr_read_b32 v87, a47
    s_waitcnt vmcnt(5)
    s_add_u32 s88, s79, 16384
    v_mfma_f32_16x16x16_bf16 v[168:171], v[128:129], a[112:113], 0
    ds_read_b64_tr_b16 a[36:37], v130 offset:9216
    v_mfma_f32_16x16x16_bf16 v[168:171], v[128:129], a[116:117], v[168:171]
    ds_read_b64_tr_b16 a[38:39], v130 offset:11520
    v_mfma_f32_16x16x16_bf16 v[168:171], v[128:129], a[120:121], v[168:171]
    ds_read_b64_tr_b16 a[40:41], v130 offset:9248
    v_mfma_f32_16x16x16_bf16 v[168:171], v[128:129], a[124:125], v[168:171]
    ds_read_b64_tr_b16 a[42:43], v130 offset:11552
    v_mfma_f32_16x16x16_bf16 v[172:175], v[128:129], a[114:115], 0
    ds_read_b64_tr_b16 a[44:45], v130 offset:9280
    v_mfma_f32_16x16x16_bf16 v[172:175], v[128:129], a[118:119], v[172:175]
    ds_read_b64_tr_b16 a[46:47], v130 offset:11584
    v_mfma_f32_16x16x16_bf16 v[172:175], v[128:129], a[122:123], v[172:175]
    ds_read_b64_tr_b16 a[48:49], v130 offset:9312
    v_mfma_f32_16x16x16_bf16 v[172:175], v[128:129], a[126:127], v[172:175]
    ds_read_b64_tr_b16 a[50:51], v130 offset:11616
    v_mfma_f32_16x16x16_bf16 v[176:179], v[128:129], a[128:129], 0
    ds_read_b64_tr_b16 a[52:53], v130 offset:9344
    v_mfma_f32_16x16x16_bf16 v[176:179], v[128:129], a[132:133], v[176:179]
    ds_read_b64_tr_b16 a[54:55], v130 offset:11648
    v_mfma_f32_16x16x16_bf16 v[176:179], v[128:129], a[136:137], v[176:179]
    buffer_load_dword v70, v135, s[24:27], s85 offen sc1
    v_mfma_f32_16x16x16_bf16 v[176:179], v[128:129], a[140:141], v[176:179]
    ds_read_b64_tr_b16 a[56:57], v130 offset:9376
    v_mfma_f32_16x16x16_bf16 v[180:183], v[128:129], a[130:131], 0
    ds_read_b64_tr_b16 a[58:59], v130 offset:11680
    v_mfma_f32_16x16x16_bf16 v[180:183], v[128:129], a[134:135], v[180:183]
    ds_read_b64_tr_b16 a[60:61], v130 offset:9408
    v_mfma_f32_16x16x16_bf16 v[180:183], v[128:129], a[138:139], v[180:183]
    ds_read_b64_tr_b16 a[62:63], v130 offset:11712
    v_mfma_f32_16x16x16_bf16 v[180:183], v[128:129], a[142:143], v[180:183]
    ds_read_b64_tr_b16 a[64:65], v130 offset:9440
    v_mfma_f32_16x16x16_bf16 v[184:187], v[128:129], a[144:145], 0
    ds_read_b64_tr_b16 a[66:67], v130 offset:11744
    v_mfma_f32_16x16x16_bf16 v[184:187], v[128:129], a[148:149], v[184:187]
    ds_read_b64_tr_b16 a[68:69], v130 offset:9472
    v_mfma_f32_16x16x16_bf16 v[184:187], v[128:129], a[152:153], v[184:187]
    ds_read_b64_tr_b16 a[70:71], v130 offset:11776
    v_mfma_f32_16x16x16_bf16 v[184:187], v[128:129], a[156:157], v[184:187]
    ds_read_b64_tr_b16 a[72:73], v130 offset:18432
    v_mfma_f32_16x16x16_bf16 v[188:191], v[128:129], a[146:147], 0
    ds_read_b64_tr_b16 a[74:75], v130 offset:20736
    v_mfma_f32_16x16x16_bf16 v[188:191], v[128:129], a[150:151], v[188:191]
    ds_read_b64_tr_b16 a[76:77], v130 offset:18464
    v_mfma_f32_16x16x16_bf16 v[188:191], v[128:129], a[154:155], v[188:191]
    ds_read_b64_tr_b16 a[78:79], v130 offset:20768
    v_mfma_f32_16x16x16_bf16 v[188:191], v[128:129], a[158:159], v[188:191]
    ds_read_b64_tr_b16 a[80:81], v130 offset:18496
    v_mfma_f32_16x16x16_bf16 v[192:195], v[128:129], a[160:161], 0
    ds_read_b64_tr_b16 a[82:83], v130 offset:20800
    v_mfma_f32_16x16x16_bf16 v[192:195], v[128:129], a[164:165], v[192:195]
    ds_read_b64_tr_b16 a[84:85], v130 offset:18528
    v_mfma_f32_16x16x16_bf16 v[192:195], v[128:129], a[168:169], v[192:195]
    ds_read_b64_tr_b16 a[86:87], v130 offset:20832
    v_mfma_f32_16x16x16_bf16 v[192:195], v[128:129], a[172:173], v[192:195]
    ds_read_b64_tr_b16 a[88:89], v130 offset:18560
    v_mfma_f32_16x16x16_bf16 v[196:199], v[128:129], a[162:163], 0
    ds_read_b64_tr_b16 a[90:91], v130 offset:20864
    v_mfma_f32_16x16x16_bf16 v[196:199], v[128:129], a[166:167], v[196:199]
    ds_read_b64_tr_b16 a[92:93], v130 offset:18592
    v_mfma_f32_16x16x16_bf16 v[196:199], v[128:129], a[170:171], v[196:199]
    ds_read_b64_tr_b16 a[94:95], v130 offset:20896
    v_mfma_f32_16x16x16_bf16 v[196:199], v[128:129], a[174:175], v[196:199]
    ds_read_b64_tr_b16 a[96:97], v130 offset:18624
    v_mfma_f32_16x16x16_bf16 v[200:203], v[128:129], a[176:177], 0
    ds_read_b64_tr_b16 a[98:99], v130 offset:20928
    v_mfma_f32_16x16x16_bf16 v[200:203], v[128:129], a[180:181], v[200:203]
    ds_read_b64_tr_b16 a[100:101], v130 offset:18656
    v_mfma_f32_16x16x16_bf16 v[200:203], v[128:129], a[184:185], v[200:203]
    ds_read_b64_tr_b16 a[102:103], v130 offset:20960
    v_mfma_f32_16x16x16_bf16 v[200:203], v[128:129], a[188:189], v[200:203]
    ds_read_b64_tr_b16 a[104:105], v130 offset:18688
    v_mfma_f32_16x16x16_bf16 v[204:207], v[128:129], a[178:179], 0
    ds_read_b64_tr_b16 a[106:107], v130 offset:20992
    v_mfma_f32_16x16x16_bf16 v[204:207], v[128:129], a[182:183], v[204:207]
    ds_read_b64_tr_b16 v[136:137], v131 offset:0
    v_mfma_f32_16x16x16_bf16 v[204:207], v[128:129], a[186:187], v[204:207]
    ds_read_b64_tr_b16 v[138:139], v131 offset:32
    v_mfma_f32_16x16x16_bf16 v[204:207], v[128:129], a[190:191], v[204:207]
    ds_read_b64_tr_b16 v[140:141], v131 offset:64
    v_mfma_f32_16x16x16_bf16 v[208:211], v[128:129], a[192:193], 0
    s_waitcnt vmcnt(0)
    s_mov_b32 s63, 0x8000
L_spinC:
    v_cmp_eq_u32 s[86:87], v67, v70
    s_sub_u32 s63, s63, 1
    s_cbranch_scc1 L_backC
    s_cmp_eq_u32 s86, 0xff
    s_cbranch_scc1 L_backC
    buffer_load_dword v70, v135, s[24:27], s85 offen sc1
    s_waitcnt vmcnt(0)
    s_branch L_spinC
L_backC:
    buffer_load_dword v72, v133, s[24:27], s80 offen offset:0 sc1
    buffer_load_dword v73, v133, s[24:27], s80 offen offset:512 sc1
    buffer_load_dword v74, v133, s[24:27], s80 offen offset:64 sc1
    buffer_load_dword v75, v133, s[24:27], s80 offen offset:576 sc1
    buffer_load_dwordx4 v[40:43], v4, s[24:27], s79 offen offset:0 sc1
    buffer_load_dwordx4 v[44:47], v4, s[24:27], s88 offen offset:0 sc1
    buffer_load_dwordx4 v[48:51], v4, s[24:27], s79 offen offset:1024 sc1
    buffer_load_dwordx4 v[52:55], v4, s[24:27], s88 offen offset:1024 sc1
    buffer_load_dwordx4 v[56:59], v4, s[24:27], s79 offen offset:2048 sc1
    buffer_load_dwordx4 v[60:63], v4, s[24:27], s88 offen offset:2048 sc1
    buffer_load_dwordx4 v[64:67], v4, s[24:27], s79 offen offset:3072 sc1
    buffer_load_dwordx4 v[68:71], v4, s[24:27], s88 offen offset:3072 sc1
    v_mfma_f32_16x16x16_bf16 v[208:211], v[128:129], a[196:197], v[208:211]
    ds_read_b64_tr_b16 v[142:143], v131 offset:96
    v_mfma_f32_16x16x16_bf16 v[208:211], v[128:129], a[200:201], v[208:211]
    ds_read_b64_tr_b16 v[144:145], v131 offset:128
    v_mfma_f32_16x16x16_bf16 v[208:211], v[128:129], a[204:205], v[208:211]
    ds_read_b64_tr_b16 v[146:147], v131 offset:160
    v_mfma_f32_16x16x16_bf16 v[212:215], v[128:129], a[194:195], 0
    ds_read_b64_tr_b16 v[148:149], v131 offset:192
    v_mfma_f32_16x16x16_bf16 v[212:215], v[128:129], a[198:199], v[212:215]
    ds_read_b64_tr_b16 v[150:151], v131 offset:224
    v_mfma_f32_16x16x16_bf16 v[212:215], v[128:129], a[202:203], v[212:215]
    ds_read_b64_tr_b16 v[152:153], v131 offset:256
    v_mfma_f32_16x16x16_bf16 v[212:215], v[128:129], a[206:207], v[212:215]
    ds_read_b64_tr_b16 a[112:113], v130 offset:0
    v_mfma_f32_16x16x16_bf16 v[216:219], v[128:129], a[208:209], 0
    ds_read_b64_tr_b16 a[114:115], v130 offset:2304
    v_mfma_f32_16x16x16_bf16 v[216:219], v[128:129], a[212:213], v[216:219]
    ds_read_b64_tr_b16 a[116:117], v130 offset:32
    v_mfma_f32_16x16x16_bf16 v[216:219], v[128:129], a[216:217], v[216:219]
    ds_read_b64_tr_b16 a[118:119], v130 offset:2336
    v_mfma_f32_16x16x16_bf16 v[216:219], v[128:129], a[220:221], v[216:219]
    ds_read_b64_tr_b16 a[120:121], v130 offset:64
    v_mfma_f32_16x16x16_bf16 v[220:223], v[128:129], a[210:211], 0
    ds_read_b64_tr_b16 a[122:123], v130 offset:2368
    v_mfma_f32_16x16x16_bf16 v[220:223], v[128:129], a[214:215], v[220:223]
    ds_read_b64_tr_b16 a[124:125], v130 offset:96
    v_mfma_f32_16x16x16_bf16 v[220:223], v[128:129], a[218:219], v[220:223]
    ds_read_b64_tr_b16 a[126:127], v130 offset:2400
    v_mfma_f32_16x16x16_bf16 v[220:223], v[128:129], a[222:223], v[220:223]
    ds_read_b64_tr_b16 a[128:129], v130 offset:128
    v_mfma_f32_16x16x16_bf16 v[224:227], v[128:129], a[224:225], 0
    ds_read_b64_tr_b16 a[130:131], v130 offset:2432
    v_mfma_f32_16x16x16_bf16 v[224:227], v[128:129], a[228:229], v[224:227]
    ds_read_b64_tr_b16 a[132:133], v130 offset:160
    v_mfma_f32_16x16x16_bf16 v[224:227], v[128:129], a[232:233], v[224:227]
    ds_read_b64_tr_b16 a[134:135], v130 offset:2464
    v_mfma_f32_16x16x16_bf16 v[224:227], v[128:129], a[236:237], v[224:227]
    ds_read_b64_tr_b16 a[136:137], v130 offset:192
    v_mfma_f32_16x16x16_bf16 v[228:231], v[128:129], a[226:227], 0
    ds_read_b64_tr_b16 a[138:139], v130 offset:2496
    v_mfma_f32_16x16x16_bf16 v[228:231], v[128:129], a[230:231], v[228:231]
    ds_read_b64_tr_b16 a[140:141], v130 offset:224
    v_mfma_f32_16x16x16_bf16 v[228:231], v[128:129], a[234:235], v[228:231]
    ds_read_b64_tr_b16 a[142:143], v130 offset:2528
    v_mfma_f32_16x16x16_bf16 v[228:231], v[128:129], a[238:239], v[228:231]
    ds_read_b64_tr_b16 a[144:145], v130 offset:256
    v_mfma_f32_16x16x16_bf16 v[232:235], v[128:129], a[240:241], 0
    ds_read_b64_tr_b16 a[146:147], v130 offset:2560
    v_mfma_f32_16x16x16_bf16 v[232:235], v[128:129], a[244:245], v[232:235]
    v_mfma_f32_16x16x16_bf16 v[232:235], v[128:129], a[248:249], v[232:235]
    v_mfma_f32_16x16x16_bf16 v[232:235], v[128:129], a[252:253], v[232:235]
    v_mfma_f32_16x16x16_bf16 v[236:239], v[128:129], a[242:243], 0
    v_mfma_f32_16x16x16_bf16 v[236:239], v[128:129], a[246:247], v[236:239]
    v_mfma_f32_16x16x16_bf16 v[236:239], v[128:129], a[250:251], v[236:239]
    v_mfma_f32_16x16x16_bf16 v[236:239], v[128:129], a[254:255], v[236:239]
    v_lshlrev_b32 v16, 16, v76
    v_and_b32 v17, 0xffff0000, v76
    v_lshlrev_b32 v18, 16, v77
    v_and_b32 v19, 0xffff0000, v77
    v_lshlrev_b32 v20, 16, v78
    v_and_b32 v21, 0xffff0000, v78
    v_lshlrev_b32 v22, 16, v79
    v_and_b32 v23, 0xffff0000, v79
    v_lshlrev_b32 v24, 16, v80
    v_and_b32 v25, 0xffff0000, v80
    v_lshlrev_b32 v26, 16, v81
    v_and_b32 v27, 0xffff0000, v81
    v_lshlrev_b32 v28, 16, v82
    v_and_b32 v29, 0xffff0000, v82
    v_lshlrev_b32 v30, 16, v83
    v_and_b32 v31, 0xffff0000, v83
    v_lshlrev_b32 v32, 16, v84
    v_and_b32 v33, 0xffff0000, v84
    v_lshlrev_b32 v34, 16, v85
    v_and_b32 v35, 0xffff0000, v85
    v_lshlrev_b32 v36, 16, v86
    v_and_b32 v37, 0xffff0000, v86
    v_lshlrev_b32 v38, 16, v87
    v_and_b32 v39, 0xffff0000, v87
    v_add_u32 v248, 55296, v122
    v_add_u32 v249, 55296, v123
    v_add_u32 v250, 55296, v124
    s_waitcnt lgkmcnt(0)
    s_waitcnt vmcnt(10)
    v_max_u32 v251, v72, v73
    s_waitcnt vmcnt(8)
    v_max3_u32 v251, v74, v75, v251
    v_cmp_eq_u32 vcc, -1, v251
    s_nop 1
    s_cbranch_vccz L_backO0
    s_mov_b32 s63, 0x4000
L_spinO0:
    s_waitcnt vmcnt(0)
    buffer_load_dword v72, v133, s[24:27], s80 offen offset:0 sc1
    buffer_load_dword v73, v133, s[24:27], s80 offen offset:512 sc1
    buffer_load_dword v74, v133, s[24:27], s80 offen offset:64 sc1
    buffer_load_dword v75, v133, s[24:27], s80 offen offset:576 sc1
    buffer_load_dwordx4 v[40:43], v4, s[24:27], s79 offen offset:0 sc1
    buffer_load_dwordx4 v[44:47], v4, s[24:27], s88 offen offset:0 sc1
    buffer_load_dwordx4 v[48:51], v4, s[24:27], s79 offen offset:1024 sc1
    buffer_load_dwordx4 v[52:55], v4, s[24:27], s88 offen offset:1024 sc1
    buffer_load_dwordx4 v[56:59], v4, s[24:27], s79 offen offset:2048 sc1
    buffer_load_dwordx4 v[60:63], v4, s[24:27], s88 offen offset:2048 sc1
    buffer_load_dwordx4 v[64:67], v4, s[24:27], s79 offen offset:3072 sc1
    buffer_load_dwordx4 v[68:71], v4, s[24:27], s88 offen offset:3072 sc1
    s_waitcnt vmcnt(10)
    v_max_u32 v251, v72, v73
    s_waitcnt vmcnt(8)
    v_max3_u32 v251, v74, v75, v251
    v_cmp_eq_u32 vcc, -1, v251
    s_sub_u32 s63, s63, 1
    s_cbranch_scc1 L_backO0
    s_cbranch_vccnz L_spinO0
L_backO0:
    v_mfma_f32_16x16x16_bf16 v[168:171], v[136:137], v[72:73], v[168:171]
    v_mfma_f32_16x16x16_bf16 v[176:179], v[138:139], v[72:73], v[176:179]
    v_mfma_f32_16x16x16_bf16 v[184:187], v[140:141], v[72:73], v[184:187]
    v_mfma_f32_16x16x16_bf16 v[192:195], v[142:143], v[72:73], v[192:195]
    v_mfma_f32_16x16x16_bf16 v[200:203], v[144:145], v[72:73], v[200:203]
    v_mfma_f32_16x16x16_bf16 v[208:211], v[146:147], v[72:73], v[208:211]
    v_mfma_f32_16x16x16_bf16 v[216:219], v[148:149], v[72:73], v[216:219]
    v_mfma_f32_16x16x16_bf16 v[224:227], v[150:151], v[72:73], v[224:227]
    s_waitcnt vmcnt(7)
    v_max_u32 v251, v40, v41
    v_max3_u32 v251, v42, v43, v251
    v_mfma_f32_16x16x16_bf16 v[232:235], v[152:153], v[72:73], v[232:235]
    s_waitcnt vmcnt(6)
    v_max3_u32 v251, v44, v45, v251
    v_max3_u32 v251, v46, v47, v251
    v_mfma_f32_16x16x16_bf16 v[172:175], v[136:137], v[74:75], v[172:175]
    s_waitcnt vmcnt(5)
    v_max3_u32 v251, v48, v49, v251
    v_max3_u32 v251, v50, v51, v251
    v_mfma_f32_16x16x16_bf16 v[180:183], v[138:139], v[74:75], v[180:183]
    s_waitcnt vmcnt(4)
    v_max3_u32 v251, v52, v53, v251
    v_max3_u32 v251, v54, v55, v251
    v_mfma_f32_16x16x16_bf16 v[188:191], v[140:141], v[74:75], v[188:191]
    s_waitcnt vmcnt(3)
    v_max3_u32 v251, v56, v57, v251
    v_max3_u32 v251, v58, v59, v251
    v_mfma_f32_16x16x16_bf16 v[196:199], v[142:143], v[74:75], v[196:199]
    s_waitcnt vmcnt(2)
    v_max3_u32 v251, v60, v61, v251
    v_max3_u32 v251, v62, v63, v251
    v_mfma_f32_16x16x16_bf16 v[204:207], v[144:145], v[74:75], v[204:207]
    s_waitcnt vmcnt(1)
    v_max3_u32 v251, v64, v65, v251
    v_max3_u32 v251, v66, v67, v251
    v_mfma_f32_16x16x16_bf16 v[212:215], v[146:147], v[74:75], v[212:215]
    s_waitcnt vmcnt(0)
    v_max3_u32 v251, v68, v69, v251
    v_max3_u32 v251, v70, v71, v251
    v_mfma_f32_16x16x16_bf16 v[220:223], v[148:149], v[74:75], v[220:223]
    v_cmp_eq_u32 vcc, -1, v251
    v_mfma_f32_16x16x16_bf16 v[228:231], v[150:151], v[74:75], v[228:231]
    v_mfma_f32_16x16x16_bf16 v[236:239], v[152:153], v[74:75], v[236:239]
    s_cbranch_vccz L_backO1
    s_mov_b32 s63, 0x4000
L_spinO1:
    s_waitcnt vmcnt(0)
    buffer_load_dwordx4 v[40:43], v4, s[24:27], s79 offen offset:0 sc1
    buffer_load_dwordx4 v[44:47], v4, s[24:27], s88 offen offset:0 sc1
    buffer_load_dwordx4 v[48:51], v4, s[24:27], s79 offen offset:1024 sc1
    buffer_load_dwordx4 v[52:55], v4, s[24:27], s88 offen offset:1024 sc1
    buffer_load_dwordx4 v[56:59], v4, s[24:27], s79 offen offset:2048 sc1
    buffer_load_dwordx4 v[60:63], v4, s[24:27], s88 offen offset:2048 sc1
    buffer_load_dwordx4 v[64:67], v4, s[24:27], s79 offen offset:3072 sc1
    buffer_load_dwordx4 v[68:71], v4, s[24:27], s88 offen offset:3072 sc1
    s_waitcnt vmcnt(7)
    v_max_u32 v251, v40, v41
    v_max3_u32 v251, v42, v43, v251
    s_waitcnt vmcnt(6)
    v_max3_u32 v251, v44, v45, v251
    v_max3_u32 v251, v46, v47, v251
    s_waitcnt vmcnt(5)
    v_max3_u32 v251, v48, v49, v251
    v_max3_u32 v251, v50, v51, v251
    s_waitcnt vmcnt(4)
    v_max3_u32 v251, v52, v53, v251
    v_max3_u32 v251, v54, v55, v251
    s_waitcnt vmcnt(3)
    v_max3_u32 v251, v56, v57, v251
    v_max3_u32 v251, v58, v59, v251
    s_waitcnt vmcnt(2)
    v_max3_u32 v251, v60, v61, v251
    v_max3_u32 v251, v62, v63, v251
    s_waitcnt vmcnt(1)
    v_max3_u32 v251, v64, v65, v251
L_pg18:
    s_cbranch_execz L_tour_ret
    v_max3_u32 v251, v66, v67, v251
    s_waitcnt vmcnt(0)
    v_max3_u32 v251, v68, v69, v251
    v_max3_u32 v251, v70, v71, v251
    v_cmp_eq_u32 vcc, -1, v251
    s_sub_u32 s63, s63, 1
    s_cbranch_scc1 L_backO1
    s_cbranch_vccnz L_spinO1
L_backO1:
    v_mfma_f32_16x16x32_bf16 v[168:171], a[0:3], v[40:43], v[168:171]
    v_mfma_f32_16x16x32_bf16 v[168:171], a[36:39], v[48:51], v[168:171]
    v_mfma_f32_16x16x32_bf16 v[168:171], a[72:75], v[56:59], v[168:171]
    v_mfma_f32_16x16x32_bf16 v[168:171], a[112:115], v[64:67], v[168:171]
    v_mfma_f32_16x16x32_bf16 v[176:179], a[116:119], v[64:67], v[176:179]
    v_mfma_f32_16x16x32_bf16 v[176:179], a[76:79], v[56:59], v[176:179]
    v_mfma_f32_16x16x32_bf16 v[176:179], a[40:43], v[48:51], v[176:179]
    v_mfma_f32_16x16x32_bf16 v[176:179], a[4:7], v[40:43], v[176:179]
    v_mfma_f32_16x16x32_bf16 v[184:187], a[8:11], v[40:43], v[184:187]
    v_mfma_f32_16x16x32_bf16 v[184:187], a[44:47], v[48:51], v[184:187]
    v_mfma_f32_16x16x32_bf16 v[184:187], a[80:83], v[56:59], v[184:187]
    v_mfma_f32_16x16x32_bf16 v[184:187], a[120:123], v[64:67], v[184:187]
    ds_write_b128 v132, v[168:171] offset:0
    v_mfma_f32_16x16x32_bf16 v[192:195], a[124:127], v[64:67], v[192:195]
    v_mfma_f32_16x16x32_bf16 v[192:195], a[84:87], v[56:59], v[192:195]
    v_mfma_f32_16x16x32_bf16 v[192:195], a[48:51], v[48:51], v[192:195]
    v_mfma_f32_16x16x32_bf16 v[192:195], a[12:15], v[40:43], v[192:195]
    ds_write_b128 v132, v[176:179] offset:32
    v_mfma_f32_16x16x32_bf16 v[200:203], a[16:19], v[40:43], v[200:203]
    v_mfma_f32_16x16x32_bf16 v[200:203], a[52:55], v[48:51], v[200:203]
    v_mfma_f32_16x16x32_bf16 v[200:203], a[88:91], v[56:59], v[200:203]
    v_mfma_f32_16x16x32_bf16 v[200:203], a[128:131], v[64:67], v[200:203]
    ds_write_b128 v132, v[184:187] offset:64
    v_mfma_f32_16x16x32_bf16 v[208:211], a[132:135], v[64:67], v[208:211]
    v_mfma_f32_16x16x32_bf16 v[208:211], a[92:95], v[56:59], v[208:211]
    v_mfma_f32_16x16x32_bf16 v[208:211], a[56:59], v[48:51], v[208:211]
    v_mfma_f32_16x16x32_bf16 v[208:211], a[20:23], v[40:43], v[208:211]
    ds_write_b128 v132, v[192:195] offset:96
    v_mfma_f32_16x16x32_bf16 v[216:219], a[24:27], v[40:43], v[216:219]
    v_mfma_f32_16x16x32_bf16 v[216:219], a[60:63], v[48:51], v[216:219]
    v_mfma_f32_16x16x32_bf16 v[216:219], a[96:99], v[56:59], v[216:219]
    v_mfma_f32_16x16x32_bf16 v[216:219], a[136:139], v[64:67], v[216:219]
    ds_write_b128 v132, v[200:203] offset:128
    v_mfma_f32_16x16x32_bf16 v[224:227], a[140:143], v[64:67], v[224:227]
    v_mfma_f32_16x16x32_bf16 v[224:227], a[100:103], v[56:59], v[224:227]
    v_mfma_f32_16x16x32_bf16 v[224:227], a[64:67], v[48:51], v[224:227]
    v_mfma_f32_16x16x32_bf16 v[224:227], a[28:31], v[40:43], v[224:227]
    ds_write_b128 v132, v[208:211] offset:160
    v_mfma_f32_16x16x32_bf16 v[232:235], a[32:35], v[40:43], v[232:235]
    v_mfma_f32_16x16x32_bf16 v[232:235], a[68:71], v[48:51], v[232:235]
    v_mfma_f32_16x16x32_bf16 v[232:235], a[104:107], v[56:59], v[232:235]
    v_mfma_f32_16x16x32_bf16 v[232:235], a[144:147], v[64:67], v[232:235]
    ds_write_b128 v132, v[216:219] offset:192
    v_mfma_f32_16x16x32_bf16 v[172:175], a[0:3], v[44:47], v[172:175]
    v_mfma_f32_16x16x32_bf16 v[172:175], a[36:39], v[52:55], v[172:175]
    v_mfma_f32_16x16x32_bf16 v[172:175], a[72:75], v[60:63], v[172:175]
    v_mfma_f32_16x16x32_bf16 v[172:175], a[112:115], v[68:71], v[172:175]
    ds_write_b128 v132, v[224:227] offset:224
    v_mfma_f32_16x16x32_bf16 v[180:183], a[116:119], v[68:71], v[180:183]
    v_mfma_f32_16x16x32_bf16 v[180:183], a[76:79], v[60:63], v[180:183]
    v_mfma_f32_16x16x32_bf16 v[180:183], a[40:43], v[52:55], v[180:183]
    v_mfma_f32_16x16x32_bf16 v[180:183], a[4:7], v[44:47], v[180:183]
    ds_write_b128 v132, v[232:235] offset:256
    v_mfma_f32_16x16x32_bf16 v[188:191], a[8:11], v[44:47], v[188:191]
    v_mfma_f32_16x16x32_bf16 v[188:191], a[44:47], v[52:55], v[188:191]
    v_mfma_f32_16x16x32_bf16 v[188:191], a[80:83], v[60:63], v[188:191]
    v_mfma_f32_16x16x32_bf16 v[188:191], a[120:123], v[68:71], v[188:191]
    ds_write_b128 v132, v[172:175] offset:4608
    v_mfma_f32_16x16x32_bf16 v[196:199], a[124:127], v[68:71], v[196:199]
    v_mfma_f32_16x16x32_bf16 v[196:199], a[84:87], v[60:63], v[196:199]
    v_mfma_f32_16x16x32_bf16 v[196:199], a[48:51], v[52:55], v[196:199]
    v_mfma_f32_16x16x32_bf16 v[196:199], a[12:15], v[44:47], v[196:199]
    ds_write_b128 v132, v[180:183] offset:4640
    v_mfma_f32_16x16x32_bf16 v[204:207], a[16:19], v[44:47], v[204:207]
    v_mfma_f32_16x16x32_bf16 v[204:207], a[52:55], v[52:55], v[204:207]
    v_mfma_f32_16x16x32_bf16 v[204:207], a[88:91], v[60:63], v[204:207]
    v_mfma_f32_16x16x32_bf16 v[204:207], a[128:131], v[68:71], v[204:207]
    ds_write_b128 v132, v[188:191] offset:4672
    v_mfma_f32_16x16x32_bf16 v[212:215], a[132:135], v[68:71], v[212:215]
    v_mfma_f32_16x16x32_bf16 v[212:215], a[92:95], v[60:63], v[212:215]
    v_mfma_f32_16x16x32_bf16 v[212:215], a[56:59], v[52:55], v[212:215]
    v_mfma_f32_16x16x32_bf16 v[212:215], a[20:23], v[44:47], v[212:215]
    ds_write_b128 v132, v[196:199] offset:4704
    v_mfma_f32_16x16x32_bf16 v[220:223], a[24:27], v[44:47], v[220:223]
    v_mfma_f32_16x16x32_bf16 v[220:223], a[60:63], v[52:55], v[220:223]
    v_mfma_f32_16x16x32_bf16 v[220:223], a[96:99], v[60:63], v[220:223]
    v_mfma_f32_16x16x32_bf16 v[220:223], a[136:139], v[68:71], v[220:223]
    ds_write_b128 v132, v[204:207] offset:4736
    v_mfma_f32_16x16x32_bf16 v[228:231], a[140:143], v[68:71], v[228:231]
    v_mfma_f32_16x16x32_bf16 v[228:231], a[100:103], v[60:63], v[228:231]
    v_mfma_f32_16x16x32_bf16 v[228:231], a[64:67], v[52:55], v[228:231]
    v_mfma_f32_16x16x32_bf16 v[228:231], a[28:31], v[44:47], v[228:231]
    ds_write_b128 v132, v[212:215] offset:4768
    v_mfma_f32_16x16x32_bf16 v[236:239], a[32:35], v[44:47], v[236:239]
    v_mfma_f32_16x16x32_bf16 v[236:239], a[68:71], v[52:55], v[236:239]
    v_mfma_f32_16x16x32_bf16 v[236:239], a[104:107], v[60:63], v[236:239]
    v_mfma_f32_16x16x32_bf16 v[236:239], a[144:147], v[68:71], v[236:239]
    ds_write_b128 v132, v[220:223] offset:4800
    s_nop 1
    ds_write_b128 v132, v[228:231] offset:4832
    s_nop 3
    ds_write_b128 v132, v[236:239] offset:4864
    s_waitcnt lgkmcnt(0)
    s_barrier
    ds_read_b128 v[168:171], v122 offset:0
    ds_read_b128 v[172:175], v122 offset:9856
    ds_read_b128 v[176:179], v122 offset:27648
    ds_read_b128 v[180:183], v122 offset:37504
    ds_read_b128 v[184:187], v248 offset:0
    ds_read_b128 v[188:191], v248 offset:9856
    ds_read_b128 v[192:195], v248 offset:27648
    ds_read_b128 v[196:199], v248 offset:37504
    ds_read_b128 v[200:203], v123 offset:0
    ds_read_b128 v[204:207], v123 offset:9856
    ds_read_b128 v[208:211], v123 offset:27648
    ds_read_b128 v[212:215], v123 offset:37504
    ds_read_b128 v[216:219], v249 offset:0
    ds_read_b128 v[220:223], v249 offset:9856
    ds_read_b128 v[224:227], v249 offset:27648
    ds_read_b128 v[228:231], v249 offset:37504
    ds_read_b128 v[40:43], v124 offset:0
    ds_read_b128 v[44:47], v124 offset:9856
    ds_read_b128 v[48:51], v124 offset:27648
    ds_read_b128 v[52:55], v124 offset:37504
    ds_read_b128 v[56:59], v250 offset:0
    ds_read_b128 v[60:63], v250 offset:9856
    ds_read_b128 v[64:67], v250 offset:27648
    ds_read_b128 v[68:71], v250 offset:37504
    s_waitcnt lgkmcnt(15)
    v_pk_add_f32 v[16:17], v[16:17], v[168:169]
    v_pk_add_f32 v[18:19], v[18:19], v[170:171]
    v_pk_add_f32 v[20:21], v[20:21], v[172:173]
    v_pk_add_f32 v[22:23], v[22:23], v[174:175]
    v_pk_add_f32 v[16:17], v[16:17], v[176:177]
    v_pk_add_f32 v[18:19], v[18:19], v[178:179]
    v_pk_add_f32 v[20:21], v[20:21], v[180:181]
    v_pk_add_f32 v[22:23], v[22:23], v[182:183]
    v_pk_add_f32 v[16:17], v[16:17], v[184:185]
    v_pk_add_f32 v[18:19], v[18:19], v[186:187]
    v_pk_add_f32 v[20:21], v[20:21], v[188:189]
    v_pk_add_f32 v[22:23], v[22:23], v[190:191]
    v_pk_add_f32 v[16:17], v[16:17], v[192:193]
    v_pk_add_f32 v[18:19], v[18:19], v[194:195]
    v_pk_add_f32 v[20:21], v[20:21], v[196:197]
    v_pk_add_f32 v[22:23], v[22:23], v[198:199]
    v_cvt_pk_bf16_f32 v76, v16, v17
    v_cvt_pk_bf16_f32 v77, v18, v19
    v_cvt_pk_bf16_f32 v78, v20, v21
    v_cvt_pk_bf16_f32 v79, v22, v23
    buffer_store_dwordx4 v[76:79], v125, s[32:35], s78 offen nt
    s_waitcnt lgkmcnt(12)
    v_pk_add_f32 v[24:25], v[24:25], v[200:201]
    v_pk_add_f32 v[26:27], v[26:27], v[202:203]
    v_pk_add_f32 v[28:29], v[28:29], v[204:205]
    v_pk_add_f32 v[30:31], v[30:31], v[206:207]
    v_pk_add_f32 v[24:25], v[24:25], v[208:209]
    v_pk_add_f32 v[26:27], v[26:27], v[210:211]
    v_pk_add_f32 v[28:29], v[28:29], v[212:213]
    v_pk_add_f32 v[30:31], v[30:31], v[214:215]
    s_waitcnt lgkmcnt(8)
    v_pk_add_f32 v[24:25], v[24:25], v[216:217]
    v_pk_add_f32 v[26:27], v[26:27], v[218:219]
    v_pk_add_f32 v[28:29], v[28:29], v[220:221]
    v_pk_add_f32 v[30:31], v[30:31], v[222:223]
    v_pk_add_f32 v[24:25], v[24:25], v[224:225]
    v_pk_add_f32 v[26:27], v[26:27], v[226:227]
    v_pk_add_f32 v[28:29], v[28:29], v[228:229]
    v_pk_add_f32 v[30:31], v[30:31], v[230:231]
    v_cvt_pk_bf16_f32 v80, v24, v25
    v_cvt_pk_bf16_f32 v81, v26, v27
    v_cvt_pk_bf16_f32 v82, v28, v29
    v_cvt_pk_bf16_f32 v83, v30, v31
    buffer_store_dwordx4 v[80:83], v126, s[32:35], s78 offen nt
    s_waitcnt lgkmcnt(4)
    v_pk_add_f32 v[32:33], v[32:33], v[40:41]
    v_pk_add_f32 v[34:35], v[34:35], v[42:43]
    v_pk_add_f32 v[36:37], v[36:37], v[44:45]
    v_pk_add_f32 v[38:39], v[38:39], v[46:47]
    v_pk_add_f32 v[32:33], v[32:33], v[48:49]
    v_pk_add_f32 v[34:35], v[34:35], v[50:51]
    v_pk_add_f32 v[36:37], v[36:37], v[52:53]
    v_pk_add_f32 v[38:39], v[38:39], v[54:55]
    s_waitcnt lgkmcnt(0)
    v_pk_add_f32 v[32:33], v[32:33], v[56:57]
    v_pk_add_f32 v[34:35], v[34:35], v[58:59]
    v_pk_add_f32 v[36:37], v[36:37], v[60:61]
    v_pk_add_f32 v[38:39], v[38:39], v[62:63]
    v_pk_add_f32 v[32:33], v[32:33], v[64:65]
    v_pk_add_f32 v[34:35], v[34:35], v[66:67]
    v_pk_add_f32 v[36:37], v[36:37], v[68:69]
    v_pk_add_f32 v[38:39], v[38:39], v[70:71]
    v_cvt_pk_bf16_f32 v84, v32, v33
    v_cvt_pk_bf16_f32 v85, v34, v35
    v_cvt_pk_bf16_f32 v86, v36, v37
    v_cvt_pk_bf16_f32 v87, v38, v39
    buffer_store_dwordx4 v[84:87], v127, s[32:35], s78 offen nt
L_end:
    s_endpgm
L_Bqk:
    s_cmp_ge_u32 s80, 11
    s_cbranch_scc1 L_Bno
    v_mfma_f32_16x16x32_bf16 v[104:107], v[16:19], a[0:3], 0
    s_waitcnt lgkmcnt(3)
    ds_read_b64_tr_b16 v[28:29], v1 offset:12288
    v_lshrrev_b32 v253, 5, v0
    v_mfma_f32_16x16x32_bf16 v[104:107], v[20:23], a[16:19], v[104:107]
    s_waitcnt lgkmcnt(2)
    ds_read_b64_tr_b16 v[30:31], v1 offset:12800
    v_bfe_u32 v5, v0, 0, 5
    v_mfma_f32_16x16x32_bf16 v[104:107], v[24:27], a[32:35], v[104:107]
    ds_read_b64_tr_b16 v[32:33], v1 offset:16384
    v_lshrrev_b32 v14, 6, v0
    v_mfma_f32_16x16x32_bf16 v[108:111], v[24:27], a[36:39], 0
    ds_read_b64_tr_b16 v[34:35], v1 offset:16896
    v_lshl_add_u32 v5, v5, 0, v14
    v_mfma_f32_16x16x32_bf16 v[108:111], v[20:23], a[20:23], v[108:111]
    ds_read_b64_tr_b16 v[36:37], v1 offset:20480
    v_lshl_add_u32 v253, s78, 2, v253
    v_mfma_f32_16x16x32_bf16 v[108:111], v[16:19], a[4:7], v[108:111]
    ds_read_b64_tr_b16 v[38:39], v1 offset:20992
    v_mul_u32_u24 v5, 16, v5
    v_mfma_f32_16x16x32_bf16 v[112:115], v[16:19], a[8:11], 0
    ds_write_b128 v8, v[176:179] offset:38912
    v_mfma_f32_16x16x32_bf16 v[112:115], v[20:23], a[24:27], v[112:115]
    v_add_u32 v5, 2359296, v5
    v_mul_u32_u24 v14, 7296, v253
    v_mfma_f32_16x16x32_bf16 v[112:115], v[24:27], a[40:43], v[112:115]
    v_lshrrev_b32 v14, 16, v14
    v_mul_u32_u24 v14, 290304, v14
    v_mfma_f32_16x16x32_bf16 v[116:119], v[24:27], a[44:47], 0
    v_lshl_add_u32 v14, v253, 9, v14
    v_add_u32 v14, v5, v14
    v_mfma_f32_16x16x32_bf16 v[116:119], v[20:23], a[28:31], v[116:119]
    ds_write_b128 v8, v[172:175] offset:37888
    v_mfma_f32_16x16x32_bf16 v[116:119], v[16:19], a[12:15], v[116:119]
    s_waitcnt lgkmcnt(6)
    v_add_u32 v253, 2, v253
    v_mul_u32_u24 v15, 7296, v253
    v_mfma_f32_16x16x32_bf16 v[116:119], v[28:31], a[60:63], v[116:119]
    s_waitcnt lgkmcnt(4)
    ds_read_b64_tr_b16 v[16:17], v1 offset:24576
    v_lshrrev_b32 v15, 16, v15
    v_mfma_f32_16x16x32_bf16 v[116:119], v[32:35], a[76:79], v[116:119]
    s_waitcnt lgkmcnt(3)
    ds_read_b64_tr_b16 v[18:19], v1 offset:25088
    v_mul_u32_u24 v15, 290304, v15
    v_mfma_f32_16x16x32_bf16 v[116:119], v[36:39], a[92:95], v[116:119]
    ds_read_b64_tr_b16 v[20:21], v1 offset:28672
    v_lshl_add_u32 v15, v253, 9, v15
    v_mfma_f32_16x16x32_bf16 v[112:115], v[36:39], a[88:91], v[112:115]
    ds_read_b64_tr_b16 v[22:23], v1 offset:29184
    v_add_u32 v15, v5, v15
    v_mfma_f32_16x16x32_bf16 v[112:115], v[32:35], a[72:75], v[112:115]
    ds_read_b64_tr_b16 v[24:25], v1 offset:32768
    v_mul_f32 v102, v102, v166
    v_mfma_f32_16x16x32_bf16 v[112:115], v[28:31], a[56:59], v[112:115]
    ds_write_b128 v8, v[168:171] offset:36864
    v_mfma_f32_16x16x32_bf16 v[108:111], v[28:31], a[52:55], v[108:111]
    ds_read_b64_tr_b16 v[26:27], v1 offset:33280
    v_mul_f32 v103, v103, v167
    v_mfma_f32_16x16x32_bf16 v[108:111], v[32:35], a[68:71], v[108:111]
    v_cvt_pk_bf16_f32 v230, v100, v101
    v_cvt_pk_bf16_f32 v231, v102, v103
    v_mfma_f32_16x16x32_bf16 v[108:111], v[36:39], a[84:87], v[108:111]
    v_mul_f32 v248, v248, v160
    v_mul_f32 v249, v161, v161
    v_mfma_f32_16x16x32_bf16 v[104:107], v[36:39], a[80:83], v[104:107]
    ds_write_b128 v8, v[196:199] offset:3072
    v_mfma_f32_16x16x32_bf16 v[104:107], v[32:35], a[64:67], v[104:107]
    v_exp_f32 v248, v248
    v_mfma_f32_16x16x32_bf16 v[104:107], v[28:31], a[48:51], v[104:107]
    s_waitcnt lgkmcnt(6)
    v_add_f32 v248, 1.0, v248
    v_fma_f32 v249, v249, s79, v252
    v_mfma_f32_16x16x32_bf16 v[104:107], v[16:19], a[96:99], v[104:107]
    s_waitcnt lgkmcnt(4)
    ds_read_b64_tr_b16 v[28:29], v2 offset:24576
    v_mul_f32 v249, v249, v161
    v_mfma_f32_16x16x32_bf16 v[104:107], v[20:23], a[112:115], v[104:107]
    s_waitcnt lgkmcnt(2)
    ds_read_b64_tr_b16 v[30:31], v2 offset:25088
    v_mul_f32 v250, v162, v162
    v_mfma_f32_16x16x32_bf16 v[104:107], v[24:27], a[128:131], v[104:107]
    ds_read_b64_tr_b16 v[32:33], v2 offset:28672
    v_fma_f32 v250, v250, s79, v252
    v_mfma_f32_16x16x32_bf16 v[108:111], v[24:27], a[132:135], v[108:111]
    ds_write_b128 v8, v[192:195] offset:2048
    v_mfma_f32_16x16x32_bf16 v[108:111], v[20:23], a[116:119], v[108:111]
    ds_read_b64_tr_b16 v[34:35], v2 offset:29184
    v_mul_f32 v250, v250, v162
    v_mfma_f32_16x16x32_bf16 v[108:111], v[16:19], a[100:103], v[108:111]
    ds_read_b64_tr_b16 v[36:37], v2 offset:32768
    v_mul_f32 v251, v163, v163
    v_mfma_f32_16x16x32_bf16 v[112:115], v[16:19], a[104:107], v[112:115]
    ds_read_b64_tr_b16 v[38:39], v2 offset:33280
    v_fma_f32 v251, v251, s79, v252
    v_mfma_f32_16x16x32_bf16 v[112:115], v[20:23], a[120:123], v[112:115]
    ds_write_b128 v8, v[188:191] offset:1024
    v_mfma_f32_16x16x32_bf16 v[112:115], v[24:27], a[136:139], v[112:115]
    v_rcp_f32 v248, v248
    v_mfma_f32_16x16x32_bf16 v[116:119], v[24:27], a[140:143], v[116:119]
    v_exp_f32 v249, v249
    v_mfma_f32_16x16x32_bf16 v[116:119], v[20:23], a[124:127], v[116:119]
    v_exp_f32 v250, v250
    v_mfma_f32_16x16x32_bf16 v[116:119], v[16:19], a[108:111], v[116:119]
    s_waitcnt lgkmcnt(6)
    ds_write_b128 v8, v[184:187] offset:0
    v_mfma_f32_16x16x32_bf16 v[132:135], v[28:31], a[108:111], 0
    s_waitcnt lgkmcnt(4)
    ds_read_b64_tr_b16 v[16:17], v2 offset:12288
    v_mul_f32 v160, v160, v248
    v_mfma_f32_16x16x32_bf16 v[132:135], v[32:35], a[124:127], v[132:135]
    s_waitcnt lgkmcnt(3)
    ds_read_b64_tr_b16 v[18:19], v2 offset:12800
    v_mul_f32 v96, v96, v160
    v_mfma_f32_16x16x32_bf16 v[132:135], v[36:39], a[140:143], v[132:135]
    ds_read_b64_tr_b16 v[20:21], v2 offset:16384
    v_add_f32 v249, 1.0, v249
    v_mfma_f32_16x16x32_bf16 v[128:131], v[36:39], a[136:139], 0
    ds_read_b64_tr_b16 v[22:23], v2 offset:16896
    v_add_f32 v250, 1.0, v250
    v_mfma_f32_16x16x32_bf16 v[128:131], v[32:35], a[120:123], v[128:131]
    ds_read_b64_tr_b16 v[24:25], v2 offset:20480
    v_mul_f32 v251, v251, v163
    v_mfma_f32_16x16x32_bf16 v[128:131], v[28:31], a[104:107], v[128:131]
    ds_read_b64_tr_b16 v[26:27], v2 offset:20992
    v_mul_f32 v248, v156, v156
    v_mfma_f32_16x16x32_bf16 v[124:127], v[28:31], a[100:103], 0
    ds_write_b128 v8, v[212:215] offset:19456
    v_mfma_f32_16x16x32_bf16 v[124:127], v[32:35], a[116:119], v[124:127]
    v_rcp_f32 v249, v249
    v_mfma_f32_16x16x32_bf16 v[124:127], v[36:39], a[132:135], v[124:127]
    v_rcp_f32 v250, v250
    v_mfma_f32_16x16x32_bf16 v[120:123], v[36:39], a[128:131], 0
    v_exp_f32 v251, v251
    v_mfma_f32_16x16x32_bf16 v[120:123], v[32:35], a[112:115], v[120:123]
    ds_write_b128 v8, v[208:211] offset:18432
    v_mfma_f32_16x16x32_bf16 v[120:123], v[28:31], a[96:99], v[120:123]
    s_waitcnt lgkmcnt(6)
    v_mul_f32 v161, v161, v249
    v_mul_f32 v97, v97, v161
    v_mfma_f32_16x16x32_bf16 v[120:123], v[16:19], a[48:51], v[120:123]
    s_waitcnt lgkmcnt(4)
    ds_read_b64_tr_b16 v[28:29], v2 offset:0
    v_cvt_pk_bf16_f32 v226, v96, v97
    v_mfma_f32_16x16x32_bf16 v[120:123], v[20:23], a[64:67], v[120:123]
    s_waitcnt lgkmcnt(3)
    ds_read_b64_tr_b16 v[30:31], v2 offset:512
    v_mul_f32 v162, v162, v250
    v_mfma_f32_16x16x32_bf16 v[120:123], v[24:27], a[80:83], v[120:123]
    ds_read_b64_tr_b16 v[32:33], v2 offset:4096
    v_mul_f32 v98, v98, v162
    v_mfma_f32_16x16x32_bf16 v[124:127], v[24:27], a[84:87], v[124:127]
    ds_read_b64_tr_b16 v[34:35], v2 offset:4608
    v_add_f32 v251, 1.0, v251
    v_mfma_f32_16x16x32_bf16 v[124:127], v[20:23], a[68:71], v[124:127]
    ds_write_b128 v8, v[204:207] offset:17408
    v_mfma_f32_16x16x32_bf16 v[124:127], v[16:19], a[52:55], v[124:127]
    ds_read_b64_tr_b16 v[36:37], v2 offset:8192
    v_fma_f32 v248, v248, s79, v252
    v_mfma_f32_16x16x32_bf16 v[128:131], v[16:19], a[56:59], v[128:131]
    ds_read_b64_tr_b16 v[38:39], v2 offset:8704
    v_mul_f32 v248, v248, v156
    v_mfma_f32_16x16x32_bf16 v[128:131], v[20:23], a[72:75], v[128:131]
    v_add_u32 v1, 36864, v1
    v_add_u32 v2, 36864, v2
    v_mfma_f32_16x16x32_bf16 v[128:131], v[24:27], a[88:91], v[128:131]
    s_add_u32 s60, s65, 128
    ds_write_b128 v8, v[200:203] offset:16384
    v_mfma_f32_16x16x32_bf16 v[132:135], v[24:27], a[92:95], v[132:135]
    s_add_u32 m0, s55, 0
    v_rcp_f32 v251, v251
    v_mfma_f32_16x16x32_bf16 v[132:135], v[20:23], a[76:79], v[132:135]
    v_exp_f32 v248, v248
    v_mfma_f32_16x16x32_bf16 v[132:135], v[16:19], a[60:63], v[132:135]
    s_waitcnt lgkmcnt(6)
    v_mul_f32 v163, v163, v251
    v_mul_f32 v99, v99, v163
    v_mfma_f32_16x16x32_bf16 v[132:135], v[28:31], a[12:15], v[132:135]
    s_waitcnt lgkmcnt(4)
    v_cvt_pk_bf16_f32 v227, v98, v99
    v_add_f32 v248, 1.0, v248
    v_mfma_f32_16x16x32_bf16 v[132:135], v[32:35], a[28:31], v[132:135]
    s_waitcnt vmcnt(15) lgkmcnt(0)
    s_barrier
    v_mfma_f32_16x16x32_bf16 v[132:135], v[36:39], a[44:47], v[132:135]
    buffer_load_dwordx4 v7, s[20:23], s60 offen  lds
    v_mfma_f32_16x16x32_bf16 v[128:131], v[36:39], a[40:43], v[128:131]
    s_add_u32 s60, s65, 36992
    ds_read_b64_tr_b16 v[16:17], v1 offset:0
    v_mul_f32 v249, v157, v157
    v_mfma_f32_16x16x32_bf16 v[128:131], v[32:35], a[24:27], v[128:131]
    s_add_u32 m0, s55, 4096
    ds_read_b64_tr_b16 v[18:19], v1 offset:512
    v_fma_f32 v249, v249, s79, v252
    v_mfma_f32_16x16x32_bf16 v[128:131], v[28:31], a[8:11], v[128:131]
    ds_read_b64_tr_b16 v[20:21], v1 offset:4096
    v_mul_f32 v249, v249, v157
    v_mfma_f32_16x16x32_bf16 v[124:127], v[28:31], a[4:7], v[124:127]
    ds_read_b64_tr_b16 v[22:23], v1 offset:4608
    v_mul_f32 v250, v158, v158
    v_mfma_f32_16x16x32_bf16 v[124:127], v[32:35], a[20:23], v[124:127]
    ds_read_b64_tr_b16 v[24:25], v1 offset:8192
    v_fma_f32 v250, v250, s79, v252
    v_mfma_f32_16x16x32_bf16 v[124:127], v[36:39], a[36:39], v[124:127]
    ds_read_b64_tr_b16 v[26:27], v1 offset:8704
    v_mul_f32 v250, v250, v158
    v_mfma_f32_16x16x32_bf16 v[120:123], v[36:39], a[32:35], v[120:123]
    buffer_load_dwordx4 v7, s[20:23], s60 offen  lds
    v_mfma_f32_16x16x32_bf16 v[120:123], v[32:35], a[16:19], v[120:123]
    s_add_u32 s60, s65, 73856
    v_rcp_f32 v248, v248
    v_mfma_f32_16x16x32_bf16 v[120:123], v[28:31], a[0:3], v[120:123]
    s_waitcnt lgkmcnt(4)
    v_exp_f32 v249, v249
    v_mfma_f32_16x16x32_bf16 v[104:107], v[16:19], a[144:147], v[104:107]
    s_waitcnt lgkmcnt(2)
    ds_read_b64_tr_b16 v[28:29], v1 offset:12288
    v_mul_f32 v156, v156, v248
    v_mfma_f32_16x16x32_bf16 v[104:107], v[20:23], a[160:163], v[104:107]
    s_waitcnt lgkmcnt(1)
    ds_read_b64_tr_b16 v[30:31], v1 offset:12800
    v_mul_f32 v92, v92, v156
    v_mfma_f32_16x16x32_bf16 v[104:107], v[24:27], a[176:179], v[104:107]
    s_add_u32 m0, s55, 8192
    ds_read_b64_tr_b16 v[32:33], v1 offset:16384
    v_add_f32 v249, 1.0, v249
    v_mfma_f32_16x16x32_bf16 v[108:111], v[24:27], a[180:183], v[108:111]
    ds_read_b64_tr_b16 v[34:35], v1 offset:16896
    v_mul_f32 v251, v159, v159
    v_mfma_f32_16x16x32_bf16 v[108:111], v[20:23], a[164:167], v[108:111]
    buffer_load_dwordx4 v7, s[20:23], s60 offen  lds
    v_mfma_f32_16x16x32_bf16 v[108:111], v[16:19], a[148:151], v[108:111]
    s_add_u32 s60, s65, 110720
    ds_read_b64_tr_b16 v[36:37], v1 offset:20480
    v_fma_f32 v251, v251, s79, v252
    v_mfma_f32_16x16x32_bf16 v[112:115], v[16:19], a[152:155], v[112:115]
    s_add_u32 m0, s55, 12288
    ds_read_b64_tr_b16 v[38:39], v1 offset:20992
    v_mul_f32 v251, v251, v159
    v_mfma_f32_16x16x32_bf16 v[112:115], v[20:23], a[168:171], v[112:115]
    v_rcp_f32 v249, v249
    v_mfma_f32_16x16x32_bf16 v[112:115], v[24:27], a[184:187], v[112:115]
    v_exp_f32 v250, v250
    v_mfma_f32_16x16x32_bf16 v[116:119], v[24:27], a[188:191], v[116:119]
    ds_read_b128 a[0:3], v9 offset:36864
    v_mul_f32 v157, v157, v249
    v_mfma_f32_16x16x32_bf16 v[116:119], v[20:23], a[172:175], v[116:119]
    v_exp_f32 v251, v251
    v_mfma_f32_16x16x32_bf16 v[116:119], v[16:19], a[156:159], v[116:119]
    s_waitcnt lgkmcnt(5)
    v_mul_f32 v93, v93, v157
    v_cvt_pk_bf16_f32 v222, v92, v93
    v_mfma_f32_16x16x32_bf16 v[116:119], v[28:31], a[204:207], v[116:119]
    s_waitcnt lgkmcnt(3)
    ds_read_b64_tr_b16 v[16:17], v1 offset:24576
    v_add_f32 v250, 1.0, v250
    v_mfma_f32_16x16x32_bf16 v[116:119], v[32:35], a[220:223], v[116:119]
    s_waitcnt lgkmcnt(2)
    ds_read_b128 a[4:7], v9 offset:37888
    v_add_f32 v251, 1.0, v251
    v_mfma_f32_16x16x32_bf16 v[116:119], v[36:39], a[236:239], v[116:119]
    buffer_load_dwordx4 v7, s[20:23], s60 offen  lds
    v_mfma_f32_16x16x32_bf16 v[112:115], v[36:39], a[232:235], v[112:115]
    s_add_u32 s60, s65, 147584
    ds_read_b64_tr_b16 v[18:19], v1 offset:25088
    v_mul_f32 v248, v152, v152
    v_mfma_f32_16x16x32_bf16 v[112:115], v[32:35], a[216:219], v[112:115]
    s_add_u32 m0, s55, 16384
    ds_read_b64_tr_b16 v[20:21], v1 offset:28672
    v_fma_f32 v248, v248, s79, v252
    v_mfma_f32_16x16x32_bf16 v[112:115], v[28:31], a[200:203], v[112:115]
    ds_read_b128 a[8:11], v9 offset:38912
    v_mul_f32 v248, v248, v152
    v_mfma_f32_16x16x32_bf16 v[108:111], v[28:31], a[196:199], v[108:111]
    ds_read_b64_tr_b16 v[22:23], v1 offset:29184
    v_mul_f32 v249, v153, v153
    v_mfma_f32_16x16x32_bf16 v[108:111], v[32:35], a[212:215], v[108:111]
    buffer_load_dwordx4 v7, s[20:23], s60 offen  lds
    v_mfma_f32_16x16x32_bf16 v[108:111], v[36:39], a[228:231], v[108:111]
    s_add_u32 s60, s65, 184448
    ds_read_b64_tr_b16 v[24:25], v1 offset:32768
    ds_read_b64_tr_b16 v[26:27], v1 offset:33280
    v_mfma_f32_16x16x32_bf16 v[104:107], v[36:39], a[224:227], v[104:107]
    s_add_u32 m0, s55, 20480
    ds_read_b128 a[12:15], v9 offset:39936
    v_fma_f32 v249, v249, s79, v252
    v_mfma_f32_16x16x32_bf16 v[104:107], v[32:35], a[208:211], v[104:107]
    v_rcp_f32 v250, v250
    v_mfma_f32_16x16x32_bf16 v[104:107], v[28:31], a[192:195], v[104:107]
    s_waitcnt lgkmcnt(6)
    v_rcp_f32 v251, v251
    v_mfma_f32_16x16x32_bf16 v[104:107], v[16:19], a[240:243], v[104:107]
    s_waitcnt lgkmcnt(3)
    ds_read_b64_tr_b16 v[28:29], v2 offset:24576
    v_mul_f32 v158, v158, v250
    v_mfma_f32_16x16x32_bf16 v[104:107], v[20:23], v[40:43], v[104:107]
    s_waitcnt lgkmcnt(2)
    ds_read_b128 a[16:19], v9 offset:0
    v_mul_f32 v94, v94, v158
    v_mfma_f32_16x16x32_bf16 v[104:107], v[24:27], v[56:59], v[104:107]
    buffer_load_dwordx4 v7, s[20:23], s60 offen  lds
    v_mfma_f32_16x16x32_bf16 v[108:111], v[24:27], v[60:63], v[108:111]
    s_add_u32 s60, s65, 221312
    ds_read_b64_tr_b16 v[30:31], v2 offset:25088
    v_mul_f32 v159, v159, v251
    v_mfma_f32_16x16x32_bf16 v[108:111], v[20:23], v[44:47], v[108:111]
    s_add_u32 m0, s55, 24576
    ds_read_b64_tr_b16 v[32:33], v2 offset:28672
    v_mul_f32 v95, v95, v159
    v_mfma_f32_16x16x32_bf16 v[108:111], v[16:19], a[244:247], v[108:111]
    ds_read_b128 a[20:23], v9 offset:1024
    v_cvt_pk_bf16_f32 v223, v94, v95
    v_mfma_f32_16x16x32_bf16 v[112:115], v[16:19], a[248:251], v[112:115]
    ds_read_b64_tr_b16 v[34:35], v2 offset:29184
    v_mul_f32 v249, v249, v153
    v_mfma_f32_16x16x32_bf16 v[112:115], v[20:23], v[48:51], v[112:115]
    ds_read_b64_tr_b16 v[36:37], v2 offset:32768
    v_mul_f32 v250, v154, v154
    v_mfma_f32_16x16x32_bf16 v[112:115], v[24:27], v[64:67], v[112:115]
    ds_read_b64_tr_b16 v[38:39], v2 offset:33280
    v_fma_f32 v250, v250, s79, v252
    v_mfma_f32_16x16x32_bf16 v[116:119], v[24:27], v[68:71], v[116:119]
    ds_read_b128 a[24:27], v9 offset:2048
    v_mul_f32 v250, v250, v154
    v_mfma_f32_16x16x32_bf16 v[116:119], v[20:23], v[52:55], v[116:119]
    buffer_load_dwordx4 v7, s[20:23], s60 offen  lds
    v_mfma_f32_16x16x32_bf16 v[116:119], v[16:19], a[252:255], v[116:119]
    s_waitcnt lgkmcnt(6)
    v_cvt_pk_bf16_f32 v104, v104, v105
    v_cvt_pk_bf16_f32 v105, v106, v107
    v_mfma_f32_16x16x32_bf16 v[132:135], v[28:31], a[252:255], v[132:135]
    s_waitcnt lgkmcnt(3)
    ds_read_b64_tr_b16 v[16:17], v2 offset:12288
    v_mul_f32 v251, v155, v155
    v_mfma_f32_16x16x32_bf16 v[132:135], v[32:35], v[52:55], v[132:135]
    s_waitcnt lgkmcnt(2)
    ds_read_b128 a[28:31], v9 offset:3072
    v_cvt_pk_bf16_f32 v106, v108, v109
    v_mfma_f32_16x16x32_bf16 v[132:135], v[36:39], v[68:71], v[132:135]
    s_add_u32 s60, s65, 258176
    ds_read_b64_tr_b16 v[18:19], v2 offset:12800
    v_cvt_pk_bf16_f32 v107, v110, v111
    v_mfma_f32_16x16x32_bf16 v[128:131], v[36:39], v[64:67], v[128:131]
    s_add_u32 m0, s55, 28672
    ds_read_b64_tr_b16 v[20:21], v2 offset:16384
    v_fma_f32 v251, v251, s79, v252
    v_mfma_f32_16x16x32_bf16 v[128:131], v[32:35], v[48:51], v[128:131]
    ds_read_b64_tr_b16 v[22:23], v2 offset:16896
    v_permlane16_swap_b32 v104, v106
    v_mfma_f32_16x16x32_bf16 v[128:131], v[28:31], a[248:251], v[128:131]
    ds_read_b128 a[32:35], v9 offset:16384
    v_permlane16_swap_b32 v105, v107
    v_mfma_f32_16x16x32_bf16 v[124:127], v[28:31], a[244:247], v[124:127]
    buffer_load_dwordx4 v7, s[20:23], s60 offen  lds
    v_mfma_f32_16x16x32_bf16 v[124:127], v[32:35], v[44:47], v[124:127]
    s_add_u32 s60, s66, 128
    ds_read_b64_tr_b16 v[24:25], v2 offset:20480
    v_cvt_pk_bf16_f32 v112, v112, v113
    v_mfma_f32_16x16x32_bf16 v[124:127], v[36:39], v[60:63], v[124:127]
    s_add_u32 m0, s55, 32768
    ds_read_b64_tr_b16 v[26:27], v2 offset:20992
    v_cvt_pk_bf16_f32 v113, v114, v115
    v_mfma_f32_16x16x32_bf16 v[120:123], v[36:39], v[56:59], v[120:123]
    ds_read_b128 a[36:39], v9 offset:17408
    v_cvt_pk_bf16_f32 v114, v116, v117
    v_mfma_f32_16x16x32_bf16 v[120:123], v[32:35], v[40:43], v[120:123]
    buffer_store_dwordx4 v[104:107], v14, s[48:51], s70 offen sc1
    v_mfma_f32_16x16x32_bf16 v[120:123], v[28:31], a[240:243], v[120:123]
    s_waitcnt lgkmcnt(6)
    v_cvt_pk_bf16_f32 v115, v118, v119
    v_mul_f32 v251, v251, v155
    v_mfma_f32_16x16x32_bf16 v[120:123], v[16:19], a[192:195], v[120:123]
    s_waitcnt lgkmcnt(4)
    ds_read_b64_tr_b16 v[28:29], v2 offset:0
    ds_read_b128 a[40:43], v9 offset:18432
    v_mfma_f32_16x16x32_bf16 v[120:123], v[20:23], a[208:211], v[120:123]
    s_waitcnt lgkmcnt(3)
L_pg19:
    s_cbranch_execz L_tour_ret
    ds_read_b64_tr_b16 v[30:31], v2 offset:512
    v_permlane16_swap_b32 v112, v114
    v_mfma_f32_16x16x32_bf16 v[120:123], v[24:27], a[224:227], v[120:123]
    buffer_load_dwordx4 v7, s[20:23], s60 offen  lds
    v_mfma_f32_16x16x32_bf16 v[124:127], v[24:27], a[228:231], v[124:127]
    ds_read_b64_tr_b16 v[32:33], v2 offset:4096
    v_permlane16_swap_b32 v113, v115
    v_mfma_f32_16x16x32_bf16 v[124:127], v[20:23], a[212:215], v[124:127]
    ds_read_b64_tr_b16 v[34:35], v2 offset:4608
    ds_read_b128 a[44:47], v9 offset:19456
    v_mfma_f32_16x16x32_bf16 v[124:127], v[16:19], a[196:199], v[124:127]
    ds_read_b64_tr_b16 v[36:37], v2 offset:8192
    v_lshlrev_b32 v4, 4, v0
    v_mfma_f32_16x16x32_bf16 v[128:131], v[16:19], a[200:203], v[128:131]
    ds_read_b64_tr_b16 v[38:39], v2 offset:8704
    v_mfma_f32_16x16x32_bf16 v[128:131], v[20:23], a[216:219], v[128:131]
    buffer_store_dwordx4 v[112:115], v14, s[48:51], s71 offen sc1
    v_mfma_f32_16x16x32_bf16 v[128:131], v[24:27], a[232:235], v[128:131]
    v_exp_f32 v248, v248
    v_mfma_f32_16x16x32_bf16 v[132:135], v[24:27], a[236:239], v[132:135]
    v_exp_f32 v249, v249
    v_mfma_f32_16x16x32_bf16 v[132:135], v[20:23], a[220:223], v[132:135]
    v_exp_f32 v250, v250
    v_mfma_f32_16x16x32_bf16 v[132:135], v[16:19], a[204:207], v[132:135]
    s_waitcnt lgkmcnt(5)
    v_exp_f32 v251, v251
    v_mfma_f32_16x16x32_bf16 v[132:135], v[28:31], a[156:159], v[132:135]
    s_waitcnt lgkmcnt(3)
    v_add_f32 v248, 1.0, v248
    v_add_f32 v249, 1.0, v249
    v_mfma_f32_16x16x32_bf16 v[132:135], v[32:35], a[172:175], v[132:135]
    s_waitcnt vmcnt(16) lgkmcnt(0)
    s_barrier
    v_mfma_f32_16x16x32_bf16 v[132:135], v[36:39], a[188:191], v[132:135]
    ds_read_b64_tr_b16 v[16:17], v10 offset:0
    v_add_f32 v250, 1.0, v250
    v_mfma_f32_16x16x32_bf16 v[128:131], v[36:39], a[184:187], v[128:131]
    ds_read_b64_tr_b16 v[18:19], v10 offset:2048
    v_add_f32 v251, 1.0, v251
    v_mfma_f32_16x16x32_bf16 v[128:131], v[32:35], a[168:171], v[128:131]
    ds_read_b64_tr_b16 v[20:21], v10 offset:8192
    v_mfma_f32_16x16x32_bf16 v[128:131], v[28:31], a[152:155], v[128:131]
    ds_read_b64_tr_b16 v[22:23], v10 offset:10240
    v_mfma_f32_16x16x32_bf16 v[124:127], v[28:31], a[148:151], v[124:127]
    ds_read_b64_tr_b16 v[24:25], v10 offset:16384
    v_mfma_f32_16x16x32_bf16 v[124:127], v[32:35], a[164:167], v[124:127]
    ds_read_b64_tr_b16 v[26:27], v10 offset:18432
    v_mfma_f32_16x16x32_bf16 v[124:127], v[36:39], a[180:183], v[124:127]
    v_rcp_f32 v248, v248
    v_mfma_f32_16x16x32_bf16 v[120:123], v[36:39], a[176:179], v[120:123]
    v_rcp_f32 v249, v249
    v_mfma_f32_16x16x32_bf16 v[120:123], v[32:35], a[160:163], v[120:123]
    v_rcp_f32 v250, v250
    v_mfma_f32_16x16x32_bf16 v[120:123], v[28:31], a[144:147], v[120:123]
    s_waitcnt lgkmcnt(4)
    v_rcp_f32 v251, v251
    s_branch L_Bdone
L_Bno:
    s_nop 7
    v_lshrrev_b32 v253, 5, v0
    v_bfe_u32 v5, v0, 0, 5
    v_lshrrev_b32 v14, 6, v0
    v_lshl_add_u32 v5, v5, 0, v14
    v_lshl_add_u32 v253, s78, 2, v253
    v_mul_u32_u24 v5, 16, v5
    ds_write_b128 v8, v[176:179] offset:38912
    v_add_u32 v5, 2359296, v5
    v_mul_u32_u24 v14, 7296, v253
    v_lshrrev_b32 v14, 16, v14
    v_mul_u32_u24 v14, 290304, v14
    v_lshl_add_u32 v14, v253, 9, v14
    v_add_u32 v14, v5, v14
    ds_write_b128 v8, v[172:175] offset:37888
    v_add_u32 v253, 2, v253
    v_mul_u32_u24 v15, 7296, v253
    v_lshrrev_b32 v15, 16, v15
    v_mul_u32_u24 v15, 290304, v15
    v_lshl_add_u32 v15, v253, 9, v15
    v_add_u32 v15, v5, v15
    v_mul_f32 v102, v102, v166
    ds_write_b128 v8, v[168:171] offset:36864
    v_mul_f32 v103, v103, v167
    v_cvt_pk_bf16_f32 v230, v100, v101
    v_cvt_pk_bf16_f32 v231, v102, v103
    v_mul_f32 v248, v248, v160
    v_mul_f32 v249, v161, v161
    ds_write_b128 v8, v[196:199] offset:3072
    v_exp_f32 v248, v248
    s_nop 0
    v_add_f32 v248, 1.0, v248
    v_fma_f32 v249, v249, s79, v252
    v_mul_f32 v249, v249, v161
    v_mul_f32 v250, v162, v162
    v_fma_f32 v250, v250, s79, v252
    ds_write_b128 v8, v[192:195] offset:2048
    v_mul_f32 v250, v250, v162
    v_mul_f32 v251, v163, v163
    v_fma_f32 v251, v251, s79, v252
    ds_write_b128 v8, v[188:191] offset:1024
    v_rcp_f32 v248, v248
    v_exp_f32 v249, v249
    v_exp_f32 v250, v250
    ds_write_b128 v8, v[184:187] offset:0
    v_mul_f32 v160, v160, v248
    v_mul_f32 v96, v96, v160
    v_add_f32 v249, 1.0, v249
    v_add_f32 v250, 1.0, v250
    v_mul_f32 v251, v251, v163
    v_mul_f32 v248, v156, v156
    ds_write_b128 v8, v[212:215] offset:19456
    v_rcp_f32 v249, v249
    v_rcp_f32 v250, v250
    v_exp_f32 v251, v251
    ds_write_b128 v8, v[208:211] offset:18432
    v_mul_f32 v161, v161, v249
    v_mul_f32 v97, v97, v161
    v_cvt_pk_bf16_f32 v226, v96, v97
    v_mul_f32 v162, v162, v250
    v_mul_f32 v98, v98, v162
    v_add_f32 v251, 1.0, v251
    ds_write_b128 v8, v[204:207] offset:17408
    v_fma_f32 v248, v248, s79, v252
    v_mul_f32 v248, v248, v156
    v_add_u32 v1, 36864, v1
    v_add_u32 v2, 36864, v2
    s_add_u32 s60, s65, 128
    ds_write_b128 v8, v[200:203] offset:16384
    s_add_u32 m0, s55, 0
    v_rcp_f32 v251, v251
    v_exp_f32 v248, v248
    v_mul_f32 v163, v163, v251
    v_mul_f32 v99, v99, v163
    v_cvt_pk_bf16_f32 v227, v98, v99
    v_add_f32 v248, 1.0, v248
    s_waitcnt vmcnt(15) lgkmcnt(0)
    s_waitcnt lgkmcnt(0)
    s_barrier
    buffer_load_dwordx4 v7, s[20:23], s60 offen  lds
    s_add_u32 s60, s65, 36992
    v_mul_f32 v249, v157, v157
    s_add_u32 m0, s55, 4096
    v_fma_f32 v249, v249, s79, v252
    v_mul_f32 v249, v249, v157
    v_mul_f32 v250, v158, v158
    v_fma_f32 v250, v250, s79, v252
    v_mul_f32 v250, v250, v158
    buffer_load_dwordx4 v7, s[20:23], s60 offen  lds
    s_add_u32 s60, s65, 73856
    v_rcp_f32 v248, v248
    v_exp_f32 v249, v249
    v_mul_f32 v156, v156, v248
    v_mul_f32 v92, v92, v156
    s_add_u32 m0, s55, 8192
    v_add_f32 v249, 1.0, v249
    v_mul_f32 v251, v159, v159
    buffer_load_dwordx4 v7, s[20:23], s60 offen  lds
    s_add_u32 s60, s65, 110720
    v_fma_f32 v251, v251, s79, v252
    s_add_u32 m0, s55, 12288
    v_mul_f32 v251, v251, v159
    v_rcp_f32 v249, v249
    v_exp_f32 v250, v250
    ds_read_b128 a[0:3], v9 offset:36864
    v_mul_f32 v157, v157, v249
    v_exp_f32 v251, v251
    v_mul_f32 v93, v93, v157
    v_cvt_pk_bf16_f32 v222, v92, v93
    v_add_f32 v250, 1.0, v250
    ds_read_b128 a[4:7], v9 offset:37888
    v_add_f32 v251, 1.0, v251
    buffer_load_dwordx4 v7, s[20:23], s60 offen  lds
    s_add_u32 s60, s65, 147584
    v_mul_f32 v248, v152, v152
    s_add_u32 m0, s55, 16384
    v_fma_f32 v248, v248, s79, v252
    ds_read_b128 a[8:11], v9 offset:38912
    v_mul_f32 v248, v248, v152
    v_mul_f32 v249, v153, v153
    buffer_load_dwordx4 v7, s[20:23], s60 offen  lds
    s_add_u32 s60, s65, 184448
    s_add_u32 m0, s55, 20480
    ds_read_b128 a[12:15], v9 offset:39936
    v_fma_f32 v249, v249, s79, v252
    v_rcp_f32 v250, v250
    v_rcp_f32 v251, v251
    v_mul_f32 v158, v158, v250
    ds_read_b128 a[16:19], v9 offset:0
    v_mul_f32 v94, v94, v158
    buffer_load_dwordx4 v7, s[20:23], s60 offen  lds
    s_add_u32 s60, s65, 221312
    v_mul_f32 v159, v159, v251
    s_add_u32 m0, s55, 24576
    v_mul_f32 v95, v95, v159
    ds_read_b128 a[20:23], v9 offset:1024
    v_cvt_pk_bf16_f32 v223, v94, v95
    v_mul_f32 v249, v249, v153
    v_mul_f32 v250, v154, v154
    v_fma_f32 v250, v250, s79, v252
    ds_read_b128 a[24:27], v9 offset:2048
    v_mul_f32 v250, v250, v154
    buffer_load_dwordx4 v7, s[20:23], s60 offen  lds
    v_cvt_pk_bf16_f32 v104, v104, v105
    v_cvt_pk_bf16_f32 v105, v106, v107
    v_mul_f32 v251, v155, v155
    ds_read_b128 a[28:31], v9 offset:3072
    v_cvt_pk_bf16_f32 v106, v108, v109
    s_add_u32 s60, s65, 258176
    v_cvt_pk_bf16_f32 v107, v110, v111
    s_add_u32 m0, s55, 28672
    v_fma_f32 v251, v251, s79, v252
    v_permlane16_swap_b32 v104, v106
    ds_read_b128 a[32:35], v9 offset:16384
    v_permlane16_swap_b32 v105, v107
    buffer_load_dwordx4 v7, s[20:23], s60 offen  lds
    s_add_u32 s60, s66, 128
    v_cvt_pk_bf16_f32 v112, v112, v113
    s_add_u32 m0, s55, 32768
    v_cvt_pk_bf16_f32 v113, v114, v115
    ds_read_b128 a[36:39], v9 offset:17408
    v_cvt_pk_bf16_f32 v114, v116, v117
    buffer_store_dwordx4 v[104:107], v14, s[48:51], s70 offen sc1
    v_cvt_pk_bf16_f32 v115, v118, v119
    v_mul_f32 v251, v251, v155
    ds_read_b128 a[40:43], v9 offset:18432
    v_permlane16_swap_b32 v112, v114
    buffer_load_dwordx4 v7, s[20:23], s60 offen  lds
    v_permlane16_swap_b32 v113, v115
    ds_read_b128 a[44:47], v9 offset:19456
    v_lshlrev_b32 v4, 4, v0
    buffer_store_dwordx4 v[112:115], v14, s[48:51], s71 offen sc1
    v_exp_f32 v248, v248
    v_exp_f32 v249, v249
    v_exp_f32 v250, v250
    v_exp_f32 v251, v251
    v_add_f32 v248, 1.0, v248
    v_add_f32 v249, 1.0, v249
    s_waitcnt vmcnt(16) lgkmcnt(0)
    s_waitcnt lgkmcnt(0)
    s_barrier
    ds_read_b64_tr_b16 v[16:17], v10 offset:0
    v_add_f32 v250, 1.0, v250
    ds_read_b64_tr_b16 v[18:19], v10 offset:2048
    v_add_f32 v251, 1.0, v251
    ds_read_b64_tr_b16 v[20:21], v10 offset:8192
    ds_read_b64_tr_b16 v[22:23], v10 offset:10240
    ds_read_b64_tr_b16 v[24:25], v10 offset:16384
    ds_read_b64_tr_b16 v[26:27], v10 offset:18432
    v_rcp_f32 v248, v248
    v_rcp_f32 v249, v249
    v_rcp_f32 v250, v250
    v_rcp_f32 v251, v251
    s_waitcnt lgkmcnt(0)
    s_nop 1
    s_branch L_Bdone
L_spinA:
    s_mov_b32 s63, 0x8000
L_spinlA:
    buffer_load_dword v70, v71, s[40:43], 0 offen sc1
    s_waitcnt vmcnt(0)
    v_cmp_le_u32 s[86:87], 64, v70
    s_sub_u32 s63, s63, 1
    s_cbranch_scc1 L_backA
    s_cmp_eq_u32 s86, 15
    s_cbranch_scc0 L_spinlA
    s_branch L_backA
L_spinB:
    s_mov_b32 s63, 0x8000
L_spinlB:
    buffer_load_dword v70, v135, s[24:27], s84 offen sc1
    s_waitcnt vmcnt(0)
    v_cmp_eq_u32 s[86:87], v67, v70
    s_sub_u32 s63, s63, 1
    s_cbranch_scc1 L_backB
    s_cmp_eq_u32 s86, 255
    s_cbranch_scc0 L_spinlB
    s_branch L_backB
L_slow:
    s_waitcnt vmcnt(0) lgkmcnt(0)
    s_and_b32 s88, s54, 1
    s_mul_i32 s89, s88, 147456
    s_sub_u32 s64, s64, s89
    s_mul_i32 s89, s88, 40960
    s_sub_u32 s67, s67, s89
    v_mov_b32 v248, 0xff800000
    v_mov_b32 v249, 0xff800000
    v_mov_b32 v16, 0
    v_mov_b32 v17, 0
    v_mov_b32 v18, 0
    v_mov_b32 v19, 0
    v_mov_b32 v20, 0
    v_mov_b32 v21, 0
    v_mov_b32 v22, 0
    v_mov_b32 v23, 0
    v_mov_b32 v24, 0
    v_mov_b32 v25, 0
    v_mov_b32 v26, 0
    v_mov_b32 v27, 0
    v_mov_b32 v28, 0
    v_mov_b32 v29, 0
    v_mov_b32 v30, 0
    v_mov_b32 v31, 0
    v_mov_b32 v232, 0
    v_mov_b32 v233, 0
    v_mov_b32 v234, 0
    v_mov_b32 v235, 0
    v_mov_b32 v236, 0
    v_mov_b32 v237, 0
    v_mov_b32 v238, 0
    v_mov_b32 v239, 0
    v_mov_b32 v240, 0
    v_mov_b32 v241, 0
    v_mov_b32 v242, 0
    v_mov_b32 v243, 0
    v_mov_b32 v244, 0
    v_mov_b32 v245, 0
    v_mov_b32 v246, 0
    v_mov_b32 v247, 0
    s_mov_b32 s61, s64
    s_mov_b32 s62, s67
    s_mov_b32 s63, 64
L_slow0:
    buffer_load_dwordx2 v[60:61], v65, s[24:27], s61 offen sc1
    buffer_load_dwordx4 a[64:67], v64, s[24:27], s61 offen sc1
    s_waitcnt vmcnt(1)
    v_mfma_f32_32x32x4_2b_bf16 v[168:199], v[60:61], v[58:59], 0 cbsz:1 abid:0
    s_waitcnt vmcnt(0)
    s_nop 15
    s_nop 0
    v_mfma_f32_32x32x16_bf16 v[168:183], a[64:67], v[48:51], v[168:183]
    v_mfma_f32_32x32x16_bf16 v[184:199], a[64:67], v[52:55], v[184:199]
    s_nop 10
    v_max3_f32 v248, v168, v169, v248
    v_max3_f32 v248, v170, v171, v248
    v_max3_f32 v248, v172, v173, v248
    v_max3_f32 v248, v174, v175, v248
    v_max3_f32 v248, v176, v177, v248
    v_max3_f32 v248, v178, v179, v248
    v_max3_f32 v248, v180, v181, v248
    v_max3_f32 v248, v182, v183, v248
    v_max3_f32 v249, v184, v185, v249
    v_max3_f32 v249, v186, v187, v249
    v_max3_f32 v249, v188, v189, v249
    v_max3_f32 v249, v190, v191, v249
    v_max3_f32 v249, v192, v193, v249
    v_max3_f32 v249, v194, v195, v249
    v_max3_f32 v249, v196, v197, v249
    v_max3_f32 v249, v198, v199, v249
    s_add_u32 s61, s61, 4608
    s_add_u32 s62, s62, 1280
    s_sub_u32 s63, s63, 1
    s_cmp_lg_u32 s63, 0
    s_cbranch_scc1 L_slow0
    v_mov_b32 v250, v248
    s_nop 1
    v_permlane32_swap_b32 v248, v250
    s_nop 1
    v_max_f32 v248, v248, v250
    v_mov_b32 v250, v249
    s_nop 1
    v_permlane32_swap_b32 v249, v250
    s_nop 1
    v_max_f32 v249, v249, v250
    s_mov_b32 s61, s64
    s_mov_b32 s62, s67
    s_mov_b32 s63, 64
L_slow1:
    buffer_load_dwordx2 v[60:61], v65, s[24:27], s61 offen sc1
    buffer_load_dwordx4 a[64:67], v64, s[24:27], s61 offen sc1
    buffer_load_dwordx4 a[80:83], v66, s[24:27], s62 offen offset:0 sc1
    buffer_load_dwordx4 a[84:87], v66, s[24:27], s62 offen offset:640 sc1
    s_waitcnt vmcnt(3)
    v_mfma_f32_32x32x4_2b_bf16 v[168:199], v[60:61], v[58:59], 0 cbsz:1 abid:0
    s_waitcnt vmcnt(2)
    s_nop 15
    s_nop 0
    v_mfma_f32_32x32x16_bf16 v[168:183], a[64:67], v[48:51], v[168:183]
    v_mfma_f32_32x32x16_bf16 v[184:199], a[64:67], v[52:55], v[184:199]
    s_nop 10
    v_sub_f32 v168, v168, v248
    v_sub_f32 v169, v169, v248
    v_sub_f32 v170, v170, v248
    v_sub_f32 v171, v171, v248
    v_sub_f32 v172, v172, v248
    v_sub_f32 v173, v173, v248
    v_sub_f32 v174, v174, v248
    v_sub_f32 v175, v175, v248
    v_sub_f32 v176, v176, v248
    v_sub_f32 v177, v177, v248
    v_sub_f32 v178, v178, v248
    v_sub_f32 v179, v179, v248
    v_sub_f32 v180, v180, v248
    v_sub_f32 v181, v181, v248
    v_sub_f32 v182, v182, v248
    v_sub_f32 v183, v183, v248
    v_exp_f32 v168, v168
    v_exp_f32 v169, v169
    v_exp_f32 v170, v170
    v_exp_f32 v171, v171
    v_exp_f32 v172, v172
    v_exp_f32 v173, v173
    v_exp_f32 v174, v174
    v_exp_f32 v175, v175
    v_exp_f32 v176, v176
    v_exp_f32 v177, v177
    v_exp_f32 v178, v178
    v_exp_f32 v179, v179
    v_exp_f32 v180, v180
    v_exp_f32 v181, v181
    v_exp_f32 v182, v182
    v_exp_f32 v183, v183
    s_waitcnt vmcnt(1)
    v_smfmac_f32_32x32x32_bf16 v[16:31], a[80:83], v[168:175], v67
    s_waitcnt vmcnt(0)
    v_smfmac_f32_32x32x32_bf16 v[16:31], a[84:87], v[176:183], v67
    v_sub_f32 v184, v184, v249
    v_sub_f32 v185, v185, v249
    v_sub_f32 v186, v186, v249
    v_sub_f32 v187, v187, v249
    v_sub_f32 v188, v188, v249
    v_sub_f32 v189, v189, v249
    v_sub_f32 v190, v190, v249
    v_sub_f32 v191, v191, v249
    v_sub_f32 v192, v192, v249
    v_sub_f32 v193, v193, v249
    v_sub_f32 v194, v194, v249
    v_sub_f32 v195, v195, v249
    v_sub_f32 v196, v196, v249
    v_sub_f32 v197, v197, v249
    v_sub_f32 v198, v198, v249
    v_sub_f32 v199, v199, v249
    v_exp_f32 v184, v184
    v_exp_f32 v185, v185
    v_exp_f32 v186, v186
    v_exp_f32 v187, v187
    v_exp_f32 v188, v188
    v_exp_f32 v189, v189
    v_exp_f32 v190, v190
    v_exp_f32 v191, v191
    v_exp_f32 v192, v192
    v_exp_f32 v193, v193
    v_exp_f32 v194, v194
    v_exp_f32 v195, v195
    v_exp_f32 v196, v196
    v_exp_f32 v197, v197
    v_exp_f32 v198, v198
    v_exp_f32 v199, v199
    v_smfmac_f32_32x32x32_bf16 v[232:247], a[80:83], v[184:191], v67
    s_nop 0
    v_smfmac_f32_32x32x32_bf16 v[232:247], a[84:87], v[192:199], v67
    s_add_u32 s61, s61, 4608
    s_add_u32 s62, s62, 1280
    s_sub_u32 s63, s63, 1
    s_cmp_lg_u32 s63, 0
    s_cbranch_scc1 L_slow1
    s_nop 15
    s_branch L_norm
L_last:
.section .rodata,"a"
.p2align 6
.amdhsa_kernel parallel_sum__mha_block__glu_gated_geglu__prompt_kernel
  .amdhsa_next_free_vgpr 512
  .amdhsa_next_free_sgpr 102
  .amdhsa_accum_offset 256
  .amdhsa_group_segment_fixed_size 0
  .amdhsa_kernarg_size 80
  .amdhsa_user_sgpr_count 2
  .amdhsa_user_sgpr_kernarg_segment_ptr 1
  .amdhsa_system_sgpr_workgroup_id_x 1
.end_amdhsa_kernel
```
